```python
import torch

def _softmax(x, axis=-1):
    return torch.softmax(x, dim=axis)

def _gelu(x):
    return torch.nn.functional.gelu(x, approximate='tanh')

def _silu(x):
    return torch.nn.functional.silu(x)

def _sigmoid(x):
    return torch.sigmoid(x)

def _layernorm(x, axis=-1, eps=1e-05):
    m = x.mean(dim=axis, keepdim=True)
    v = x.var(dim=axis, keepdim=True, unbiased=False)
    return (x - m) / torch.sqrt(v + eps)

def _scatter_add(tgt, idx, src, axis=0):
    return tgt.clone().index_add_(axis, idx, src)

def _segment_sum(src, seg, n):
    out = torch.zeros((n,) + src.shape[1:], dtype=src.dtype)
    return out.index_add_(0, seg, src)

def _pad(x, pw):
    flat = tuple((v for pair in reversed(pw) for v in pair))
    return torch.nn.functional.pad(x, flat)
kernel_name = 'sequential_preLN__memory_aug_recurrent_mem_tr__glu_gated_swiglu__prompt'

def setup_inputs():

    _w = lambda a: (lambda t: t.to(torch.bfloat16) if t.is_floating_point() else t)(torch.as_tensor(a))

    def _A_setup():
        B, S, Dm = (1, 2048, 640)
        H, Dh = (32, 128)
        M, seg = (8, 32)
        seg = min(seg, S)
        S = S // seg * seg
        return {'x': _w((lambda *s: torch.randn(*s, dtype=torch.bfloat16) * 0.05)(B, S, Dm)), 'mem0': _w((lambda *s: torch.randn(*s, dtype=torch.bfloat16) * 0.2)(B, M, Dm)), 'Wq': _w((lambda *s: torch.randn(*s, dtype=torch.bfloat16) * 1.6)(Dm, H, Dh) * Dm ** (-0.5)), 'Wk': _w((lambda *s: torch.randn(*s, dtype=torch.bfloat16) * 1.6)(Dm, H, Dh) * Dm ** (-0.5)), 'Wv': _w((lambda *s: torch.randn(*s, dtype=torch.bfloat16) * 0.2)(Dm, H, Dh) * Dm ** (-0.5)), 'Wo': _w((lambda *s: torch.randn(*s, dtype=torch.bfloat16) * 0.2)(H, Dh, Dm) * (H * Dh) ** (-0.5)), 'seg_len': seg}
    _A_in = _A_setup()

    def _B_setup():
        B, S, D, F = (1, 2048, 640, 1728)
        return {'x': _w((lambda *s: torch.randn(*s, dtype=torch.bfloat16) * 0.05)(B, S, D)), 'w1': _w((lambda *s: torch.randn(*s, dtype=torch.bfloat16) * 0.2)(D, F) * (2.0 / D) ** 0.5), 'w3': _w((lambda *s: torch.randn(*s, dtype=torch.bfloat16) * 0.2)(D, F) * (2.0 / D) ** 0.5), 'w2': _w((lambda *s: torch.randn(*s, dtype=torch.bfloat16) * 0.2)(F, D) * (2.0 / F) ** 0.5)}
    _B_in = _B_setup()
    return {'A_x': _A_in['x'], 'A_mem0': _A_in['mem0'], 'A_Wq': _A_in['Wq'], 'A_Wk': _A_in['Wk'], 'A_Wv': _A_in['Wv'], 'A_Wo': _A_in['Wo'], 'A_seg_len': _A_in['seg_len'], 'B_x': _B_in['x'], 'B_w1': _B_in['w1'], 'B_w3': _B_in['w3'], 'B_w2': _B_in['w2']}

def reference(A_x, A_mem0, A_Wq, A_Wk, A_Wv, A_Wo, A_seg_len, B_x, B_w1, B_w3, B_w2):

    def _A_ref(x, mem0, Wq, Wk, Wv, Wo, seg_len):
        B, S, Dm = x.shape
        H, Dh = (Wq.shape[1], Wq.shape[2])
        M = mem0.shape[1]
        scale = Dh ** (-0.5)
        n_seg = S // seg_len
        L = M + seg_len
        idx = torch.arange(L)
        mask = (idx[:, None] < M) | (idx[:, None] >= idx[None, :])
        mem = mem0
        outs = []
        for s in range(n_seg):
            xs = x[:, s * seg_len:(s + 1) * seg_len, :].clone()
            h = torch.concatenate([mem, xs], axis=1)
            q = torch.einsum('btd,dhe->bhte', h, Wq)
            k = torch.einsum('btd,dhe->bhte', h, Wk)
            v = torch.einsum('btd,dhe->bhte', h, Wv)
            scores = torch.einsum('bhqe,bhke->bhqk', q, k) * scale
            scores = torch.where(mask[None, None], scores, -1000000000.0)
            p = _softmax(scores, axis=-1)
            o = torch.einsum('bhqk,bhke->bhqe', p, v)
            o = torch.einsum('bhte,hed->btd', o, Wo)
            mem = o[:, :M, :].clone()
            outs.append(o[:, M:, :])
        return torch.concatenate(outs, axis=1)

    def _B_ref(x, w1, w3, w2):
        gate = torch.einsum('bsd,df->bsf', x, w1)
        up = torch.einsum('bsd,df->bsf', x, w3)
        h = _silu(gate) * up
        out = torch.einsum('bsf,fd->bsd', h, w2)
        return out
    x = A_x
    h = x + _A_ref(_layernorm(x, axis=-1), A_mem0, A_Wq, A_Wk, A_Wv, A_Wo, A_seg_len)
    h2 = h + _B_ref(_layernorm(h, axis=-1), B_w1, B_w3, B_w2)
    return h2
```

```asm
; @launch kernel=prep_kernel grid=(2313,1,1) block=(256,1,1) lds=0
; @launch kernel=chain_kernel grid=(256,1,1) block=(256,1,1) lds=122880
; @launch kernel=wo_kernel grid=(256,1,1) block=(256,1,1) lds=61440
; @launch kernel=ln_kernel grid=(128,1,1) block=(64,1,1) lds=0
; @launch kernel=ffn1_kernel grid=(216,1,1) block=(512,1,1) lds=98304
; @launch kernel=ffn2_kernel grid=(256,1,1) block=(256,1,1) lds=61440
.amdgcn_target "amdgcn-amd-amdhsa--gfx950"
.text
.globl prep_kernel
.p2align 8
.type prep_kernel,@function
prep_kernel:
  s_load_dwordx2 s[8:9], s[0:1], 104
  s_waitcnt lgkmcnt(0)
  s_and_b32 s9, s9, 0xffff
  s_mov_b32 s10, 268435456
  s_mov_b32 s11, 0x20000
  v_lshrrev_b32 v1, 6, v0
  s_nop 0
  v_readfirstlane_b32 s3, v1
  v_and_b32 v0, 63, v0
  s_mov_b32 s4, s2
  s_cmp_ge_u32 s4, 32
  s_cbranch_scc1 prep_kernel_seg1
  s_load_dwordx2 s[12:13], s[0:1], 0
  s_waitcnt lgkmcnt(0)
  s_and_b32 s13, s13, 0xffff
  s_mov_b32 s14, 2621440
  s_mov_b32 s15, 0x20000
  s_lshl_b32 s5, s4, 2
  s_add_u32 s5, s5, s3
  s_mul_i32 s6, s5, 20480
  s_mul_i32 s7, s5, 20480
  s_add_u32 s7, s7, 15728640
  v_and_b32 v1, 15, v0
  v_lshrrev_b32 v2, 4, v0
  v_mul_u32_u24 v3, 1280, v1
  v_lshl_add_u32 v3, v2, 4, v3
  v_lshlrev_b32 v4, 4, v0
  buffer_load_dwordx4 v[8:11], v3, s[12:15], s6 offen offset:0
  buffer_load_dwordx4 v[12:15], v3, s[12:15], s6 offen offset:64
  buffer_load_dwordx4 v[16:19], v3, s[12:15], s6 offen offset:128
  buffer_load_dwordx4 v[20:23], v3, s[12:15], s6 offen offset:192
  buffer_load_dwordx4 v[24:27], v3, s[12:15], s6 offen offset:256
  buffer_load_dwordx4 v[28:31], v3, s[12:15], s6 offen offset:320
  buffer_load_dwordx4 v[32:35], v3, s[12:15], s6 offen offset:384
  buffer_load_dwordx4 v[36:39], v3, s[12:15], s6 offen offset:448
  buffer_load_dwordx4 v[40:43], v3, s[12:15], s6 offen offset:512
  buffer_load_dwordx4 v[44:47], v3, s[12:15], s6 offen offset:576
  buffer_load_dwordx4 v[48:51], v3, s[12:15], s6 offen offset:640
  buffer_load_dwordx4 v[52:55], v3, s[12:15], s6 offen offset:704
  buffer_load_dwordx4 v[56:59], v3, s[12:15], s6 offen offset:768
  buffer_load_dwordx4 v[60:63], v3, s[12:15], s6 offen offset:832
  buffer_load_dwordx4 v[64:67], v3, s[12:15], s6 offen offset:896
  buffer_load_dwordx4 v[68:71], v3, s[12:15], s6 offen offset:960
  buffer_load_dwordx4 v[72:75], v3, s[12:15], s6 offen offset:1024
  buffer_load_dwordx4 v[76:79], v3, s[12:15], s6 offen offset:1088
  buffer_load_dwordx4 v[80:83], v3, s[12:15], s6 offen offset:1152
  buffer_load_dwordx4 v[84:87], v3, s[12:15], s6 offen offset:1216
  v_mov_b32 v88, 0
  v_mov_b32 v89, 0
  v_mov_b32 v92, 0
  v_mov_b32 v93, 0
  s_waitcnt vmcnt(19)
  v_lshlrev_b32 v90, 16, v8
  v_and_b32 v91, 0xffff0000, v8
  v_pk_add_f32 v[88:89], v[88:89], v[90:91]
  v_pk_fma_f32 v[92:93], v[90:91], v[90:91], v[92:93]
  v_lshlrev_b32 v94, 16, v9
  v_and_b32 v95, 0xffff0000, v9
  v_pk_add_f32 v[88:89], v[88:89], v[94:95]
  v_pk_fma_f32 v[92:93], v[94:95], v[94:95], v[92:93]
  v_lshlrev_b32 v90, 16, v10
  v_and_b32 v91, 0xffff0000, v10
  v_pk_add_f32 v[88:89], v[88:89], v[90:91]
  v_pk_fma_f32 v[92:93], v[90:91], v[90:91], v[92:93]
  v_lshlrev_b32 v94, 16, v11
  v_and_b32 v95, 0xffff0000, v11
  v_pk_add_f32 v[88:89], v[88:89], v[94:95]
  v_pk_fma_f32 v[92:93], v[94:95], v[94:95], v[92:93]
  s_waitcnt vmcnt(18)
  v_lshlrev_b32 v90, 16, v12
  v_and_b32 v91, 0xffff0000, v12
  v_pk_add_f32 v[88:89], v[88:89], v[90:91]
  v_pk_fma_f32 v[92:93], v[90:91], v[90:91], v[92:93]
  v_lshlrev_b32 v94, 16, v13
  v_and_b32 v95, 0xffff0000, v13
  v_pk_add_f32 v[88:89], v[88:89], v[94:95]
  v_pk_fma_f32 v[92:93], v[94:95], v[94:95], v[92:93]
  v_lshlrev_b32 v90, 16, v14
  v_and_b32 v91, 0xffff0000, v14
  v_pk_add_f32 v[88:89], v[88:89], v[90:91]
  v_pk_fma_f32 v[92:93], v[90:91], v[90:91], v[92:93]
  v_lshlrev_b32 v94, 16, v15
  v_and_b32 v95, 0xffff0000, v15
  v_pk_add_f32 v[88:89], v[88:89], v[94:95]
  v_pk_fma_f32 v[92:93], v[94:95], v[94:95], v[92:93]
  s_waitcnt vmcnt(17)
  v_lshlrev_b32 v90, 16, v16
  v_and_b32 v91, 0xffff0000, v16
  v_pk_add_f32 v[88:89], v[88:89], v[90:91]
  v_pk_fma_f32 v[92:93], v[90:91], v[90:91], v[92:93]
  v_lshlrev_b32 v94, 16, v17
  v_and_b32 v95, 0xffff0000, v17
  v_pk_add_f32 v[88:89], v[88:89], v[94:95]
  v_pk_fma_f32 v[92:93], v[94:95], v[94:95], v[92:93]
  v_lshlrev_b32 v90, 16, v18
  v_and_b32 v91, 0xffff0000, v18
  v_pk_add_f32 v[88:89], v[88:89], v[90:91]
  v_pk_fma_f32 v[92:93], v[90:91], v[90:91], v[92:93]
  v_lshlrev_b32 v94, 16, v19
  v_and_b32 v95, 0xffff0000, v19
  v_pk_add_f32 v[88:89], v[88:89], v[94:95]
  v_pk_fma_f32 v[92:93], v[94:95], v[94:95], v[92:93]
  s_waitcnt vmcnt(16)
  v_lshlrev_b32 v90, 16, v20
  v_and_b32 v91, 0xffff0000, v20
  v_pk_add_f32 v[88:89], v[88:89], v[90:91]
  v_pk_fma_f32 v[92:93], v[90:91], v[90:91], v[92:93]
  v_lshlrev_b32 v94, 16, v21
  v_and_b32 v95, 0xffff0000, v21
  v_pk_add_f32 v[88:89], v[88:89], v[94:95]
  v_pk_fma_f32 v[92:93], v[94:95], v[94:95], v[92:93]
  v_lshlrev_b32 v90, 16, v22
  v_and_b32 v91, 0xffff0000, v22
  v_pk_add_f32 v[88:89], v[88:89], v[90:91]
  v_pk_fma_f32 v[92:93], v[90:91], v[90:91], v[92:93]
  v_lshlrev_b32 v94, 16, v23
  v_and_b32 v95, 0xffff0000, v23
  v_pk_add_f32 v[88:89], v[88:89], v[94:95]
  v_pk_fma_f32 v[92:93], v[94:95], v[94:95], v[92:93]
  s_waitcnt vmcnt(15)
  v_lshlrev_b32 v90, 16, v24
  v_and_b32 v91, 0xffff0000, v24
  v_pk_add_f32 v[88:89], v[88:89], v[90:91]
  v_pk_fma_f32 v[92:93], v[90:91], v[90:91], v[92:93]
  v_lshlrev_b32 v94, 16, v25
  v_and_b32 v95, 0xffff0000, v25
  v_pk_add_f32 v[88:89], v[88:89], v[94:95]
  v_pk_fma_f32 v[92:93], v[94:95], v[94:95], v[92:93]
  v_lshlrev_b32 v90, 16, v26
  v_and_b32 v91, 0xffff0000, v26
  v_pk_add_f32 v[88:89], v[88:89], v[90:91]
  v_pk_fma_f32 v[92:93], v[90:91], v[90:91], v[92:93]
  v_lshlrev_b32 v94, 16, v27
  v_and_b32 v95, 0xffff0000, v27
  v_pk_add_f32 v[88:89], v[88:89], v[94:95]
  v_pk_fma_f32 v[92:93], v[94:95], v[94:95], v[92:93]
  s_waitcnt vmcnt(14)
  v_lshlrev_b32 v90, 16, v28
  v_and_b32 v91, 0xffff0000, v28
  v_pk_add_f32 v[88:89], v[88:89], v[90:91]
  v_pk_fma_f32 v[92:93], v[90:91], v[90:91], v[92:93]
  v_lshlrev_b32 v94, 16, v29
  v_and_b32 v95, 0xffff0000, v29
  v_pk_add_f32 v[88:89], v[88:89], v[94:95]
  v_pk_fma_f32 v[92:93], v[94:95], v[94:95], v[92:93]
  v_lshlrev_b32 v90, 16, v30
  v_and_b32 v91, 0xffff0000, v30
  v_pk_add_f32 v[88:89], v[88:89], v[90:91]
  v_pk_fma_f32 v[92:93], v[90:91], v[90:91], v[92:93]
  v_lshlrev_b32 v94, 16, v31
  v_and_b32 v95, 0xffff0000, v31
  v_pk_add_f32 v[88:89], v[88:89], v[94:95]
  v_pk_fma_f32 v[92:93], v[94:95], v[94:95], v[92:93]
  s_waitcnt vmcnt(13)
  v_lshlrev_b32 v90, 16, v32
  v_and_b32 v91, 0xffff0000, v32
  v_pk_add_f32 v[88:89], v[88:89], v[90:91]
  v_pk_fma_f32 v[92:93], v[90:91], v[90:91], v[92:93]
  v_lshlrev_b32 v94, 16, v33
  v_and_b32 v95, 0xffff0000, v33
  v_pk_add_f32 v[88:89], v[88:89], v[94:95]
  v_pk_fma_f32 v[92:93], v[94:95], v[94:95], v[92:93]
  v_lshlrev_b32 v90, 16, v34
  v_and_b32 v91, 0xffff0000, v34
  v_pk_add_f32 v[88:89], v[88:89], v[90:91]
  v_pk_fma_f32 v[92:93], v[90:91], v[90:91], v[92:93]
  v_lshlrev_b32 v94, 16, v35
  v_and_b32 v95, 0xffff0000, v35
  v_pk_add_f32 v[88:89], v[88:89], v[94:95]
  v_pk_fma_f32 v[92:93], v[94:95], v[94:95], v[92:93]
  s_waitcnt vmcnt(12)
  v_lshlrev_b32 v90, 16, v36
  v_and_b32 v91, 0xffff0000, v36
  v_pk_add_f32 v[88:89], v[88:89], v[90:91]
  v_pk_fma_f32 v[92:93], v[90:91], v[90:91], v[92:93]
  v_lshlrev_b32 v94, 16, v37
  v_and_b32 v95, 0xffff0000, v37
  v_pk_add_f32 v[88:89], v[88:89], v[94:95]
  v_pk_fma_f32 v[92:93], v[94:95], v[94:95], v[92:93]
  v_lshlrev_b32 v90, 16, v38
  v_and_b32 v91, 0xffff0000, v38
  v_pk_add_f32 v[88:89], v[88:89], v[90:91]
  v_pk_fma_f32 v[92:93], v[90:91], v[90:91], v[92:93]
  v_lshlrev_b32 v94, 16, v39
  v_and_b32 v95, 0xffff0000, v39
  v_pk_add_f32 v[88:89], v[88:89], v[94:95]
  v_pk_fma_f32 v[92:93], v[94:95], v[94:95], v[92:93]
  s_waitcnt vmcnt(11)
  v_lshlrev_b32 v90, 16, v40
  v_and_b32 v91, 0xffff0000, v40
  v_pk_add_f32 v[88:89], v[88:89], v[90:91]
  v_pk_fma_f32 v[92:93], v[90:91], v[90:91], v[92:93]
  v_lshlrev_b32 v94, 16, v41
  v_and_b32 v95, 0xffff0000, v41
  v_pk_add_f32 v[88:89], v[88:89], v[94:95]
  v_pk_fma_f32 v[92:93], v[94:95], v[94:95], v[92:93]
  v_lshlrev_b32 v90, 16, v42
  v_and_b32 v91, 0xffff0000, v42
  v_pk_add_f32 v[88:89], v[88:89], v[90:91]
  v_pk_fma_f32 v[92:93], v[90:91], v[90:91], v[92:93]
  v_lshlrev_b32 v94, 16, v43
  v_and_b32 v95, 0xffff0000, v43
  v_pk_add_f32 v[88:89], v[88:89], v[94:95]
  v_pk_fma_f32 v[92:93], v[94:95], v[94:95], v[92:93]
  s_waitcnt vmcnt(10)
  v_lshlrev_b32 v90, 16, v44
  v_and_b32 v91, 0xffff0000, v44
  v_pk_add_f32 v[88:89], v[88:89], v[90:91]
  v_pk_fma_f32 v[92:93], v[90:91], v[90:91], v[92:93]
  v_lshlrev_b32 v94, 16, v45
  v_and_b32 v95, 0xffff0000, v45
  v_pk_add_f32 v[88:89], v[88:89], v[94:95]
  v_pk_fma_f32 v[92:93], v[94:95], v[94:95], v[92:93]
  v_lshlrev_b32 v90, 16, v46
  v_and_b32 v91, 0xffff0000, v46
  v_pk_add_f32 v[88:89], v[88:89], v[90:91]
  v_pk_fma_f32 v[92:93], v[90:91], v[90:91], v[92:93]
  v_lshlrev_b32 v94, 16, v47
  v_and_b32 v95, 0xffff0000, v47
  v_pk_add_f32 v[88:89], v[88:89], v[94:95]
  v_pk_fma_f32 v[92:93], v[94:95], v[94:95], v[92:93]
  s_waitcnt vmcnt(9)
  v_lshlrev_b32 v90, 16, v48
  v_and_b32 v91, 0xffff0000, v48
  v_pk_add_f32 v[88:89], v[88:89], v[90:91]
  v_pk_fma_f32 v[92:93], v[90:91], v[90:91], v[92:93]
  v_lshlrev_b32 v94, 16, v49
  v_and_b32 v95, 0xffff0000, v49
  v_pk_add_f32 v[88:89], v[88:89], v[94:95]
  v_pk_fma_f32 v[92:93], v[94:95], v[94:95], v[92:93]
  v_lshlrev_b32 v90, 16, v50
  v_and_b32 v91, 0xffff0000, v50
  v_pk_add_f32 v[88:89], v[88:89], v[90:91]
  v_pk_fma_f32 v[92:93], v[90:91], v[90:91], v[92:93]
  v_lshlrev_b32 v94, 16, v51
  v_and_b32 v95, 0xffff0000, v51
  v_pk_add_f32 v[88:89], v[88:89], v[94:95]
  v_pk_fma_f32 v[92:93], v[94:95], v[94:95], v[92:93]
  s_waitcnt vmcnt(8)
  v_lshlrev_b32 v90, 16, v52
  v_and_b32 v91, 0xffff0000, v52
  v_pk_add_f32 v[88:89], v[88:89], v[90:91]
  v_pk_fma_f32 v[92:93], v[90:91], v[90:91], v[92:93]
  v_lshlrev_b32 v94, 16, v53
  v_and_b32 v95, 0xffff0000, v53
  v_pk_add_f32 v[88:89], v[88:89], v[94:95]
  v_pk_fma_f32 v[92:93], v[94:95], v[94:95], v[92:93]
  v_lshlrev_b32 v90, 16, v54
  v_and_b32 v91, 0xffff0000, v54
  v_pk_add_f32 v[88:89], v[88:89], v[90:91]
  v_pk_fma_f32 v[92:93], v[90:91], v[90:91], v[92:93]
  v_lshlrev_b32 v94, 16, v55
  v_and_b32 v95, 0xffff0000, v55
  v_pk_add_f32 v[88:89], v[88:89], v[94:95]
  v_pk_fma_f32 v[92:93], v[94:95], v[94:95], v[92:93]
  s_waitcnt vmcnt(7)
  v_lshlrev_b32 v90, 16, v56
  v_and_b32 v91, 0xffff0000, v56
  v_pk_add_f32 v[88:89], v[88:89], v[90:91]
  v_pk_fma_f32 v[92:93], v[90:91], v[90:91], v[92:93]
  v_lshlrev_b32 v94, 16, v57
  v_and_b32 v95, 0xffff0000, v57
  v_pk_add_f32 v[88:89], v[88:89], v[94:95]
  v_pk_fma_f32 v[92:93], v[94:95], v[94:95], v[92:93]
  v_lshlrev_b32 v90, 16, v58
  v_and_b32 v91, 0xffff0000, v58
  v_pk_add_f32 v[88:89], v[88:89], v[90:91]
  v_pk_fma_f32 v[92:93], v[90:91], v[90:91], v[92:93]
  v_lshlrev_b32 v94, 16, v59
  v_and_b32 v95, 0xffff0000, v59
  v_pk_add_f32 v[88:89], v[88:89], v[94:95]
  v_pk_fma_f32 v[92:93], v[94:95], v[94:95], v[92:93]
  s_waitcnt vmcnt(6)
  v_lshlrev_b32 v90, 16, v60
  v_and_b32 v91, 0xffff0000, v60
  v_pk_add_f32 v[88:89], v[88:89], v[90:91]
  v_pk_fma_f32 v[92:93], v[90:91], v[90:91], v[92:93]
  v_lshlrev_b32 v94, 16, v61
  v_and_b32 v95, 0xffff0000, v61
  v_pk_add_f32 v[88:89], v[88:89], v[94:95]
  v_pk_fma_f32 v[92:93], v[94:95], v[94:95], v[92:93]
  v_lshlrev_b32 v90, 16, v62
  v_and_b32 v91, 0xffff0000, v62
  v_pk_add_f32 v[88:89], v[88:89], v[90:91]
  v_pk_fma_f32 v[92:93], v[90:91], v[90:91], v[92:93]
  v_lshlrev_b32 v94, 16, v63
  v_and_b32 v95, 0xffff0000, v63
  v_pk_add_f32 v[88:89], v[88:89], v[94:95]
  v_pk_fma_f32 v[92:93], v[94:95], v[94:95], v[92:93]
  s_waitcnt vmcnt(5)
  v_lshlrev_b32 v90, 16, v64
  v_and_b32 v91, 0xffff0000, v64
  v_pk_add_f32 v[88:89], v[88:89], v[90:91]
  v_pk_fma_f32 v[92:93], v[90:91], v[90:91], v[92:93]
  v_lshlrev_b32 v94, 16, v65
  v_and_b32 v95, 0xffff0000, v65
  v_pk_add_f32 v[88:89], v[88:89], v[94:95]
  v_pk_fma_f32 v[92:93], v[94:95], v[94:95], v[92:93]
  v_lshlrev_b32 v90, 16, v66
  v_and_b32 v91, 0xffff0000, v66
  v_pk_add_f32 v[88:89], v[88:89], v[90:91]
  v_pk_fma_f32 v[92:93], v[90:91], v[90:91], v[92:93]
  v_lshlrev_b32 v94, 16, v67
  v_and_b32 v95, 0xffff0000, v67
  v_pk_add_f32 v[88:89], v[88:89], v[94:95]
  v_pk_fma_f32 v[92:93], v[94:95], v[94:95], v[92:93]
  s_waitcnt vmcnt(4)
  v_lshlrev_b32 v90, 16, v68
  v_and_b32 v91, 0xffff0000, v68
  v_pk_add_f32 v[88:89], v[88:89], v[90:91]
  v_pk_fma_f32 v[92:93], v[90:91], v[90:91], v[92:93]
  v_lshlrev_b32 v94, 16, v69
  v_and_b32 v95, 0xffff0000, v69
  v_pk_add_f32 v[88:89], v[88:89], v[94:95]
  v_pk_fma_f32 v[92:93], v[94:95], v[94:95], v[92:93]
  v_lshlrev_b32 v90, 16, v70
  v_and_b32 v91, 0xffff0000, v70
  v_pk_add_f32 v[88:89], v[88:89], v[90:91]
  v_pk_fma_f32 v[92:93], v[90:91], v[90:91], v[92:93]
  v_lshlrev_b32 v94, 16, v71
  v_and_b32 v95, 0xffff0000, v71
  v_pk_add_f32 v[88:89], v[88:89], v[94:95]
  v_pk_fma_f32 v[92:93], v[94:95], v[94:95], v[92:93]
  s_waitcnt vmcnt(3)
  v_lshlrev_b32 v90, 16, v72
  v_and_b32 v91, 0xffff0000, v72
  v_pk_add_f32 v[88:89], v[88:89], v[90:91]
  v_pk_fma_f32 v[92:93], v[90:91], v[90:91], v[92:93]
  v_lshlrev_b32 v94, 16, v73
  v_and_b32 v95, 0xffff0000, v73
  v_pk_add_f32 v[88:89], v[88:89], v[94:95]
  v_pk_fma_f32 v[92:93], v[94:95], v[94:95], v[92:93]
  v_lshlrev_b32 v90, 16, v74
  v_and_b32 v91, 0xffff0000, v74
  v_pk_add_f32 v[88:89], v[88:89], v[90:91]
  v_pk_fma_f32 v[92:93], v[90:91], v[90:91], v[92:93]
  v_lshlrev_b32 v94, 16, v75
  v_and_b32 v95, 0xffff0000, v75
  v_pk_add_f32 v[88:89], v[88:89], v[94:95]
  v_pk_fma_f32 v[92:93], v[94:95], v[94:95], v[92:93]
  s_waitcnt vmcnt(2)
  v_lshlrev_b32 v90, 16, v76
  v_and_b32 v91, 0xffff0000, v76
  v_pk_add_f32 v[88:89], v[88:89], v[90:91]
  v_pk_fma_f32 v[92:93], v[90:91], v[90:91], v[92:93]
  v_lshlrev_b32 v94, 16, v77
  v_and_b32 v95, 0xffff0000, v77
  v_pk_add_f32 v[88:89], v[88:89], v[94:95]
  v_pk_fma_f32 v[92:93], v[94:95], v[94:95], v[92:93]
  v_lshlrev_b32 v90, 16, v78
  v_and_b32 v91, 0xffff0000, v78
  v_pk_add_f32 v[88:89], v[88:89], v[90:91]
  v_pk_fma_f32 v[92:93], v[90:91], v[90:91], v[92:93]
  v_lshlrev_b32 v94, 16, v79
  v_and_b32 v95, 0xffff0000, v79
  v_pk_add_f32 v[88:89], v[88:89], v[94:95]
  v_pk_fma_f32 v[92:93], v[94:95], v[94:95], v[92:93]
  s_waitcnt vmcnt(1)
  v_lshlrev_b32 v90, 16, v80
  v_and_b32 v91, 0xffff0000, v80
  v_pk_add_f32 v[88:89], v[88:89], v[90:91]
  v_pk_fma_f32 v[92:93], v[90:91], v[90:91], v[92:93]
  v_lshlrev_b32 v94, 16, v81
  v_and_b32 v95, 0xffff0000, v81
  v_pk_add_f32 v[88:89], v[88:89], v[94:95]
  v_pk_fma_f32 v[92:93], v[94:95], v[94:95], v[92:93]
  v_lshlrev_b32 v90, 16, v82
  v_and_b32 v91, 0xffff0000, v82
  v_pk_add_f32 v[88:89], v[88:89], v[90:91]
  v_pk_fma_f32 v[92:93], v[90:91], v[90:91], v[92:93]
  v_lshlrev_b32 v94, 16, v83
  v_and_b32 v95, 0xffff0000, v83
  v_pk_add_f32 v[88:89], v[88:89], v[94:95]
  v_pk_fma_f32 v[92:93], v[94:95], v[94:95], v[92:93]
  s_waitcnt vmcnt(0)
  v_lshlrev_b32 v90, 16, v84
  v_and_b32 v91, 0xffff0000, v84
  v_pk_add_f32 v[88:89], v[88:89], v[90:91]
  v_pk_fma_f32 v[92:93], v[90:91], v[90:91], v[92:93]
  v_lshlrev_b32 v94, 16, v85
  v_and_b32 v95, 0xffff0000, v85
  v_pk_add_f32 v[88:89], v[88:89], v[94:95]
  v_pk_fma_f32 v[92:93], v[94:95], v[94:95], v[92:93]
  v_lshlrev_b32 v90, 16, v86
  v_and_b32 v91, 0xffff0000, v86
  v_pk_add_f32 v[88:89], v[88:89], v[90:91]
  v_pk_fma_f32 v[92:93], v[90:91], v[90:91], v[92:93]
  v_lshlrev_b32 v94, 16, v87
  v_and_b32 v95, 0xffff0000, v87
  v_pk_add_f32 v[88:89], v[88:89], v[94:95]
  v_pk_fma_f32 v[92:93], v[94:95], v[94:95], v[92:93]
  v_add_f32 v5, v88, v89
  v_add_f32 v6, v92, v93
  v_mov_b32 v90, v5
  s_nop 1
  v_permlane32_swap_b32 v90, v5
  s_nop 1
  v_add_f32 v5, v5, v90
  v_mov_b32 v90, v5
  s_nop 1
  v_permlane16_swap_b32 v90, v5
  s_nop 1
  v_add_f32 v5, v5, v90
  v_mov_b32 v90, v6
  s_nop 1
  v_permlane32_swap_b32 v90, v6
  s_nop 1
  v_add_f32 v6, v6, v90
  v_mov_b32 v90, v6
  s_nop 1
  v_permlane16_swap_b32 v90, v6
  s_nop 1
  v_add_f32 v6, v6, v90
  v_mul_f32 v5, 0x3acccccd, v5
  v_mul_f32 v6, 0x3acccccd, v6
  v_fma_f32 v6, -v5, v5, v6
  v_max_f32 v6, 0, v6
  v_add_f32 v6, 0x3727c5ac, v6
  v_rsq_f32 v7, v6
  s_nop 0
  v_mul_f32 v88, v5, v7
  v_sub_f32 v88, 0, v88
  v_mov_b32 v89, v88
  v_mov_b32 v92, v7
  v_mov_b32 v93, v7
  v_lshlrev_b32 v90, 16, v8
  v_and_b32 v91, 0xffff0000, v8
  v_pk_fma_f32 v[90:91], v[90:91], v[92:93], v[88:89]
  v_cvt_pk_bf16_f32 v8, v90, v91
  v_lshlrev_b32 v94, 16, v9
  v_and_b32 v95, 0xffff0000, v9
  v_pk_fma_f32 v[94:95], v[94:95], v[92:93], v[88:89]
  v_cvt_pk_bf16_f32 v9, v94, v95
  v_lshlrev_b32 v90, 16, v10
  v_and_b32 v91, 0xffff0000, v10
  v_pk_fma_f32 v[90:91], v[90:91], v[92:93], v[88:89]
  v_cvt_pk_bf16_f32 v10, v90, v91
  v_lshlrev_b32 v94, 16, v11
  v_and_b32 v95, 0xffff0000, v11
  v_pk_fma_f32 v[94:95], v[94:95], v[92:93], v[88:89]
  v_cvt_pk_bf16_f32 v11, v94, v95
  s_add_u32 s20, s7, 0
  buffer_store_dwordx4 v[8:11], v4, s[8:11], s20 offen
  v_lshlrev_b32 v90, 16, v12
  v_and_b32 v91, 0xffff0000, v12
  v_pk_fma_f32 v[90:91], v[90:91], v[92:93], v[88:89]
  v_cvt_pk_bf16_f32 v12, v90, v91
  v_lshlrev_b32 v94, 16, v13
  v_and_b32 v95, 0xffff0000, v13
  v_pk_fma_f32 v[94:95], v[94:95], v[92:93], v[88:89]
  v_cvt_pk_bf16_f32 v13, v94, v95
  v_lshlrev_b32 v90, 16, v14
  v_and_b32 v91, 0xffff0000, v14
  v_pk_fma_f32 v[90:91], v[90:91], v[92:93], v[88:89]
  v_cvt_pk_bf16_f32 v14, v90, v91
  v_lshlrev_b32 v94, 16, v15
  v_and_b32 v95, 0xffff0000, v15
  v_pk_fma_f32 v[94:95], v[94:95], v[92:93], v[88:89]
  v_cvt_pk_bf16_f32 v15, v94, v95
  s_add_u32 s20, s7, 1024
  buffer_store_dwordx4 v[12:15], v4, s[8:11], s20 offen
  v_lshlrev_b32 v90, 16, v16
  v_and_b32 v91, 0xffff0000, v16
  v_pk_fma_f32 v[90:91], v[90:91], v[92:93], v[88:89]
  v_cvt_pk_bf16_f32 v16, v90, v91
  v_lshlrev_b32 v94, 16, v17
  v_and_b32 v95, 0xffff0000, v17
  v_pk_fma_f32 v[94:95], v[94:95], v[92:93], v[88:89]
  v_cvt_pk_bf16_f32 v17, v94, v95
  v_lshlrev_b32 v90, 16, v18
  v_and_b32 v91, 0xffff0000, v18
  v_pk_fma_f32 v[90:91], v[90:91], v[92:93], v[88:89]
  v_cvt_pk_bf16_f32 v18, v90, v91
  v_lshlrev_b32 v94, 16, v19
  v_and_b32 v95, 0xffff0000, v19
  v_pk_fma_f32 v[94:95], v[94:95], v[92:93], v[88:89]
  v_cvt_pk_bf16_f32 v19, v94, v95
  s_add_u32 s20, s7, 2048
  buffer_store_dwordx4 v[16:19], v4, s[8:11], s20 offen
  v_lshlrev_b32 v90, 16, v20
  v_and_b32 v91, 0xffff0000, v20
  v_pk_fma_f32 v[90:91], v[90:91], v[92:93], v[88:89]
  v_cvt_pk_bf16_f32 v20, v90, v91
  v_lshlrev_b32 v94, 16, v21
  v_and_b32 v95, 0xffff0000, v21
  v_pk_fma_f32 v[94:95], v[94:95], v[92:93], v[88:89]
  v_cvt_pk_bf16_f32 v21, v94, v95
  v_lshlrev_b32 v90, 16, v22
  v_and_b32 v91, 0xffff0000, v22
  v_pk_fma_f32 v[90:91], v[90:91], v[92:93], v[88:89]
  v_cvt_pk_bf16_f32 v22, v90, v91
  v_lshlrev_b32 v94, 16, v23
  v_and_b32 v95, 0xffff0000, v23
  v_pk_fma_f32 v[94:95], v[94:95], v[92:93], v[88:89]
  v_cvt_pk_bf16_f32 v23, v94, v95
  s_add_u32 s20, s7, 3072
  buffer_store_dwordx4 v[20:23], v4, s[8:11], s20 offen
  v_lshlrev_b32 v90, 16, v24
  v_and_b32 v91, 0xffff0000, v24
  v_pk_fma_f32 v[90:91], v[90:91], v[92:93], v[88:89]
  v_cvt_pk_bf16_f32 v24, v90, v91
  v_lshlrev_b32 v94, 16, v25
  v_and_b32 v95, 0xffff0000, v25
  v_pk_fma_f32 v[94:95], v[94:95], v[92:93], v[88:89]
  v_cvt_pk_bf16_f32 v25, v94, v95
  v_lshlrev_b32 v90, 16, v26
  v_and_b32 v91, 0xffff0000, v26
  v_pk_fma_f32 v[90:91], v[90:91], v[92:93], v[88:89]
  v_cvt_pk_bf16_f32 v26, v90, v91
  v_lshlrev_b32 v94, 16, v27
  v_and_b32 v95, 0xffff0000, v27
  v_pk_fma_f32 v[94:95], v[94:95], v[92:93], v[88:89]
  v_cvt_pk_bf16_f32 v27, v94, v95
  s_add_u32 s20, s7, 4096
  buffer_store_dwordx4 v[24:27], v4, s[8:11], s20 offen
  v_lshlrev_b32 v90, 16, v28
  v_and_b32 v91, 0xffff0000, v28
  v_pk_fma_f32 v[90:91], v[90:91], v[92:93], v[88:89]
  v_cvt_pk_bf16_f32 v28, v90, v91
  v_lshlrev_b32 v94, 16, v29
  v_and_b32 v95, 0xffff0000, v29
  v_pk_fma_f32 v[94:95], v[94:95], v[92:93], v[88:89]
  v_cvt_pk_bf16_f32 v29, v94, v95
  v_lshlrev_b32 v90, 16, v30
  v_and_b32 v91, 0xffff0000, v30
  v_pk_fma_f32 v[90:91], v[90:91], v[92:93], v[88:89]
  v_cvt_pk_bf16_f32 v30, v90, v91
  v_lshlrev_b32 v94, 16, v31
  v_and_b32 v95, 0xffff0000, v31
  v_pk_fma_f32 v[94:95], v[94:95], v[92:93], v[88:89]
  v_cvt_pk_bf16_f32 v31, v94, v95
  s_add_u32 s20, s7, 5120
  buffer_store_dwordx4 v[28:31], v4, s[8:11], s20 offen
  v_lshlrev_b32 v90, 16, v32
  v_and_b32 v91, 0xffff0000, v32
  v_pk_fma_f32 v[90:91], v[90:91], v[92:93], v[88:89]
  v_cvt_pk_bf16_f32 v32, v90, v91
  v_lshlrev_b32 v94, 16, v33
  v_and_b32 v95, 0xffff0000, v33
  v_pk_fma_f32 v[94:95], v[94:95], v[92:93], v[88:89]
  v_cvt_pk_bf16_f32 v33, v94, v95
  v_lshlrev_b32 v90, 16, v34
  v_and_b32 v91, 0xffff0000, v34
  v_pk_fma_f32 v[90:91], v[90:91], v[92:93], v[88:89]
  v_cvt_pk_bf16_f32 v34, v90, v91
  v_lshlrev_b32 v94, 16, v35
  v_and_b32 v95, 0xffff0000, v35
  v_pk_fma_f32 v[94:95], v[94:95], v[92:93], v[88:89]
  v_cvt_pk_bf16_f32 v35, v94, v95
  s_add_u32 s20, s7, 6144
  buffer_store_dwordx4 v[32:35], v4, s[8:11], s20 offen
  v_lshlrev_b32 v90, 16, v36
  v_and_b32 v91, 0xffff0000, v36
  v_pk_fma_f32 v[90:91], v[90:91], v[92:93], v[88:89]
  v_cvt_pk_bf16_f32 v36, v90, v91
  v_lshlrev_b32 v94, 16, v37
  v_and_b32 v95, 0xffff0000, v37
  v_pk_fma_f32 v[94:95], v[94:95], v[92:93], v[88:89]
  v_cvt_pk_bf16_f32 v37, v94, v95
  v_lshlrev_b32 v90, 16, v38
  v_and_b32 v91, 0xffff0000, v38
  v_pk_fma_f32 v[90:91], v[90:91], v[92:93], v[88:89]
  v_cvt_pk_bf16_f32 v38, v90, v91
  v_lshlrev_b32 v94, 16, v39
  v_and_b32 v95, 0xffff0000, v39
  v_pk_fma_f32 v[94:95], v[94:95], v[92:93], v[88:89]
  v_cvt_pk_bf16_f32 v39, v94, v95
  s_add_u32 s20, s7, 7168
  buffer_store_dwordx4 v[36:39], v4, s[8:11], s20 offen
  v_lshlrev_b32 v90, 16, v40
  v_and_b32 v91, 0xffff0000, v40
  v_pk_fma_f32 v[90:91], v[90:91], v[92:93], v[88:89]
  v_cvt_pk_bf16_f32 v40, v90, v91
  v_lshlrev_b32 v94, 16, v41
  v_and_b32 v95, 0xffff0000, v41
  v_pk_fma_f32 v[94:95], v[94:95], v[92:93], v[88:89]
  v_cvt_pk_bf16_f32 v41, v94, v95
  v_lshlrev_b32 v90, 16, v42
  v_and_b32 v91, 0xffff0000, v42
  v_pk_fma_f32 v[90:91], v[90:91], v[92:93], v[88:89]
  v_cvt_pk_bf16_f32 v42, v90, v91
  v_lshlrev_b32 v94, 16, v43
  v_and_b32 v95, 0xffff0000, v43
  v_pk_fma_f32 v[94:95], v[94:95], v[92:93], v[88:89]
  v_cvt_pk_bf16_f32 v43, v94, v95
  s_add_u32 s20, s7, 8192
  buffer_store_dwordx4 v[40:43], v4, s[8:11], s20 offen
  v_lshlrev_b32 v90, 16, v44
  v_and_b32 v91, 0xffff0000, v44
  v_pk_fma_f32 v[90:91], v[90:91], v[92:93], v[88:89]
  v_cvt_pk_bf16_f32 v44, v90, v91
  v_lshlrev_b32 v94, 16, v45
  v_and_b32 v95, 0xffff0000, v45
  v_pk_fma_f32 v[94:95], v[94:95], v[92:93], v[88:89]
  v_cvt_pk_bf16_f32 v45, v94, v95
  v_lshlrev_b32 v90, 16, v46
  v_and_b32 v91, 0xffff0000, v46
  v_pk_fma_f32 v[90:91], v[90:91], v[92:93], v[88:89]
  v_cvt_pk_bf16_f32 v46, v90, v91
  v_lshlrev_b32 v94, 16, v47
  v_and_b32 v95, 0xffff0000, v47
  v_pk_fma_f32 v[94:95], v[94:95], v[92:93], v[88:89]
  v_cvt_pk_bf16_f32 v47, v94, v95
  s_add_u32 s20, s7, 9216
  buffer_store_dwordx4 v[44:47], v4, s[8:11], s20 offen
  v_lshlrev_b32 v90, 16, v48
  v_and_b32 v91, 0xffff0000, v48
  v_pk_fma_f32 v[90:91], v[90:91], v[92:93], v[88:89]
  v_cvt_pk_bf16_f32 v48, v90, v91
  v_lshlrev_b32 v94, 16, v49
  v_and_b32 v95, 0xffff0000, v49
  v_pk_fma_f32 v[94:95], v[94:95], v[92:93], v[88:89]
  v_cvt_pk_bf16_f32 v49, v94, v95
  v_lshlrev_b32 v90, 16, v50
  v_and_b32 v91, 0xffff0000, v50
  v_pk_fma_f32 v[90:91], v[90:91], v[92:93], v[88:89]
  v_cvt_pk_bf16_f32 v50, v90, v91
  v_lshlrev_b32 v94, 16, v51
  v_and_b32 v95, 0xffff0000, v51
  v_pk_fma_f32 v[94:95], v[94:95], v[92:93], v[88:89]
  v_cvt_pk_bf16_f32 v51, v94, v95
  s_add_u32 s20, s7, 10240
  buffer_store_dwordx4 v[48:51], v4, s[8:11], s20 offen
  v_lshlrev_b32 v90, 16, v52
  v_and_b32 v91, 0xffff0000, v52
  v_pk_fma_f32 v[90:91], v[90:91], v[92:93], v[88:89]
  v_cvt_pk_bf16_f32 v52, v90, v91
  v_lshlrev_b32 v94, 16, v53
  v_and_b32 v95, 0xffff0000, v53
  v_pk_fma_f32 v[94:95], v[94:95], v[92:93], v[88:89]
  v_cvt_pk_bf16_f32 v53, v94, v95
  v_lshlrev_b32 v90, 16, v54
  v_and_b32 v91, 0xffff0000, v54
  v_pk_fma_f32 v[90:91], v[90:91], v[92:93], v[88:89]
  v_cvt_pk_bf16_f32 v54, v90, v91
  v_lshlrev_b32 v94, 16, v55
  v_and_b32 v95, 0xffff0000, v55
  v_pk_fma_f32 v[94:95], v[94:95], v[92:93], v[88:89]
  v_cvt_pk_bf16_f32 v55, v94, v95
  s_add_u32 s20, s7, 11264
  buffer_store_dwordx4 v[52:55], v4, s[8:11], s20 offen
  v_lshlrev_b32 v90, 16, v56
  v_and_b32 v91, 0xffff0000, v56
  v_pk_fma_f32 v[90:91], v[90:91], v[92:93], v[88:89]
  v_cvt_pk_bf16_f32 v56, v90, v91
  v_lshlrev_b32 v94, 16, v57
  v_and_b32 v95, 0xffff0000, v57
  v_pk_fma_f32 v[94:95], v[94:95], v[92:93], v[88:89]
  v_cvt_pk_bf16_f32 v57, v94, v95
  v_lshlrev_b32 v90, 16, v58
  v_and_b32 v91, 0xffff0000, v58
  v_pk_fma_f32 v[90:91], v[90:91], v[92:93], v[88:89]
  v_cvt_pk_bf16_f32 v58, v90, v91
  v_lshlrev_b32 v94, 16, v59
  v_and_b32 v95, 0xffff0000, v59
  v_pk_fma_f32 v[94:95], v[94:95], v[92:93], v[88:89]
  v_cvt_pk_bf16_f32 v59, v94, v95
  s_add_u32 s20, s7, 12288
  buffer_store_dwordx4 v[56:59], v4, s[8:11], s20 offen
  v_lshlrev_b32 v90, 16, v60
  v_and_b32 v91, 0xffff0000, v60
  v_pk_fma_f32 v[90:91], v[90:91], v[92:93], v[88:89]
  v_cvt_pk_bf16_f32 v60, v90, v91
  v_lshlrev_b32 v94, 16, v61
  v_and_b32 v95, 0xffff0000, v61
  v_pk_fma_f32 v[94:95], v[94:95], v[92:93], v[88:89]
  v_cvt_pk_bf16_f32 v61, v94, v95
  v_lshlrev_b32 v90, 16, v62
  v_and_b32 v91, 0xffff0000, v62
  v_pk_fma_f32 v[90:91], v[90:91], v[92:93], v[88:89]
  v_cvt_pk_bf16_f32 v62, v90, v91
  v_lshlrev_b32 v94, 16, v63
  v_and_b32 v95, 0xffff0000, v63
  v_pk_fma_f32 v[94:95], v[94:95], v[92:93], v[88:89]
  v_cvt_pk_bf16_f32 v63, v94, v95
  s_add_u32 s20, s7, 13312
  buffer_store_dwordx4 v[60:63], v4, s[8:11], s20 offen
  v_lshlrev_b32 v90, 16, v64
  v_and_b32 v91, 0xffff0000, v64
  v_pk_fma_f32 v[90:91], v[90:91], v[92:93], v[88:89]
  v_cvt_pk_bf16_f32 v64, v90, v91
  v_lshlrev_b32 v94, 16, v65
  v_and_b32 v95, 0xffff0000, v65
  v_pk_fma_f32 v[94:95], v[94:95], v[92:93], v[88:89]
  v_cvt_pk_bf16_f32 v65, v94, v95
  v_lshlrev_b32 v90, 16, v66
  v_and_b32 v91, 0xffff0000, v66
  v_pk_fma_f32 v[90:91], v[90:91], v[92:93], v[88:89]
  v_cvt_pk_bf16_f32 v66, v90, v91
  v_lshlrev_b32 v94, 16, v67
  v_and_b32 v95, 0xffff0000, v67
  v_pk_fma_f32 v[94:95], v[94:95], v[92:93], v[88:89]
  v_cvt_pk_bf16_f32 v67, v94, v95
  s_add_u32 s20, s7, 14336
  buffer_store_dwordx4 v[64:67], v4, s[8:11], s20 offen
  v_lshlrev_b32 v90, 16, v68
  v_and_b32 v91, 0xffff0000, v68
  v_pk_fma_f32 v[90:91], v[90:91], v[92:93], v[88:89]
  v_cvt_pk_bf16_f32 v68, v90, v91
  v_lshlrev_b32 v94, 16, v69
  v_and_b32 v95, 0xffff0000, v69
  v_pk_fma_f32 v[94:95], v[94:95], v[92:93], v[88:89]
  v_cvt_pk_bf16_f32 v69, v94, v95
  v_lshlrev_b32 v90, 16, v70
  v_and_b32 v91, 0xffff0000, v70
  v_pk_fma_f32 v[90:91], v[90:91], v[92:93], v[88:89]
  v_cvt_pk_bf16_f32 v70, v90, v91
  v_lshlrev_b32 v94, 16, v71
  v_and_b32 v95, 0xffff0000, v71
  v_pk_fma_f32 v[94:95], v[94:95], v[92:93], v[88:89]
  v_cvt_pk_bf16_f32 v71, v94, v95
  s_add_u32 s20, s7, 15360
  buffer_store_dwordx4 v[68:71], v4, s[8:11], s20 offen
  v_lshlrev_b32 v90, 16, v72
  v_and_b32 v91, 0xffff0000, v72
  v_pk_fma_f32 v[90:91], v[90:91], v[92:93], v[88:89]
  v_cvt_pk_bf16_f32 v72, v90, v91
  v_lshlrev_b32 v94, 16, v73
  v_and_b32 v95, 0xffff0000, v73
  v_pk_fma_f32 v[94:95], v[94:95], v[92:93], v[88:89]
  v_cvt_pk_bf16_f32 v73, v94, v95
  v_lshlrev_b32 v90, 16, v74
  v_and_b32 v91, 0xffff0000, v74
  v_pk_fma_f32 v[90:91], v[90:91], v[92:93], v[88:89]
  v_cvt_pk_bf16_f32 v74, v90, v91
  v_lshlrev_b32 v94, 16, v75
  v_and_b32 v95, 0xffff0000, v75
  v_pk_fma_f32 v[94:95], v[94:95], v[92:93], v[88:89]
  v_cvt_pk_bf16_f32 v75, v94, v95
  s_add_u32 s20, s7, 16384
  buffer_store_dwordx4 v[72:75], v4, s[8:11], s20 offen
  v_lshlrev_b32 v90, 16, v76
  v_and_b32 v91, 0xffff0000, v76
  v_pk_fma_f32 v[90:91], v[90:91], v[92:93], v[88:89]
  v_cvt_pk_bf16_f32 v76, v90, v91
  v_lshlrev_b32 v94, 16, v77
  v_and_b32 v95, 0xffff0000, v77
  v_pk_fma_f32 v[94:95], v[94:95], v[92:93], v[88:89]
  v_cvt_pk_bf16_f32 v77, v94, v95
  v_lshlrev_b32 v90, 16, v78
  v_and_b32 v91, 0xffff0000, v78
  v_pk_fma_f32 v[90:91], v[90:91], v[92:93], v[88:89]
  v_cvt_pk_bf16_f32 v78, v90, v91
  v_lshlrev_b32 v94, 16, v79
  v_and_b32 v95, 0xffff0000, v79
  v_pk_fma_f32 v[94:95], v[94:95], v[92:93], v[88:89]
  v_cvt_pk_bf16_f32 v79, v94, v95
  s_add_u32 s20, s7, 17408
  buffer_store_dwordx4 v[76:79], v4, s[8:11], s20 offen
  v_lshlrev_b32 v90, 16, v80
  v_and_b32 v91, 0xffff0000, v80
  v_pk_fma_f32 v[90:91], v[90:91], v[92:93], v[88:89]
  v_cvt_pk_bf16_f32 v80, v90, v91
  v_lshlrev_b32 v94, 16, v81
  v_and_b32 v95, 0xffff0000, v81
  v_pk_fma_f32 v[94:95], v[94:95], v[92:93], v[88:89]
  v_cvt_pk_bf16_f32 v81, v94, v95
  v_lshlrev_b32 v90, 16, v82
  v_and_b32 v91, 0xffff0000, v82
  v_pk_fma_f32 v[90:91], v[90:91], v[92:93], v[88:89]
  v_cvt_pk_bf16_f32 v82, v90, v91
  v_lshlrev_b32 v94, 16, v83
  v_and_b32 v95, 0xffff0000, v83
  v_pk_fma_f32 v[94:95], v[94:95], v[92:93], v[88:89]
  v_cvt_pk_bf16_f32 v83, v94, v95
  s_add_u32 s20, s7, 18432
  buffer_store_dwordx4 v[80:83], v4, s[8:11], s20 offen
  v_lshlrev_b32 v90, 16, v84
  v_and_b32 v91, 0xffff0000, v84
  v_pk_fma_f32 v[90:91], v[90:91], v[92:93], v[88:89]
  v_cvt_pk_bf16_f32 v84, v90, v91
  v_lshlrev_b32 v94, 16, v85
  v_and_b32 v95, 0xffff0000, v85
  v_pk_fma_f32 v[94:95], v[94:95], v[92:93], v[88:89]
  v_cvt_pk_bf16_f32 v85, v94, v95
  v_lshlrev_b32 v90, 16, v86
  v_and_b32 v91, 0xffff0000, v86
  v_pk_fma_f32 v[90:91], v[90:91], v[92:93], v[88:89]
  v_cvt_pk_bf16_f32 v86, v90, v91
  v_lshlrev_b32 v94, 16, v87
  v_and_b32 v95, 0xffff0000, v87
  v_pk_fma_f32 v[94:95], v[94:95], v[92:93], v[88:89]
  v_cvt_pk_bf16_f32 v87, v94, v95
  s_add_u32 s20, s7, 19456
  buffer_store_dwordx4 v[84:87], v4, s[8:11], s20 offen
  s_endpgm
prep_kernel_seg1:
  s_sub_u32 s4, s4, 32
  s_cmp_ge_u32 s4, 320
  s_cbranch_scc1 prep_kernel_seg2
  s_load_dwordx2 s[12:13], s[0:1], 16
  s_waitcnt lgkmcnt(0)
  s_and_b32 s13, s13, 0xffff
  s_mov_b32 s14, 5242880
  s_mov_b32 s15, 0x20000
  s_lshl_b32 s5, s4, 2
  s_add_u32 s5, s5, s3
  s_lshr_b32 s7, s5, 6
  s_and_b32 s6, s5, 63
  v_and_b32 v1, 15, v0
  v_lshrrev_b32 v2, 4, v0
  s_mov_b32 s21, 65536
  v_mul_lo_u32 v3, v2, s21
  v_lshl_add_u32 v3, v1, 3, v3
  s_mul_i32 s20, s7, 262144
  s_lshl_b32 s18, s6, 7
  s_add_u32 s20, s20, s18
  buffer_load_dwordx2 v[16:17], v3, s[12:15], s20 offen
  s_add_u32 s20, s20, 8192
  buffer_load_dwordx2 v[18:19], v3, s[12:15], s20 offen
  s_add_u32 s20, s20, 8192
  buffer_load_dwordx2 v[20:21], v3, s[12:15], s20 offen
  s_add_u32 s20, s20, 8192
  buffer_load_dwordx2 v[22:23], v3, s[12:15], s20 offen
  s_add_u32 s20, s20, 8192
  buffer_load_dwordx2 v[24:25], v3, s[12:15], s20 offen
  s_add_u32 s20, s20, 8192
  buffer_load_dwordx2 v[26:27], v3, s[12:15], s20 offen
  s_add_u32 s20, s20, 8192
  buffer_load_dwordx2 v[28:29], v3, s[12:15], s20 offen
  s_add_u32 s20, s20, 8192
  buffer_load_dwordx2 v[30:31], v3, s[12:15], s20 offen
  s_add_u32 s20, s20, 8192
  v_lshrrev_b32 v4, 3, v1
  v_mul_u32_u24 v4, 2, v4
  v_and_b32 v5, 1, v1
  v_add_u32 v4, v4, v5
  v_mul_u32_u24 v4, 20480, v4
  v_lshl_add_u32 v4, v2, 8, v4
  v_bfe_u32 v5, v1, 1, 2
  v_lshl_add_u32 v4, v5, 6, v4
  s_mul_i32 s19, s6, 4
  s_add_u32 s19, s19, 0
  s_mul_i32 s19, s19, 20
  s_add_u32 s19, s19, s7
  s_lshl_b32 s19, s19, 10
  s_add_u32 s19, s19, 0
  s_mov_b32 s22, 0x05040100
  s_mov_b32 s23, 0x07060302
  s_waitcnt vmcnt(0)
  v_perm_b32 v32, v18, v16, s22
  v_perm_b32 v33, v22, v20, s22
  v_perm_b32 v34, v26, v24, s22
  v_perm_b32 v35, v30, v28, s22
  buffer_store_dwordx4 v[32:35], v4, s[8:11], s19 offen offset:0
  v_perm_b32 v36, v18, v16, s23
  v_perm_b32 v37, v22, v20, s23
  v_perm_b32 v38, v26, v24, s23
  v_perm_b32 v39, v30, v28, s23
  buffer_store_dwordx4 v[36:39], v4, s[8:11], s19 offen offset:16
  v_perm_b32 v40, v19, v17, s22
  v_perm_b32 v41, v23, v21, s22
  v_perm_b32 v42, v27, v25, s22
  v_perm_b32 v43, v31, v29, s22
  buffer_store_dwordx4 v[40:43], v4, s[8:11], s19 offen offset:32
  v_perm_b32 v44, v19, v17, s23
  v_perm_b32 v45, v23, v21, s23
  v_perm_b32 v46, v27, v25, s23
  v_perm_b32 v47, v31, v29, s23
  buffer_store_dwordx4 v[44:47], v4, s[8:11], s19 offen offset:48
  s_endpgm
prep_kernel_seg2:
  s_sub_u32 s4, s4, 320
  s_cmp_ge_u32 s4, 320
  s_cbranch_scc1 prep_kernel_seg3
  s_load_dwordx2 s[12:13], s[0:1], 24
  s_waitcnt lgkmcnt(0)
  s_and_b32 s13, s13, 0xffff
  s_mov_b32 s14, 5242880
  s_mov_b32 s15, 0x20000
  s_lshl_b32 s5, s4, 2
  s_add_u32 s5, s5, s3
  s_lshr_b32 s7, s5, 6
  s_and_b32 s6, s5, 63
  v_and_b32 v1, 15, v0
  v_lshrrev_b32 v2, 4, v0
  s_mov_b32 s21, 65536
  v_mul_lo_u32 v3, v2, s21
  v_lshl_add_u32 v3, v1, 3, v3
  s_mul_i32 s20, s7, 262144
  s_lshl_b32 s18, s6, 7
  s_add_u32 s20, s20, s18
  buffer_load_dwordx2 v[16:17], v3, s[12:15], s20 offen
  s_add_u32 s20, s20, 8192
  buffer_load_dwordx2 v[18:19], v3, s[12:15], s20 offen
  s_add_u32 s20, s20, 8192
  buffer_load_dwordx2 v[20:21], v3, s[12:15], s20 offen
  s_add_u32 s20, s20, 8192
  buffer_load_dwordx2 v[22:23], v3, s[12:15], s20 offen
  s_add_u32 s20, s20, 8192
  buffer_load_dwordx2 v[24:25], v3, s[12:15], s20 offen
  s_add_u32 s20, s20, 8192
  buffer_load_dwordx2 v[26:27], v3, s[12:15], s20 offen
  s_add_u32 s20, s20, 8192
  buffer_load_dwordx2 v[28:29], v3, s[12:15], s20 offen
  s_add_u32 s20, s20, 8192
  buffer_load_dwordx2 v[30:31], v3, s[12:15], s20 offen
  s_add_u32 s20, s20, 8192
  v_lshrrev_b32 v4, 3, v1
  v_mul_u32_u24 v4, 2, v4
  v_and_b32 v5, 1, v1
  v_add_u32 v4, v4, v5
  v_mul_u32_u24 v4, 20480, v4
  v_lshl_add_u32 v4, v2, 8, v4
  v_bfe_u32 v5, v1, 1, 2
  v_lshl_add_u32 v4, v5, 6, v4
  s_mul_i32 s19, s6, 4
  s_add_u32 s19, s19, 0
  s_mul_i32 s19, s19, 20
  s_add_u32 s19, s19, s7
  s_lshl_b32 s19, s19, 10
  s_add_u32 s19, s19, 5242880
  s_mov_b32 s22, 0x05040100
  s_mov_b32 s23, 0x07060302
  s_waitcnt vmcnt(0)
  v_perm_b32 v32, v18, v16, s22
  v_perm_b32 v33, v22, v20, s22
  v_perm_b32 v34, v26, v24, s22
  v_perm_b32 v35, v30, v28, s22
  buffer_store_dwordx4 v[32:35], v4, s[8:11], s19 offen offset:0
  v_perm_b32 v36, v18, v16, s23
  v_perm_b32 v37, v22, v20, s23
  v_perm_b32 v38, v26, v24, s23
  v_perm_b32 v39, v30, v28, s23
  buffer_store_dwordx4 v[36:39], v4, s[8:11], s19 offen offset:16
  v_perm_b32 v40, v19, v17, s22
  v_perm_b32 v41, v23, v21, s22
  v_perm_b32 v42, v27, v25, s22
  v_perm_b32 v43, v31, v29, s22
  buffer_store_dwordx4 v[40:43], v4, s[8:11], s19 offen offset:32
  v_perm_b32 v44, v19, v17, s23
  v_perm_b32 v45, v23, v21, s23
  v_perm_b32 v46, v27, v25, s23
  v_perm_b32 v47, v31, v29, s23
  buffer_store_dwordx4 v[44:47], v4, s[8:11], s19 offen offset:48
  s_endpgm
prep_kernel_seg3:
  s_sub_u32 s4, s4, 320
  s_cmp_ge_u32 s4, 320
  s_cbranch_scc1 prep_kernel_seg4
  s_load_dwordx2 s[12:13], s[0:1], 32
  s_waitcnt lgkmcnt(0)
  s_and_b32 s13, s13, 0xffff
  s_mov_b32 s14, 5242880
  s_mov_b32 s15, 0x20000
  s_lshl_b32 s5, s4, 2
  s_add_u32 s5, s5, s3
  s_lshr_b32 s7, s5, 6
  s_and_b32 s6, s5, 63
  v_and_b32 v1, 15, v0
  v_lshrrev_b32 v2, 4, v0
  s_mov_b32 s21, 65536
  v_mul_lo_u32 v3, v2, s21
  v_lshl_add_u32 v3, v1, 3, v3
  s_mul_i32 s20, s7, 262144
  s_lshl_b32 s18, s6, 7
  s_add_u32 s20, s20, s18
  buffer_load_dwordx2 v[16:17], v3, s[12:15], s20 offen
  s_add_u32 s20, s20, 8192
  buffer_load_dwordx2 v[18:19], v3, s[12:15], s20 offen
  s_add_u32 s20, s20, 8192
  buffer_load_dwordx2 v[20:21], v3, s[12:15], s20 offen
  s_add_u32 s20, s20, 8192
  buffer_load_dwordx2 v[22:23], v3, s[12:15], s20 offen
  s_add_u32 s20, s20, 8192
  buffer_load_dwordx2 v[24:25], v3, s[12:15], s20 offen
  s_add_u32 s20, s20, 8192
  buffer_load_dwordx2 v[26:27], v3, s[12:15], s20 offen
  s_add_u32 s20, s20, 8192
  buffer_load_dwordx2 v[28:29], v3, s[12:15], s20 offen
  s_add_u32 s20, s20, 8192
  buffer_load_dwordx2 v[30:31], v3, s[12:15], s20 offen
  s_add_u32 s20, s20, 8192
  v_lshrrev_b32 v4, 3, v1
  v_mul_u32_u24 v4, 2, v4
  v_and_b32 v5, 1, v1
  v_add_u32 v4, v4, v5
  v_mul_u32_u24 v4, 20480, v4
  v_lshl_add_u32 v4, v2, 8, v4
  v_bfe_u32 v5, v1, 1, 2
  v_lshl_add_u32 v4, v5, 6, v4
  s_mul_i32 s19, s6, 4
  s_add_u32 s19, s19, 0
  s_mul_i32 s19, s19, 20
  s_add_u32 s19, s19, s7
  s_lshl_b32 s19, s19, 10
  s_add_u32 s19, s19, 10485760
  s_mov_b32 s22, 0x05040100
  s_mov_b32 s23, 0x07060302
  s_waitcnt vmcnt(0)
  v_perm_b32 v32, v18, v16, s22
  v_perm_b32 v33, v22, v20, s22
  v_perm_b32 v34, v26, v24, s22
  v_perm_b32 v35, v30, v28, s22
  buffer_store_dwordx4 v[32:35], v4, s[8:11], s19 offen offset:0
  v_perm_b32 v36, v18, v16, s23
  v_perm_b32 v37, v22, v20, s23
  v_perm_b32 v38, v26, v24, s23
  v_perm_b32 v39, v30, v28, s23
  buffer_store_dwordx4 v[36:39], v4, s[8:11], s19 offen offset:16
  v_perm_b32 v40, v19, v17, s22
  v_perm_b32 v41, v23, v21, s22
  v_perm_b32 v42, v27, v25, s22
  v_perm_b32 v43, v31, v29, s22
  buffer_store_dwordx4 v[40:43], v4, s[8:11], s19 offen offset:32
  v_perm_b32 v44, v19, v17, s23
  v_perm_b32 v45, v23, v21, s23
  v_perm_b32 v46, v27, v25, s23
  v_perm_b32 v47, v31, v29, s23
  buffer_store_dwordx4 v[44:47], v4, s[8:11], s19 offen offset:48
  s_endpgm
prep_kernel_seg4:
  s_sub_u32 s4, s4, 320
  s_cmp_ge_u32 s4, 320
  s_cbranch_scc1 prep_kernel_seg5
  s_load_dwordx2 s[12:13], s[0:1], 40
  s_waitcnt lgkmcnt(0)
  s_and_b32 s13, s13, 0xffff
  s_mov_b32 s14, 5242880
  s_mov_b32 s15, 0x20000
  s_lshl_b32 s5, s4, 2
  s_add_u32 s5, s5, s3
  s_mul_i32 s7, s5, 6554
  s_lshr_b32 s7, s7, 16
  s_mul_i32 s6, s7, 10
  s_sub_u32 s6, s5, s6
  v_and_b32 v1, 15, v0
  v_lshrrev_b32 v2, 4, v0
  s_mov_b32 s21, 10240
  v_mul_lo_u32 v3, v2, s21
  v_lshl_add_u32 v3, v1, 3, v3
  s_mul_i32 s20, s7, 40960
  s_lshl_b32 s18, s6, 7
  s_add_u32 s20, s20, s18
  buffer_load_dwordx2 v[16:17], v3, s[12:15], s20 offen
  s_add_u32 s20, s20, 1280
  buffer_load_dwordx2 v[18:19], v3, s[12:15], s20 offen
  s_add_u32 s20, s20, 1280
  buffer_load_dwordx2 v[20:21], v3, s[12:15], s20 offen
  s_add_u32 s20, s20, 1280
  buffer_load_dwordx2 v[22:23], v3, s[12:15], s20 offen
  s_add_u32 s20, s20, 1280
  buffer_load_dwordx2 v[24:25], v3, s[12:15], s20 offen
  s_add_u32 s20, s20, 1280
  buffer_load_dwordx2 v[26:27], v3, s[12:15], s20 offen
  s_add_u32 s20, s20, 1280
  buffer_load_dwordx2 v[28:29], v3, s[12:15], s20 offen
  s_add_u32 s20, s20, 1280
  buffer_load_dwordx2 v[30:31], v3, s[12:15], s20 offen
  s_add_u32 s20, s20, 1280
  v_lshrrev_b32 v4, 3, v1
  v_mul_u32_u24 v4, 2, v4
  v_and_b32 v5, 1, v1
  v_add_u32 v4, v4, v5
  v_mul_u32_u24 v4, 131072, v4
  v_lshl_add_u32 v4, v2, 8, v4
  v_bfe_u32 v5, v1, 1, 2
  v_lshl_add_u32 v4, v5, 6, v4
  s_mul_i32 s19, s6, 4
  s_add_u32 s19, s19, 0
  s_mul_i32 s19, s19, 128
  s_add_u32 s19, s19, s7
  s_lshl_b32 s19, s19, 10
  s_add_u32 s19, s19, 18350080
  s_mov_b32 s22, 0x05040100
  s_mov_b32 s23, 0x07060302
  s_waitcnt vmcnt(0)
  v_perm_b32 v32, v18, v16, s22
  v_perm_b32 v33, v22, v20, s22
  v_perm_b32 v34, v26, v24, s22
  v_perm_b32 v35, v30, v28, s22
  buffer_store_dwordx4 v[32:35], v4, s[8:11], s19 offen offset:0
  v_perm_b32 v36, v18, v16, s23
  v_perm_b32 v37, v22, v20, s23
  v_perm_b32 v38, v26, v24, s23
  v_perm_b32 v39, v30, v28, s23
  buffer_store_dwordx4 v[36:39], v4, s[8:11], s19 offen offset:16
  v_perm_b32 v40, v19, v17, s22
  v_perm_b32 v41, v23, v21, s22
  v_perm_b32 v42, v27, v25, s22
  v_perm_b32 v43, v31, v29, s22
  buffer_store_dwordx4 v[40:43], v4, s[8:11], s19 offen offset:32
  v_perm_b32 v44, v19, v17, s23
  v_perm_b32 v45, v23, v21, s23
  v_perm_b32 v46, v27, v25, s23
  v_perm_b32 v47, v31, v29, s23
  buffer_store_dwordx4 v[44:47], v4, s[8:11], s19 offen offset:48
  s_endpgm
prep_kernel_seg5:
  s_sub_u32 s4, s4, 320
  s_cmp_ge_u32 s4, 135
  s_cbranch_scc1 prep_kernel_seg6
  s_load_dwordx2 s[12:13], s[0:1], 64
  s_waitcnt lgkmcnt(0)
  s_and_b32 s13, s13, 0xffff
  s_mov_b32 s14, 2211840
  s_mov_b32 s15, 0x20000
  s_lshl_b32 s5, s4, 2
  s_add_u32 s5, s5, s3
  s_mul_i32 s7, s5, 2428
  s_lshr_b32 s7, s7, 16
  s_mul_i32 s6, s7, 27
  s_sub_u32 s6, s5, s6
  v_and_b32 v1, 15, v0
  v_lshrrev_b32 v2, 4, v0
  s_mov_b32 s21, 27648
  v_mul_lo_u32 v3, v2, s21
  v_lshl_add_u32 v3, v1, 3, v3
  s_mul_i32 s20, s7, 110592
  s_lshl_b32 s18, s6, 7
  s_add_u32 s20, s20, s18
  buffer_load_dwordx2 v[16:17], v3, s[12:15], s20 offen
  s_add_u32 s20, s20, 3456
  buffer_load_dwordx2 v[18:19], v3, s[12:15], s20 offen
  s_add_u32 s20, s20, 3456
  buffer_load_dwordx2 v[20:21], v3, s[12:15], s20 offen
  s_add_u32 s20, s20, 3456
  buffer_load_dwordx2 v[22:23], v3, s[12:15], s20 offen
  s_add_u32 s20, s20, 3456
  buffer_load_dwordx2 v[24:25], v3, s[12:15], s20 offen
  s_add_u32 s20, s20, 3456
  buffer_load_dwordx2 v[26:27], v3, s[12:15], s20 offen
  s_add_u32 s20, s20, 3456
  buffer_load_dwordx2 v[28:29], v3, s[12:15], s20 offen
  s_add_u32 s20, s20, 3456
  buffer_load_dwordx2 v[30:31], v3, s[12:15], s20 offen
  s_add_u32 s20, s20, 3456
  v_lshrrev_b32 v4, 3, v1
  v_mul_u32_u24 v4, 4, v4
  v_and_b32 v5, 1, v1
  v_add_u32 v4, v4, v5
  v_mul_u32_u24 v4, 20480, v4
  v_lshl_add_u32 v4, v2, 8, v4
  v_bfe_u32 v5, v1, 1, 2
  v_lshl_add_u32 v4, v5, 6, v4
  s_mul_i32 s19, s6, 8
  s_add_u32 s19, s19, 0
  s_mul_i32 s19, s19, 20
  s_add_u32 s19, s19, s7
  s_lshl_b32 s19, s19, 10
  s_add_u32 s19, s19, 23592960
  s_mov_b32 s22, 0x05040100
  s_mov_b32 s23, 0x07060302
  s_waitcnt vmcnt(0)
  v_perm_b32 v32, v18, v16, s22
  v_perm_b32 v33, v22, v20, s22
  v_perm_b32 v34, v26, v24, s22
  v_perm_b32 v35, v30, v28, s22
  buffer_store_dwordx4 v[32:35], v4, s[8:11], s19 offen offset:0
  v_perm_b32 v36, v18, v16, s23
  v_perm_b32 v37, v22, v20, s23
  v_perm_b32 v38, v26, v24, s23
  v_perm_b32 v39, v30, v28, s23
  buffer_store_dwordx4 v[36:39], v4, s[8:11], s19 offen offset:16
  v_perm_b32 v40, v19, v17, s22
  v_perm_b32 v41, v23, v21, s22
  v_perm_b32 v42, v27, v25, s22
  v_perm_b32 v43, v31, v29, s22
  buffer_store_dwordx4 v[40:43], v4, s[8:11], s19 offen offset:32
  v_perm_b32 v44, v19, v17, s23
  v_perm_b32 v45, v23, v21, s23
  v_perm_b32 v46, v27, v25, s23
  v_perm_b32 v47, v31, v29, s23
  buffer_store_dwordx4 v[44:47], v4, s[8:11], s19 offen offset:48
  s_endpgm
prep_kernel_seg6:
  s_sub_u32 s4, s4, 135
  s_cmp_ge_u32 s4, 135
  s_cbranch_scc1 prep_kernel_seg7
  s_load_dwordx2 s[12:13], s[0:1], 72
  s_waitcnt lgkmcnt(0)
  s_and_b32 s13, s13, 0xffff
  s_mov_b32 s14, 2211840
  s_mov_b32 s15, 0x20000
  s_lshl_b32 s5, s4, 2
  s_add_u32 s5, s5, s3
  s_mul_i32 s7, s5, 2428
  s_lshr_b32 s7, s7, 16
  s_mul_i32 s6, s7, 27
  s_sub_u32 s6, s5, s6
  v_and_b32 v1, 15, v0
  v_lshrrev_b32 v2, 4, v0
  s_mov_b32 s21, 27648
  v_mul_lo_u32 v3, v2, s21
  v_lshl_add_u32 v3, v1, 3, v3
  s_mul_i32 s20, s7, 110592
  s_lshl_b32 s18, s6, 7
  s_add_u32 s20, s20, s18
  buffer_load_dwordx2 v[16:17], v3, s[12:15], s20 offen
  s_add_u32 s20, s20, 3456
  buffer_load_dwordx2 v[18:19], v3, s[12:15], s20 offen
  s_add_u32 s20, s20, 3456
  buffer_load_dwordx2 v[20:21], v3, s[12:15], s20 offen
  s_add_u32 s20, s20, 3456
  buffer_load_dwordx2 v[22:23], v3, s[12:15], s20 offen
  s_add_u32 s20, s20, 3456
  buffer_load_dwordx2 v[24:25], v3, s[12:15], s20 offen
  s_add_u32 s20, s20, 3456
  buffer_load_dwordx2 v[26:27], v3, s[12:15], s20 offen
  s_add_u32 s20, s20, 3456
  buffer_load_dwordx2 v[28:29], v3, s[12:15], s20 offen
  s_add_u32 s20, s20, 3456
  buffer_load_dwordx2 v[30:31], v3, s[12:15], s20 offen
  s_add_u32 s20, s20, 3456
  v_lshrrev_b32 v4, 3, v1
  v_mul_u32_u24 v4, 4, v4
  v_and_b32 v5, 1, v1
  v_add_u32 v4, v4, v5
  v_mul_u32_u24 v4, 20480, v4
  v_lshl_add_u32 v4, v2, 8, v4
  v_bfe_u32 v5, v1, 1, 2
  v_lshl_add_u32 v4, v5, 6, v4
  s_mul_i32 s19, s6, 8
  s_add_u32 s19, s19, 2
  s_mul_i32 s19, s19, 20
  s_add_u32 s19, s19, s7
  s_lshl_b32 s19, s19, 10
  s_add_u32 s19, s19, 23592960
  s_mov_b32 s22, 0x05040100
  s_mov_b32 s23, 0x07060302
  s_waitcnt vmcnt(0)
  v_perm_b32 v32, v18, v16, s22
  v_perm_b32 v33, v22, v20, s22
  v_perm_b32 v34, v26, v24, s22
  v_perm_b32 v35, v30, v28, s22
  buffer_store_dwordx4 v[32:35], v4, s[8:11], s19 offen offset:0
  v_perm_b32 v36, v18, v16, s23
  v_perm_b32 v37, v22, v20, s23
  v_perm_b32 v38, v26, v24, s23
  v_perm_b32 v39, v30, v28, s23
  buffer_store_dwordx4 v[36:39], v4, s[8:11], s19 offen offset:16
  v_perm_b32 v40, v19, v17, s22
  v_perm_b32 v41, v23, v21, s22
  v_perm_b32 v42, v27, v25, s22
  v_perm_b32 v43, v31, v29, s22
  buffer_store_dwordx4 v[40:43], v4, s[8:11], s19 offen offset:32
  v_perm_b32 v44, v19, v17, s23
  v_perm_b32 v45, v23, v21, s23
  v_perm_b32 v46, v27, v25, s23
  v_perm_b32 v47, v31, v29, s23
  buffer_store_dwordx4 v[44:47], v4, s[8:11], s19 offen offset:48
  s_endpgm
prep_kernel_seg7:
  s_sub_u32 s4, s4, 135
  s_cmp_ge_u32 s4, 135
  s_cbranch_scc1 prep_kernel_seg8
  s_load_dwordx2 s[12:13], s[0:1], 80
  s_waitcnt lgkmcnt(0)
  s_and_b32 s13, s13, 0xffff
  s_mov_b32 s14, 2211840
  s_mov_b32 s15, 0x20000
  s_lshl_b32 s5, s4, 2
  s_add_u32 s5, s5, s3
  s_mul_i32 s7, s5, 6554
  s_lshr_b32 s7, s7, 16
  s_mul_i32 s6, s7, 10
  s_sub_u32 s6, s5, s6
  v_and_b32 v1, 15, v0
  v_lshrrev_b32 v2, 4, v0
  s_mov_b32 s21, 10240
  v_mul_lo_u32 v3, v2, s21
  v_lshl_add_u32 v3, v1, 3, v3
  s_mul_i32 s20, s7, 40960
  s_lshl_b32 s18, s6, 7
  s_add_u32 s20, s20, s18
  buffer_load_dwordx2 v[16:17], v3, s[12:15], s20 offen
  s_add_u32 s20, s20, 1280
  buffer_load_dwordx2 v[18:19], v3, s[12:15], s20 offen
  s_add_u32 s20, s20, 1280
  buffer_load_dwordx2 v[20:21], v3, s[12:15], s20 offen
  s_add_u32 s20, s20, 1280
  buffer_load_dwordx2 v[22:23], v3, s[12:15], s20 offen
  s_add_u32 s20, s20, 1280
  buffer_load_dwordx2 v[24:25], v3, s[12:15], s20 offen
  s_add_u32 s20, s20, 1280
  buffer_load_dwordx2 v[26:27], v3, s[12:15], s20 offen
  s_add_u32 s20, s20, 1280
  buffer_load_dwordx2 v[28:29], v3, s[12:15], s20 offen
  s_add_u32 s20, s20, 1280
  buffer_load_dwordx2 v[30:31], v3, s[12:15], s20 offen
  s_add_u32 s20, s20, 1280
  v_lshrrev_b32 v4, 3, v1
  v_mul_u32_u24 v4, 2, v4
  v_and_b32 v5, 1, v1
  v_add_u32 v4, v4, v5
  v_mul_u32_u24 v4, 55296, v4
  v_lshl_add_u32 v4, v2, 8, v4
  v_bfe_u32 v5, v1, 1, 2
  v_lshl_add_u32 v4, v5, 6, v4
  s_mul_i32 s19, s6, 4
  s_add_u32 s19, s19, 0
  s_mul_i32 s19, s19, 54
  s_add_u32 s19, s19, s7
  s_lshl_b32 s19, s19, 10
  s_add_u32 s19, s19, 28016640
  s_mov_b32 s22, 0x05040100
  s_mov_b32 s23, 0x07060302
  s_waitcnt vmcnt(0)
  v_perm_b32 v32, v18, v16, s22
  v_perm_b32 v33, v22, v20, s22
  v_perm_b32 v34, v26, v24, s22
  v_perm_b32 v35, v30, v28, s22
  buffer_store_dwordx4 v[32:35], v4, s[8:11], s19 offen offset:0
  v_perm_b32 v36, v18, v16, s23
  v_perm_b32 v37, v22, v20, s23
  v_perm_b32 v38, v26, v24, s23
  v_perm_b32 v39, v30, v28, s23
  buffer_store_dwordx4 v[36:39], v4, s[8:11], s19 offen offset:16
  v_perm_b32 v40, v19, v17, s22
  v_perm_b32 v41, v23, v21, s22
  v_perm_b32 v42, v27, v25, s22
  v_perm_b32 v43, v31, v29, s22
  buffer_store_dwordx4 v[40:43], v4, s[8:11], s19 offen offset:32
  v_perm_b32 v44, v19, v17, s23
  v_perm_b32 v45, v23, v21, s23
  v_perm_b32 v46, v27, v25, s23
  v_perm_b32 v47, v31, v29, s23
  buffer_store_dwordx4 v[44:47], v4, s[8:11], s19 offen offset:48
  s_endpgm
prep_kernel_seg8:
  s_sub_u32 s4, s4, 135
  s_cmp_ge_u32 s4, 1
  s_cbranch_scc1 prep_kernel_seg9
  s_load_dwordx2 s[12:13], s[0:1], 8
  s_waitcnt lgkmcnt(0)
  s_and_b32 s13, s13, 0xffff
  s_mov_b32 s14, 10240
  s_mov_b32 s15, 0x20000
  v_and_b32 v1, 7, v0
  v_lshrrev_b32 v2, 3, v0
  v_mul_u32_u24 v3, 1280, v1
  v_lshl_add_u32 v3, v2, 4, v3
  v_lshlrev_b32 v4, 4, v0
  buffer_load_dwordx4 v[8:11], v3, s[12:15], 0 offen offset:0
  buffer_load_dwordx4 v[12:15], v3, s[12:15], 0 offen offset:128
  buffer_load_dwordx4 v[16:19], v3, s[12:15], 0 offen offset:256
  buffer_load_dwordx4 v[20:23], v3, s[12:15], 0 offen offset:384
  buffer_load_dwordx4 v[24:27], v3, s[12:15], 0 offen offset:512
  buffer_load_dwordx4 v[28:31], v3, s[12:15], 0 offen offset:640
  buffer_load_dwordx4 v[32:35], v3, s[12:15], 0 offen offset:768
  buffer_load_dwordx4 v[36:39], v3, s[12:15], 0 offen offset:896
  buffer_load_dwordx4 v[40:43], v3, s[12:15], 0 offen offset:1024
  buffer_load_dwordx4 v[44:47], v3, s[12:15], 0 offen offset:1152
  s_mul_i32 s5, s3, 20480
  s_add_u32 s5, s5, 83886080
  s_waitcnt vmcnt(0)
  buffer_store_dwordx4 v[8:11], v4, s[8:11], s5 offen
  s_add_u32 s5, s5, 1024
  buffer_store_dwordx4 v[12:15], v4, s[8:11], s5 offen
  s_add_u32 s5, s5, 1024
  buffer_store_dwordx4 v[16:19], v4, s[8:11], s5 offen
  s_add_u32 s5, s5, 1024
  buffer_store_dwordx4 v[20:23], v4, s[8:11], s5 offen
  s_add_u32 s5, s5, 1024
  buffer_store_dwordx4 v[24:27], v4, s[8:11], s5 offen
  s_add_u32 s5, s5, 1024
  buffer_store_dwordx4 v[28:31], v4, s[8:11], s5 offen
  s_add_u32 s5, s5, 1024
  buffer_store_dwordx4 v[32:35], v4, s[8:11], s5 offen
  s_add_u32 s5, s5, 1024
  buffer_store_dwordx4 v[36:39], v4, s[8:11], s5 offen
  s_add_u32 s5, s5, 1024
  buffer_store_dwordx4 v[40:43], v4, s[8:11], s5 offen
  s_add_u32 s5, s5, 1024
  buffer_store_dwordx4 v[44:47], v4, s[8:11], s5 offen
  s_add_u32 s5, s5, 1024
  buffer_store_dwordx4 v[8:11], v4, s[8:11], s5 offen
  s_add_u32 s5, s5, 1024
  buffer_store_dwordx4 v[12:15], v4, s[8:11], s5 offen
  s_add_u32 s5, s5, 1024
  buffer_store_dwordx4 v[16:19], v4, s[8:11], s5 offen
  s_add_u32 s5, s5, 1024
  buffer_store_dwordx4 v[20:23], v4, s[8:11], s5 offen
  s_add_u32 s5, s5, 1024
  buffer_store_dwordx4 v[24:27], v4, s[8:11], s5 offen
  s_add_u32 s5, s5, 1024
  buffer_store_dwordx4 v[28:31], v4, s[8:11], s5 offen
  s_add_u32 s5, s5, 1024
  buffer_store_dwordx4 v[32:35], v4, s[8:11], s5 offen
  s_add_u32 s5, s5, 1024
  buffer_store_dwordx4 v[36:39], v4, s[8:11], s5 offen
  s_add_u32 s5, s5, 1024
  buffer_store_dwordx4 v[40:43], v4, s[8:11], s5 offen
  s_add_u32 s5, s5, 1024
  buffer_store_dwordx4 v[44:47], v4, s[8:11], s5 offen
  s_add_u32 s5, s5, 1024
  s_endpgm
prep_kernel_seg9:
  s_sub_u32 s4, s4, 1
  s_cmp_ge_u32 s4, 35
  s_cbranch_scc1 prep_kernel_seg10
  s_lshl_b32 s5, s4, 14
  s_lshl_b32 s6, s3, 10
  s_add_u32 s5, s5, s6
  s_add_u32 s5, s5, 83968000
  v_lshlrev_b32 v4, 4, v0
  v_mov_b32 v8, -1
  v_mov_b32 v9, -1
  v_mov_b32 v10, -1
  v_mov_b32 v11, -1
  buffer_store_dwordx4 v[8:11], v4, s[8:11], s5 offen
  s_add_u32 s5, s5, 4096
  buffer_store_dwordx4 v[8:11], v4, s[8:11], s5 offen
  s_add_u32 s5, s5, 4096
  buffer_store_dwordx4 v[8:11], v4, s[8:11], s5 offen
  s_add_u32 s5, s5, 4096
  buffer_store_dwordx4 v[8:11], v4, s[8:11], s5 offen
  s_add_u32 s5, s5, 4096
  s_endpgm
prep_kernel_seg10:
  s_sub_u32 s4, s4, 35
  s_cmp_ge_u32 s4, 96
  s_cbranch_scc1 prep_kernel_seg11
  s_lshl_b32 s5, s4, 14
  s_lshl_b32 s6, s3, 10
  s_add_u32 s5, s5, s6
  s_add_u32 s5, s5, 89210880
  v_lshlrev_b32 v4, 4, v0
  v_mov_b32 v8, -1
  v_mov_b32 v9, -1
  v_mov_b32 v10, -1
  v_mov_b32 v11, -1
  buffer_store_dwordx4 v[8:11], v4, s[8:11], s5 offen
  s_add_u32 s5, s5, 4096
  buffer_store_dwordx4 v[8:11], v4, s[8:11], s5 offen
  s_add_u32 s5, s5, 4096
  buffer_store_dwordx4 v[8:11], v4, s[8:11], s5 offen
  s_add_u32 s5, s5, 4096
  buffer_store_dwordx4 v[8:11], v4, s[8:11], s5 offen
  s_add_u32 s5, s5, 4096
  s_endpgm
prep_kernel_seg11:
  s_sub_u32 s4, s4, 96
  s_cmp_ge_u32 s4, 80
  s_cbranch_scc1 prep_kernel_seg12
  s_lshl_b32 s5, s4, 14
  s_lshl_b32 s6, s3, 10
  s_add_u32 s5, s5, s6
  s_add_u32 s5, s5, 101793792
  v_lshlrev_b32 v4, 4, v0
  v_mov_b32 v8, -1
  v_mov_b32 v9, -1
  v_mov_b32 v10, -1
  v_mov_b32 v11, -1
  buffer_store_dwordx4 v[8:11], v4, s[8:11], s5 offen
  s_add_u32 s5, s5, 4096
  buffer_store_dwordx4 v[8:11], v4, s[8:11], s5 offen
  s_add_u32 s5, s5, 4096
  buffer_store_dwordx4 v[8:11], v4, s[8:11], s5 offen
  s_add_u32 s5, s5, 4096
  buffer_store_dwordx4 v[8:11], v4, s[8:11], s5 offen
  s_add_u32 s5, s5, 4096
  s_endpgm
prep_kernel_seg12:
  s_sub_u32 s4, s4, 80
  s_cmp_ge_u32 s4, 256
  s_cbranch_scc1 prep_kernel_seg13
  s_lshl_b32 s5, s4, 14
  s_lshl_b32 s6, s3, 10
  s_add_u32 s5, s5, s6
  s_add_u32 s5, s5, 33554432
  v_lshlrev_b32 v4, 4, v0
  v_mov_b32 v8, -1
  v_mov_b32 v9, -1
  v_mov_b32 v10, -1
  v_mov_b32 v11, -1
  buffer_store_dwordx4 v[8:11], v4, s[8:11], s5 offen
  s_add_u32 s5, s5, 4096
  buffer_store_dwordx4 v[8:11], v4, s[8:11], s5 offen
  s_add_u32 s5, s5, 4096
  buffer_store_dwordx4 v[8:11], v4, s[8:11], s5 offen
  s_add_u32 s5, s5, 4096
  buffer_store_dwordx4 v[8:11], v4, s[8:11], s5 offen
  s_add_u32 s5, s5, 4096
  s_endpgm
prep_kernel_seg13:
  s_sub_u32 s4, s4, 256
  s_cmp_ge_u32 s4, 128
  s_cbranch_scc1 prep_kernel_seg14
  s_lshl_b32 s5, s4, 14
  s_lshl_b32 s6, s3, 10
  s_add_u32 s5, s5, s6
  s_add_u32 s5, s5, 67108864
  v_lshlrev_b32 v4, 4, v0
  v_mov_b32 v8, -1
  v_mov_b32 v9, -1
  v_mov_b32 v10, -1
  v_mov_b32 v11, -1
  buffer_store_dwordx4 v[8:11], v4, s[8:11], s5 offen
  s_add_u32 s5, s5, 4096
  buffer_store_dwordx4 v[8:11], v4, s[8:11], s5 offen
  s_add_u32 s5, s5, 4096
  buffer_store_dwordx4 v[8:11], v4, s[8:11], s5 offen
  s_add_u32 s5, s5, 4096
  buffer_store_dwordx4 v[8:11], v4, s[8:11], s5 offen
  s_add_u32 s5, s5, 4096
  s_endpgm
prep_kernel_seg14:
  s_sub_u32 s4, s4, 128
prep_done:
  s_endpgm
.section .rodata,"a"
.p2align 6
.amdhsa_kernel prep_kernel
  .amdhsa_next_free_vgpr 96
  .amdhsa_next_free_sgpr 40
  .amdhsa_accum_offset 96
  .amdhsa_group_segment_fixed_size 0
  .amdhsa_kernarg_size 112
  .amdhsa_user_sgpr_count 2
  .amdhsa_user_sgpr_kernarg_segment_ptr 1
  .amdhsa_system_sgpr_workgroup_id_x 1
.end_amdhsa_kernel

.text
.globl chain_kernel
.p2align 8
.type chain_kernel,@function
chain_kernel:
  s_cmp_ge_u32 s2, 256
  s_cbranch_scc1 chain_done
  s_load_dwordx2 s[8:9], s[0:1], 104
  s_waitcnt lgkmcnt(0)
  s_and_b32 s9, s9, 0xffff
  s_mov_b32 s10, 268435456
  s_mov_b32 s11, 0x20000
  v_lshrrev_b32 v1, 6, v0
  s_nop 0
  v_readfirstlane_b32 s3, v1
  v_and_b32 v0, 63, v0
  v_lshlrev_b32 v2, 4, v0
  s_load_dwordx2 s[64:65], s[0:1], 96
  s_waitcnt lgkmcnt(0)
  s_and_b32 s65, s65, 0xffff
  s_mov_b32 s66, 256
  s_mov_b32 s67, 0x20000
  s_getreg_b32 s40, hwreg(HW_REG_XCC_ID)
  s_and_b32 s40, s40, 7
  s_cmp_eq_u32 s3, 0
  s_cbranch_scc0 ch_reg_wait
  v_mov_b32 v4, 1
  s_lshl_b32 s12, s40, 2
  v_mov_b32 v5, s12
  s_mov_b64 exec, 1
  buffer_atomic_add v4, v5, s[64:67], 0 offen sc0 sc1
  s_waitcnt vmcnt(0)
  v_mov_b32 v6, 1
  v_mov_b32 v7, 32
  buffer_atomic_add v6, v7, s[64:67], 0 offen sc0 sc1
  s_waitcnt vmcnt(0)
  s_mov_b64 exec, -1
  s_mov_b32 s61, 65536
  v_lshlrev_b32 v8, 2, v0
ch_reg_poll:
  buffer_load_dword v9, v8, s[64:67], 0 offen sc1
  s_waitcnt vmcnt(0)
  v_readlane_b32 s12, v9, 8
  s_sub_u32 s61, s61, 1
  s_cmp_eq_u32 s61, 0
  s_cbranch_scc1 ch_reg_got
  s_cmp_lt_u32 s12, 256
  s_cbranch_scc1 ch_reg_poll
ch_reg_got:
  v_cmp_ne_u32 vcc, 32, v9
  s_nop 1
  s_and_b32 s12, vcc_lo, 0xff
  v_readfirstlane_b32 s13, v4
  v_readfirstlane_b32 s14, v6
  s_cmp_eq_u32 s12, 0
  s_cselect_b32 s15, 1, 0
  v_mov_b32 v11, s13
  v_mov_b32 v12, s14
  v_mov_b32 v10, s15
  v_mov_b32 v8, 16384
  ds_write_b96 v8, v[10:12]
  s_waitcnt lgkmcnt(0)
ch_reg_wait:
  s_barrier
  v_mov_b32 v8, 16384
  ds_read_b96 v[12:14], v8
  s_waitcnt lgkmcnt(0)
  v_readfirstlane_b32 s15, v12
  v_readfirstlane_b32 s41, v13
  v_readfirstlane_b32 s14, v14
  s_cmp_eq_u32 s15, 1
  s_cbranch_scc0 ch_slow
  v_and_b32 v8, 15, v0
  v_lshrrev_b32 v9, 4, v0
  v_lshlrev_b32 v9, 2, v9
  v_mov_b32 v10, 0xff800000
  v_add_u32 v11, 0, v9
  v_cmp_gt_u32 vcc, v11, v8
  s_nop 1
  v_cndmask_b32 v36, 0, v10, vcc
  v_add_u32 v11, 1, v9
  v_cmp_gt_u32 vcc, v11, v8
  s_nop 1
  v_cndmask_b32 v37, 0, v10, vcc
  v_add_u32 v11, 2, v9
  v_cmp_gt_u32 vcc, v11, v8
  s_nop 1
  v_cndmask_b32 v38, 0, v10, vcc
  v_add_u32 v11, 3, v9
  v_cmp_gt_u32 vcc, v11, v8
  s_nop 1
  v_cndmask_b32 v39, 0, v10, vcc
  v_cmp_le_u32 vcc, 32, v0
  s_nop 1
  v_cndmask_b32 v3, 0, v10, vcc
  v_and_b32 v12, 7, v0
  v_lshrrev_b32 v13, 4, v0
  v_lshlrev_b32 v12, 4, v12
  v_lshl_add_u32 v12, v13, 7, v12
  v_and_b32 v14, 15, v0
  v_and_b32 v15, 1, v13
  v_lshlrev_b32 v14, 4, v14
  v_lshl_add_u32 v14, v15, 8, v14
  v_lshrrev_b32 v18, 5, v0
  v_bfe_u32 v19, v0, 3, 2
  v_and_b32 v20, 7, v0
  v_lshlrev_b32 v16, 10, v18
  v_lshl_add_u32 v16, v19, 8, v16
  v_lshl_add_u32 v16, v20, 4, v16
  v_lshlrev_b32 v17, 7, v19
  v_lshl_add_u32 v17, v20, 4, v17
  v_lshl_add_u32 v17, v18, 3, v17
  v_mov_b32 v21, -2
  v_mov_b32 v56, -1
  v_mov_b32 v57, -1
  v_mov_b32 v58, -1
  v_mov_b32 v59, -1
  v_and_b32 v18, 8, v0
  v_cmp_eq_u32 s[50:51], 0, v18
  s_mov_b32 s52, -1
  s_mov_b32 s53, 0
  s_lshr_b32 s42, s41, 3
  s_and_b32 s43, s41, 7
  s_lshl_b32 s44, s40, 2
  s_add_u32 s45, s44, s42
  s_cmp_eq_u32 s3, 3
  s_cbranch_scc1 ch_f_nowa
  s_lshl_b32 s12, s3, 8
  s_lshl_b32 s13, s45, 3
  s_add_u32 s12, s12, s13
  s_add_u32 s12, s12, s43
  s_mul_i32 s12, s12, 20480
  s_add_u32 s12, s12, 0
  buffer_load_dwordx4 a[0:3], v2, s[8:11], s12 offen offset:0
  buffer_load_dwordx4 a[4:7], v2, s[8:11], s12 offen offset:1024
  buffer_load_dwordx4 a[8:11], v2, s[8:11], s12 offen offset:2048
  buffer_load_dwordx4 a[12:15], v2, s[8:11], s12 offen offset:3072
  s_add_u32 s12, s12, 4096
  buffer_load_dwordx4 a[16:19], v2, s[8:11], s12 offen offset:0
  buffer_load_dwordx4 a[20:23], v2, s[8:11], s12 offen offset:1024
  buffer_load_dwordx4 a[24:27], v2, s[8:11], s12 offen offset:2048
  buffer_load_dwordx4 a[28:31], v2, s[8:11], s12 offen offset:3072
  s_add_u32 s12, s12, 4096
  buffer_load_dwordx4 a[32:35], v2, s[8:11], s12 offen offset:0
  buffer_load_dwordx4 a[36:39], v2, s[8:11], s12 offen offset:1024
  buffer_load_dwordx4 a[40:43], v2, s[8:11], s12 offen offset:2048
  buffer_load_dwordx4 a[44:47], v2, s[8:11], s12 offen offset:3072
  s_add_u32 s12, s12, 4096
  buffer_load_dwordx4 a[48:51], v2, s[8:11], s12 offen offset:0
  buffer_load_dwordx4 a[52:55], v2, s[8:11], s12 offen offset:1024
  buffer_load_dwordx4 a[56:59], v2, s[8:11], s12 offen offset:2048
  buffer_load_dwordx4 a[60:63], v2, s[8:11], s12 offen offset:3072
  s_add_u32 s12, s12, 4096
  buffer_load_dwordx4 a[64:67], v2, s[8:11], s12 offen offset:0
  buffer_load_dwordx4 a[68:71], v2, s[8:11], s12 offen offset:1024
  buffer_load_dwordx4 a[72:75], v2, s[8:11], s12 offen offset:2048
  buffer_load_dwordx4 a[76:79], v2, s[8:11], s12 offen offset:3072
ch_f_nowa:
  s_add_u32 s46, s44, s3
  s_cmp_ge_u32 s41, 20
  s_cbranch_scc1 ch_f_nowo
  s_lshl_b32 s12, s41, 1
  s_add_u32 s12, s12, 0
  s_lshl_b32 s12, s12, 7
  s_lshl_b32 s13, s46, 2
  s_add_u32 s12, s12, s13
  s_lshl_b32 s12, s12, 10
  s_add_u32 s12, s12, 18350080
  buffer_load_dwordx4 a[80:83], v2, s[8:11], s12 offen offset:0
  buffer_load_dwordx4 a[84:87], v2, s[8:11], s12 offen offset:1024
  buffer_load_dwordx4 a[88:91], v2, s[8:11], s12 offen offset:2048
  buffer_load_dwordx4 a[92:95], v2, s[8:11], s12 offen offset:3072
  s_lshl_b32 s12, s41, 1
  s_add_u32 s12, s12, 1
  s_lshl_b32 s12, s12, 7
  s_lshl_b32 s13, s46, 2
  s_add_u32 s12, s12, s13
  s_lshl_b32 s12, s12, 10
  s_add_u32 s12, s12, 18350080
  buffer_load_dwordx4 a[96:99], v2, s[8:11], s12 offen offset:0
  buffer_load_dwordx4 a[100:103], v2, s[8:11], s12 offen offset:1024
  buffer_load_dwordx4 a[104:107], v2, s[8:11], s12 offen offset:2048
  buffer_load_dwordx4 a[108:111], v2, s[8:11], s12 offen offset:3072
  s_lshl_b32 s54, s46, 12
  s_add_u32 s54, s54, 33685504
  s_lshl_b32 s55, s46, 13
  s_add_u32 s55, s55, 67108864
ch_f_nowo:
  s_mov_b32 s20, 15728640
  s_mul_i32 s21, s3, 14336
  s_mov_b32 s24, 0
  s_mov_b32 s25, 0
  s_lshl_b32 s12, s45, 2
  s_lshr_b32 s13, s43, 1
  s_add_u32 s12, s12, s13
  s_lshl_b32 s13, s3, 7
  s_add_u32 s12, s12, s13
  s_lshl_b32 s12, s12, 10
  s_add_u32 s22, s12, 33554432
  s_lshl_b32 s12, s45, 3
  s_add_u32 s12, s12, s43
  s_lshl_b32 s12, s12, 10
  s_add_u32 s23, s12, 67108864
  s_and_b32 s12, s43, 1
  s_lshl_b32 s12, s12, 3
  v_add_u32 v42, s12, v2
  s_cmp_eq_u32 s3, 3
  s_cbranch_scc1 ch_f_p1
  s_and_b32 s26, s25, 1
  s_mul_i32 s26, s26, 40960
  s_add_u32 s26, s26, 40960
  s_add_u32 s12, s21, 0
  s_min_u32 s12, s12, 39936
  s_add_u32 m0, s12, s26
  s_add_u32 s12, s12, s20
  buffer_load_dwordx4 v2, s[8:11], s12 offen lds
  s_add_u32 s12, s21, 1024
  s_min_u32 s12, s12, 39936
  s_add_u32 m0, s12, s26
  s_add_u32 s12, s12, s20
  buffer_load_dwordx4 v2, s[8:11], s12 offen lds
  s_add_u32 s12, s21, 2048
  s_min_u32 s12, s12, 39936
  s_add_u32 m0, s12, s26
  s_add_u32 s12, s12, s20
  buffer_load_dwordx4 v2, s[8:11], s12 offen lds
  s_add_u32 s12, s21, 3072
  s_min_u32 s12, s12, 39936
  s_add_u32 m0, s12, s26
  s_add_u32 s12, s12, s20
  buffer_load_dwordx4 v2, s[8:11], s12 offen lds
  s_add_u32 s12, s21, 4096
  s_min_u32 s12, s12, 39936
  s_add_u32 m0, s12, s26
  s_add_u32 s12, s12, s20
  buffer_load_dwordx4 v2, s[8:11], s12 offen lds
  s_add_u32 s12, s21, 5120
  s_min_u32 s12, s12, 39936
  s_add_u32 m0, s12, s26
  s_add_u32 s12, s12, s20
  buffer_load_dwordx4 v2, s[8:11], s12 offen lds
  s_add_u32 s12, s21, 6144
  s_min_u32 s12, s12, 39936
  s_add_u32 m0, s12, s26
  s_add_u32 s12, s12, s20
  buffer_load_dwordx4 v2, s[8:11], s12 offen lds
  s_add_u32 s12, s21, 7168
  s_min_u32 s12, s12, 39936
  s_add_u32 m0, s12, s26
  s_add_u32 s12, s12, s20
  buffer_load_dwordx4 v2, s[8:11], s12 offen lds
  s_add_u32 s12, s21, 8192
  s_min_u32 s12, s12, 39936
  s_add_u32 m0, s12, s26
  s_add_u32 s12, s12, s20
  buffer_load_dwordx4 v2, s[8:11], s12 offen lds
  s_add_u32 s12, s21, 9216
  s_min_u32 s12, s12, 39936
  s_add_u32 m0, s12, s26
  s_add_u32 s12, s12, s20
  buffer_load_dwordx4 v2, s[8:11], s12 offen lds
  s_add_u32 s12, s21, 10240
  s_min_u32 s12, s12, 39936
  s_add_u32 m0, s12, s26
  s_add_u32 s12, s12, s20
  buffer_load_dwordx4 v2, s[8:11], s12 offen lds
  s_add_u32 s12, s21, 11264
  s_min_u32 s12, s12, 39936
  s_add_u32 m0, s12, s26
  s_add_u32 s12, s12, s20
  buffer_load_dwordx4 v2, s[8:11], s12 offen lds
  s_add_u32 s12, s21, 12288
  s_min_u32 s12, s12, 39936
  s_add_u32 m0, s12, s26
  s_add_u32 s12, s12, s20
  buffer_load_dwordx4 v2, s[8:11], s12 offen lds
  s_add_u32 s12, s21, 13312
  s_min_u32 s12, s12, 39936
  s_add_u32 m0, s12, s26
  s_add_u32 s12, s12, s20
  buffer_load_dwordx4 v2, s[8:11], s12 offen lds
  s_add_u32 s20, s20, 40960
  s_add_u32 s25, s25, 1
  s_and_b32 s26, s25, 1
  s_mul_i32 s26, s26, 40960
  s_add_u32 s26, s26, 40960
  s_add_u32 s12, s21, 0
  s_min_u32 s12, s12, 39936
  s_add_u32 m0, s12, s26
  s_add_u32 s12, s12, s20
  buffer_load_dwordx4 v2, s[8:11], s12 offen lds
  s_add_u32 s12, s21, 1024
  s_min_u32 s12, s12, 39936
  s_add_u32 m0, s12, s26
  s_add_u32 s12, s12, s20
  buffer_load_dwordx4 v2, s[8:11], s12 offen lds
  s_add_u32 s12, s21, 2048
  s_min_u32 s12, s12, 39936
  s_add_u32 m0, s12, s26
  s_add_u32 s12, s12, s20
  buffer_load_dwordx4 v2, s[8:11], s12 offen lds
  s_add_u32 s12, s21, 3072
  s_min_u32 s12, s12, 39936
  s_add_u32 m0, s12, s26
  s_add_u32 s12, s12, s20
  buffer_load_dwordx4 v2, s[8:11], s12 offen lds
  s_add_u32 s12, s21, 4096
  s_min_u32 s12, s12, 39936
  s_add_u32 m0, s12, s26
  s_add_u32 s12, s12, s20
  buffer_load_dwordx4 v2, s[8:11], s12 offen lds
  s_add_u32 s12, s21, 5120
  s_min_u32 s12, s12, 39936
  s_add_u32 m0, s12, s26
  s_add_u32 s12, s12, s20
  buffer_load_dwordx4 v2, s[8:11], s12 offen lds
  s_add_u32 s12, s21, 6144
  s_min_u32 s12, s12, 39936
  s_add_u32 m0, s12, s26
  s_add_u32 s12, s12, s20
  buffer_load_dwordx4 v2, s[8:11], s12 offen lds
  s_add_u32 s12, s21, 7168
  s_min_u32 s12, s12, 39936
  s_add_u32 m0, s12, s26
  s_add_u32 s12, s12, s20
  buffer_load_dwordx4 v2, s[8:11], s12 offen lds
  s_add_u32 s12, s21, 8192
  s_min_u32 s12, s12, 39936
  s_add_u32 m0, s12, s26
  s_add_u32 s12, s12, s20
  buffer_load_dwordx4 v2, s[8:11], s12 offen lds
  s_add_u32 s12, s21, 9216
  s_min_u32 s12, s12, 39936
  s_add_u32 m0, s12, s26
  s_add_u32 s12, s12, s20
  buffer_load_dwordx4 v2, s[8:11], s12 offen lds
  s_add_u32 s12, s21, 10240
  s_min_u32 s12, s12, 39936
  s_add_u32 m0, s12, s26
  s_add_u32 s12, s12, s20
  buffer_load_dwordx4 v2, s[8:11], s12 offen lds
  s_add_u32 s12, s21, 11264
  s_min_u32 s12, s12, 39936
  s_add_u32 m0, s12, s26
  s_add_u32 s12, s12, s20
  buffer_load_dwordx4 v2, s[8:11], s12 offen lds
  s_add_u32 s12, s21, 12288
  s_min_u32 s12, s12, 39936
  s_add_u32 m0, s12, s26
  s_add_u32 s12, s12, s20
  buffer_load_dwordx4 v2, s[8:11], s12 offen lds
  s_add_u32 s12, s21, 13312
  s_min_u32 s12, s12, 39936
  s_add_u32 m0, s12, s26
  s_add_u32 s12, s12, s20
  buffer_load_dwordx4 v2, s[8:11], s12 offen lds
  s_add_u32 s20, s20, 40960
  s_add_u32 s25, s25, 1
ch_f_p1:
  s_waitcnt vmcnt(0)
  s_barrier
  s_cmp_eq_u32 s3, 3
  s_cbranch_scc1 ch_f_p2
  s_and_b32 s12, s24, 1
  s_mul_i32 s12, s12, 40960
  s_add_u32 s12, s12, 40960
  v_add_u32 v40, s12, v2
  ds_read_b128 v[96:99], v40 offset:0
  ds_read_b128 v[100:103], v40 offset:20480
  ds_read_b128 v[104:107], v40 offset:1024
  ds_read_b128 v[108:111], v40 offset:21504
  ds_read_b128 v[112:115], v40 offset:2048
  ds_read_b128 v[116:119], v40 offset:22528
  ds_read_b128 v[120:123], v40 offset:3072
  ds_read_b128 v[124:127], v40 offset:23552
  ds_read_b128 v[128:131], v40 offset:4096
  ds_read_b128 v[132:135], v40 offset:24576
  ds_read_b128 v[136:139], v40 offset:5120
  ds_read_b128 v[140:143], v40 offset:25600
  s_cmp_eq_u32 s3, 2
  s_cbranch_scc1 ch_f_tvp0
  s_waitcnt lgkmcnt(11)
  v_mfma_f32_16x16x32_bf16 v[144:147], a[0:3], v[96:99], 0
  ds_read_b128 v[96:99], v40 offset:6144
  s_waitcnt lgkmcnt(11)
  v_mfma_f32_16x16x32_bf16 v[148:151], a[0:3], v[100:103], 0
  ds_read_b128 v[100:103], v40 offset:26624
  s_waitcnt lgkmcnt(11)
  v_mfma_f32_16x16x32_bf16 v[144:147], a[4:7], v[104:107], v[144:147]
  ds_read_b128 v[104:107], v40 offset:7168
  s_waitcnt lgkmcnt(11)
  v_mfma_f32_16x16x32_bf16 v[148:151], a[4:7], v[108:111], v[148:151]
  ds_read_b128 v[108:111], v40 offset:27648
  s_waitcnt lgkmcnt(11)
  v_mfma_f32_16x16x32_bf16 v[144:147], a[8:11], v[112:115], v[144:147]
  ds_read_b128 v[112:115], v40 offset:8192
  s_waitcnt lgkmcnt(11)
  v_mfma_f32_16x16x32_bf16 v[148:151], a[8:11], v[116:119], v[148:151]
  ds_read_b128 v[116:119], v40 offset:28672
  s_waitcnt lgkmcnt(11)
  v_mfma_f32_16x16x32_bf16 v[144:147], a[12:15], v[120:123], v[144:147]
  ds_read_b128 v[120:123], v40 offset:9216
  s_waitcnt lgkmcnt(11)
  v_mfma_f32_16x16x32_bf16 v[148:151], a[12:15], v[124:127], v[148:151]
  ds_read_b128 v[124:127], v40 offset:29696
  s_waitcnt lgkmcnt(11)
  v_mfma_f32_16x16x32_bf16 v[144:147], a[16:19], v[128:131], v[144:147]
  ds_read_b128 v[128:131], v40 offset:10240
  s_waitcnt lgkmcnt(11)
  v_mfma_f32_16x16x32_bf16 v[148:151], a[16:19], v[132:135], v[148:151]
  ds_read_b128 v[132:135], v40 offset:30720
  s_waitcnt lgkmcnt(11)
  v_mfma_f32_16x16x32_bf16 v[144:147], a[20:23], v[136:139], v[144:147]
  ds_read_b128 v[136:139], v40 offset:11264
  s_waitcnt lgkmcnt(11)
  v_mfma_f32_16x16x32_bf16 v[148:151], a[20:23], v[140:143], v[148:151]
  ds_read_b128 v[140:143], v40 offset:31744
  s_waitcnt lgkmcnt(11)
  v_mfma_f32_16x16x32_bf16 v[144:147], a[24:27], v[96:99], v[144:147]
  ds_read_b128 v[96:99], v40 offset:12288
  s_waitcnt lgkmcnt(11)
  v_mfma_f32_16x16x32_bf16 v[148:151], a[24:27], v[100:103], v[148:151]
  ds_read_b128 v[100:103], v40 offset:32768
  s_waitcnt lgkmcnt(11)
  v_mfma_f32_16x16x32_bf16 v[144:147], a[28:31], v[104:107], v[144:147]
  ds_read_b128 v[104:107], v40 offset:13312
  s_waitcnt lgkmcnt(11)
  v_mfma_f32_16x16x32_bf16 v[148:151], a[28:31], v[108:111], v[148:151]
  ds_read_b128 v[108:111], v40 offset:33792
  s_waitcnt lgkmcnt(11)
  v_mfma_f32_16x16x32_bf16 v[144:147], a[32:35], v[112:115], v[144:147]
  ds_read_b128 v[112:115], v40 offset:14336
  s_waitcnt lgkmcnt(11)
  v_mfma_f32_16x16x32_bf16 v[148:151], a[32:35], v[116:119], v[148:151]
  ds_read_b128 v[116:119], v40 offset:34816
  s_waitcnt lgkmcnt(11)
  v_mfma_f32_16x16x32_bf16 v[144:147], a[36:39], v[120:123], v[144:147]
  ds_read_b128 v[120:123], v40 offset:15360
  s_waitcnt lgkmcnt(11)
  v_mfma_f32_16x16x32_bf16 v[148:151], a[36:39], v[124:127], v[148:151]
  ds_read_b128 v[124:127], v40 offset:35840
  s_waitcnt lgkmcnt(11)
  v_mfma_f32_16x16x32_bf16 v[144:147], a[40:43], v[128:131], v[144:147]
  ds_read_b128 v[128:131], v40 offset:16384
  s_waitcnt lgkmcnt(11)
  v_mfma_f32_16x16x32_bf16 v[148:151], a[40:43], v[132:135], v[148:151]
  ds_read_b128 v[132:135], v40 offset:36864
  s_waitcnt lgkmcnt(11)
  v_mfma_f32_16x16x32_bf16 v[144:147], a[44:47], v[136:139], v[144:147]
  ds_read_b128 v[136:139], v40 offset:17408
  s_waitcnt lgkmcnt(11)
  v_mfma_f32_16x16x32_bf16 v[148:151], a[44:47], v[140:143], v[148:151]
  ds_read_b128 v[140:143], v40 offset:37888
  s_waitcnt lgkmcnt(11)
  v_mfma_f32_16x16x32_bf16 v[144:147], a[48:51], v[96:99], v[144:147]
  ds_read_b128 v[96:99], v40 offset:18432
  s_waitcnt lgkmcnt(11)
  v_mfma_f32_16x16x32_bf16 v[148:151], a[48:51], v[100:103], v[148:151]
  ds_read_b128 v[100:103], v40 offset:38912
  s_waitcnt lgkmcnt(11)
  v_mfma_f32_16x16x32_bf16 v[144:147], a[52:55], v[104:107], v[144:147]
  ds_read_b128 v[104:107], v40 offset:19456
  s_waitcnt lgkmcnt(11)
  v_mfma_f32_16x16x32_bf16 v[148:151], a[52:55], v[108:111], v[148:151]
  ds_read_b128 v[108:111], v40 offset:39936
  s_waitcnt lgkmcnt(11)
  v_mfma_f32_16x16x32_bf16 v[144:147], a[56:59], v[112:115], v[144:147]
  s_waitcnt lgkmcnt(10)
  v_mfma_f32_16x16x32_bf16 v[148:151], a[56:59], v[116:119], v[148:151]
  s_waitcnt lgkmcnt(9)
  v_mfma_f32_16x16x32_bf16 v[144:147], a[60:63], v[120:123], v[144:147]
  s_waitcnt lgkmcnt(8)
  v_mfma_f32_16x16x32_bf16 v[148:151], a[60:63], v[124:127], v[148:151]
  s_waitcnt lgkmcnt(7)
  v_mfma_f32_16x16x32_bf16 v[144:147], a[64:67], v[128:131], v[144:147]
  s_waitcnt lgkmcnt(6)
  v_mfma_f32_16x16x32_bf16 v[148:151], a[64:67], v[132:135], v[148:151]
  s_waitcnt lgkmcnt(5)
  v_mfma_f32_16x16x32_bf16 v[144:147], a[68:71], v[136:139], v[144:147]
  s_waitcnt lgkmcnt(4)
  v_mfma_f32_16x16x32_bf16 v[148:151], a[68:71], v[140:143], v[148:151]
  s_waitcnt lgkmcnt(3)
  v_mfma_f32_16x16x32_bf16 v[144:147], a[72:75], v[96:99], v[144:147]
  s_waitcnt lgkmcnt(2)
  v_mfma_f32_16x16x32_bf16 v[148:151], a[72:75], v[100:103], v[148:151]
  s_waitcnt lgkmcnt(1)
  v_mfma_f32_16x16x32_bf16 v[144:147], a[76:79], v[104:107], v[144:147]
  s_waitcnt lgkmcnt(0)
  v_mfma_f32_16x16x32_bf16 v[148:151], a[76:79], v[108:111], v[148:151]
  s_nop 7
  s_nop 7
  v_cvt_pk_bf16_f32 v152, v144, v145
  v_cvt_pk_bf16_f32 v153, v146, v147
  v_cvt_pk_bf16_f32 v154, v148, v149
  v_cvt_pk_bf16_f32 v155, v150, v151
  buffer_store_dwordx2 v[152:153], v42, s[8:11], s22 offen
  s_add_u32 s12, s22, 262144
  buffer_store_dwordx2 v[154:155], v42, s[8:11], s12 offen
  s_branch ch_f_tep0
ch_f_tvp0:
  s_waitcnt lgkmcnt(11)
  v_mfma_f32_16x16x32_bf16 v[144:147], v[96:99], a[0:3], 0
  ds_read_b128 v[96:99], v40 offset:6144
  s_waitcnt lgkmcnt(11)
  v_mfma_f32_16x16x32_bf16 v[148:151], v[100:103], a[0:3], 0
  ds_read_b128 v[100:103], v40 offset:26624
  s_waitcnt lgkmcnt(11)
  v_mfma_f32_16x16x32_bf16 v[144:147], v[104:107], a[4:7], v[144:147]
  ds_read_b128 v[104:107], v40 offset:7168
  s_waitcnt lgkmcnt(11)
  v_mfma_f32_16x16x32_bf16 v[148:151], v[108:111], a[4:7], v[148:151]
  ds_read_b128 v[108:111], v40 offset:27648
  s_waitcnt lgkmcnt(11)
  v_mfma_f32_16x16x32_bf16 v[144:147], v[112:115], a[8:11], v[144:147]
  ds_read_b128 v[112:115], v40 offset:8192
  s_waitcnt lgkmcnt(11)
  v_mfma_f32_16x16x32_bf16 v[148:151], v[116:119], a[8:11], v[148:151]
  ds_read_b128 v[116:119], v40 offset:28672
  s_waitcnt lgkmcnt(11)
  v_mfma_f32_16x16x32_bf16 v[144:147], v[120:123], a[12:15], v[144:147]
  ds_read_b128 v[120:123], v40 offset:9216
  s_waitcnt lgkmcnt(11)
  v_mfma_f32_16x16x32_bf16 v[148:151], v[124:127], a[12:15], v[148:151]
  ds_read_b128 v[124:127], v40 offset:29696
  s_waitcnt lgkmcnt(11)
  v_mfma_f32_16x16x32_bf16 v[144:147], v[128:131], a[16:19], v[144:147]
  ds_read_b128 v[128:131], v40 offset:10240
  s_waitcnt lgkmcnt(11)
  v_mfma_f32_16x16x32_bf16 v[148:151], v[132:135], a[16:19], v[148:151]
  ds_read_b128 v[132:135], v40 offset:30720
  s_waitcnt lgkmcnt(11)
  v_mfma_f32_16x16x32_bf16 v[144:147], v[136:139], a[20:23], v[144:147]
  ds_read_b128 v[136:139], v40 offset:11264
  s_waitcnt lgkmcnt(11)
  v_mfma_f32_16x16x32_bf16 v[148:151], v[140:143], a[20:23], v[148:151]
  ds_read_b128 v[140:143], v40 offset:31744
  s_waitcnt lgkmcnt(11)
  v_mfma_f32_16x16x32_bf16 v[144:147], v[96:99], a[24:27], v[144:147]
  ds_read_b128 v[96:99], v40 offset:12288
  s_waitcnt lgkmcnt(11)
  v_mfma_f32_16x16x32_bf16 v[148:151], v[100:103], a[24:27], v[148:151]
  ds_read_b128 v[100:103], v40 offset:32768
  s_waitcnt lgkmcnt(11)
  v_mfma_f32_16x16x32_bf16 v[144:147], v[104:107], a[28:31], v[144:147]
  ds_read_b128 v[104:107], v40 offset:13312
  s_waitcnt lgkmcnt(11)
  v_mfma_f32_16x16x32_bf16 v[148:151], v[108:111], a[28:31], v[148:151]
  ds_read_b128 v[108:111], v40 offset:33792
  s_waitcnt lgkmcnt(11)
  v_mfma_f32_16x16x32_bf16 v[144:147], v[112:115], a[32:35], v[144:147]
  ds_read_b128 v[112:115], v40 offset:14336
  s_waitcnt lgkmcnt(11)
  v_mfma_f32_16x16x32_bf16 v[148:151], v[116:119], a[32:35], v[148:151]
  ds_read_b128 v[116:119], v40 offset:34816
  s_waitcnt lgkmcnt(11)
  v_mfma_f32_16x16x32_bf16 v[144:147], v[120:123], a[36:39], v[144:147]
  ds_read_b128 v[120:123], v40 offset:15360
  s_waitcnt lgkmcnt(11)
  v_mfma_f32_16x16x32_bf16 v[148:151], v[124:127], a[36:39], v[148:151]
  ds_read_b128 v[124:127], v40 offset:35840
  s_waitcnt lgkmcnt(11)
  v_mfma_f32_16x16x32_bf16 v[144:147], v[128:131], a[40:43], v[144:147]
  ds_read_b128 v[128:131], v40 offset:16384
  s_waitcnt lgkmcnt(11)
  v_mfma_f32_16x16x32_bf16 v[148:151], v[132:135], a[40:43], v[148:151]
  ds_read_b128 v[132:135], v40 offset:36864
  s_waitcnt lgkmcnt(11)
  v_mfma_f32_16x16x32_bf16 v[144:147], v[136:139], a[44:47], v[144:147]
  ds_read_b128 v[136:139], v40 offset:17408
  s_waitcnt lgkmcnt(11)
  v_mfma_f32_16x16x32_bf16 v[148:151], v[140:143], a[44:47], v[148:151]
  ds_read_b128 v[140:143], v40 offset:37888
  s_waitcnt lgkmcnt(11)
  v_mfma_f32_16x16x32_bf16 v[144:147], v[96:99], a[48:51], v[144:147]
  ds_read_b128 v[96:99], v40 offset:18432
  s_waitcnt lgkmcnt(11)
  v_mfma_f32_16x16x32_bf16 v[148:151], v[100:103], a[48:51], v[148:151]
  ds_read_b128 v[100:103], v40 offset:38912
  s_waitcnt lgkmcnt(11)
  v_mfma_f32_16x16x32_bf16 v[144:147], v[104:107], a[52:55], v[144:147]
  ds_read_b128 v[104:107], v40 offset:19456
  s_waitcnt lgkmcnt(11)
  v_mfma_f32_16x16x32_bf16 v[148:151], v[108:111], a[52:55], v[148:151]
  ds_read_b128 v[108:111], v40 offset:39936
  s_waitcnt lgkmcnt(11)
  v_mfma_f32_16x16x32_bf16 v[144:147], v[112:115], a[56:59], v[144:147]
  s_waitcnt lgkmcnt(10)
  v_mfma_f32_16x16x32_bf16 v[148:151], v[116:119], a[56:59], v[148:151]
  s_waitcnt lgkmcnt(9)
  v_mfma_f32_16x16x32_bf16 v[144:147], v[120:123], a[60:63], v[144:147]
  s_waitcnt lgkmcnt(8)
  v_mfma_f32_16x16x32_bf16 v[148:151], v[124:127], a[60:63], v[148:151]
  s_waitcnt lgkmcnt(7)
  v_mfma_f32_16x16x32_bf16 v[144:147], v[128:131], a[64:67], v[144:147]
  s_waitcnt lgkmcnt(6)
  v_mfma_f32_16x16x32_bf16 v[148:151], v[132:135], a[64:67], v[148:151]
  s_waitcnt lgkmcnt(5)
  v_mfma_f32_16x16x32_bf16 v[144:147], v[136:139], a[68:71], v[144:147]
  s_waitcnt lgkmcnt(4)
  v_mfma_f32_16x16x32_bf16 v[148:151], v[140:143], a[68:71], v[148:151]
  s_waitcnt lgkmcnt(3)
  v_mfma_f32_16x16x32_bf16 v[144:147], v[96:99], a[72:75], v[144:147]
  s_waitcnt lgkmcnt(2)
  v_mfma_f32_16x16x32_bf16 v[148:151], v[100:103], a[72:75], v[148:151]
  s_waitcnt lgkmcnt(1)
  v_mfma_f32_16x16x32_bf16 v[144:147], v[104:107], a[76:79], v[144:147]
  s_waitcnt lgkmcnt(0)
  v_mfma_f32_16x16x32_bf16 v[148:151], v[108:111], a[76:79], v[148:151]
  s_nop 7
  s_nop 7
  v_cvt_pk_bf16_f32 v152, v144, v145
  v_cvt_pk_bf16_f32 v153, v146, v147
  v_cvt_pk_bf16_f32 v154, v148, v149
  v_cvt_pk_bf16_f32 v155, v150, v151
  buffer_store_dwordx4 v[152:155], v2, s[8:11], s23 offen
ch_f_tep0:
  s_add_u32 s22, s22, 524288
  s_add_u32 s23, s23, 262144
  s_add_u32 s24, s24, 1
  s_bitset0_b32 s22, 22
  s_bitset0_b32 s23, 21
  s_and_b32 s12, s24, 1
  s_mul_i32 s12, s12, 40960
  s_add_u32 s12, s12, 40960
  v_add_u32 v40, s12, v2
  ds_read_b128 v[96:99], v40 offset:0
  ds_read_b128 v[100:103], v40 offset:20480
  ds_read_b128 v[104:107], v40 offset:1024
  ds_read_b128 v[108:111], v40 offset:21504
  ds_read_b128 v[112:115], v40 offset:2048
  ds_read_b128 v[116:119], v40 offset:22528
  ds_read_b128 v[120:123], v40 offset:3072
  ds_read_b128 v[124:127], v40 offset:23552
  ds_read_b128 v[128:131], v40 offset:4096
  ds_read_b128 v[132:135], v40 offset:24576
  ds_read_b128 v[136:139], v40 offset:5120
  ds_read_b128 v[140:143], v40 offset:25600
  s_cmp_eq_u32 s3, 2
  s_cbranch_scc1 ch_f_tvp1
  s_waitcnt lgkmcnt(11)
  v_mfma_f32_16x16x32_bf16 v[144:147], a[0:3], v[96:99], 0
  ds_read_b128 v[96:99], v40 offset:6144
  s_waitcnt lgkmcnt(11)
  v_mfma_f32_16x16x32_bf16 v[148:151], a[0:3], v[100:103], 0
  ds_read_b128 v[100:103], v40 offset:26624
  s_waitcnt lgkmcnt(11)
  v_mfma_f32_16x16x32_bf16 v[144:147], a[4:7], v[104:107], v[144:147]
  ds_read_b128 v[104:107], v40 offset:7168
  s_waitcnt lgkmcnt(11)
  v_mfma_f32_16x16x32_bf16 v[148:151], a[4:7], v[108:111], v[148:151]
  ds_read_b128 v[108:111], v40 offset:27648
  s_waitcnt lgkmcnt(11)
  v_mfma_f32_16x16x32_bf16 v[144:147], a[8:11], v[112:115], v[144:147]
  ds_read_b128 v[112:115], v40 offset:8192
  s_waitcnt lgkmcnt(11)
  v_mfma_f32_16x16x32_bf16 v[148:151], a[8:11], v[116:119], v[148:151]
  ds_read_b128 v[116:119], v40 offset:28672
  s_waitcnt lgkmcnt(11)
  v_mfma_f32_16x16x32_bf16 v[144:147], a[12:15], v[120:123], v[144:147]
  ds_read_b128 v[120:123], v40 offset:9216
  s_waitcnt lgkmcnt(11)
  v_mfma_f32_16x16x32_bf16 v[148:151], a[12:15], v[124:127], v[148:151]
  ds_read_b128 v[124:127], v40 offset:29696
  s_waitcnt lgkmcnt(11)
  v_mfma_f32_16x16x32_bf16 v[144:147], a[16:19], v[128:131], v[144:147]
  ds_read_b128 v[128:131], v40 offset:10240
  s_waitcnt lgkmcnt(11)
  v_mfma_f32_16x16x32_bf16 v[148:151], a[16:19], v[132:135], v[148:151]
  ds_read_b128 v[132:135], v40 offset:30720
  s_waitcnt lgkmcnt(11)
  v_mfma_f32_16x16x32_bf16 v[144:147], a[20:23], v[136:139], v[144:147]
  ds_read_b128 v[136:139], v40 offset:11264
  s_waitcnt lgkmcnt(11)
  v_mfma_f32_16x16x32_bf16 v[148:151], a[20:23], v[140:143], v[148:151]
  ds_read_b128 v[140:143], v40 offset:31744
  s_waitcnt lgkmcnt(11)
  v_mfma_f32_16x16x32_bf16 v[144:147], a[24:27], v[96:99], v[144:147]
  ds_read_b128 v[96:99], v40 offset:12288
  s_waitcnt lgkmcnt(11)
  v_mfma_f32_16x16x32_bf16 v[148:151], a[24:27], v[100:103], v[148:151]
  ds_read_b128 v[100:103], v40 offset:32768
  s_waitcnt lgkmcnt(11)
  v_mfma_f32_16x16x32_bf16 v[144:147], a[28:31], v[104:107], v[144:147]
  ds_read_b128 v[104:107], v40 offset:13312
  s_waitcnt lgkmcnt(11)
  v_mfma_f32_16x16x32_bf16 v[148:151], a[28:31], v[108:111], v[148:151]
  ds_read_b128 v[108:111], v40 offset:33792
  s_waitcnt lgkmcnt(11)
  v_mfma_f32_16x16x32_bf16 v[144:147], a[32:35], v[112:115], v[144:147]
  ds_read_b128 v[112:115], v40 offset:14336
  s_waitcnt lgkmcnt(11)
  v_mfma_f32_16x16x32_bf16 v[148:151], a[32:35], v[116:119], v[148:151]
  ds_read_b128 v[116:119], v40 offset:34816
  s_waitcnt lgkmcnt(11)
  v_mfma_f32_16x16x32_bf16 v[144:147], a[36:39], v[120:123], v[144:147]
  ds_read_b128 v[120:123], v40 offset:15360
  s_waitcnt lgkmcnt(11)
  v_mfma_f32_16x16x32_bf16 v[148:151], a[36:39], v[124:127], v[148:151]
  ds_read_b128 v[124:127], v40 offset:35840
  s_waitcnt lgkmcnt(11)
  v_mfma_f32_16x16x32_bf16 v[144:147], a[40:43], v[128:131], v[144:147]
  ds_read_b128 v[128:131], v40 offset:16384
  s_waitcnt lgkmcnt(11)
  v_mfma_f32_16x16x32_bf16 v[148:151], a[40:43], v[132:135], v[148:151]
  ds_read_b128 v[132:135], v40 offset:36864
  s_waitcnt lgkmcnt(11)
  v_mfma_f32_16x16x32_bf16 v[144:147], a[44:47], v[136:139], v[144:147]
  ds_read_b128 v[136:139], v40 offset:17408
  s_waitcnt lgkmcnt(11)
  v_mfma_f32_16x16x32_bf16 v[148:151], a[44:47], v[140:143], v[148:151]
  ds_read_b128 v[140:143], v40 offset:37888
  s_waitcnt lgkmcnt(11)
  v_mfma_f32_16x16x32_bf16 v[144:147], a[48:51], v[96:99], v[144:147]
  ds_read_b128 v[96:99], v40 offset:18432
  s_waitcnt lgkmcnt(11)
  v_mfma_f32_16x16x32_bf16 v[148:151], a[48:51], v[100:103], v[148:151]
  ds_read_b128 v[100:103], v40 offset:38912
  s_waitcnt lgkmcnt(11)
  v_mfma_f32_16x16x32_bf16 v[144:147], a[52:55], v[104:107], v[144:147]
  ds_read_b128 v[104:107], v40 offset:19456
  s_waitcnt lgkmcnt(11)
  v_mfma_f32_16x16x32_bf16 v[148:151], a[52:55], v[108:111], v[148:151]
  ds_read_b128 v[108:111], v40 offset:39936
  s_waitcnt lgkmcnt(11)
  v_mfma_f32_16x16x32_bf16 v[144:147], a[56:59], v[112:115], v[144:147]
  s_waitcnt lgkmcnt(10)
  v_mfma_f32_16x16x32_bf16 v[148:151], a[56:59], v[116:119], v[148:151]
  s_waitcnt lgkmcnt(9)
  v_mfma_f32_16x16x32_bf16 v[144:147], a[60:63], v[120:123], v[144:147]
  s_waitcnt lgkmcnt(8)
  v_mfma_f32_16x16x32_bf16 v[148:151], a[60:63], v[124:127], v[148:151]
  s_waitcnt lgkmcnt(7)
  v_mfma_f32_16x16x32_bf16 v[144:147], a[64:67], v[128:131], v[144:147]
  s_waitcnt lgkmcnt(6)
  v_mfma_f32_16x16x32_bf16 v[148:151], a[64:67], v[132:135], v[148:151]
  s_waitcnt lgkmcnt(5)
  v_mfma_f32_16x16x32_bf16 v[144:147], a[68:71], v[136:139], v[144:147]
  s_waitcnt lgkmcnt(4)
  v_mfma_f32_16x16x32_bf16 v[148:151], a[68:71], v[140:143], v[148:151]
  s_waitcnt lgkmcnt(3)
  v_mfma_f32_16x16x32_bf16 v[144:147], a[72:75], v[96:99], v[144:147]
  s_waitcnt lgkmcnt(2)
  v_mfma_f32_16x16x32_bf16 v[148:151], a[72:75], v[100:103], v[148:151]
  s_waitcnt lgkmcnt(1)
  v_mfma_f32_16x16x32_bf16 v[144:147], a[76:79], v[104:107], v[144:147]
  s_waitcnt lgkmcnt(0)
  v_mfma_f32_16x16x32_bf16 v[148:151], a[76:79], v[108:111], v[148:151]
  s_nop 7
  s_nop 7
  v_cvt_pk_bf16_f32 v152, v144, v145
  v_cvt_pk_bf16_f32 v153, v146, v147
  v_cvt_pk_bf16_f32 v154, v148, v149
  v_cvt_pk_bf16_f32 v155, v150, v151
  buffer_store_dwordx2 v[152:153], v42, s[8:11], s22 offen
  s_add_u32 s12, s22, 262144
  buffer_store_dwordx2 v[154:155], v42, s[8:11], s12 offen
  s_branch ch_f_tep1
ch_f_tvp1:
  s_waitcnt lgkmcnt(11)
  v_mfma_f32_16x16x32_bf16 v[144:147], v[96:99], a[0:3], 0
  ds_read_b128 v[96:99], v40 offset:6144
  s_waitcnt lgkmcnt(11)
  v_mfma_f32_16x16x32_bf16 v[148:151], v[100:103], a[0:3], 0
  ds_read_b128 v[100:103], v40 offset:26624
  s_waitcnt lgkmcnt(11)
  v_mfma_f32_16x16x32_bf16 v[144:147], v[104:107], a[4:7], v[144:147]
  ds_read_b128 v[104:107], v40 offset:7168
  s_waitcnt lgkmcnt(11)
  v_mfma_f32_16x16x32_bf16 v[148:151], v[108:111], a[4:7], v[148:151]
  ds_read_b128 v[108:111], v40 offset:27648
  s_waitcnt lgkmcnt(11)
  v_mfma_f32_16x16x32_bf16 v[144:147], v[112:115], a[8:11], v[144:147]
  ds_read_b128 v[112:115], v40 offset:8192
  s_waitcnt lgkmcnt(11)
  v_mfma_f32_16x16x32_bf16 v[148:151], v[116:119], a[8:11], v[148:151]
  ds_read_b128 v[116:119], v40 offset:28672
  s_waitcnt lgkmcnt(11)
  v_mfma_f32_16x16x32_bf16 v[144:147], v[120:123], a[12:15], v[144:147]
  ds_read_b128 v[120:123], v40 offset:9216
  s_waitcnt lgkmcnt(11)
  v_mfma_f32_16x16x32_bf16 v[148:151], v[124:127], a[12:15], v[148:151]
  ds_read_b128 v[124:127], v40 offset:29696
  s_waitcnt lgkmcnt(11)
  v_mfma_f32_16x16x32_bf16 v[144:147], v[128:131], a[16:19], v[144:147]
  ds_read_b128 v[128:131], v40 offset:10240
  s_waitcnt lgkmcnt(11)
  v_mfma_f32_16x16x32_bf16 v[148:151], v[132:135], a[16:19], v[148:151]
  ds_read_b128 v[132:135], v40 offset:30720
  s_waitcnt lgkmcnt(11)
  v_mfma_f32_16x16x32_bf16 v[144:147], v[136:139], a[20:23], v[144:147]
  ds_read_b128 v[136:139], v40 offset:11264
  s_waitcnt lgkmcnt(11)
  v_mfma_f32_16x16x32_bf16 v[148:151], v[140:143], a[20:23], v[148:151]
  ds_read_b128 v[140:143], v40 offset:31744
  s_waitcnt lgkmcnt(11)
  v_mfma_f32_16x16x32_bf16 v[144:147], v[96:99], a[24:27], v[144:147]
  ds_read_b128 v[96:99], v40 offset:12288
  s_waitcnt lgkmcnt(11)
  v_mfma_f32_16x16x32_bf16 v[148:151], v[100:103], a[24:27], v[148:151]
  ds_read_b128 v[100:103], v40 offset:32768
  s_waitcnt lgkmcnt(11)
  v_mfma_f32_16x16x32_bf16 v[144:147], v[104:107], a[28:31], v[144:147]
  ds_read_b128 v[104:107], v40 offset:13312
  s_waitcnt lgkmcnt(11)
  v_mfma_f32_16x16x32_bf16 v[148:151], v[108:111], a[28:31], v[148:151]
  ds_read_b128 v[108:111], v40 offset:33792
  s_waitcnt lgkmcnt(11)
  v_mfma_f32_16x16x32_bf16 v[144:147], v[112:115], a[32:35], v[144:147]
  ds_read_b128 v[112:115], v40 offset:14336
  s_waitcnt lgkmcnt(11)
  v_mfma_f32_16x16x32_bf16 v[148:151], v[116:119], a[32:35], v[148:151]
  ds_read_b128 v[116:119], v40 offset:34816
  s_waitcnt lgkmcnt(11)
  v_mfma_f32_16x16x32_bf16 v[144:147], v[120:123], a[36:39], v[144:147]
  ds_read_b128 v[120:123], v40 offset:15360
  s_waitcnt lgkmcnt(11)
  v_mfma_f32_16x16x32_bf16 v[148:151], v[124:127], a[36:39], v[148:151]
  ds_read_b128 v[124:127], v40 offset:35840
  s_waitcnt lgkmcnt(11)
  v_mfma_f32_16x16x32_bf16 v[144:147], v[128:131], a[40:43], v[144:147]
  ds_read_b128 v[128:131], v40 offset:16384
  s_waitcnt lgkmcnt(11)
  v_mfma_f32_16x16x32_bf16 v[148:151], v[132:135], a[40:43], v[148:151]
  ds_read_b128 v[132:135], v40 offset:36864
  s_waitcnt lgkmcnt(11)
  v_mfma_f32_16x16x32_bf16 v[144:147], v[136:139], a[44:47], v[144:147]
  ds_read_b128 v[136:139], v40 offset:17408
  s_waitcnt lgkmcnt(11)
  v_mfma_f32_16x16x32_bf16 v[148:151], v[140:143], a[44:47], v[148:151]
  ds_read_b128 v[140:143], v40 offset:37888
  s_waitcnt lgkmcnt(11)
  v_mfma_f32_16x16x32_bf16 v[144:147], v[96:99], a[48:51], v[144:147]
  ds_read_b128 v[96:99], v40 offset:18432
  s_waitcnt lgkmcnt(11)
  v_mfma_f32_16x16x32_bf16 v[148:151], v[100:103], a[48:51], v[148:151]
  ds_read_b128 v[100:103], v40 offset:38912
  s_waitcnt lgkmcnt(11)
  v_mfma_f32_16x16x32_bf16 v[144:147], v[104:107], a[52:55], v[144:147]
  ds_read_b128 v[104:107], v40 offset:19456
  s_waitcnt lgkmcnt(11)
  v_mfma_f32_16x16x32_bf16 v[148:151], v[108:111], a[52:55], v[148:151]
  ds_read_b128 v[108:111], v40 offset:39936
  s_waitcnt lgkmcnt(11)
  v_mfma_f32_16x16x32_bf16 v[144:147], v[112:115], a[56:59], v[144:147]
  s_waitcnt lgkmcnt(10)
  v_mfma_f32_16x16x32_bf16 v[148:151], v[116:119], a[56:59], v[148:151]
  s_waitcnt lgkmcnt(9)
  v_mfma_f32_16x16x32_bf16 v[144:147], v[120:123], a[60:63], v[144:147]
  s_waitcnt lgkmcnt(8)
  v_mfma_f32_16x16x32_bf16 v[148:151], v[124:127], a[60:63], v[148:151]
  s_waitcnt lgkmcnt(7)
  v_mfma_f32_16x16x32_bf16 v[144:147], v[128:131], a[64:67], v[144:147]
  s_waitcnt lgkmcnt(6)
  v_mfma_f32_16x16x32_bf16 v[148:151], v[132:135], a[64:67], v[148:151]
  s_waitcnt lgkmcnt(5)
  v_mfma_f32_16x16x32_bf16 v[144:147], v[136:139], a[68:71], v[144:147]
  s_waitcnt lgkmcnt(4)
  v_mfma_f32_16x16x32_bf16 v[148:151], v[140:143], a[68:71], v[148:151]
  s_waitcnt lgkmcnt(3)
  v_mfma_f32_16x16x32_bf16 v[144:147], v[96:99], a[72:75], v[144:147]
  s_waitcnt lgkmcnt(2)
  v_mfma_f32_16x16x32_bf16 v[148:151], v[100:103], a[72:75], v[148:151]
  s_waitcnt lgkmcnt(1)
  v_mfma_f32_16x16x32_bf16 v[144:147], v[104:107], a[76:79], v[144:147]
  s_waitcnt lgkmcnt(0)
  v_mfma_f32_16x16x32_bf16 v[148:151], v[108:111], a[76:79], v[148:151]
  s_nop 7
  s_nop 7
  v_cvt_pk_bf16_f32 v152, v144, v145
  v_cvt_pk_bf16_f32 v153, v146, v147
  v_cvt_pk_bf16_f32 v154, v148, v149
  v_cvt_pk_bf16_f32 v155, v150, v151
  buffer_store_dwordx4 v[152:155], v2, s[8:11], s23 offen
ch_f_tep1:
  s_add_u32 s22, s22, 524288
  s_add_u32 s23, s23, 262144
  s_add_u32 s24, s24, 1
  s_bitset0_b32 s22, 22
  s_bitset0_b32 s23, 21
ch_f_p2:
  s_waitcnt vmcnt(0)
  s_barrier
  s_cmp_eq_u32 s3, 3
  s_cbranch_scc1 ch_f_p3
  s_and_b32 s26, s25, 1
  s_mul_i32 s26, s26, 40960
  s_add_u32 s26, s26, 40960
  s_add_u32 s12, s21, 0
  s_min_u32 s12, s12, 39936
  s_add_u32 m0, s12, s26
  s_add_u32 s12, s12, s20
  buffer_load_dwordx4 v2, s[8:11], s12 offen lds
  s_add_u32 s12, s21, 1024
  s_min_u32 s12, s12, 39936
  s_add_u32 m0, s12, s26
  s_add_u32 s12, s12, s20
  buffer_load_dwordx4 v2, s[8:11], s12 offen lds
  s_add_u32 s12, s21, 2048
  s_min_u32 s12, s12, 39936
  s_add_u32 m0, s12, s26
  s_add_u32 s12, s12, s20
  buffer_load_dwordx4 v2, s[8:11], s12 offen lds
  s_add_u32 s12, s21, 3072
  s_min_u32 s12, s12, 39936
  s_add_u32 m0, s12, s26
  s_add_u32 s12, s12, s20
  buffer_load_dwordx4 v2, s[8:11], s12 offen lds
  s_add_u32 s12, s21, 4096
  s_min_u32 s12, s12, 39936
  s_add_u32 m0, s12, s26
  s_add_u32 s12, s12, s20
  buffer_load_dwordx4 v2, s[8:11], s12 offen lds
  s_add_u32 s12, s21, 5120
  s_min_u32 s12, s12, 39936
  s_add_u32 m0, s12, s26
  s_add_u32 s12, s12, s20
  buffer_load_dwordx4 v2, s[8:11], s12 offen lds
  s_add_u32 s12, s21, 6144
  s_min_u32 s12, s12, 39936
  s_add_u32 m0, s12, s26
  s_add_u32 s12, s12, s20
  buffer_load_dwordx4 v2, s[8:11], s12 offen lds
  s_add_u32 s12, s21, 7168
  s_min_u32 s12, s12, 39936
  s_add_u32 m0, s12, s26
  s_add_u32 s12, s12, s20
  buffer_load_dwordx4 v2, s[8:11], s12 offen lds
  s_add_u32 s12, s21, 8192
  s_min_u32 s12, s12, 39936
  s_add_u32 m0, s12, s26
  s_add_u32 s12, s12, s20
  buffer_load_dwordx4 v2, s[8:11], s12 offen lds
  s_add_u32 s12, s21, 9216
  s_min_u32 s12, s12, 39936
  s_add_u32 m0, s12, s26
  s_add_u32 s12, s12, s20
  buffer_load_dwordx4 v2, s[8:11], s12 offen lds
  s_add_u32 s12, s21, 10240
  s_min_u32 s12, s12, 39936
  s_add_u32 m0, s12, s26
  s_add_u32 s12, s12, s20
  buffer_load_dwordx4 v2, s[8:11], s12 offen lds
  s_add_u32 s12, s21, 11264
  s_min_u32 s12, s12, 39936
  s_add_u32 m0, s12, s26
  s_add_u32 s12, s12, s20
  buffer_load_dwordx4 v2, s[8:11], s12 offen lds
  s_add_u32 s12, s21, 12288
  s_min_u32 s12, s12, 39936
  s_add_u32 m0, s12, s26
  s_add_u32 s12, s12, s20
  buffer_load_dwordx4 v2, s[8:11], s12 offen lds
  s_add_u32 s12, s21, 13312
  s_min_u32 s12, s12, 39936
  s_add_u32 m0, s12, s26
  s_add_u32 s12, s12, s20
  buffer_load_dwordx4 v2, s[8:11], s12 offen lds
  s_add_u32 s20, s20, 40960
  s_add_u32 s25, s25, 1
  s_cmp_eq_u32 s3, 0
  s_cbranch_scc0 ch_f_p3
  s_lshl_b32 s12, s40, 2
  s_add_u32 s12, s12, 64
  v_mov_b32 v44, 1
  v_mov_b32 v45, s12
  s_mov_b64 exec, 1
  buffer_atomic_add v44, v45, s[64:67], 0 offen sc1
  s_mov_b32 s61, 65536
ch_f_sy:
  buffer_load_dword v46, v45, s[64:67], 0 offen sc1
  s_waitcnt vmcnt(0)
  v_readfirstlane_b32 s12, v46
  s_sub_u32 s61, s61, 1
  s_cmp_eq_u32 s61, 0
  s_cbranch_scc1 ch_f_sy2
  s_cmp_lt_u32 s12, 32
  s_cbranch_scc1 ch_f_sy
ch_f_sy2:
  s_mov_b64 exec, -1
ch_f_p3:
  s_barrier
  s_cmp_ge_u32 s41, 20
  s_cbranch_scc1 ch_f_nopf0
  s_add_u32 s12, s54, 0
  buffer_load_dwordx4 a[112:115], v2, s[8:11], s12 offen offset:0 sc1
  buffer_load_dwordx4 a[116:119], v2, s[8:11], s12 offen offset:1024 sc1
  buffer_load_dwordx4 a[120:123], v2, s[8:11], s12 offen offset:2048 sc1
  buffer_load_dwordx4 a[124:127], v2, s[8:11], s12 offen offset:3072 sc1
  s_add_u32 s12, s54, 262144
  buffer_load_dwordx4 a[128:131], v2, s[8:11], s12 offen offset:0 sc1
  buffer_load_dwordx4 a[132:135], v2, s[8:11], s12 offen offset:1024 sc1
  buffer_load_dwordx4 a[136:139], v2, s[8:11], s12 offen offset:2048 sc1
  buffer_load_dwordx4 a[140:143], v2, s[8:11], s12 offen offset:3072 sc1
  s_add_u32 s54, s54, 524288
  s_bitset0_b32 s54, 22
  s_add_u32 s12, s55, 0
  buffer_load_dwordx4 a[144:147], v2, s[8:11], s12 offen offset:0 sc1
  buffer_load_dwordx4 a[148:151], v2, s[8:11], s12 offen offset:1024 sc1
  buffer_load_dwordx4 a[152:155], v2, s[8:11], s12 offen offset:2048 sc1
  buffer_load_dwordx4 a[156:159], v2, s[8:11], s12 offen offset:3072 sc1
  s_add_u32 s12, s55, 4096
  buffer_load_dwordx4 a[160:163], v2, s[8:11], s12 offen offset:0 sc1
  buffer_load_dwordx4 a[164:167], v2, s[8:11], s12 offen offset:1024 sc1
  buffer_load_dwordx4 a[168:171], v2, s[8:11], s12 offen offset:2048 sc1
  buffer_load_dwordx4 a[172:175], v2, s[8:11], s12 offen offset:3072 sc1
  s_add_u32 s55, s55, 262144
  s_bitset0_b32 s55, 21
ch_f_nopf0:
  s_mul_i32 s92, s40, 10240
  s_add_u32 s92, s92, 83886080
  s_mul_i32 s93, s45, 6144
  s_add_u32 s93, s93, 89210880
  s_mul_i32 s94, s46, 6144
  s_add_u32 s94, s94, 89210880
  s_lshl_b32 s95, s41, 10
  s_add_u32 s95, s95, 101793792
  s_sub_u32 s12, s41, 20
  s_lshr_b32 s12, s12, 1
  s_add_u32 s12, s12, s44
  s_and_b32 s91, s41, 1
  s_lshl_b32 s13, s12, 12
  s_lshl_b32 s14, s91, 18
  s_add_u32 s68, s13, s14
  s_add_u32 s68, s68, 33554432
  s_add_u32 s69, s13, 33685504
  s_lshl_b32 s70, s12, 13
  s_add_u32 s70, s70, 67108864
  s_mul_i32 s71, s12, 6144
  s_add_u32 s71, s71, 89210880
  s_lshl_b32 s14, s91, 17
  s_add_u32 s88, s13, s14
  s_add_u32 s88, s88, 112283648
  s_mov_b32 s89, 0
  s_mov_b32 s90, 0
  s_cmp_eq_u32 s3, 3
  s_cbranch_scc0 ch_f_not
  s_cmp_lt_u32 s41, 20
  s_cbranch_scc1 ch_f_not
  s_cmp_ge_u32 s41, 28
  s_cbranch_scc1 ch_f_not
  s_mov_b32 s90, 1
  buffer_load_dwordx4 v[64:67], v2, s[8:11], s68 offen offset:0 sc1
  buffer_load_dwordx4 v[68:71], v2, s[8:11], s68 offen offset:1024 sc1
  buffer_load_dwordx4 v[72:75], v2, s[8:11], s68 offen offset:2048 sc1
  buffer_load_dwordx4 v[76:79], v2, s[8:11], s68 offen offset:3072 sc1
  s_add_u32 s12, s69, 0
  buffer_load_dwordx4 v[96:99], v2, s[8:11], s12 offen offset:0 sc1
  buffer_load_dwordx4 v[100:103], v2, s[8:11], s12 offen offset:1024 sc1
  buffer_load_dwordx4 v[104:107], v2, s[8:11], s12 offen offset:2048 sc1
  buffer_load_dwordx4 v[108:111], v2, s[8:11], s12 offen offset:3072 sc1
  s_add_u32 s12, s69, 262144
  buffer_load_dwordx4 v[112:115], v2, s[8:11], s12 offen offset:0 sc1
  buffer_load_dwordx4 v[116:119], v2, s[8:11], s12 offen offset:1024 sc1
  buffer_load_dwordx4 v[120:123], v2, s[8:11], s12 offen offset:2048 sc1
  buffer_load_dwordx4 v[124:127], v2, s[8:11], s12 offen offset:3072 sc1
  s_add_u32 s12, s70, 0
  buffer_load_dwordx4 v[144:147], v2, s[8:11], s12 offen offset:0 sc1
  buffer_load_dwordx4 v[148:151], v2, s[8:11], s12 offen offset:1024 sc1
  buffer_load_dwordx4 v[152:155], v2, s[8:11], s12 offen offset:2048 sc1
  buffer_load_dwordx4 v[156:159], v2, s[8:11], s12 offen offset:3072 sc1
  s_add_u32 s12, s70, 4096
  buffer_load_dwordx4 v[160:163], v2, s[8:11], s12 offen offset:0 sc1
  buffer_load_dwordx4 v[164:167], v2, s[8:11], s12 offen offset:1024 sc1
  buffer_load_dwordx4 v[168:171], v2, s[8:11], s12 offen offset:2048 sc1
  buffer_load_dwordx4 v[172:175], v2, s[8:11], s12 offen offset:3072 sc1
  s_add_u32 s68, s68, 524288
  s_add_u32 s69, s69, 524288
  s_add_u32 s70, s70, 262144
  s_bitset0_b32 s68, 22
  s_bitset0_b32 s69, 22
  s_bitset0_b32 s70, 21
ch_f_not:
  s_lshr_b32 s12, s43, 1
  s_lshl_b32 s12, s12, 9
  s_and_b32 s13, s43, 1
  s_lshl_b32 s13, s13, 3
  s_add_u32 s12, s12, s13
  s_lshl_b32 s13, s3, 11
  s_add_u32 s12, s12, s13
  s_cmp_eq_u32 s3, 2
  s_cbranch_scc1 ch_f_vo
  v_add_u32 v22, s12, v12
  s_branch ch_f_vo2
ch_f_vo:
  v_add_u32 v22, s12, v14
ch_f_vo2:
  s_mov_b32 s60, 0
  v_mov_b32 v192, 0
  v_mov_b32 v193, 0
  v_mov_b32 v194, 0
  v_mov_b32 v195, 0
  v_mov_b32 v196, 0
  v_mov_b32 v197, 0
  v_mov_b32 v198, 0
  v_mov_b32 v199, 0
  v_mov_b32 v200, 0
  v_mov_b32 v201, 0
  v_mov_b32 v202, 0
  v_mov_b32 v203, 0
  v_mov_b32 v204, 0
  v_mov_b32 v205, 0
  v_mov_b32 v206, 0
  v_mov_b32 v207, 0
  v_mov_b32 v208, 0
  v_mov_b32 v209, 0
  v_mov_b32 v210, 0
  v_mov_b32 v211, 0
  v_mov_b32 v212, 0
  v_mov_b32 v213, 0
  v_mov_b32 v214, 0
  v_mov_b32 v215, 0
  v_mov_b32 v216, 0
  v_mov_b32 v217, 0
  v_mov_b32 v218, 0
  v_mov_b32 v219, 0
  v_mov_b32 v220, 0
  v_mov_b32 v221, 0
  v_mov_b32 v222, 0
  v_mov_b32 v223, 0
  v_mov_b32 v224, 0
  v_mov_b32 v225, 0
  v_mov_b32 v226, 0
  v_mov_b32 v227, 0
  v_mov_b32 v228, 0
  v_mov_b32 v229, 0
  v_mov_b32 v230, 0
  v_mov_b32 v231, 0
  v_mov_b32 v232, 0
  v_mov_b32 v233, 0
  v_mov_b32 v234, 0
  v_mov_b32 v235, 0
  v_mov_b32 v236, 0
  v_mov_b32 v237, 0
  v_mov_b32 v238, 0
  v_mov_b32 v239, 0
  v_mov_b32 v240, 0x3f803f80
  v_mov_b32 v241, 0x3f803f80
  v_mov_b32 v242, 0x3f803f80
  v_mov_b32 v243, 0x3f803f80
  s_lshl_b32 s62, s3, 10
  v_add_u32 v23, s62, v2
  s_cmp_eq_u32 s3, 0
  s_cselect_b32 s67, 9216, 0
  s_waitcnt vmcnt(0)
ch_f_loop:
  s_and_b32 s12, s60, 7
  s_mul_i32 s13, s12, 81920
  s_add_u32 s56, s92, s13
  s_mul_i32 s13, s12, 196608
  s_add_u32 s57, s93, s13
  s_add_u32 s58, s94, s13
  s_mul_i32 s13, s12, 163840
  s_add_u32 s59, s95, s13
  s_add_u32 s47, s60, 2
  s_and_b32 s47, s47, 7
  s_and_b32 s12, s60, 1
  s_mul_i32 s63, s12, 10240
  s_add_u32 s63, s63, 16448
  v_add_u32 v18, s63, v23
  s_cmp_eq_u32 s3, 3
  s_cbranch_scc0 ch_f_nw
  s_cmp_gt_u32 s60, 61
  s_cbranch_scc1 ch_f_nw
  s_cmp_lt_u32 s41, 20
  s_cbranch_scc1 ch_f_nw
  s_mul_i32 s12, s47, 196608
  s_mul_i32 s13, s44, 6144
  s_add_u32 s12, s12, s13
  s_add_u32 s12, s12, 89210880
  s_lshl_b32 s13, s41, 10
  s_add_u32 s12, s12, s13
  s_mul_i32 s15, s47, 81920
  s_add_u32 s15, s15, s92
  s_sub_u32 s14, s15, 24576
  s_add_u32 s14, s14, s13
  s_cmp_lt_u32 s41, 24
  s_cselect_b32 s12, s12, s14
  buffer_store_dwordx4 v[56:59], v2, s[8:11], s12 offen
  s_add_u32 s14, s15, 8192
  s_and_b32 s13, s13, 1024
  s_add_u32 s14, s14, s13
  buffer_store_dwordx4 v[56:59], v2, s[8:11], s14 offen
  s_waitcnt vmcnt(0)
ch_f_nw:
  s_cmp_eq_u32 s3, 3
  s_cbranch_scc1 ch_f_A3
  s_add_u32 s64, s56, 3072
  s_add_u32 s65, s56, 6144
  s_add_u32 s66, s56, s67
  s_mov_b32 s61, 65536
ch_f_Ap:
  buffer_load_dwordx4 v[64:67], v23, s[8:11], s56 offen sc1
  buffer_load_dwordx4 v[68:71], v23, s[8:11], s64 offen sc1
  buffer_load_dwordx4 v[72:75], v23, s[8:11], s65 offen sc1
  buffer_load_dwordx4 v[76:79], v23, s[8:11], s66 offen sc1
  s_waitcnt vmcnt(0)
  v_max3_u32 v8, v64, v66, v68
  v_max3_u32 v9, v70, v72, v74
  v_max3_u32 v8, v8, v76, v78
  v_max_u32 v8, v8, v9
  v_cmp_eq_u32 vcc, -1, v8
  s_sub_u32 s61, s61, 1
  s_cmp_eq_u32 s61, 0
  s_cbranch_scc1 ch_f_Ad0
  s_cbranch_vccz ch_f_Ad0
  buffer_load_dwordx4 v[80:83], v23, s[8:11], s56 offen sc1
  buffer_load_dwordx4 v[84:87], v23, s[8:11], s64 offen sc1
  buffer_load_dwordx4 v[88:91], v23, s[8:11], s65 offen sc1
  buffer_load_dwordx4 v[92:95], v23, s[8:11], s66 offen sc1
  s_waitcnt vmcnt(0)
  v_max3_u32 v8, v80, v82, v84
  v_max3_u32 v9, v86, v88, v90
  v_max3_u32 v8, v8, v92, v94
  v_max_u32 v8, v8, v9
  v_cmp_eq_u32 vcc, -1, v8
  s_sub_u32 s61, s61, 1
  s_cmp_eq_u32 s61, 0
  s_cbranch_scc1 ch_f_Ad1
  s_cbranch_vccz ch_f_Ad1
  s_branch ch_f_Ap
ch_f_Ad0:
  ds_write_b128 v18, v[64:67]
  ds_write_b128 v18, v[68:71] offset:3072
  ds_write_b128 v18, v[72:75] offset:6144
  s_cmp_eq_u32 s3, 0
  s_cbranch_scc0 ch_f_A3
  ds_write_b128 v18, v[76:79] offset:9216
  s_branch ch_f_A3
ch_f_Ad1:
  ds_write_b128 v18, v[80:83]
  ds_write_b128 v18, v[84:87] offset:3072
  ds_write_b128 v18, v[88:91] offset:6144
  s_cmp_eq_u32 s3, 0
  s_cbranch_scc0 ch_f_A3
  ds_write_b128 v18, v[92:95] offset:9216
  s_branch ch_f_A3
ch_f_A3:
  v_add_u32 v18, s63, v12
  s_waitcnt lgkmcnt(0)
  s_barrier
  s_cmp_eq_u32 s3, 3
  s_cbranch_scc1 ch_f_B
  ds_read_b128 v[96:99], v18 offset:0
  ds_read_b128 v[100:103], v18 offset:512
  ds_read_b128 v[104:107], v18 offset:1024
  ds_read_b128 v[108:111], v18 offset:1536
  ds_read_b128 v[112:115], v18 offset:2048
  ds_read_b128 v[116:119], v18 offset:2560
  ds_read_b128 v[120:123], v18 offset:3072
  ds_read_b128 v[124:127], v18 offset:3584
  ds_read_b128 v[128:131], v18 offset:4096
  ds_read_b128 v[132:135], v18 offset:4608
  ds_read_b128 v[136:139], v18 offset:5120
  ds_read_b128 v[140:143], v18 offset:5632
  s_cmp_eq_u32 s3, 2
  s_cbranch_scc1 ch_f_Av
  s_waitcnt lgkmcnt(11)
  v_mfma_f32_16x16x32_bf16 v[180:183], a[0:3], v[96:99], 0
  ds_read_b128 v[96:99], v18 offset:6144
  s_waitcnt lgkmcnt(11)
  v_mfma_f32_16x16x32_bf16 v[180:183], a[4:7], v[100:103], v[180:183]
  ds_read_b128 v[100:103], v18 offset:6656
  s_waitcnt lgkmcnt(11)
  v_mfma_f32_16x16x32_bf16 v[180:183], a[8:11], v[104:107], v[180:183]
  ds_read_b128 v[104:107], v18 offset:7168
  s_waitcnt lgkmcnt(11)
  v_mfma_f32_16x16x32_bf16 v[180:183], a[12:15], v[108:111], v[180:183]
  ds_read_b128 v[108:111], v18 offset:7680
  s_waitcnt lgkmcnt(11)
  v_mfma_f32_16x16x32_bf16 v[180:183], a[16:19], v[112:115], v[180:183]
  ds_read_b128 v[112:115], v18 offset:8192
  s_waitcnt lgkmcnt(11)
  v_mfma_f32_16x16x32_bf16 v[180:183], a[20:23], v[116:119], v[180:183]
  ds_read_b128 v[116:119], v18 offset:8704
  s_waitcnt lgkmcnt(11)
  v_mfma_f32_16x16x32_bf16 v[180:183], a[24:27], v[120:123], v[180:183]
  ds_read_b128 v[120:123], v18 offset:9216
  s_waitcnt lgkmcnt(11)
  v_mfma_f32_16x16x32_bf16 v[180:183], a[28:31], v[124:127], v[180:183]
  ds_read_b128 v[124:127], v18 offset:9728
  s_waitcnt lgkmcnt(11)
  v_mfma_f32_16x16x32_bf16 v[180:183], a[32:35], v[128:131], v[180:183]
  s_waitcnt lgkmcnt(10)
  v_mfma_f32_16x16x32_bf16 v[180:183], a[36:39], v[132:135], v[180:183]
  s_waitcnt lgkmcnt(9)
  v_mfma_f32_16x16x32_bf16 v[180:183], a[40:43], v[136:139], v[180:183]
  s_waitcnt lgkmcnt(8)
  v_mfma_f32_16x16x32_bf16 v[180:183], a[44:47], v[140:143], v[180:183]
  s_waitcnt lgkmcnt(7)
  v_mfma_f32_16x16x32_bf16 v[180:183], a[48:51], v[96:99], v[180:183]
  s_waitcnt lgkmcnt(6)
  v_mfma_f32_16x16x32_bf16 v[180:183], a[52:55], v[100:103], v[180:183]
  s_waitcnt lgkmcnt(5)
  v_mfma_f32_16x16x32_bf16 v[180:183], a[56:59], v[104:107], v[180:183]
  s_waitcnt lgkmcnt(4)
  v_mfma_f32_16x16x32_bf16 v[180:183], a[60:63], v[108:111], v[180:183]
  s_waitcnt lgkmcnt(3)
  v_mfma_f32_16x16x32_bf16 v[180:183], a[64:67], v[112:115], v[180:183]
  s_waitcnt lgkmcnt(2)
  v_mfma_f32_16x16x32_bf16 v[180:183], a[68:71], v[116:119], v[180:183]
  s_waitcnt lgkmcnt(1)
  v_mfma_f32_16x16x32_bf16 v[180:183], a[72:75], v[120:123], v[180:183]
  s_waitcnt lgkmcnt(0)
  v_mfma_f32_16x16x32_bf16 v[180:183], a[76:79], v[124:127], v[180:183]
  s_nop 7
  v_cvt_pk_bf16_f32 v188, v180, v181
  v_cvt_pk_bf16_f32 v189, v182, v183
  v_min_u32 v188, v188, v21
  s_mov_b64 exec, s[50:51]
  buffer_store_dwordx2 v[188:189], v22, s[8:11], s57 offen
  s_mov_b64 exec, -1
  s_branch ch_f_B
ch_f_Av:
  s_waitcnt lgkmcnt(11)
  v_mfma_f32_16x16x32_bf16 v[180:183], v[96:99], a[0:3], 0
  ds_read_b128 v[96:99], v18 offset:6144
  s_waitcnt lgkmcnt(11)
  v_mfma_f32_16x16x32_bf16 v[180:183], v[100:103], a[4:7], v[180:183]
  ds_read_b128 v[100:103], v18 offset:6656
  s_waitcnt lgkmcnt(11)
  v_mfma_f32_16x16x32_bf16 v[180:183], v[104:107], a[8:11], v[180:183]
  ds_read_b128 v[104:107], v18 offset:7168
  s_waitcnt lgkmcnt(11)
  v_mfma_f32_16x16x32_bf16 v[180:183], v[108:111], a[12:15], v[180:183]
  ds_read_b128 v[108:111], v18 offset:7680
  s_waitcnt lgkmcnt(11)
  v_mfma_f32_16x16x32_bf16 v[180:183], v[112:115], a[16:19], v[180:183]
  ds_read_b128 v[112:115], v18 offset:8192
  s_waitcnt lgkmcnt(11)
  v_mfma_f32_16x16x32_bf16 v[180:183], v[116:119], a[20:23], v[180:183]
  ds_read_b128 v[116:119], v18 offset:8704
  s_waitcnt lgkmcnt(11)
  v_mfma_f32_16x16x32_bf16 v[180:183], v[120:123], a[24:27], v[180:183]
  ds_read_b128 v[120:123], v18 offset:9216
  s_waitcnt lgkmcnt(11)
  v_mfma_f32_16x16x32_bf16 v[180:183], v[124:127], a[28:31], v[180:183]
  ds_read_b128 v[124:127], v18 offset:9728
  s_waitcnt lgkmcnt(11)
  v_mfma_f32_16x16x32_bf16 v[180:183], v[128:131], a[32:35], v[180:183]
  s_waitcnt lgkmcnt(10)
  v_mfma_f32_16x16x32_bf16 v[180:183], v[132:135], a[36:39], v[180:183]
  s_waitcnt lgkmcnt(9)
  v_mfma_f32_16x16x32_bf16 v[180:183], v[136:139], a[40:43], v[180:183]
  s_waitcnt lgkmcnt(8)
  v_mfma_f32_16x16x32_bf16 v[180:183], v[140:143], a[44:47], v[180:183]
  s_waitcnt lgkmcnt(7)
  v_mfma_f32_16x16x32_bf16 v[180:183], v[96:99], a[48:51], v[180:183]
  s_waitcnt lgkmcnt(6)
  v_mfma_f32_16x16x32_bf16 v[180:183], v[100:103], a[52:55], v[180:183]
  s_waitcnt lgkmcnt(5)
  v_mfma_f32_16x16x32_bf16 v[180:183], v[104:107], a[56:59], v[180:183]
  s_waitcnt lgkmcnt(4)
  v_mfma_f32_16x16x32_bf16 v[180:183], v[108:111], a[60:63], v[180:183]
  s_waitcnt lgkmcnt(3)
  v_mfma_f32_16x16x32_bf16 v[180:183], v[112:115], a[64:67], v[180:183]
  s_waitcnt lgkmcnt(2)
  v_mfma_f32_16x16x32_bf16 v[180:183], v[116:119], a[68:71], v[180:183]
  s_waitcnt lgkmcnt(1)
  v_mfma_f32_16x16x32_bf16 v[180:183], v[120:123], a[72:75], v[180:183]
  s_waitcnt lgkmcnt(0)
  v_mfma_f32_16x16x32_bf16 v[180:183], v[124:127], a[76:79], v[180:183]
  s_nop 7
  v_cvt_pk_bf16_f32 v188, v180, v181
  v_cvt_pk_bf16_f32 v189, v182, v183
  v_min_u32 v188, v188, v21
  s_mov_b64 exec, s[52:53]
  buffer_store_dwordx2 v[188:189], v22, s[8:11], s57 offen
  s_mov_b64 exec, -1
ch_f_B:
  s_cmp_ge_u32 s41, 20
  s_cbranch_scc1 ch_f_hi
  s_cmp_eq_u32 s60, 63
  s_cbranch_scc1 ch_f_end
  s_sleep 4
ch_f_bsd:
  s_mov_b32 s61, 65536
ch_f_Bp:
  s_mov_b64 exec, s[50:51]
  buffer_load_dwordx4 v[192:195], v12, s[8:11], s58 offen offset:0 sc1
  buffer_load_dwordx4 v[196:199], v12, s[8:11], s58 offen offset:512 sc1
  buffer_load_dwordx4 v[200:203], v12, s[8:11], s58 offen offset:1024 sc1
  buffer_load_dwordx4 v[204:207], v12, s[8:11], s58 offen offset:1536 sc1
  buffer_load_dwordx4 v[208:211], v12, s[8:11], s58 offen offset:2048 sc1
  buffer_load_dwordx4 v[212:215], v12, s[8:11], s58 offen offset:2560 sc1
  buffer_load_dwordx4 v[216:219], v12, s[8:11], s58 offen offset:3072 sc1
  buffer_load_dwordx4 v[220:223], v12, s[8:11], s58 offen offset:3584 sc1
  s_add_u32 s12, s58, 4096
  s_mov_b64 exec, s[52:53]
  buffer_load_dwordx4 v[224:227], v14, s[8:11], s12 offen offset:0 sc1
  buffer_load_dwordx4 v[228:231], v14, s[8:11], s12 offen offset:512 sc1
  buffer_load_dwordx4 v[232:235], v14, s[8:11], s12 offen offset:1024 sc1
  buffer_load_dwordx4 v[236:239], v14, s[8:11], s12 offen offset:1536 sc1
  s_mov_b64 exec, -1
  s_waitcnt vmcnt(11)
  v_max_u32 v8, v192, v194
  v_mfma_f32_16x16x32_bf16 v[112:115], a[112:115], v[192:195], 0
  v_mfma_f32_16x16x32_bf16 v[116:119], a[128:131], v[192:195], 0
  s_waitcnt vmcnt(10)
  v_max3_u32 v8, v8, v196, v198
  v_mfma_f32_16x16x32_bf16 v[112:115], a[116:119], v[196:199], v[112:115]
  v_mfma_f32_16x16x32_bf16 v[116:119], a[132:135], v[196:199], v[116:119]
  s_waitcnt vmcnt(9)
  v_max3_u32 v8, v8, v200, v202
  v_mfma_f32_16x16x32_bf16 v[112:115], a[120:123], v[200:203], v[112:115]
  v_mfma_f32_16x16x32_bf16 v[116:119], a[136:139], v[200:203], v[116:119]
  s_waitcnt vmcnt(8)
  v_max3_u32 v8, v8, v204, v206
  v_mfma_f32_16x16x32_bf16 v[112:115], a[124:127], v[204:207], v[112:115]
  v_mfma_f32_16x16x32_bf16 v[116:119], a[140:143], v[204:207], v[116:119]
  s_waitcnt vmcnt(7)
  v_max3_u32 v8, v8, v208, v210
  v_mfma_f32_16x16x32_bf16 v[120:123], v[208:211], v[192:195], 0
  s_waitcnt vmcnt(6)
  v_max3_u32 v8, v8, v212, v214
  v_mfma_f32_16x16x32_bf16 v[120:123], v[212:215], v[196:199], v[120:123]
  s_waitcnt vmcnt(5)
  v_max3_u32 v8, v8, v216, v218
  v_mfma_f32_16x16x32_bf16 v[120:123], v[216:219], v[200:203], v[120:123]
  s_waitcnt vmcnt(4)
  v_max3_u32 v8, v8, v220, v222
  v_mfma_f32_16x16x32_bf16 v[120:123], v[220:223], v[204:207], v[120:123]
  s_waitcnt vmcnt(3)
  v_max3_u32 v8, v8, v224, v226
  s_waitcnt vmcnt(2)
  v_max3_u32 v8, v8, v228, v230
  s_waitcnt vmcnt(1)
  v_max3_u32 v8, v8, v232, v234
  s_waitcnt vmcnt(0)
  v_max3_u32 v8, v8, v236, v238
  v_cmp_eq_u32 vcc, -1, v8
  s_sub_u32 s61, s61, 1
  s_cmp_eq_u32 s61, 0
  s_cbranch_scc1 ch_f_Bd
  s_cbranch_vccnz ch_f_Bp
ch_f_Bd:
  s_add_u32 s12, s54, 0
  buffer_load_dwordx4 a[112:115], v2, s[8:11], s12 offen offset:0 sc1
  buffer_load_dwordx4 a[116:119], v2, s[8:11], s12 offen offset:1024 sc1
  buffer_load_dwordx4 a[120:123], v2, s[8:11], s12 offen offset:2048 sc1
  buffer_load_dwordx4 a[124:127], v2, s[8:11], s12 offen offset:3072 sc1
  s_add_u32 s12, s54, 262144
  buffer_load_dwordx4 a[128:131], v2, s[8:11], s12 offen offset:0 sc1
  buffer_load_dwordx4 a[132:135], v2, s[8:11], s12 offen offset:1024 sc1
  buffer_load_dwordx4 a[136:139], v2, s[8:11], s12 offen offset:2048 sc1
  buffer_load_dwordx4 a[140:143], v2, s[8:11], s12 offen offset:3072 sc1
  s_add_u32 s54, s54, 524288
  s_bitset0_b32 s54, 22
  v_add_f32 v120, v120, v3
  v_add_f32 v121, v121, v3
  v_add_f32 v122, v122, v3
  v_add_f32 v123, v123, v3
  v_max3_f32 v8, v112, v113, v114
  v_max3_f32 v9, v115, v116, v117
  v_max3_f32 v8, v8, v118, v119
  v_max3_f32 v9, v9, v120, v121
  v_max3_f32 v8, v8, v122, v123
  v_max_f32 v8, v8, v9
  v_mov_b32 v9, v8
  s_nop 1
  v_permlane32_swap_b32 v9, v8
  s_nop 1
  v_max_f32 v8, v8, v9
  v_mov_b32 v9, v8
  s_nop 1
  v_permlane16_swap_b32 v9, v8
  s_nop 1
  v_max_f32 v8, v8, v9
  v_mul_f32 v8, 0x3e0293ee, v8
  s_mov_b32 s39, 0x3e0293ee
  v_fma_f32 v112, v112, s39, -v8
  v_fma_f32 v113, v113, s39, -v8
  v_fma_f32 v114, v114, s39, -v8
  v_fma_f32 v115, v115, s39, -v8
  v_fma_f32 v116, v116, s39, -v8
  v_fma_f32 v117, v117, s39, -v8
  v_fma_f32 v118, v118, s39, -v8
  v_fma_f32 v119, v119, s39, -v8
  v_fma_f32 v120, v120, s39, -v8
  v_fma_f32 v121, v121, s39, -v8
  v_fma_f32 v122, v122, s39, -v8
  v_fma_f32 v123, v123, s39, -v8
  v_exp_f32 v112, v112
  v_exp_f32 v113, v113
  v_exp_f32 v114, v114
  v_exp_f32 v115, v115
  v_exp_f32 v116, v116
  v_exp_f32 v117, v117
  v_exp_f32 v118, v118
  v_exp_f32 v119, v119
  v_exp_f32 v120, v120
  v_exp_f32 v121, v121
  v_exp_f32 v122, v122
  v_exp_f32 v123, v123
  s_nop 0
  v_cvt_pk_bf16_f32 v124, v112, v113
  v_cvt_pk_bf16_f32 v125, v114, v115
  v_cvt_pk_bf16_f32 v126, v116, v117
  v_cvt_pk_bf16_f32 v127, v118, v119
  v_cvt_pk_bf16_f32 v128, v120, v121
  v_cvt_pk_bf16_f32 v129, v122, v123
  s_nop 1
  v_mfma_f32_16x16x32_bf16 v[132:135], a[144:147], v[124:127], 0
  v_mfma_f32_16x16x32_bf16 v[136:139], a[148:151], v[124:127], 0
  v_mfma_f32_16x16x32_bf16 v[140:143], a[152:155], v[124:127], 0
  v_mfma_f32_16x16x32_bf16 v[144:147], a[156:159], v[124:127], 0
  v_mfma_f32_16x16x32_bf16 v[148:151], a[160:163], v[124:127], 0
  v_mfma_f32_16x16x32_bf16 v[152:155], a[164:167], v[124:127], 0
  v_mfma_f32_16x16x32_bf16 v[156:159], a[168:171], v[124:127], 0
  v_mfma_f32_16x16x32_bf16 v[160:163], a[172:175], v[124:127], 0
  v_mfma_f32_16x16x32_bf16 v[244:247], v[240:243], v[124:127], 0
  v_mfma_f32_16x16x16_bf16 v[132:135], v[224:225], v[128:129], v[132:135]
  v_mfma_f32_16x16x16_bf16 v[136:139], v[226:227], v[128:129], v[136:139]
  v_mfma_f32_16x16x16_bf16 v[140:143], v[228:229], v[128:129], v[140:143]
  v_mfma_f32_16x16x16_bf16 v[144:147], v[230:231], v[128:129], v[144:147]
  v_mfma_f32_16x16x16_bf16 v[148:151], v[232:233], v[128:129], v[148:151]
  v_mfma_f32_16x16x16_bf16 v[152:155], v[234:235], v[128:129], v[152:155]
  v_mfma_f32_16x16x16_bf16 v[156:159], v[236:237], v[128:129], v[156:159]
  v_mfma_f32_16x16x16_bf16 v[160:163], v[238:239], v[128:129], v[160:163]
  v_mfma_f32_16x16x16_bf16 v[244:247], v[240:241], v[128:129], v[244:247]
  s_nop 1
  v_cvt_pk_bf16_f32 v164, v132, v133
  v_cvt_pk_bf16_f32 v165, v134, v135
  v_cvt_pk_bf16_f32 v166, v136, v137
  v_cvt_pk_bf16_f32 v167, v138, v139
  v_cvt_pk_bf16_f32 v168, v140, v141
  v_cvt_pk_bf16_f32 v169, v142, v143
  v_cvt_pk_bf16_f32 v170, v144, v145
  v_cvt_pk_bf16_f32 v171, v146, v147
  v_mfma_f32_16x16x32_bf16 v[180:183], a[80:83], v[164:167], 0
  v_mfma_f32_16x16x32_bf16 v[184:187], a[96:99], v[164:167], 0
  v_cvt_pk_bf16_f32 v172, v148, v149
  v_cvt_pk_bf16_f32 v173, v150, v151
  v_cvt_pk_bf16_f32 v174, v152, v153
  v_cvt_pk_bf16_f32 v175, v154, v155
  v_mfma_f32_16x16x32_bf16 v[180:183], a[84:87], v[168:171], v[180:183]
  v_mfma_f32_16x16x32_bf16 v[184:187], a[100:103], v[168:171], v[184:187]
  v_rcp_f32 v8, v244
  v_cvt_pk_bf16_f32 v176, v156, v157
  v_cvt_pk_bf16_f32 v177, v158, v159
  v_cvt_pk_bf16_f32 v178, v160, v161
  v_cvt_pk_bf16_f32 v179, v162, v163
  v_mfma_f32_16x16x32_bf16 v[180:183], a[88:91], v[172:175], v[180:183]
  v_mfma_f32_16x16x32_bf16 v[184:187], a[104:107], v[172:175], v[184:187]
  s_nop 0
  v_mfma_f32_16x16x32_bf16 v[180:183], a[92:95], v[176:179], v[180:183]
  v_mfma_f32_16x16x32_bf16 v[184:187], a[108:111], v[176:179], v[184:187]
  s_nop 7
  v_mul_f32 v180, v180, v8
  v_mul_f32 v181, v181, v8
  v_mul_f32 v182, v182, v8
  v_mul_f32 v183, v183, v8
  v_mul_f32 v184, v184, v8
  v_mul_f32 v185, v185, v8
  v_mul_f32 v186, v186, v8
  v_mul_f32 v187, v187, v8
  s_and_b32 s12, s60, 1
  s_lshl_b32 s12, s12, 13
  s_lshl_b32 s13, s3, 11
  s_add_u32 s13, s13, s12
  v_add_u32 v18, s13, v2
  ds_write_b128 v18, v[180:183]
  ds_write_b128 v18, v[184:187] offset:1024
  s_waitcnt lgkmcnt(0)
  s_barrier
  s_cmp_eq_u32 s3, 3
  s_cbranch_scc0 ch_f_pf
  v_add_u32 v18, s12, v16
  ds_read_b128 v[64:67], v18 offset:0
  ds_read_b128 v[68:71], v18 offset:2048
  ds_read_b128 v[72:75], v18 offset:4096
  ds_read_b128 v[76:79], v18 offset:6144
  s_waitcnt lgkmcnt(0)
  v_add_f32 v64, v64, v68
  v_add_f32 v72, v72, v76
  v_add_f32 v64, v64, v72
  v_add_f32 v65, v65, v69
  v_add_f32 v73, v73, v77
  v_add_f32 v65, v65, v73
  v_add_f32 v66, v66, v70
  v_add_f32 v74, v74, v78
  v_add_f32 v66, v66, v74
  v_add_f32 v67, v67, v71
  v_add_f32 v75, v75, v79
  v_add_f32 v67, v67, v75
  v_min_u32 v64, v64, v21
  s_mul_i32 s12, s40, 20480
  s_add_u32 s12, s12, s59
  buffer_store_dwordx4 v[64:67], v2, s[8:11], s12 offen sc1
  s_add_u32 s48, s60, 1
  s_and_b32 s48, s48, 7
  s_mul_i32 s48, s48, 81920
  s_add_u32 s48, s48, s92
  s_add_u32 s12, s55, 0
  buffer_load_dwordx4 a[144:147], v2, s[8:11], s12 offen offset:0 sc1
  buffer_load_dwordx4 a[148:151], v2, s[8:11], s12 offen offset:1024 sc1
  buffer_load_dwordx4 a[152:155], v2, s[8:11], s12 offen offset:2048 sc1
  buffer_load_dwordx4 a[156:159], v2, s[8:11], s12 offen offset:3072 sc1
  s_add_u32 s12, s55, 4096
  buffer_load_dwordx4 a[160:163], v2, s[8:11], s12 offen offset:0 sc1
  buffer_load_dwordx4 a[164:167], v2, s[8:11], s12 offen offset:1024 sc1
  buffer_load_dwordx4 a[168:171], v2, s[8:11], s12 offen offset:2048 sc1
  buffer_load_dwordx4 a[172:175], v2, s[8:11], s12 offen offset:3072 sc1
  s_add_u32 s55, s55, 262144
  s_bitset0_b32 s55, 21
  s_mov_b32 s61, 65536
ch_f_Cp:
  s_mov_b32 s12, s59
  buffer_load_dwordx4 v[80:83], v2, s[8:11], s12 offen sc1
  s_add_u32 s12, s12, 20480
  buffer_load_dwordx4 v[84:87], v2, s[8:11], s12 offen sc1
  s_add_u32 s12, s12, 20480
  buffer_load_dwordx4 v[88:91], v2, s[8:11], s12 offen sc1
  s_add_u32 s12, s12, 20480
  buffer_load_dwordx4 v[92:95], v2, s[8:11], s12 offen sc1
  s_add_u32 s12, s12, 20480
  buffer_load_dwordx4 v[96:99], v2, s[8:11], s12 offen sc1
  s_add_u32 s12, s12, 20480
  buffer_load_dwordx4 v[100:103], v2, s[8:11], s12 offen sc1
  s_add_u32 s12, s12, 20480
  buffer_load_dwordx4 v[104:107], v2, s[8:11], s12 offen sc1
  s_add_u32 s12, s12, 20480
  buffer_load_dwordx4 v[108:111], v2, s[8:11], s12 offen sc1
  s_add_u32 s12, s12, 20480
  s_waitcnt vmcnt(0)
  v_max3_u32 v8, v80, v84, v88
  v_max3_u32 v9, v92, v96, v100
  v_max3_u32 v8, v8, v104, v108
  v_max_u32 v8, v8, v9
  v_cmp_eq_u32 vcc, -1, v8
  s_sub_u32 s61, s61, 1
  s_cmp_eq_u32 s61, 0
  s_cbranch_scc1 ch_f_Cd0
  s_cbranch_vccz ch_f_Cd0
  s_mov_b32 s12, s59
  buffer_load_dwordx4 v[112:115], v2, s[8:11], s12 offen sc1
  s_add_u32 s12, s12, 20480
  buffer_load_dwordx4 v[116:119], v2, s[8:11], s12 offen sc1
  s_add_u32 s12, s12, 20480
  buffer_load_dwordx4 v[120:123], v2, s[8:11], s12 offen sc1
  s_add_u32 s12, s12, 20480
  buffer_load_dwordx4 v[124:127], v2, s[8:11], s12 offen sc1
  s_add_u32 s12, s12, 20480
  buffer_load_dwordx4 v[128:131], v2, s[8:11], s12 offen sc1
  s_add_u32 s12, s12, 20480
  buffer_load_dwordx4 v[132:135], v2, s[8:11], s12 offen sc1
  s_add_u32 s12, s12, 20480
  buffer_load_dwordx4 v[136:139], v2, s[8:11], s12 offen sc1
  s_add_u32 s12, s12, 20480
  buffer_load_dwordx4 v[140:143], v2, s[8:11], s12 offen sc1
  s_add_u32 s12, s12, 20480
  s_waitcnt vmcnt(0)
  v_max3_u32 v8, v112, v116, v120
  v_max3_u32 v9, v124, v128, v132
  v_max3_u32 v8, v8, v136, v140
  v_max_u32 v8, v8, v9
  v_cmp_eq_u32 vcc, -1, v8
  s_sub_u32 s61, s61, 1
  s_cmp_eq_u32 s61, 0
  s_cbranch_scc1 ch_f_Cd1
  s_cbranch_vccz ch_f_Cd1
  s_branch ch_f_Cp
ch_f_Cd0:
  v_add_f32 v80, v80, v84
  v_add_f32 v88, v88, v92
  v_add_f32 v96, v96, v100
  v_add_f32 v104, v104, v108
  v_add_f32 v80, v80, v88
  v_add_f32 v96, v96, v104
  v_add_f32 v80, v80, v96
  v_add_f32 v81, v81, v85
  v_add_f32 v89, v89, v93
  v_add_f32 v97, v97, v101
  v_add_f32 v105, v105, v109
  v_add_f32 v81, v81, v89
  v_add_f32 v97, v97, v105
  v_add_f32 v81, v81, v97
  v_add_f32 v82, v82, v86
  v_add_f32 v90, v90, v94
  v_add_f32 v98, v98, v102
  v_add_f32 v106, v106, v110
  v_add_f32 v82, v82, v90
  v_add_f32 v98, v98, v106
  v_add_f32 v82, v82, v98
  v_add_f32 v83, v83, v87
  v_add_f32 v91, v91, v95
  v_add_f32 v99, v99, v103
  v_add_f32 v107, v107, v111
  v_add_f32 v83, v83, v91
  v_add_f32 v99, v99, v107
  v_add_f32 v83, v83, v99
  v_cvt_pk_bf16_f32 v188, v80, v81
  v_cvt_pk_bf16_f32 v189, v82, v83
  v_min_u32 v188, v188, v21
  s_branch ch_f_Ce
ch_f_Cd1:
  v_add_f32 v112, v112, v116
  v_add_f32 v120, v120, v124
  v_add_f32 v128, v128, v132
  v_add_f32 v136, v136, v140
  v_add_f32 v112, v112, v120
  v_add_f32 v128, v128, v136
  v_add_f32 v112, v112, v128
  v_add_f32 v113, v113, v117
  v_add_f32 v121, v121, v125
  v_add_f32 v129, v129, v133
  v_add_f32 v137, v137, v141
  v_add_f32 v113, v113, v121
  v_add_f32 v129, v129, v137
  v_add_f32 v113, v113, v129
  v_add_f32 v114, v114, v118
  v_add_f32 v122, v122, v126
  v_add_f32 v130, v130, v134
  v_add_f32 v138, v138, v142
  v_add_f32 v114, v114, v122
  v_add_f32 v130, v130, v138
  v_add_f32 v114, v114, v130
  v_add_f32 v115, v115, v119
  v_add_f32 v123, v123, v127
  v_add_f32 v131, v131, v135
  v_add_f32 v139, v139, v143
  v_add_f32 v115, v115, v123
  v_add_f32 v131, v131, v139
  v_add_f32 v115, v115, v131
  v_cvt_pk_bf16_f32 v188, v112, v113
  v_cvt_pk_bf16_f32 v189, v114, v115
  v_min_u32 v188, v188, v21
ch_f_Ce:
  s_lshl_b32 s12, s41, 9
  s_add_u32 s12, s12, s48
  buffer_store_dwordx2 v[188:189], v17, s[8:11], s12 offen
  s_branch ch_f_next
ch_f_pf:
  s_cmp_eq_u32 s3, 1
  s_cbranch_scc0 ch_f_nwl
  s_cmp_gt_u32 s60, 61
  s_cbranch_scc1 ch_f_nwl
  s_mul_i32 s12, s47, 196608
  s_mul_i32 s13, s44, 6144
  s_add_u32 s12, s12, s13
  s_add_u32 s12, s12, 89210880
  s_lshl_b32 s13, s41, 10
  s_add_u32 s12, s12, s13
  s_mul_i32 s15, s47, 81920
  s_add_u32 s15, s15, s92
  s_sub_u32 s14, s15, 24576
  s_add_u32 s14, s14, s13
  s_cmp_lt_u32 s41, 24
  s_cselect_b32 s12, s12, s14
  buffer_store_dwordx4 v[56:59], v2, s[8:11], s12 offen
  s_add_u32 s14, s15, 8192
  s_and_b32 s13, s13, 1024
  s_add_u32 s14, s14, s13
  buffer_store_dwordx4 v[56:59], v2, s[8:11], s14 offen
ch_f_nwl:
  s_cmp_eq_u32 s3, 0
  s_cbranch_scc0 ch_f_npf
  s_cmp_gt_u32 s60, 61
  s_cbranch_scc1 ch_f_npf
  s_mul_i32 s12, s40, 20480
  s_add_u32 s12, s12, s95
  s_mul_i32 s13, s47, 163840
  s_add_u32 s12, s12, s13
  buffer_store_dwordx4 v[56:59], v2, s[8:11], s12 offen sc1
ch_f_npf:
  s_add_u32 s12, s55, 0
  buffer_load_dwordx4 a[144:147], v2, s[8:11], s12 offen offset:0 sc1
  buffer_load_dwordx4 a[148:151], v2, s[8:11], s12 offen offset:1024 sc1
  buffer_load_dwordx4 a[152:155], v2, s[8:11], s12 offen offset:2048 sc1
  buffer_load_dwordx4 a[156:159], v2, s[8:11], s12 offen offset:3072 sc1
  s_add_u32 s12, s55, 4096
  buffer_load_dwordx4 a[160:163], v2, s[8:11], s12 offen offset:0 sc1
  buffer_load_dwordx4 a[164:167], v2, s[8:11], s12 offen offset:1024 sc1
  buffer_load_dwordx4 a[168:171], v2, s[8:11], s12 offen offset:2048 sc1
  buffer_load_dwordx4 a[172:175], v2, s[8:11], s12 offen offset:3072 sc1
  s_add_u32 s55, s55, 262144
  s_bitset0_b32 s55, 21
  s_cmp_gt_u32 s60, 61
  s_cbranch_scc1 ch_f_wxlo
  s_cmp_eq_u32 s60, 61
  s_cbranch_scc1 ch_f_wnlo
  s_and_b32 s12, s24, 1
  s_mul_i32 s12, s12, 40960
  s_add_u32 s12, s12, 40960
  v_add_u32 v40, s12, v2
  s_and_b32 s26, s25, 1
  s_mul_i32 s26, s26, 40960
  s_add_u32 s26, s26, 40960
  ds_read_b128 v[96:99], v40 offset:0
  ds_read_b128 v[100:103], v40 offset:20480
  ds_read_b128 v[104:107], v40 offset:1024
  ds_read_b128 v[108:111], v40 offset:21504
  ds_read_b128 v[112:115], v40 offset:2048
  ds_read_b128 v[116:119], v40 offset:22528
  ds_read_b128 v[120:123], v40 offset:3072
  ds_read_b128 v[124:127], v40 offset:23552
  ds_read_b128 v[128:131], v40 offset:4096
  ds_read_b128 v[132:135], v40 offset:24576
  ds_read_b128 v[136:139], v40 offset:5120
  ds_read_b128 v[140:143], v40 offset:25600
  s_cmp_eq_u32 s3, 2
  s_cbranch_scc1 ch_f_tvloa
  s_waitcnt lgkmcnt(11)
  v_mfma_f32_16x16x32_bf16 v[144:147], a[0:3], v[96:99], 0
  ds_read_b128 v[96:99], v40 offset:6144
  s_waitcnt lgkmcnt(11)
  v_mfma_f32_16x16x32_bf16 v[148:151], a[0:3], v[100:103], 0
  ds_read_b128 v[100:103], v40 offset:26624
  s_add_u32 s12, s21, 0
  s_min_u32 s12, s12, 39936
  s_add_u32 m0, s12, s26
  s_add_u32 s12, s12, s20
  buffer_load_dwordx4 v2, s[8:11], s12 offen lds
  s_waitcnt lgkmcnt(11)
  v_mfma_f32_16x16x32_bf16 v[144:147], a[4:7], v[104:107], v[144:147]
  ds_read_b128 v[104:107], v40 offset:7168
  s_waitcnt lgkmcnt(11)
  v_mfma_f32_16x16x32_bf16 v[148:151], a[4:7], v[108:111], v[148:151]
  ds_read_b128 v[108:111], v40 offset:27648
  s_add_u32 s12, s21, 1024
  s_min_u32 s12, s12, 39936
  s_add_u32 m0, s12, s26
  s_add_u32 s12, s12, s20
  buffer_load_dwordx4 v2, s[8:11], s12 offen lds
  s_waitcnt lgkmcnt(11)
  v_mfma_f32_16x16x32_bf16 v[144:147], a[8:11], v[112:115], v[144:147]
  ds_read_b128 v[112:115], v40 offset:8192
  s_waitcnt lgkmcnt(11)
  v_mfma_f32_16x16x32_bf16 v[148:151], a[8:11], v[116:119], v[148:151]
  ds_read_b128 v[116:119], v40 offset:28672
  s_add_u32 s12, s21, 2048
  s_min_u32 s12, s12, 39936
  s_add_u32 m0, s12, s26
  s_add_u32 s12, s12, s20
  buffer_load_dwordx4 v2, s[8:11], s12 offen lds
  s_waitcnt lgkmcnt(11)
  v_mfma_f32_16x16x32_bf16 v[144:147], a[12:15], v[120:123], v[144:147]
  ds_read_b128 v[120:123], v40 offset:9216
  s_waitcnt lgkmcnt(11)
  v_mfma_f32_16x16x32_bf16 v[148:151], a[12:15], v[124:127], v[148:151]
  ds_read_b128 v[124:127], v40 offset:29696
  s_add_u32 s12, s21, 3072
  s_min_u32 s12, s12, 39936
  s_add_u32 m0, s12, s26
  s_add_u32 s12, s12, s20
  buffer_load_dwordx4 v2, s[8:11], s12 offen lds
  s_waitcnt lgkmcnt(11)
  v_mfma_f32_16x16x32_bf16 v[144:147], a[16:19], v[128:131], v[144:147]
  ds_read_b128 v[128:131], v40 offset:10240
  s_waitcnt lgkmcnt(11)
  v_mfma_f32_16x16x32_bf16 v[148:151], a[16:19], v[132:135], v[148:151]
  ds_read_b128 v[132:135], v40 offset:30720
  s_add_u32 s12, s21, 4096
  s_min_u32 s12, s12, 39936
  s_add_u32 m0, s12, s26
  s_add_u32 s12, s12, s20
  buffer_load_dwordx4 v2, s[8:11], s12 offen lds
  s_waitcnt lgkmcnt(11)
  v_mfma_f32_16x16x32_bf16 v[144:147], a[20:23], v[136:139], v[144:147]
  ds_read_b128 v[136:139], v40 offset:11264
  s_waitcnt lgkmcnt(11)
  v_mfma_f32_16x16x32_bf16 v[148:151], a[20:23], v[140:143], v[148:151]
  ds_read_b128 v[140:143], v40 offset:31744
  s_add_u32 s12, s21, 5120
  s_min_u32 s12, s12, 39936
  s_add_u32 m0, s12, s26
  s_add_u32 s12, s12, s20
  buffer_load_dwordx4 v2, s[8:11], s12 offen lds
  s_waitcnt lgkmcnt(11)
  v_mfma_f32_16x16x32_bf16 v[144:147], a[24:27], v[96:99], v[144:147]
  ds_read_b128 v[96:99], v40 offset:12288
  s_waitcnt lgkmcnt(11)
  v_mfma_f32_16x16x32_bf16 v[148:151], a[24:27], v[100:103], v[148:151]
  ds_read_b128 v[100:103], v40 offset:32768
  s_add_u32 s12, s21, 6144
  s_min_u32 s12, s12, 39936
  s_add_u32 m0, s12, s26
  s_add_u32 s12, s12, s20
  buffer_load_dwordx4 v2, s[8:11], s12 offen lds
  s_waitcnt lgkmcnt(11)
  v_mfma_f32_16x16x32_bf16 v[144:147], a[28:31], v[104:107], v[144:147]
  ds_read_b128 v[104:107], v40 offset:13312
  s_waitcnt lgkmcnt(11)
  v_mfma_f32_16x16x32_bf16 v[148:151], a[28:31], v[108:111], v[148:151]
  ds_read_b128 v[108:111], v40 offset:33792
  s_add_u32 s12, s21, 7168
  s_min_u32 s12, s12, 39936
  s_add_u32 m0, s12, s26
  s_add_u32 s12, s12, s20
  buffer_load_dwordx4 v2, s[8:11], s12 offen lds
  s_waitcnt lgkmcnt(11)
  v_mfma_f32_16x16x32_bf16 v[144:147], a[32:35], v[112:115], v[144:147]
  ds_read_b128 v[112:115], v40 offset:14336
  s_waitcnt lgkmcnt(11)
  v_mfma_f32_16x16x32_bf16 v[148:151], a[32:35], v[116:119], v[148:151]
  ds_read_b128 v[116:119], v40 offset:34816
  s_add_u32 s12, s21, 8192
  s_min_u32 s12, s12, 39936
  s_add_u32 m0, s12, s26
  s_add_u32 s12, s12, s20
  buffer_load_dwordx4 v2, s[8:11], s12 offen lds
  s_waitcnt lgkmcnt(11)
  v_mfma_f32_16x16x32_bf16 v[144:147], a[36:39], v[120:123], v[144:147]
  ds_read_b128 v[120:123], v40 offset:15360
  s_waitcnt lgkmcnt(11)
  v_mfma_f32_16x16x32_bf16 v[148:151], a[36:39], v[124:127], v[148:151]
  ds_read_b128 v[124:127], v40 offset:35840
  s_add_u32 s12, s21, 9216
  s_min_u32 s12, s12, 39936
  s_add_u32 m0, s12, s26
  s_add_u32 s12, s12, s20
  buffer_load_dwordx4 v2, s[8:11], s12 offen lds
  s_waitcnt lgkmcnt(11)
  v_mfma_f32_16x16x32_bf16 v[144:147], a[40:43], v[128:131], v[144:147]
  ds_read_b128 v[128:131], v40 offset:16384
  s_waitcnt lgkmcnt(11)
  v_mfma_f32_16x16x32_bf16 v[148:151], a[40:43], v[132:135], v[148:151]
  ds_read_b128 v[132:135], v40 offset:36864
  s_add_u32 s12, s21, 10240
  s_min_u32 s12, s12, 39936
  s_add_u32 m0, s12, s26
  s_add_u32 s12, s12, s20
  buffer_load_dwordx4 v2, s[8:11], s12 offen lds
  s_waitcnt lgkmcnt(11)
  v_mfma_f32_16x16x32_bf16 v[144:147], a[44:47], v[136:139], v[144:147]
  ds_read_b128 v[136:139], v40 offset:17408
  s_waitcnt lgkmcnt(11)
  v_mfma_f32_16x16x32_bf16 v[148:151], a[44:47], v[140:143], v[148:151]
  ds_read_b128 v[140:143], v40 offset:37888
  s_add_u32 s12, s21, 11264
  s_min_u32 s12, s12, 39936
  s_add_u32 m0, s12, s26
  s_add_u32 s12, s12, s20
  buffer_load_dwordx4 v2, s[8:11], s12 offen lds
  s_waitcnt lgkmcnt(11)
  v_mfma_f32_16x16x32_bf16 v[144:147], a[48:51], v[96:99], v[144:147]
  ds_read_b128 v[96:99], v40 offset:18432
  s_waitcnt lgkmcnt(11)
  v_mfma_f32_16x16x32_bf16 v[148:151], a[48:51], v[100:103], v[148:151]
  ds_read_b128 v[100:103], v40 offset:38912
  s_add_u32 s12, s21, 12288
  s_min_u32 s12, s12, 39936
  s_add_u32 m0, s12, s26
  s_add_u32 s12, s12, s20
  buffer_load_dwordx4 v2, s[8:11], s12 offen lds
  s_waitcnt lgkmcnt(11)
  v_mfma_f32_16x16x32_bf16 v[144:147], a[52:55], v[104:107], v[144:147]
  ds_read_b128 v[104:107], v40 offset:19456
  s_waitcnt lgkmcnt(11)
  v_mfma_f32_16x16x32_bf16 v[148:151], a[52:55], v[108:111], v[148:151]
  ds_read_b128 v[108:111], v40 offset:39936
  s_add_u32 s12, s21, 13312
  s_min_u32 s12, s12, 39936
  s_add_u32 m0, s12, s26
  s_add_u32 s12, s12, s20
  buffer_load_dwordx4 v2, s[8:11], s12 offen lds
  s_waitcnt lgkmcnt(11)
  v_mfma_f32_16x16x32_bf16 v[144:147], a[56:59], v[112:115], v[144:147]
  s_waitcnt lgkmcnt(10)
  v_mfma_f32_16x16x32_bf16 v[148:151], a[56:59], v[116:119], v[148:151]
  s_waitcnt lgkmcnt(9)
  v_mfma_f32_16x16x32_bf16 v[144:147], a[60:63], v[120:123], v[144:147]
  s_waitcnt lgkmcnt(8)
  v_mfma_f32_16x16x32_bf16 v[148:151], a[60:63], v[124:127], v[148:151]
  s_waitcnt lgkmcnt(7)
  v_mfma_f32_16x16x32_bf16 v[144:147], a[64:67], v[128:131], v[144:147]
  s_waitcnt lgkmcnt(6)
  v_mfma_f32_16x16x32_bf16 v[148:151], a[64:67], v[132:135], v[148:151]
  s_waitcnt lgkmcnt(5)
  v_mfma_f32_16x16x32_bf16 v[144:147], a[68:71], v[136:139], v[144:147]
  s_waitcnt lgkmcnt(4)
  v_mfma_f32_16x16x32_bf16 v[148:151], a[68:71], v[140:143], v[148:151]
  s_waitcnt lgkmcnt(3)
  v_mfma_f32_16x16x32_bf16 v[144:147], a[72:75], v[96:99], v[144:147]
  s_waitcnt lgkmcnt(2)
  v_mfma_f32_16x16x32_bf16 v[148:151], a[72:75], v[100:103], v[148:151]
  s_waitcnt lgkmcnt(1)
  v_mfma_f32_16x16x32_bf16 v[144:147], a[76:79], v[104:107], v[144:147]
  s_waitcnt lgkmcnt(0)
  v_mfma_f32_16x16x32_bf16 v[148:151], a[76:79], v[108:111], v[148:151]
  s_nop 7
  s_nop 7
  v_cvt_pk_bf16_f32 v152, v144, v145
  v_cvt_pk_bf16_f32 v153, v146, v147
  v_cvt_pk_bf16_f32 v154, v148, v149
  v_cvt_pk_bf16_f32 v155, v150, v151
  buffer_store_dwordx2 v[152:153], v42, s[8:11], s22 offen
  s_add_u32 s12, s22, 262144
  buffer_store_dwordx2 v[154:155], v42, s[8:11], s12 offen
  s_branch ch_f_teloa
ch_f_tvloa:
  s_waitcnt lgkmcnt(11)
  v_mfma_f32_16x16x32_bf16 v[144:147], v[96:99], a[0:3], 0
  ds_read_b128 v[96:99], v40 offset:6144
  s_waitcnt lgkmcnt(11)
  v_mfma_f32_16x16x32_bf16 v[148:151], v[100:103], a[0:3], 0
  ds_read_b128 v[100:103], v40 offset:26624
  s_add_u32 s12, s21, 0
  s_min_u32 s12, s12, 39936
  s_add_u32 m0, s12, s26
  s_add_u32 s12, s12, s20
  buffer_load_dwordx4 v2, s[8:11], s12 offen lds
  s_waitcnt lgkmcnt(11)
  v_mfma_f32_16x16x32_bf16 v[144:147], v[104:107], a[4:7], v[144:147]
  ds_read_b128 v[104:107], v40 offset:7168
  s_waitcnt lgkmcnt(11)
  v_mfma_f32_16x16x32_bf16 v[148:151], v[108:111], a[4:7], v[148:151]
  ds_read_b128 v[108:111], v40 offset:27648
  s_add_u32 s12, s21, 1024
  s_min_u32 s12, s12, 39936
  s_add_u32 m0, s12, s26
  s_add_u32 s12, s12, s20
  buffer_load_dwordx4 v2, s[8:11], s12 offen lds
  s_waitcnt lgkmcnt(11)
  v_mfma_f32_16x16x32_bf16 v[144:147], v[112:115], a[8:11], v[144:147]
  ds_read_b128 v[112:115], v40 offset:8192
  s_waitcnt lgkmcnt(11)
  v_mfma_f32_16x16x32_bf16 v[148:151], v[116:119], a[8:11], v[148:151]
  ds_read_b128 v[116:119], v40 offset:28672
  s_add_u32 s12, s21, 2048
  s_min_u32 s12, s12, 39936
  s_add_u32 m0, s12, s26
  s_add_u32 s12, s12, s20
  buffer_load_dwordx4 v2, s[8:11], s12 offen lds
  s_waitcnt lgkmcnt(11)
  v_mfma_f32_16x16x32_bf16 v[144:147], v[120:123], a[12:15], v[144:147]
  ds_read_b128 v[120:123], v40 offset:9216
  s_waitcnt lgkmcnt(11)
  v_mfma_f32_16x16x32_bf16 v[148:151], v[124:127], a[12:15], v[148:151]
  ds_read_b128 v[124:127], v40 offset:29696
  s_add_u32 s12, s21, 3072
  s_min_u32 s12, s12, 39936
  s_add_u32 m0, s12, s26
  s_add_u32 s12, s12, s20
  buffer_load_dwordx4 v2, s[8:11], s12 offen lds
  s_waitcnt lgkmcnt(11)
  v_mfma_f32_16x16x32_bf16 v[144:147], v[128:131], a[16:19], v[144:147]
  ds_read_b128 v[128:131], v40 offset:10240
  s_waitcnt lgkmcnt(11)
  v_mfma_f32_16x16x32_bf16 v[148:151], v[132:135], a[16:19], v[148:151]
  ds_read_b128 v[132:135], v40 offset:30720
  s_add_u32 s12, s21, 4096
  s_min_u32 s12, s12, 39936
  s_add_u32 m0, s12, s26
  s_add_u32 s12, s12, s20
  buffer_load_dwordx4 v2, s[8:11], s12 offen lds
  s_waitcnt lgkmcnt(11)
  v_mfma_f32_16x16x32_bf16 v[144:147], v[136:139], a[20:23], v[144:147]
  ds_read_b128 v[136:139], v40 offset:11264
  s_waitcnt lgkmcnt(11)
  v_mfma_f32_16x16x32_bf16 v[148:151], v[140:143], a[20:23], v[148:151]
  ds_read_b128 v[140:143], v40 offset:31744
  s_add_u32 s12, s21, 5120
  s_min_u32 s12, s12, 39936
  s_add_u32 m0, s12, s26
  s_add_u32 s12, s12, s20
  buffer_load_dwordx4 v2, s[8:11], s12 offen lds
  s_waitcnt lgkmcnt(11)
  v_mfma_f32_16x16x32_bf16 v[144:147], v[96:99], a[24:27], v[144:147]
  ds_read_b128 v[96:99], v40 offset:12288
  s_waitcnt lgkmcnt(11)
  v_mfma_f32_16x16x32_bf16 v[148:151], v[100:103], a[24:27], v[148:151]
  ds_read_b128 v[100:103], v40 offset:32768
  s_add_u32 s12, s21, 6144
  s_min_u32 s12, s12, 39936
  s_add_u32 m0, s12, s26
  s_add_u32 s12, s12, s20
  buffer_load_dwordx4 v2, s[8:11], s12 offen lds
  s_waitcnt lgkmcnt(11)
  v_mfma_f32_16x16x32_bf16 v[144:147], v[104:107], a[28:31], v[144:147]
  ds_read_b128 v[104:107], v40 offset:13312
  s_waitcnt lgkmcnt(11)
  v_mfma_f32_16x16x32_bf16 v[148:151], v[108:111], a[28:31], v[148:151]
  ds_read_b128 v[108:111], v40 offset:33792
  s_add_u32 s12, s21, 7168
  s_min_u32 s12, s12, 39936
  s_add_u32 m0, s12, s26
  s_add_u32 s12, s12, s20
  buffer_load_dwordx4 v2, s[8:11], s12 offen lds
  s_waitcnt lgkmcnt(11)
  v_mfma_f32_16x16x32_bf16 v[144:147], v[112:115], a[32:35], v[144:147]
  ds_read_b128 v[112:115], v40 offset:14336
  s_waitcnt lgkmcnt(11)
  v_mfma_f32_16x16x32_bf16 v[148:151], v[116:119], a[32:35], v[148:151]
  ds_read_b128 v[116:119], v40 offset:34816
  s_add_u32 s12, s21, 8192
  s_min_u32 s12, s12, 39936
  s_add_u32 m0, s12, s26
  s_add_u32 s12, s12, s20
  buffer_load_dwordx4 v2, s[8:11], s12 offen lds
  s_waitcnt lgkmcnt(11)
  v_mfma_f32_16x16x32_bf16 v[144:147], v[120:123], a[36:39], v[144:147]
  ds_read_b128 v[120:123], v40 offset:15360
  s_waitcnt lgkmcnt(11)
  v_mfma_f32_16x16x32_bf16 v[148:151], v[124:127], a[36:39], v[148:151]
  ds_read_b128 v[124:127], v40 offset:35840
  s_add_u32 s12, s21, 9216
  s_min_u32 s12, s12, 39936
  s_add_u32 m0, s12, s26
  s_add_u32 s12, s12, s20
  buffer_load_dwordx4 v2, s[8:11], s12 offen lds
  s_waitcnt lgkmcnt(11)
  v_mfma_f32_16x16x32_bf16 v[144:147], v[128:131], a[40:43], v[144:147]
  ds_read_b128 v[128:131], v40 offset:16384
  s_waitcnt lgkmcnt(11)
  v_mfma_f32_16x16x32_bf16 v[148:151], v[132:135], a[40:43], v[148:151]
  ds_read_b128 v[132:135], v40 offset:36864
  s_add_u32 s12, s21, 10240
  s_min_u32 s12, s12, 39936
  s_add_u32 m0, s12, s26
  s_add_u32 s12, s12, s20
  buffer_load_dwordx4 v2, s[8:11], s12 offen lds
  s_waitcnt lgkmcnt(11)
  v_mfma_f32_16x16x32_bf16 v[144:147], v[136:139], a[44:47], v[144:147]
  ds_read_b128 v[136:139], v40 offset:17408
  s_waitcnt lgkmcnt(11)
  v_mfma_f32_16x16x32_bf16 v[148:151], v[140:143], a[44:47], v[148:151]
  ds_read_b128 v[140:143], v40 offset:37888
  s_add_u32 s12, s21, 11264
  s_min_u32 s12, s12, 39936
  s_add_u32 m0, s12, s26
  s_add_u32 s12, s12, s20
  buffer_load_dwordx4 v2, s[8:11], s12 offen lds
  s_waitcnt lgkmcnt(11)
  v_mfma_f32_16x16x32_bf16 v[144:147], v[96:99], a[48:51], v[144:147]
  ds_read_b128 v[96:99], v40 offset:18432
  s_waitcnt lgkmcnt(11)
  v_mfma_f32_16x16x32_bf16 v[148:151], v[100:103], a[48:51], v[148:151]
  ds_read_b128 v[100:103], v40 offset:38912
  s_add_u32 s12, s21, 12288
  s_min_u32 s12, s12, 39936
  s_add_u32 m0, s12, s26
  s_add_u32 s12, s12, s20
  buffer_load_dwordx4 v2, s[8:11], s12 offen lds
  s_waitcnt lgkmcnt(11)
  v_mfma_f32_16x16x32_bf16 v[144:147], v[104:107], a[52:55], v[144:147]
  ds_read_b128 v[104:107], v40 offset:19456
  s_waitcnt lgkmcnt(11)
  v_mfma_f32_16x16x32_bf16 v[148:151], v[108:111], a[52:55], v[148:151]
  ds_read_b128 v[108:111], v40 offset:39936
  s_add_u32 s12, s21, 13312
  s_min_u32 s12, s12, 39936
  s_add_u32 m0, s12, s26
  s_add_u32 s12, s12, s20
  buffer_load_dwordx4 v2, s[8:11], s12 offen lds
  s_waitcnt lgkmcnt(11)
  v_mfma_f32_16x16x32_bf16 v[144:147], v[112:115], a[56:59], v[144:147]
  s_waitcnt lgkmcnt(10)
  v_mfma_f32_16x16x32_bf16 v[148:151], v[116:119], a[56:59], v[148:151]
  s_waitcnt lgkmcnt(9)
  v_mfma_f32_16x16x32_bf16 v[144:147], v[120:123], a[60:63], v[144:147]
  s_waitcnt lgkmcnt(8)
  v_mfma_f32_16x16x32_bf16 v[148:151], v[124:127], a[60:63], v[148:151]
  s_waitcnt lgkmcnt(7)
  v_mfma_f32_16x16x32_bf16 v[144:147], v[128:131], a[64:67], v[144:147]
  s_waitcnt lgkmcnt(6)
  v_mfma_f32_16x16x32_bf16 v[148:151], v[132:135], a[64:67], v[148:151]
  s_waitcnt lgkmcnt(5)
  v_mfma_f32_16x16x32_bf16 v[144:147], v[136:139], a[68:71], v[144:147]
  s_waitcnt lgkmcnt(4)
  v_mfma_f32_16x16x32_bf16 v[148:151], v[140:143], a[68:71], v[148:151]
  s_waitcnt lgkmcnt(3)
  v_mfma_f32_16x16x32_bf16 v[144:147], v[96:99], a[72:75], v[144:147]
  s_waitcnt lgkmcnt(2)
  v_mfma_f32_16x16x32_bf16 v[148:151], v[100:103], a[72:75], v[148:151]
  s_waitcnt lgkmcnt(1)
  v_mfma_f32_16x16x32_bf16 v[144:147], v[104:107], a[76:79], v[144:147]
  s_waitcnt lgkmcnt(0)
  v_mfma_f32_16x16x32_bf16 v[148:151], v[108:111], a[76:79], v[148:151]
  s_nop 7
  s_nop 7
  v_cvt_pk_bf16_f32 v152, v144, v145
  v_cvt_pk_bf16_f32 v153, v146, v147
  v_cvt_pk_bf16_f32 v154, v148, v149
  v_cvt_pk_bf16_f32 v155, v150, v151
  buffer_store_dwordx4 v[152:155], v2, s[8:11], s23 offen
ch_f_teloa:
  s_add_u32 s22, s22, 524288
  s_add_u32 s23, s23, 262144
  s_add_u32 s24, s24, 1
  s_bitset0_b32 s22, 22
  s_bitset0_b32 s23, 21
  s_add_u32 s20, s20, 40960
  s_add_u32 s25, s25, 1
  s_branch ch_f_wxlo
ch_f_wnlo:
  s_and_b32 s12, s24, 1
  s_mul_i32 s12, s12, 40960
  s_add_u32 s12, s12, 40960
  v_add_u32 v40, s12, v2
  ds_read_b128 v[96:99], v40 offset:0
  ds_read_b128 v[100:103], v40 offset:20480
  ds_read_b128 v[104:107], v40 offset:1024
  ds_read_b128 v[108:111], v40 offset:21504
  ds_read_b128 v[112:115], v40 offset:2048
  ds_read_b128 v[116:119], v40 offset:22528
  ds_read_b128 v[120:123], v40 offset:3072
  ds_read_b128 v[124:127], v40 offset:23552
  ds_read_b128 v[128:131], v40 offset:4096
  ds_read_b128 v[132:135], v40 offset:24576
  ds_read_b128 v[136:139], v40 offset:5120
  ds_read_b128 v[140:143], v40 offset:25600
  s_cmp_eq_u32 s3, 2
  s_cbranch_scc1 ch_f_tvlob
  s_waitcnt lgkmcnt(11)
  v_mfma_f32_16x16x32_bf16 v[144:147], a[0:3], v[96:99], 0
  ds_read_b128 v[96:99], v40 offset:6144
  s_waitcnt lgkmcnt(11)
  v_mfma_f32_16x16x32_bf16 v[148:151], a[0:3], v[100:103], 0
  ds_read_b128 v[100:103], v40 offset:26624
  s_waitcnt lgkmcnt(11)
  v_mfma_f32_16x16x32_bf16 v[144:147], a[4:7], v[104:107], v[144:147]
  ds_read_b128 v[104:107], v40 offset:7168
  s_waitcnt lgkmcnt(11)
  v_mfma_f32_16x16x32_bf16 v[148:151], a[4:7], v[108:111], v[148:151]
  ds_read_b128 v[108:111], v40 offset:27648
  s_waitcnt lgkmcnt(11)
  v_mfma_f32_16x16x32_bf16 v[144:147], a[8:11], v[112:115], v[144:147]
  ds_read_b128 v[112:115], v40 offset:8192
  s_waitcnt lgkmcnt(11)
  v_mfma_f32_16x16x32_bf16 v[148:151], a[8:11], v[116:119], v[148:151]
  ds_read_b128 v[116:119], v40 offset:28672
  s_waitcnt lgkmcnt(11)
  v_mfma_f32_16x16x32_bf16 v[144:147], a[12:15], v[120:123], v[144:147]
  ds_read_b128 v[120:123], v40 offset:9216
  s_waitcnt lgkmcnt(11)
  v_mfma_f32_16x16x32_bf16 v[148:151], a[12:15], v[124:127], v[148:151]
  ds_read_b128 v[124:127], v40 offset:29696
  s_waitcnt lgkmcnt(11)
  v_mfma_f32_16x16x32_bf16 v[144:147], a[16:19], v[128:131], v[144:147]
  ds_read_b128 v[128:131], v40 offset:10240
  s_waitcnt lgkmcnt(11)
  v_mfma_f32_16x16x32_bf16 v[148:151], a[16:19], v[132:135], v[148:151]
  ds_read_b128 v[132:135], v40 offset:30720
  s_waitcnt lgkmcnt(11)
  v_mfma_f32_16x16x32_bf16 v[144:147], a[20:23], v[136:139], v[144:147]
  ds_read_b128 v[136:139], v40 offset:11264
  s_waitcnt lgkmcnt(11)
  v_mfma_f32_16x16x32_bf16 v[148:151], a[20:23], v[140:143], v[148:151]
  ds_read_b128 v[140:143], v40 offset:31744
  s_waitcnt lgkmcnt(11)
  v_mfma_f32_16x16x32_bf16 v[144:147], a[24:27], v[96:99], v[144:147]
  ds_read_b128 v[96:99], v40 offset:12288
  s_waitcnt lgkmcnt(11)
  v_mfma_f32_16x16x32_bf16 v[148:151], a[24:27], v[100:103], v[148:151]
  ds_read_b128 v[100:103], v40 offset:32768
  s_waitcnt lgkmcnt(11)
  v_mfma_f32_16x16x32_bf16 v[144:147], a[28:31], v[104:107], v[144:147]
  ds_read_b128 v[104:107], v40 offset:13312
  s_waitcnt lgkmcnt(11)
  v_mfma_f32_16x16x32_bf16 v[148:151], a[28:31], v[108:111], v[148:151]
  ds_read_b128 v[108:111], v40 offset:33792
  s_waitcnt lgkmcnt(11)
  v_mfma_f32_16x16x32_bf16 v[144:147], a[32:35], v[112:115], v[144:147]
  ds_read_b128 v[112:115], v40 offset:14336
  s_waitcnt lgkmcnt(11)
  v_mfma_f32_16x16x32_bf16 v[148:151], a[32:35], v[116:119], v[148:151]
  ds_read_b128 v[116:119], v40 offset:34816
  s_waitcnt lgkmcnt(11)
  v_mfma_f32_16x16x32_bf16 v[144:147], a[36:39], v[120:123], v[144:147]
  ds_read_b128 v[120:123], v40 offset:15360
  s_waitcnt lgkmcnt(11)
  v_mfma_f32_16x16x32_bf16 v[148:151], a[36:39], v[124:127], v[148:151]
  ds_read_b128 v[124:127], v40 offset:35840
  s_waitcnt lgkmcnt(11)
  v_mfma_f32_16x16x32_bf16 v[144:147], a[40:43], v[128:131], v[144:147]
  ds_read_b128 v[128:131], v40 offset:16384
  s_waitcnt lgkmcnt(11)
  v_mfma_f32_16x16x32_bf16 v[148:151], a[40:43], v[132:135], v[148:151]
  ds_read_b128 v[132:135], v40 offset:36864
  s_waitcnt lgkmcnt(11)
  v_mfma_f32_16x16x32_bf16 v[144:147], a[44:47], v[136:139], v[144:147]
  ds_read_b128 v[136:139], v40 offset:17408
  s_waitcnt lgkmcnt(11)
  v_mfma_f32_16x16x32_bf16 v[148:151], a[44:47], v[140:143], v[148:151]
  ds_read_b128 v[140:143], v40 offset:37888
  s_waitcnt lgkmcnt(11)
  v_mfma_f32_16x16x32_bf16 v[144:147], a[48:51], v[96:99], v[144:147]
  ds_read_b128 v[96:99], v40 offset:18432
  s_waitcnt lgkmcnt(11)
  v_mfma_f32_16x16x32_bf16 v[148:151], a[48:51], v[100:103], v[148:151]
  ds_read_b128 v[100:103], v40 offset:38912
  s_waitcnt lgkmcnt(11)
  v_mfma_f32_16x16x32_bf16 v[144:147], a[52:55], v[104:107], v[144:147]
  ds_read_b128 v[104:107], v40 offset:19456
  s_waitcnt lgkmcnt(11)
  v_mfma_f32_16x16x32_bf16 v[148:151], a[52:55], v[108:111], v[148:151]
  ds_read_b128 v[108:111], v40 offset:39936
  s_waitcnt lgkmcnt(11)
  v_mfma_f32_16x16x32_bf16 v[144:147], a[56:59], v[112:115], v[144:147]
  s_waitcnt lgkmcnt(10)
  v_mfma_f32_16x16x32_bf16 v[148:151], a[56:59], v[116:119], v[148:151]
  s_waitcnt lgkmcnt(9)
  v_mfma_f32_16x16x32_bf16 v[144:147], a[60:63], v[120:123], v[144:147]
  s_waitcnt lgkmcnt(8)
  v_mfma_f32_16x16x32_bf16 v[148:151], a[60:63], v[124:127], v[148:151]
  s_waitcnt lgkmcnt(7)
  v_mfma_f32_16x16x32_bf16 v[144:147], a[64:67], v[128:131], v[144:147]
  s_waitcnt lgkmcnt(6)
  v_mfma_f32_16x16x32_bf16 v[148:151], a[64:67], v[132:135], v[148:151]
  s_waitcnt lgkmcnt(5)
  v_mfma_f32_16x16x32_bf16 v[144:147], a[68:71], v[136:139], v[144:147]
  s_waitcnt lgkmcnt(4)
  v_mfma_f32_16x16x32_bf16 v[148:151], a[68:71], v[140:143], v[148:151]
  s_waitcnt lgkmcnt(3)
  v_mfma_f32_16x16x32_bf16 v[144:147], a[72:75], v[96:99], v[144:147]
  s_waitcnt lgkmcnt(2)
  v_mfma_f32_16x16x32_bf16 v[148:151], a[72:75], v[100:103], v[148:151]
  s_waitcnt lgkmcnt(1)
  v_mfma_f32_16x16x32_bf16 v[144:147], a[76:79], v[104:107], v[144:147]
  s_waitcnt lgkmcnt(0)
  v_mfma_f32_16x16x32_bf16 v[148:151], a[76:79], v[108:111], v[148:151]
  s_nop 7
  s_nop 7
  v_cvt_pk_bf16_f32 v152, v144, v145
  v_cvt_pk_bf16_f32 v153, v146, v147
  v_cvt_pk_bf16_f32 v154, v148, v149
  v_cvt_pk_bf16_f32 v155, v150, v151
  buffer_store_dwordx2 v[152:153], v42, s[8:11], s22 offen
  s_add_u32 s12, s22, 262144
  buffer_store_dwordx2 v[154:155], v42, s[8:11], s12 offen
  s_branch ch_f_telob
ch_f_tvlob:
  s_waitcnt lgkmcnt(11)
  v_mfma_f32_16x16x32_bf16 v[144:147], v[96:99], a[0:3], 0
  ds_read_b128 v[96:99], v40 offset:6144
  s_waitcnt lgkmcnt(11)
  v_mfma_f32_16x16x32_bf16 v[148:151], v[100:103], a[0:3], 0
  ds_read_b128 v[100:103], v40 offset:26624
  s_waitcnt lgkmcnt(11)
  v_mfma_f32_16x16x32_bf16 v[144:147], v[104:107], a[4:7], v[144:147]
  ds_read_b128 v[104:107], v40 offset:7168
  s_waitcnt lgkmcnt(11)
  v_mfma_f32_16x16x32_bf16 v[148:151], v[108:111], a[4:7], v[148:151]
  ds_read_b128 v[108:111], v40 offset:27648
  s_waitcnt lgkmcnt(11)
  v_mfma_f32_16x16x32_bf16 v[144:147], v[112:115], a[8:11], v[144:147]
  ds_read_b128 v[112:115], v40 offset:8192
  s_waitcnt lgkmcnt(11)
  v_mfma_f32_16x16x32_bf16 v[148:151], v[116:119], a[8:11], v[148:151]
  ds_read_b128 v[116:119], v40 offset:28672
  s_waitcnt lgkmcnt(11)
  v_mfma_f32_16x16x32_bf16 v[144:147], v[120:123], a[12:15], v[144:147]
  ds_read_b128 v[120:123], v40 offset:9216
  s_waitcnt lgkmcnt(11)
  v_mfma_f32_16x16x32_bf16 v[148:151], v[124:127], a[12:15], v[148:151]
  ds_read_b128 v[124:127], v40 offset:29696
  s_waitcnt lgkmcnt(11)
  v_mfma_f32_16x16x32_bf16 v[144:147], v[128:131], a[16:19], v[144:147]
  ds_read_b128 v[128:131], v40 offset:10240
  s_waitcnt lgkmcnt(11)
  v_mfma_f32_16x16x32_bf16 v[148:151], v[132:135], a[16:19], v[148:151]
  ds_read_b128 v[132:135], v40 offset:30720
  s_waitcnt lgkmcnt(11)
  v_mfma_f32_16x16x32_bf16 v[144:147], v[136:139], a[20:23], v[144:147]
  ds_read_b128 v[136:139], v40 offset:11264
  s_waitcnt lgkmcnt(11)
  v_mfma_f32_16x16x32_bf16 v[148:151], v[140:143], a[20:23], v[148:151]
  ds_read_b128 v[140:143], v40 offset:31744
  s_waitcnt lgkmcnt(11)
  v_mfma_f32_16x16x32_bf16 v[144:147], v[96:99], a[24:27], v[144:147]
  ds_read_b128 v[96:99], v40 offset:12288
  s_waitcnt lgkmcnt(11)
  v_mfma_f32_16x16x32_bf16 v[148:151], v[100:103], a[24:27], v[148:151]
  ds_read_b128 v[100:103], v40 offset:32768
  s_waitcnt lgkmcnt(11)
  v_mfma_f32_16x16x32_bf16 v[144:147], v[104:107], a[28:31], v[144:147]
  ds_read_b128 v[104:107], v40 offset:13312
  s_waitcnt lgkmcnt(11)
  v_mfma_f32_16x16x32_bf16 v[148:151], v[108:111], a[28:31], v[148:151]
  ds_read_b128 v[108:111], v40 offset:33792
  s_waitcnt lgkmcnt(11)
  v_mfma_f32_16x16x32_bf16 v[144:147], v[112:115], a[32:35], v[144:147]
  ds_read_b128 v[112:115], v40 offset:14336
  s_waitcnt lgkmcnt(11)
  v_mfma_f32_16x16x32_bf16 v[148:151], v[116:119], a[32:35], v[148:151]
  ds_read_b128 v[116:119], v40 offset:34816
  s_waitcnt lgkmcnt(11)
  v_mfma_f32_16x16x32_bf16 v[144:147], v[120:123], a[36:39], v[144:147]
  ds_read_b128 v[120:123], v40 offset:15360
  s_waitcnt lgkmcnt(11)
  v_mfma_f32_16x16x32_bf16 v[148:151], v[124:127], a[36:39], v[148:151]
  ds_read_b128 v[124:127], v40 offset:35840
  s_waitcnt lgkmcnt(11)
  v_mfma_f32_16x16x32_bf16 v[144:147], v[128:131], a[40:43], v[144:147]
  ds_read_b128 v[128:131], v40 offset:16384
  s_waitcnt lgkmcnt(11)
  v_mfma_f32_16x16x32_bf16 v[148:151], v[132:135], a[40:43], v[148:151]
  ds_read_b128 v[132:135], v40 offset:36864
  s_waitcnt lgkmcnt(11)
  v_mfma_f32_16x16x32_bf16 v[144:147], v[136:139], a[44:47], v[144:147]
  ds_read_b128 v[136:139], v40 offset:17408
  s_waitcnt lgkmcnt(11)
  v_mfma_f32_16x16x32_bf16 v[148:151], v[140:143], a[44:47], v[148:151]
  ds_read_b128 v[140:143], v40 offset:37888
  s_waitcnt lgkmcnt(11)
  v_mfma_f32_16x16x32_bf16 v[144:147], v[96:99], a[48:51], v[144:147]
  ds_read_b128 v[96:99], v40 offset:18432
  s_waitcnt lgkmcnt(11)
  v_mfma_f32_16x16x32_bf16 v[148:151], v[100:103], a[48:51], v[148:151]
  ds_read_b128 v[100:103], v40 offset:38912
  s_waitcnt lgkmcnt(11)
  v_mfma_f32_16x16x32_bf16 v[144:147], v[104:107], a[52:55], v[144:147]
  ds_read_b128 v[104:107], v40 offset:19456
  s_waitcnt lgkmcnt(11)
  v_mfma_f32_16x16x32_bf16 v[148:151], v[108:111], a[52:55], v[148:151]
  ds_read_b128 v[108:111], v40 offset:39936
  s_waitcnt lgkmcnt(11)
  v_mfma_f32_16x16x32_bf16 v[144:147], v[112:115], a[56:59], v[144:147]
  s_waitcnt lgkmcnt(10)
  v_mfma_f32_16x16x32_bf16 v[148:151], v[116:119], a[56:59], v[148:151]
  s_waitcnt lgkmcnt(9)
  v_mfma_f32_16x16x32_bf16 v[144:147], v[120:123], a[60:63], v[144:147]
  s_waitcnt lgkmcnt(8)
  v_mfma_f32_16x16x32_bf16 v[148:151], v[124:127], a[60:63], v[148:151]
  s_waitcnt lgkmcnt(7)
  v_mfma_f32_16x16x32_bf16 v[144:147], v[128:131], a[64:67], v[144:147]
  s_waitcnt lgkmcnt(6)
  v_mfma_f32_16x16x32_bf16 v[148:151], v[132:135], a[64:67], v[148:151]
  s_waitcnt lgkmcnt(5)
  v_mfma_f32_16x16x32_bf16 v[144:147], v[136:139], a[68:71], v[144:147]
  s_waitcnt lgkmcnt(4)
  v_mfma_f32_16x16x32_bf16 v[148:151], v[140:143], a[68:71], v[148:151]
  s_waitcnt lgkmcnt(3)
  v_mfma_f32_16x16x32_bf16 v[144:147], v[96:99], a[72:75], v[144:147]
  s_waitcnt lgkmcnt(2)
  v_mfma_f32_16x16x32_bf16 v[148:151], v[100:103], a[72:75], v[148:151]
  s_waitcnt lgkmcnt(1)
  v_mfma_f32_16x16x32_bf16 v[144:147], v[104:107], a[76:79], v[144:147]
  s_waitcnt lgkmcnt(0)
  v_mfma_f32_16x16x32_bf16 v[148:151], v[108:111], a[76:79], v[148:151]
  s_nop 7
  s_nop 7
  v_cvt_pk_bf16_f32 v152, v144, v145
  v_cvt_pk_bf16_f32 v153, v146, v147
  v_cvt_pk_bf16_f32 v154, v148, v149
  v_cvt_pk_bf16_f32 v155, v150, v151
  buffer_store_dwordx4 v[152:155], v2, s[8:11], s23 offen
ch_f_telob:
  s_add_u32 s22, s22, 524288
  s_add_u32 s23, s23, 262144
  s_add_u32 s24, s24, 1
  s_bitset0_b32 s22, 22
  s_bitset0_b32 s23, 21
ch_f_wxlo:
ch_f_next:
  s_add_u32 s60, s60, 1
  s_branch ch_f_loop
ch_f_end:
  s_endpgm
ch_f_hi:
  s_cmp_eq_u32 s3, 3
  s_cbranch_scc1 ch_f_hi3
  s_sleep 32
  s_cmp_gt_u32 s60, 61
  s_cbranch_scc1 ch_f_wxhi
  s_cmp_eq_u32 s60, 61
  s_cbranch_scc1 ch_f_wnhi
  s_and_b32 s12, s24, 1
  s_mul_i32 s12, s12, 40960
  s_add_u32 s12, s12, 40960
  v_add_u32 v40, s12, v2
  s_and_b32 s26, s25, 1
  s_mul_i32 s26, s26, 40960
  s_add_u32 s26, s26, 40960
  ds_read_b128 v[96:99], v40 offset:0
  ds_read_b128 v[100:103], v40 offset:20480
  ds_read_b128 v[104:107], v40 offset:1024
  ds_read_b128 v[108:111], v40 offset:21504
  ds_read_b128 v[112:115], v40 offset:2048
  ds_read_b128 v[116:119], v40 offset:22528
  ds_read_b128 v[120:123], v40 offset:3072
  ds_read_b128 v[124:127], v40 offset:23552
  ds_read_b128 v[128:131], v40 offset:4096
  ds_read_b128 v[132:135], v40 offset:24576
  ds_read_b128 v[136:139], v40 offset:5120
  ds_read_b128 v[140:143], v40 offset:25600
  s_cmp_eq_u32 s3, 2
  s_cbranch_scc1 ch_f_tvhia
  s_waitcnt lgkmcnt(11)
  v_mfma_f32_16x16x32_bf16 v[144:147], a[0:3], v[96:99], 0
  ds_read_b128 v[96:99], v40 offset:6144
  s_waitcnt lgkmcnt(11)
  v_mfma_f32_16x16x32_bf16 v[148:151], a[0:3], v[100:103], 0
  ds_read_b128 v[100:103], v40 offset:26624
  s_add_u32 s12, s21, 0
  s_min_u32 s12, s12, 39936
  s_add_u32 m0, s12, s26
  s_add_u32 s12, s12, s20
  buffer_load_dwordx4 v2, s[8:11], s12 offen lds
  s_waitcnt lgkmcnt(11)
  v_mfma_f32_16x16x32_bf16 v[144:147], a[4:7], v[104:107], v[144:147]
  ds_read_b128 v[104:107], v40 offset:7168
  s_waitcnt lgkmcnt(11)
  v_mfma_f32_16x16x32_bf16 v[148:151], a[4:7], v[108:111], v[148:151]
  ds_read_b128 v[108:111], v40 offset:27648
  s_add_u32 s12, s21, 1024
  s_min_u32 s12, s12, 39936
  s_add_u32 m0, s12, s26
  s_add_u32 s12, s12, s20
  buffer_load_dwordx4 v2, s[8:11], s12 offen lds
  s_waitcnt lgkmcnt(11)
  v_mfma_f32_16x16x32_bf16 v[144:147], a[8:11], v[112:115], v[144:147]
  ds_read_b128 v[112:115], v40 offset:8192
  s_waitcnt lgkmcnt(11)
  v_mfma_f32_16x16x32_bf16 v[148:151], a[8:11], v[116:119], v[148:151]
  ds_read_b128 v[116:119], v40 offset:28672
  s_add_u32 s12, s21, 2048
  s_min_u32 s12, s12, 39936
  s_add_u32 m0, s12, s26
  s_add_u32 s12, s12, s20
  buffer_load_dwordx4 v2, s[8:11], s12 offen lds
  s_waitcnt lgkmcnt(11)
  v_mfma_f32_16x16x32_bf16 v[144:147], a[12:15], v[120:123], v[144:147]
  ds_read_b128 v[120:123], v40 offset:9216
  s_waitcnt lgkmcnt(11)
  v_mfma_f32_16x16x32_bf16 v[148:151], a[12:15], v[124:127], v[148:151]
  ds_read_b128 v[124:127], v40 offset:29696
  s_add_u32 s12, s21, 3072
  s_min_u32 s12, s12, 39936
  s_add_u32 m0, s12, s26
  s_add_u32 s12, s12, s20
  buffer_load_dwordx4 v2, s[8:11], s12 offen lds
  s_waitcnt lgkmcnt(11)
  v_mfma_f32_16x16x32_bf16 v[144:147], a[16:19], v[128:131], v[144:147]
  ds_read_b128 v[128:131], v40 offset:10240
  s_waitcnt lgkmcnt(11)
  v_mfma_f32_16x16x32_bf16 v[148:151], a[16:19], v[132:135], v[148:151]
  ds_read_b128 v[132:135], v40 offset:30720
  s_add_u32 s12, s21, 4096
  s_min_u32 s12, s12, 39936
  s_add_u32 m0, s12, s26
  s_add_u32 s12, s12, s20
  buffer_load_dwordx4 v2, s[8:11], s12 offen lds
  s_waitcnt lgkmcnt(11)
  v_mfma_f32_16x16x32_bf16 v[144:147], a[20:23], v[136:139], v[144:147]
  ds_read_b128 v[136:139], v40 offset:11264
  s_waitcnt lgkmcnt(11)
  v_mfma_f32_16x16x32_bf16 v[148:151], a[20:23], v[140:143], v[148:151]
  ds_read_b128 v[140:143], v40 offset:31744
  s_add_u32 s12, s21, 5120
  s_min_u32 s12, s12, 39936
  s_add_u32 m0, s12, s26
  s_add_u32 s12, s12, s20
  buffer_load_dwordx4 v2, s[8:11], s12 offen lds
  s_waitcnt lgkmcnt(11)
  v_mfma_f32_16x16x32_bf16 v[144:147], a[24:27], v[96:99], v[144:147]
  ds_read_b128 v[96:99], v40 offset:12288
  s_waitcnt lgkmcnt(11)
  v_mfma_f32_16x16x32_bf16 v[148:151], a[24:27], v[100:103], v[148:151]
  ds_read_b128 v[100:103], v40 offset:32768
  s_add_u32 s12, s21, 6144
  s_min_u32 s12, s12, 39936
  s_add_u32 m0, s12, s26
  s_add_u32 s12, s12, s20
  buffer_load_dwordx4 v2, s[8:11], s12 offen lds
  s_waitcnt lgkmcnt(11)
  v_mfma_f32_16x16x32_bf16 v[144:147], a[28:31], v[104:107], v[144:147]
  ds_read_b128 v[104:107], v40 offset:13312
  s_waitcnt lgkmcnt(11)
  v_mfma_f32_16x16x32_bf16 v[148:151], a[28:31], v[108:111], v[148:151]
  ds_read_b128 v[108:111], v40 offset:33792
  s_add_u32 s12, s21, 7168
  s_min_u32 s12, s12, 39936
  s_add_u32 m0, s12, s26
  s_add_u32 s12, s12, s20
  buffer_load_dwordx4 v2, s[8:11], s12 offen lds
  s_waitcnt lgkmcnt(11)
  v_mfma_f32_16x16x32_bf16 v[144:147], a[32:35], v[112:115], v[144:147]
  ds_read_b128 v[112:115], v40 offset:14336
  s_waitcnt lgkmcnt(11)
  v_mfma_f32_16x16x32_bf16 v[148:151], a[32:35], v[116:119], v[148:151]
  ds_read_b128 v[116:119], v40 offset:34816
  s_add_u32 s12, s21, 8192
  s_min_u32 s12, s12, 39936
  s_add_u32 m0, s12, s26
  s_add_u32 s12, s12, s20
  buffer_load_dwordx4 v2, s[8:11], s12 offen lds
  s_waitcnt lgkmcnt(11)
  v_mfma_f32_16x16x32_bf16 v[144:147], a[36:39], v[120:123], v[144:147]
  ds_read_b128 v[120:123], v40 offset:15360
  s_waitcnt lgkmcnt(11)
  v_mfma_f32_16x16x32_bf16 v[148:151], a[36:39], v[124:127], v[148:151]
  ds_read_b128 v[124:127], v40 offset:35840
  s_add_u32 s12, s21, 9216
  s_min_u32 s12, s12, 39936
  s_add_u32 m0, s12, s26
  s_add_u32 s12, s12, s20
  buffer_load_dwordx4 v2, s[8:11], s12 offen lds
  s_waitcnt lgkmcnt(11)
  v_mfma_f32_16x16x32_bf16 v[144:147], a[40:43], v[128:131], v[144:147]
  ds_read_b128 v[128:131], v40 offset:16384
  s_waitcnt lgkmcnt(11)
  v_mfma_f32_16x16x32_bf16 v[148:151], a[40:43], v[132:135], v[148:151]
  ds_read_b128 v[132:135], v40 offset:36864
  s_add_u32 s12, s21, 10240
  s_min_u32 s12, s12, 39936
  s_add_u32 m0, s12, s26
  s_add_u32 s12, s12, s20
  buffer_load_dwordx4 v2, s[8:11], s12 offen lds
  s_waitcnt lgkmcnt(11)
  v_mfma_f32_16x16x32_bf16 v[144:147], a[44:47], v[136:139], v[144:147]
  ds_read_b128 v[136:139], v40 offset:17408
  s_waitcnt lgkmcnt(11)
  v_mfma_f32_16x16x32_bf16 v[148:151], a[44:47], v[140:143], v[148:151]
  ds_read_b128 v[140:143], v40 offset:37888
  s_add_u32 s12, s21, 11264
  s_min_u32 s12, s12, 39936
  s_add_u32 m0, s12, s26
  s_add_u32 s12, s12, s20
  buffer_load_dwordx4 v2, s[8:11], s12 offen lds
  s_waitcnt lgkmcnt(11)
  v_mfma_f32_16x16x32_bf16 v[144:147], a[48:51], v[96:99], v[144:147]
  ds_read_b128 v[96:99], v40 offset:18432
  s_waitcnt lgkmcnt(11)
  v_mfma_f32_16x16x32_bf16 v[148:151], a[48:51], v[100:103], v[148:151]
  ds_read_b128 v[100:103], v40 offset:38912
  s_add_u32 s12, s21, 12288
  s_min_u32 s12, s12, 39936
  s_add_u32 m0, s12, s26
  s_add_u32 s12, s12, s20
  buffer_load_dwordx4 v2, s[8:11], s12 offen lds
  s_waitcnt lgkmcnt(11)
  v_mfma_f32_16x16x32_bf16 v[144:147], a[52:55], v[104:107], v[144:147]
  ds_read_b128 v[104:107], v40 offset:19456
  s_waitcnt lgkmcnt(11)
  v_mfma_f32_16x16x32_bf16 v[148:151], a[52:55], v[108:111], v[148:151]
  ds_read_b128 v[108:111], v40 offset:39936
  s_add_u32 s12, s21, 13312
  s_min_u32 s12, s12, 39936
  s_add_u32 m0, s12, s26
  s_add_u32 s12, s12, s20
  buffer_load_dwordx4 v2, s[8:11], s12 offen lds
  s_waitcnt lgkmcnt(11)
  v_mfma_f32_16x16x32_bf16 v[144:147], a[56:59], v[112:115], v[144:147]
  s_waitcnt lgkmcnt(10)
  v_mfma_f32_16x16x32_bf16 v[148:151], a[56:59], v[116:119], v[148:151]
  s_waitcnt lgkmcnt(9)
  v_mfma_f32_16x16x32_bf16 v[144:147], a[60:63], v[120:123], v[144:147]
  s_waitcnt lgkmcnt(8)
  v_mfma_f32_16x16x32_bf16 v[148:151], a[60:63], v[124:127], v[148:151]
  s_waitcnt lgkmcnt(7)
  v_mfma_f32_16x16x32_bf16 v[144:147], a[64:67], v[128:131], v[144:147]
  s_waitcnt lgkmcnt(6)
  v_mfma_f32_16x16x32_bf16 v[148:151], a[64:67], v[132:135], v[148:151]
  s_waitcnt lgkmcnt(5)
  v_mfma_f32_16x16x32_bf16 v[144:147], a[68:71], v[136:139], v[144:147]
  s_waitcnt lgkmcnt(4)
  v_mfma_f32_16x16x32_bf16 v[148:151], a[68:71], v[140:143], v[148:151]
  s_waitcnt lgkmcnt(3)
  v_mfma_f32_16x16x32_bf16 v[144:147], a[72:75], v[96:99], v[144:147]
  s_waitcnt lgkmcnt(2)
  v_mfma_f32_16x16x32_bf16 v[148:151], a[72:75], v[100:103], v[148:151]
  s_waitcnt lgkmcnt(1)
  v_mfma_f32_16x16x32_bf16 v[144:147], a[76:79], v[104:107], v[144:147]
  s_waitcnt lgkmcnt(0)
  v_mfma_f32_16x16x32_bf16 v[148:151], a[76:79], v[108:111], v[148:151]
  s_nop 7
  s_nop 7
  v_cvt_pk_bf16_f32 v152, v144, v145
  v_cvt_pk_bf16_f32 v153, v146, v147
  v_cvt_pk_bf16_f32 v154, v148, v149
  v_cvt_pk_bf16_f32 v155, v150, v151
  buffer_store_dwordx2 v[152:153], v42, s[8:11], s22 offen
  s_add_u32 s12, s22, 262144
  buffer_store_dwordx2 v[154:155], v42, s[8:11], s12 offen
  s_branch ch_f_tehia
ch_f_tvhia:
  s_waitcnt lgkmcnt(11)
  v_mfma_f32_16x16x32_bf16 v[144:147], v[96:99], a[0:3], 0
  ds_read_b128 v[96:99], v40 offset:6144
  s_waitcnt lgkmcnt(11)
  v_mfma_f32_16x16x32_bf16 v[148:151], v[100:103], a[0:3], 0
  ds_read_b128 v[100:103], v40 offset:26624
  s_add_u32 s12, s21, 0
  s_min_u32 s12, s12, 39936
  s_add_u32 m0, s12, s26
  s_add_u32 s12, s12, s20
  buffer_load_dwordx4 v2, s[8:11], s12 offen lds
  s_waitcnt lgkmcnt(11)
  v_mfma_f32_16x16x32_bf16 v[144:147], v[104:107], a[4:7], v[144:147]
  ds_read_b128 v[104:107], v40 offset:7168
  s_waitcnt lgkmcnt(11)
  v_mfma_f32_16x16x32_bf16 v[148:151], v[108:111], a[4:7], v[148:151]
  ds_read_b128 v[108:111], v40 offset:27648
  s_add_u32 s12, s21, 1024
  s_min_u32 s12, s12, 39936
  s_add_u32 m0, s12, s26
  s_add_u32 s12, s12, s20
  buffer_load_dwordx4 v2, s[8:11], s12 offen lds
  s_waitcnt lgkmcnt(11)
  v_mfma_f32_16x16x32_bf16 v[144:147], v[112:115], a[8:11], v[144:147]
  ds_read_b128 v[112:115], v40 offset:8192
  s_waitcnt lgkmcnt(11)
  v_mfma_f32_16x16x32_bf16 v[148:151], v[116:119], a[8:11], v[148:151]
  ds_read_b128 v[116:119], v40 offset:28672
  s_add_u32 s12, s21, 2048
  s_min_u32 s12, s12, 39936
  s_add_u32 m0, s12, s26
  s_add_u32 s12, s12, s20
  buffer_load_dwordx4 v2, s[8:11], s12 offen lds
  s_waitcnt lgkmcnt(11)
  v_mfma_f32_16x16x32_bf16 v[144:147], v[120:123], a[12:15], v[144:147]
  ds_read_b128 v[120:123], v40 offset:9216
  s_waitcnt lgkmcnt(11)
  v_mfma_f32_16x16x32_bf16 v[148:151], v[124:127], a[12:15], v[148:151]
  ds_read_b128 v[124:127], v40 offset:29696
  s_add_u32 s12, s21, 3072
  s_min_u32 s12, s12, 39936
  s_add_u32 m0, s12, s26
  s_add_u32 s12, s12, s20
  buffer_load_dwordx4 v2, s[8:11], s12 offen lds
  s_waitcnt lgkmcnt(11)
  v_mfma_f32_16x16x32_bf16 v[144:147], v[128:131], a[16:19], v[144:147]
  ds_read_b128 v[128:131], v40 offset:10240
  s_waitcnt lgkmcnt(11)
  v_mfma_f32_16x16x32_bf16 v[148:151], v[132:135], a[16:19], v[148:151]
  ds_read_b128 v[132:135], v40 offset:30720
  s_add_u32 s12, s21, 4096
  s_min_u32 s12, s12, 39936
  s_add_u32 m0, s12, s26
  s_add_u32 s12, s12, s20
  buffer_load_dwordx4 v2, s[8:11], s12 offen lds
  s_waitcnt lgkmcnt(11)
  v_mfma_f32_16x16x32_bf16 v[144:147], v[136:139], a[20:23], v[144:147]
  ds_read_b128 v[136:139], v40 offset:11264
  s_waitcnt lgkmcnt(11)
  v_mfma_f32_16x16x32_bf16 v[148:151], v[140:143], a[20:23], v[148:151]
  ds_read_b128 v[140:143], v40 offset:31744
  s_add_u32 s12, s21, 5120
  s_min_u32 s12, s12, 39936
  s_add_u32 m0, s12, s26
  s_add_u32 s12, s12, s20
  buffer_load_dwordx4 v2, s[8:11], s12 offen lds
  s_waitcnt lgkmcnt(11)
  v_mfma_f32_16x16x32_bf16 v[144:147], v[96:99], a[24:27], v[144:147]
  ds_read_b128 v[96:99], v40 offset:12288
  s_waitcnt lgkmcnt(11)
  v_mfma_f32_16x16x32_bf16 v[148:151], v[100:103], a[24:27], v[148:151]
  ds_read_b128 v[100:103], v40 offset:32768
  s_add_u32 s12, s21, 6144
  s_min_u32 s12, s12, 39936
  s_add_u32 m0, s12, s26
  s_add_u32 s12, s12, s20
  buffer_load_dwordx4 v2, s[8:11], s12 offen lds
  s_waitcnt lgkmcnt(11)
  v_mfma_f32_16x16x32_bf16 v[144:147], v[104:107], a[28:31], v[144:147]
  ds_read_b128 v[104:107], v40 offset:13312
  s_waitcnt lgkmcnt(11)
  v_mfma_f32_16x16x32_bf16 v[148:151], v[108:111], a[28:31], v[148:151]
  ds_read_b128 v[108:111], v40 offset:33792
  s_add_u32 s12, s21, 7168
  s_min_u32 s12, s12, 39936
  s_add_u32 m0, s12, s26
  s_add_u32 s12, s12, s20
  buffer_load_dwordx4 v2, s[8:11], s12 offen lds
  s_waitcnt lgkmcnt(11)
  v_mfma_f32_16x16x32_bf16 v[144:147], v[112:115], a[32:35], v[144:147]
  ds_read_b128 v[112:115], v40 offset:14336
  s_waitcnt lgkmcnt(11)
  v_mfma_f32_16x16x32_bf16 v[148:151], v[116:119], a[32:35], v[148:151]
  ds_read_b128 v[116:119], v40 offset:34816
  s_add_u32 s12, s21, 8192
  s_min_u32 s12, s12, 39936
  s_add_u32 m0, s12, s26
  s_add_u32 s12, s12, s20
  buffer_load_dwordx4 v2, s[8:11], s12 offen lds
  s_waitcnt lgkmcnt(11)
  v_mfma_f32_16x16x32_bf16 v[144:147], v[120:123], a[36:39], v[144:147]
  ds_read_b128 v[120:123], v40 offset:15360
  s_waitcnt lgkmcnt(11)
  v_mfma_f32_16x16x32_bf16 v[148:151], v[124:127], a[36:39], v[148:151]
  ds_read_b128 v[124:127], v40 offset:35840
  s_add_u32 s12, s21, 9216
  s_min_u32 s12, s12, 39936
  s_add_u32 m0, s12, s26
  s_add_u32 s12, s12, s20
  buffer_load_dwordx4 v2, s[8:11], s12 offen lds
  s_waitcnt lgkmcnt(11)
  v_mfma_f32_16x16x32_bf16 v[144:147], v[128:131], a[40:43], v[144:147]
  ds_read_b128 v[128:131], v40 offset:16384
  s_waitcnt lgkmcnt(11)
  v_mfma_f32_16x16x32_bf16 v[148:151], v[132:135], a[40:43], v[148:151]
  ds_read_b128 v[132:135], v40 offset:36864
  s_add_u32 s12, s21, 10240
  s_min_u32 s12, s12, 39936
  s_add_u32 m0, s12, s26
  s_add_u32 s12, s12, s20
  buffer_load_dwordx4 v2, s[8:11], s12 offen lds
  s_waitcnt lgkmcnt(11)
  v_mfma_f32_16x16x32_bf16 v[144:147], v[136:139], a[44:47], v[144:147]
  ds_read_b128 v[136:139], v40 offset:17408
  s_waitcnt lgkmcnt(11)
  v_mfma_f32_16x16x32_bf16 v[148:151], v[140:143], a[44:47], v[148:151]
  ds_read_b128 v[140:143], v40 offset:37888
  s_add_u32 s12, s21, 11264
  s_min_u32 s12, s12, 39936
  s_add_u32 m0, s12, s26
  s_add_u32 s12, s12, s20
  buffer_load_dwordx4 v2, s[8:11], s12 offen lds
  s_waitcnt lgkmcnt(11)
  v_mfma_f32_16x16x32_bf16 v[144:147], v[96:99], a[48:51], v[144:147]
  ds_read_b128 v[96:99], v40 offset:18432
  s_waitcnt lgkmcnt(11)
  v_mfma_f32_16x16x32_bf16 v[148:151], v[100:103], a[48:51], v[148:151]
  ds_read_b128 v[100:103], v40 offset:38912
  s_add_u32 s12, s21, 12288
  s_min_u32 s12, s12, 39936
  s_add_u32 m0, s12, s26
  s_add_u32 s12, s12, s20
  buffer_load_dwordx4 v2, s[8:11], s12 offen lds
  s_waitcnt lgkmcnt(11)
  v_mfma_f32_16x16x32_bf16 v[144:147], v[104:107], a[52:55], v[144:147]
  ds_read_b128 v[104:107], v40 offset:19456
  s_waitcnt lgkmcnt(11)
  v_mfma_f32_16x16x32_bf16 v[148:151], v[108:111], a[52:55], v[148:151]
  ds_read_b128 v[108:111], v40 offset:39936
  s_add_u32 s12, s21, 13312
  s_min_u32 s12, s12, 39936
  s_add_u32 m0, s12, s26
  s_add_u32 s12, s12, s20
  buffer_load_dwordx4 v2, s[8:11], s12 offen lds
  s_waitcnt lgkmcnt(11)
  v_mfma_f32_16x16x32_bf16 v[144:147], v[112:115], a[56:59], v[144:147]
  s_waitcnt lgkmcnt(10)
  v_mfma_f32_16x16x32_bf16 v[148:151], v[116:119], a[56:59], v[148:151]
  s_waitcnt lgkmcnt(9)
  v_mfma_f32_16x16x32_bf16 v[144:147], v[120:123], a[60:63], v[144:147]
  s_waitcnt lgkmcnt(8)
  v_mfma_f32_16x16x32_bf16 v[148:151], v[124:127], a[60:63], v[148:151]
  s_waitcnt lgkmcnt(7)
  v_mfma_f32_16x16x32_bf16 v[144:147], v[128:131], a[64:67], v[144:147]
  s_waitcnt lgkmcnt(6)
  v_mfma_f32_16x16x32_bf16 v[148:151], v[132:135], a[64:67], v[148:151]
  s_waitcnt lgkmcnt(5)
  v_mfma_f32_16x16x32_bf16 v[144:147], v[136:139], a[68:71], v[144:147]
  s_waitcnt lgkmcnt(4)
  v_mfma_f32_16x16x32_bf16 v[148:151], v[140:143], a[68:71], v[148:151]
  s_waitcnt lgkmcnt(3)
  v_mfma_f32_16x16x32_bf16 v[144:147], v[96:99], a[72:75], v[144:147]
  s_waitcnt lgkmcnt(2)
  v_mfma_f32_16x16x32_bf16 v[148:151], v[100:103], a[72:75], v[148:151]
  s_waitcnt lgkmcnt(1)
  v_mfma_f32_16x16x32_bf16 v[144:147], v[104:107], a[76:79], v[144:147]
  s_waitcnt lgkmcnt(0)
  v_mfma_f32_16x16x32_bf16 v[148:151], v[108:111], a[76:79], v[148:151]
  s_nop 7
  s_nop 7
  v_cvt_pk_bf16_f32 v152, v144, v145
  v_cvt_pk_bf16_f32 v153, v146, v147
  v_cvt_pk_bf16_f32 v154, v148, v149
  v_cvt_pk_bf16_f32 v155, v150, v151
  buffer_store_dwordx4 v[152:155], v2, s[8:11], s23 offen
ch_f_tehia:
  s_add_u32 s22, s22, 524288
  s_add_u32 s23, s23, 262144
  s_add_u32 s24, s24, 1
  s_bitset0_b32 s22, 22
  s_bitset0_b32 s23, 21
  s_add_u32 s20, s20, 40960
  s_add_u32 s25, s25, 1
  s_branch ch_f_wxhi
ch_f_wnhi:
  s_and_b32 s12, s24, 1
  s_mul_i32 s12, s12, 40960
  s_add_u32 s12, s12, 40960
  v_add_u32 v40, s12, v2
  ds_read_b128 v[96:99], v40 offset:0
  ds_read_b128 v[100:103], v40 offset:20480
  ds_read_b128 v[104:107], v40 offset:1024
  ds_read_b128 v[108:111], v40 offset:21504
  ds_read_b128 v[112:115], v40 offset:2048
  ds_read_b128 v[116:119], v40 offset:22528
  ds_read_b128 v[120:123], v40 offset:3072
  ds_read_b128 v[124:127], v40 offset:23552
  ds_read_b128 v[128:131], v40 offset:4096
  ds_read_b128 v[132:135], v40 offset:24576
  ds_read_b128 v[136:139], v40 offset:5120
  ds_read_b128 v[140:143], v40 offset:25600
  s_cmp_eq_u32 s3, 2
  s_cbranch_scc1 ch_f_tvhib
  s_waitcnt lgkmcnt(11)
  v_mfma_f32_16x16x32_bf16 v[144:147], a[0:3], v[96:99], 0
  ds_read_b128 v[96:99], v40 offset:6144
  s_waitcnt lgkmcnt(11)
  v_mfma_f32_16x16x32_bf16 v[148:151], a[0:3], v[100:103], 0
  ds_read_b128 v[100:103], v40 offset:26624
  s_waitcnt lgkmcnt(11)
  v_mfma_f32_16x16x32_bf16 v[144:147], a[4:7], v[104:107], v[144:147]
  ds_read_b128 v[104:107], v40 offset:7168
  s_waitcnt lgkmcnt(11)
  v_mfma_f32_16x16x32_bf16 v[148:151], a[4:7], v[108:111], v[148:151]
  ds_read_b128 v[108:111], v40 offset:27648
  s_waitcnt lgkmcnt(11)
  v_mfma_f32_16x16x32_bf16 v[144:147], a[8:11], v[112:115], v[144:147]
  ds_read_b128 v[112:115], v40 offset:8192
  s_waitcnt lgkmcnt(11)
  v_mfma_f32_16x16x32_bf16 v[148:151], a[8:11], v[116:119], v[148:151]
  ds_read_b128 v[116:119], v40 offset:28672
  s_waitcnt lgkmcnt(11)
  v_mfma_f32_16x16x32_bf16 v[144:147], a[12:15], v[120:123], v[144:147]
  ds_read_b128 v[120:123], v40 offset:9216
  s_waitcnt lgkmcnt(11)
  v_mfma_f32_16x16x32_bf16 v[148:151], a[12:15], v[124:127], v[148:151]
  ds_read_b128 v[124:127], v40 offset:29696
  s_waitcnt lgkmcnt(11)
  v_mfma_f32_16x16x32_bf16 v[144:147], a[16:19], v[128:131], v[144:147]
  ds_read_b128 v[128:131], v40 offset:10240
  s_waitcnt lgkmcnt(11)
  v_mfma_f32_16x16x32_bf16 v[148:151], a[16:19], v[132:135], v[148:151]
  ds_read_b128 v[132:135], v40 offset:30720
  s_waitcnt lgkmcnt(11)
  v_mfma_f32_16x16x32_bf16 v[144:147], a[20:23], v[136:139], v[144:147]
  ds_read_b128 v[136:139], v40 offset:11264
  s_waitcnt lgkmcnt(11)
  v_mfma_f32_16x16x32_bf16 v[148:151], a[20:23], v[140:143], v[148:151]
  ds_read_b128 v[140:143], v40 offset:31744
  s_waitcnt lgkmcnt(11)
  v_mfma_f32_16x16x32_bf16 v[144:147], a[24:27], v[96:99], v[144:147]
  ds_read_b128 v[96:99], v40 offset:12288
  s_waitcnt lgkmcnt(11)
  v_mfma_f32_16x16x32_bf16 v[148:151], a[24:27], v[100:103], v[148:151]
  ds_read_b128 v[100:103], v40 offset:32768
  s_waitcnt lgkmcnt(11)
  v_mfma_f32_16x16x32_bf16 v[144:147], a[28:31], v[104:107], v[144:147]
  ds_read_b128 v[104:107], v40 offset:13312
  s_waitcnt lgkmcnt(11)
  v_mfma_f32_16x16x32_bf16 v[148:151], a[28:31], v[108:111], v[148:151]
  ds_read_b128 v[108:111], v40 offset:33792
  s_waitcnt lgkmcnt(11)
  v_mfma_f32_16x16x32_bf16 v[144:147], a[32:35], v[112:115], v[144:147]
  ds_read_b128 v[112:115], v40 offset:14336
  s_waitcnt lgkmcnt(11)
  v_mfma_f32_16x16x32_bf16 v[148:151], a[32:35], v[116:119], v[148:151]
  ds_read_b128 v[116:119], v40 offset:34816
  s_waitcnt lgkmcnt(11)
  v_mfma_f32_16x16x32_bf16 v[144:147], a[36:39], v[120:123], v[144:147]
  ds_read_b128 v[120:123], v40 offset:15360
  s_waitcnt lgkmcnt(11)
  v_mfma_f32_16x16x32_bf16 v[148:151], a[36:39], v[124:127], v[148:151]
  ds_read_b128 v[124:127], v40 offset:35840
  s_waitcnt lgkmcnt(11)
  v_mfma_f32_16x16x32_bf16 v[144:147], a[40:43], v[128:131], v[144:147]
  ds_read_b128 v[128:131], v40 offset:16384
  s_waitcnt lgkmcnt(11)
  v_mfma_f32_16x16x32_bf16 v[148:151], a[40:43], v[132:135], v[148:151]
  ds_read_b128 v[132:135], v40 offset:36864
  s_waitcnt lgkmcnt(11)
  v_mfma_f32_16x16x32_bf16 v[144:147], a[44:47], v[136:139], v[144:147]
  ds_read_b128 v[136:139], v40 offset:17408
  s_waitcnt lgkmcnt(11)
  v_mfma_f32_16x16x32_bf16 v[148:151], a[44:47], v[140:143], v[148:151]
  ds_read_b128 v[140:143], v40 offset:37888
  s_waitcnt lgkmcnt(11)
  v_mfma_f32_16x16x32_bf16 v[144:147], a[48:51], v[96:99], v[144:147]
  ds_read_b128 v[96:99], v40 offset:18432
  s_waitcnt lgkmcnt(11)
  v_mfma_f32_16x16x32_bf16 v[148:151], a[48:51], v[100:103], v[148:151]
  ds_read_b128 v[100:103], v40 offset:38912
  s_waitcnt lgkmcnt(11)
  v_mfma_f32_16x16x32_bf16 v[144:147], a[52:55], v[104:107], v[144:147]
  ds_read_b128 v[104:107], v40 offset:19456
  s_waitcnt lgkmcnt(11)
  v_mfma_f32_16x16x32_bf16 v[148:151], a[52:55], v[108:111], v[148:151]
  ds_read_b128 v[108:111], v40 offset:39936
  s_waitcnt lgkmcnt(11)
  v_mfma_f32_16x16x32_bf16 v[144:147], a[56:59], v[112:115], v[144:147]
  s_waitcnt lgkmcnt(10)
  v_mfma_f32_16x16x32_bf16 v[148:151], a[56:59], v[116:119], v[148:151]
  s_waitcnt lgkmcnt(9)
  v_mfma_f32_16x16x32_bf16 v[144:147], a[60:63], v[120:123], v[144:147]
  s_waitcnt lgkmcnt(8)
  v_mfma_f32_16x16x32_bf16 v[148:151], a[60:63], v[124:127], v[148:151]
  s_waitcnt lgkmcnt(7)
  v_mfma_f32_16x16x32_bf16 v[144:147], a[64:67], v[128:131], v[144:147]
  s_waitcnt lgkmcnt(6)
  v_mfma_f32_16x16x32_bf16 v[148:151], a[64:67], v[132:135], v[148:151]
  s_waitcnt lgkmcnt(5)
  v_mfma_f32_16x16x32_bf16 v[144:147], a[68:71], v[136:139], v[144:147]
  s_waitcnt lgkmcnt(4)
  v_mfma_f32_16x16x32_bf16 v[148:151], a[68:71], v[140:143], v[148:151]
  s_waitcnt lgkmcnt(3)
  v_mfma_f32_16x16x32_bf16 v[144:147], a[72:75], v[96:99], v[144:147]
  s_waitcnt lgkmcnt(2)
  v_mfma_f32_16x16x32_bf16 v[148:151], a[72:75], v[100:103], v[148:151]
  s_waitcnt lgkmcnt(1)
  v_mfma_f32_16x16x32_bf16 v[144:147], a[76:79], v[104:107], v[144:147]
  s_waitcnt lgkmcnt(0)
  v_mfma_f32_16x16x32_bf16 v[148:151], a[76:79], v[108:111], v[148:151]
  s_nop 7
  s_nop 7
  v_cvt_pk_bf16_f32 v152, v144, v145
  v_cvt_pk_bf16_f32 v153, v146, v147
  v_cvt_pk_bf16_f32 v154, v148, v149
  v_cvt_pk_bf16_f32 v155, v150, v151
  buffer_store_dwordx2 v[152:153], v42, s[8:11], s22 offen
  s_add_u32 s12, s22, 262144
  buffer_store_dwordx2 v[154:155], v42, s[8:11], s12 offen
  s_branch ch_f_tehib
ch_f_tvhib:
  s_waitcnt lgkmcnt(11)
  v_mfma_f32_16x16x32_bf16 v[144:147], v[96:99], a[0:3], 0
  ds_read_b128 v[96:99], v40 offset:6144
  s_waitcnt lgkmcnt(11)
  v_mfma_f32_16x16x32_bf16 v[148:151], v[100:103], a[0:3], 0
  ds_read_b128 v[100:103], v40 offset:26624
  s_waitcnt lgkmcnt(11)
  v_mfma_f32_16x16x32_bf16 v[144:147], v[104:107], a[4:7], v[144:147]
  ds_read_b128 v[104:107], v40 offset:7168
  s_waitcnt lgkmcnt(11)
  v_mfma_f32_16x16x32_bf16 v[148:151], v[108:111], a[4:7], v[148:151]
  ds_read_b128 v[108:111], v40 offset:27648
  s_waitcnt lgkmcnt(11)
  v_mfma_f32_16x16x32_bf16 v[144:147], v[112:115], a[8:11], v[144:147]
  ds_read_b128 v[112:115], v40 offset:8192
  s_waitcnt lgkmcnt(11)
  v_mfma_f32_16x16x32_bf16 v[148:151], v[116:119], a[8:11], v[148:151]
  ds_read_b128 v[116:119], v40 offset:28672
  s_waitcnt lgkmcnt(11)
  v_mfma_f32_16x16x32_bf16 v[144:147], v[120:123], a[12:15], v[144:147]
  ds_read_b128 v[120:123], v40 offset:9216
  s_waitcnt lgkmcnt(11)
  v_mfma_f32_16x16x32_bf16 v[148:151], v[124:127], a[12:15], v[148:151]
  ds_read_b128 v[124:127], v40 offset:29696
  s_waitcnt lgkmcnt(11)
  v_mfma_f32_16x16x32_bf16 v[144:147], v[128:131], a[16:19], v[144:147]
  ds_read_b128 v[128:131], v40 offset:10240
  s_waitcnt lgkmcnt(11)
  v_mfma_f32_16x16x32_bf16 v[148:151], v[132:135], a[16:19], v[148:151]
  ds_read_b128 v[132:135], v40 offset:30720
  s_waitcnt lgkmcnt(11)
  v_mfma_f32_16x16x32_bf16 v[144:147], v[136:139], a[20:23], v[144:147]
  ds_read_b128 v[136:139], v40 offset:11264
  s_waitcnt lgkmcnt(11)
  v_mfma_f32_16x16x32_bf16 v[148:151], v[140:143], a[20:23], v[148:151]
  ds_read_b128 v[140:143], v40 offset:31744
  s_waitcnt lgkmcnt(11)
  v_mfma_f32_16x16x32_bf16 v[144:147], v[96:99], a[24:27], v[144:147]
  ds_read_b128 v[96:99], v40 offset:12288
  s_waitcnt lgkmcnt(11)
  v_mfma_f32_16x16x32_bf16 v[148:151], v[100:103], a[24:27], v[148:151]
  ds_read_b128 v[100:103], v40 offset:32768
  s_waitcnt lgkmcnt(11)
  v_mfma_f32_16x16x32_bf16 v[144:147], v[104:107], a[28:31], v[144:147]
  ds_read_b128 v[104:107], v40 offset:13312
  s_waitcnt lgkmcnt(11)
  v_mfma_f32_16x16x32_bf16 v[148:151], v[108:111], a[28:31], v[148:151]
  ds_read_b128 v[108:111], v40 offset:33792
  s_waitcnt lgkmcnt(11)
  v_mfma_f32_16x16x32_bf16 v[144:147], v[112:115], a[32:35], v[144:147]
  ds_read_b128 v[112:115], v40 offset:14336
  s_waitcnt lgkmcnt(11)
  v_mfma_f32_16x16x32_bf16 v[148:151], v[116:119], a[32:35], v[148:151]
  ds_read_b128 v[116:119], v40 offset:34816
  s_waitcnt lgkmcnt(11)
  v_mfma_f32_16x16x32_bf16 v[144:147], v[120:123], a[36:39], v[144:147]
  ds_read_b128 v[120:123], v40 offset:15360
  s_waitcnt lgkmcnt(11)
  v_mfma_f32_16x16x32_bf16 v[148:151], v[124:127], a[36:39], v[148:151]
  ds_read_b128 v[124:127], v40 offset:35840
  s_waitcnt lgkmcnt(11)
  v_mfma_f32_16x16x32_bf16 v[144:147], v[128:131], a[40:43], v[144:147]
  ds_read_b128 v[128:131], v40 offset:16384
  s_waitcnt lgkmcnt(11)
  v_mfma_f32_16x16x32_bf16 v[148:151], v[132:135], a[40:43], v[148:151]
  ds_read_b128 v[132:135], v40 offset:36864
  s_waitcnt lgkmcnt(11)
  v_mfma_f32_16x16x32_bf16 v[144:147], v[136:139], a[44:47], v[144:147]
  ds_read_b128 v[136:139], v40 offset:17408
  s_waitcnt lgkmcnt(11)
  v_mfma_f32_16x16x32_bf16 v[148:151], v[140:143], a[44:47], v[148:151]
  ds_read_b128 v[140:143], v40 offset:37888
  s_waitcnt lgkmcnt(11)
  v_mfma_f32_16x16x32_bf16 v[144:147], v[96:99], a[48:51], v[144:147]
  ds_read_b128 v[96:99], v40 offset:18432
  s_waitcnt lgkmcnt(11)
  v_mfma_f32_16x16x32_bf16 v[148:151], v[100:103], a[48:51], v[148:151]
  ds_read_b128 v[100:103], v40 offset:38912
  s_waitcnt lgkmcnt(11)
  v_mfma_f32_16x16x32_bf16 v[144:147], v[104:107], a[52:55], v[144:147]
  ds_read_b128 v[104:107], v40 offset:19456
  s_waitcnt lgkmcnt(11)
  v_mfma_f32_16x16x32_bf16 v[148:151], v[108:111], a[52:55], v[148:151]
  ds_read_b128 v[108:111], v40 offset:39936
  s_waitcnt lgkmcnt(11)
  v_mfma_f32_16x16x32_bf16 v[144:147], v[112:115], a[56:59], v[144:147]
  s_waitcnt lgkmcnt(10)
  v_mfma_f32_16x16x32_bf16 v[148:151], v[116:119], a[56:59], v[148:151]
  s_waitcnt lgkmcnt(9)
  v_mfma_f32_16x16x32_bf16 v[144:147], v[120:123], a[60:63], v[144:147]
  s_waitcnt lgkmcnt(8)
  v_mfma_f32_16x16x32_bf16 v[148:151], v[124:127], a[60:63], v[148:151]
  s_waitcnt lgkmcnt(7)
  v_mfma_f32_16x16x32_bf16 v[144:147], v[128:131], a[64:67], v[144:147]
  s_waitcnt lgkmcnt(6)
  v_mfma_f32_16x16x32_bf16 v[148:151], v[132:135], a[64:67], v[148:151]
  s_waitcnt lgkmcnt(5)
  v_mfma_f32_16x16x32_bf16 v[144:147], v[136:139], a[68:71], v[144:147]
  s_waitcnt lgkmcnt(4)
  v_mfma_f32_16x16x32_bf16 v[148:151], v[140:143], a[68:71], v[148:151]
  s_waitcnt lgkmcnt(3)
  v_mfma_f32_16x16x32_bf16 v[144:147], v[96:99], a[72:75], v[144:147]
  s_waitcnt lgkmcnt(2)
  v_mfma_f32_16x16x32_bf16 v[148:151], v[100:103], a[72:75], v[148:151]
  s_waitcnt lgkmcnt(1)
  v_mfma_f32_16x16x32_bf16 v[144:147], v[104:107], a[76:79], v[144:147]
  s_waitcnt lgkmcnt(0)
  v_mfma_f32_16x16x32_bf16 v[148:151], v[108:111], a[76:79], v[148:151]
  s_nop 7
  s_nop 7
  v_cvt_pk_bf16_f32 v152, v144, v145
  v_cvt_pk_bf16_f32 v153, v146, v147
  v_cvt_pk_bf16_f32 v154, v148, v149
  v_cvt_pk_bf16_f32 v155, v150, v151
  buffer_store_dwordx4 v[152:155], v2, s[8:11], s23 offen
ch_f_tehib:
  s_add_u32 s22, s22, 524288
  s_add_u32 s23, s23, 262144
  s_add_u32 s24, s24, 1
  s_bitset0_b32 s22, 22
  s_bitset0_b32 s23, 21
ch_f_wxhi:
  s_branch ch_f_hid
ch_f_hi3:
  s_cmp_eq_u32 s90, 0
  s_cbranch_scc1 ch_f_hid
  s_cmp_eq_u32 s60, 0
  s_cbranch_scc1 ch_f_hid
ch_f_tl:
  s_mov_b32 s61, 65536
  s_and_b32 s49, s89, 7
  s_mul_i32 s49, s49, 196608
  s_add_u32 s49, s49, s71
ch_f_tp:
  buffer_load_dwordx4 v[128:131], v12, s[8:11], s49 offen offset:2048 sc1
  buffer_load_dwordx4 v[132:135], v12, s[8:11], s49 offen offset:2560 sc1
  buffer_load_dwordx4 v[136:139], v12, s[8:11], s49 offen offset:3072 sc1
  buffer_load_dwordx4 v[140:143], v12, s[8:11], s49 offen offset:3584 sc1
  s_add_u32 s12, s49, 4096
  buffer_load_dwordx4 v[176:179], v14, s[8:11], s12 offen offset:0 sc1
  buffer_load_dwordx4 v[180:183], v14, s[8:11], s12 offen offset:512 sc1
  buffer_load_dwordx4 v[184:187], v14, s[8:11], s12 offen offset:1024 sc1
  buffer_load_dwordx4 v[188:191], v14, s[8:11], s12 offen offset:1536 sc1
  s_waitcnt vmcnt(0)
  v_max_u32 v8, v128, v130
  v_max3_u32 v8, v8, v132, v134
  v_max3_u32 v8, v8, v136, v138
  v_max3_u32 v8, v8, v140, v142
  v_max3_u32 v8, v8, v176, v178
  v_max3_u32 v8, v8, v180, v182
  v_max3_u32 v8, v8, v184, v186
  v_max3_u32 v8, v8, v188, v190
  v_cmp_eq_u32 vcc, -1, v8
  s_sub_u32 s61, s61, 1
  s_cmp_eq_u32 s61, 0
  s_cbranch_scc1 ch_f_td
  s_cbranch_vccnz ch_f_tp
ch_f_td:
  s_cmp_eq_u32 s91, 0
  s_cbranch_scc0 ch_f_tq1
  v_mfma_f32_16x16x32_bf16 v[200:203], v[128:131], v[64:67], 0
  v_mfma_f32_16x16x32_bf16 v[192:195], v[96:99], v[64:67], 0
  v_mfma_f32_16x16x32_bf16 v[200:203], v[132:135], v[68:71], v[200:203]
  v_mfma_f32_16x16x32_bf16 v[192:195], v[100:103], v[68:71], v[192:195]
  v_mfma_f32_16x16x32_bf16 v[200:203], v[136:139], v[72:75], v[200:203]
  v_mfma_f32_16x16x32_bf16 v[192:195], v[104:107], v[72:75], v[192:195]
  v_mfma_f32_16x16x32_bf16 v[200:203], v[140:143], v[76:79], v[200:203]
  v_mfma_f32_16x16x32_bf16 v[192:195], v[108:111], v[76:79], v[192:195]
  s_nop 7
  v_add_f32 v192, v192, v36
  v_add_f32 v193, v193, v37
  v_add_f32 v194, v194, v38
  v_add_f32 v195, v195, v39
  v_add_f32 v200, v200, v3
  v_add_f32 v201, v201, v3
  v_add_f32 v202, v202, v3
  v_add_f32 v203, v203, v3
  v_max3_f32 v8, v192, v193, v194
  v_max3_f32 v8, v8, v195, v200
  v_max3_f32 v8, v8, v201, v202
  v_max_f32 v8, v8, v203
  v_mov_b32 v9, v8
  s_nop 1
  v_permlane32_swap_b32 v9, v8
  s_nop 1
  v_max_f32 v8, v8, v9
  v_mov_b32 v9, v8
  s_nop 1
  v_permlane16_swap_b32 v9, v8
  s_nop 1
  v_max_f32 v8, v8, v9
  v_mul_f32 v8, 0x3e0293ee, v8
  s_mov_b32 s39, 0x3e0293ee
  v_fma_f32 v192, v192, s39, -v8
  v_fma_f32 v193, v193, s39, -v8
  v_fma_f32 v194, v194, s39, -v8
  v_fma_f32 v195, v195, s39, -v8
  v_fma_f32 v200, v200, s39, -v8
  v_fma_f32 v201, v201, s39, -v8
  v_fma_f32 v202, v202, s39, -v8
  v_fma_f32 v203, v203, s39, -v8
  v_exp_f32 v192, v192
  v_exp_f32 v193, v193
  v_exp_f32 v194, v194
  v_exp_f32 v195, v195
  v_exp_f32 v200, v200
  v_exp_f32 v201, v201
  v_exp_f32 v202, v202
  v_exp_f32 v203, v203
  s_nop 0
  v_cvt_pk_bf16_f32 v204, v192, v193
  v_cvt_pk_bf16_f32 v205, v194, v195
  v_mov_b32 v206, 0
  v_mov_b32 v207, 0
  v_cvt_pk_bf16_f32 v208, v200, v201
  v_cvt_pk_bf16_f32 v209, v202, v203
  v_add_f32 v10, v192, v193
  v_mfma_f32_16x16x32_bf16 v[212:215], v[144:147], v[204:207], 0
  v_add_f32 v10, v10, v194
  v_mfma_f32_16x16x32_bf16 v[216:219], v[148:151], v[204:207], 0
  v_add_f32 v10, v10, v195
  v_mfma_f32_16x16x32_bf16 v[220:223], v[152:155], v[204:207], 0
  v_add_f32 v10, v10, v200
  v_mfma_f32_16x16x32_bf16 v[224:227], v[156:159], v[204:207], 0
  v_add_f32 v10, v10, v201
  v_mfma_f32_16x16x32_bf16 v[228:231], v[160:163], v[204:207], 0
  v_add_f32 v10, v10, v202
  v_mfma_f32_16x16x32_bf16 v[232:235], v[164:167], v[204:207], 0
  v_add_f32 v10, v10, v203
  v_mfma_f32_16x16x32_bf16 v[236:239], v[168:171], v[204:207], 0
  v_mfma_f32_16x16x32_bf16 v[240:243], v[172:175], v[204:207], 0
  v_mfma_f32_16x16x16_bf16 v[212:215], v[176:177], v[208:209], v[212:215]
  v_mfma_f32_16x16x16_bf16 v[216:219], v[178:179], v[208:209], v[216:219]
  v_mfma_f32_16x16x16_bf16 v[220:223], v[180:181], v[208:209], v[220:223]
  v_mfma_f32_16x16x16_bf16 v[224:227], v[182:183], v[208:209], v[224:227]
  v_mfma_f32_16x16x16_bf16 v[228:231], v[184:185], v[208:209], v[228:231]
  v_mfma_f32_16x16x16_bf16 v[232:235], v[186:187], v[208:209], v[232:235]
  v_mfma_f32_16x16x16_bf16 v[236:239], v[188:189], v[208:209], v[236:239]
  v_mfma_f32_16x16x16_bf16 v[240:243], v[190:191], v[208:209], v[240:243]
  v_mov_b32 v9, v10
  s_nop 1
  v_permlane32_swap_b32 v9, v10
  s_nop 1
  v_add_f32 v10, v10, v9
  v_mov_b32 v9, v10
  s_nop 1
  v_permlane16_swap_b32 v9, v10
  s_nop 1
  v_add_f32 v10, v10, v9
  v_rcp_f32 v10, v10
  s_nop 3
  v_mul_f32 v212, v212, v10
  v_mul_f32 v213, v213, v10
  v_mul_f32 v214, v214, v10
  v_mul_f32 v215, v215, v10
  v_mul_f32 v216, v216, v10
  v_mul_f32 v217, v217, v10
  v_mul_f32 v218, v218, v10
  v_mul_f32 v219, v219, v10
  v_mul_f32 v220, v220, v10
  v_mul_f32 v221, v221, v10
  v_mul_f32 v222, v222, v10
  v_mul_f32 v223, v223, v10
  v_mul_f32 v224, v224, v10
  v_mul_f32 v225, v225, v10
  v_mul_f32 v226, v226, v10
  v_mul_f32 v227, v227, v10
  v_mul_f32 v228, v228, v10
  v_mul_f32 v229, v229, v10
  v_mul_f32 v230, v230, v10
  v_mul_f32 v231, v231, v10
  v_mul_f32 v232, v232, v10
  v_mul_f32 v233, v233, v10
  v_mul_f32 v234, v234, v10
  v_mul_f32 v235, v235, v10
  v_mul_f32 v236, v236, v10
  v_mul_f32 v237, v237, v10
  v_mul_f32 v238, v238, v10
  v_mul_f32 v239, v239, v10
  v_mul_f32 v240, v240, v10
  v_mul_f32 v241, v241, v10
  v_mul_f32 v242, v242, v10
  v_mul_f32 v243, v243, v10
  s_branch ch_f_tq2
ch_f_tq1:
  v_mfma_f32_16x16x32_bf16 v[200:203], v[128:131], v[64:67], 0
  v_mfma_f32_16x16x32_bf16 v[192:195], v[96:99], v[64:67], 0
  v_mfma_f32_16x16x32_bf16 v[196:199], v[112:115], v[64:67], 0
  v_mfma_f32_16x16x32_bf16 v[200:203], v[132:135], v[68:71], v[200:203]
  v_mfma_f32_16x16x32_bf16 v[192:195], v[100:103], v[68:71], v[192:195]
  v_mfma_f32_16x16x32_bf16 v[196:199], v[116:119], v[68:71], v[196:199]
  v_mfma_f32_16x16x32_bf16 v[200:203], v[136:139], v[72:75], v[200:203]
  v_mfma_f32_16x16x32_bf16 v[192:195], v[104:107], v[72:75], v[192:195]
  v_mfma_f32_16x16x32_bf16 v[196:199], v[120:123], v[72:75], v[196:199]
  v_mfma_f32_16x16x32_bf16 v[200:203], v[140:143], v[76:79], v[200:203]
  v_mfma_f32_16x16x32_bf16 v[192:195], v[108:111], v[76:79], v[192:195]
  v_mfma_f32_16x16x32_bf16 v[196:199], v[124:127], v[76:79], v[196:199]
  s_nop 7
  v_add_f32 v196, v196, v36
  v_add_f32 v197, v197, v37
  v_add_f32 v198, v198, v38
  v_add_f32 v199, v199, v39
  v_add_f32 v200, v200, v3
  v_add_f32 v201, v201, v3
  v_add_f32 v202, v202, v3
  v_add_f32 v203, v203, v3
  v_max3_f32 v8, v192, v193, v194
  v_max3_f32 v8, v8, v195, v196
  v_max3_f32 v8, v8, v197, v198
  v_max3_f32 v8, v8, v199, v200
  v_max3_f32 v8, v8, v201, v202
  v_max_f32 v8, v8, v203
  v_mov_b32 v9, v8
  s_nop 1
  v_permlane32_swap_b32 v9, v8
  s_nop 1
  v_max_f32 v8, v8, v9
  v_mov_b32 v9, v8
  s_nop 1
  v_permlane16_swap_b32 v9, v8
  s_nop 1
  v_max_f32 v8, v8, v9
  v_mul_f32 v8, 0x3e0293ee, v8
  s_mov_b32 s39, 0x3e0293ee
  v_fma_f32 v192, v192, s39, -v8
  v_fma_f32 v193, v193, s39, -v8
  v_fma_f32 v194, v194, s39, -v8
  v_fma_f32 v195, v195, s39, -v8
  v_fma_f32 v196, v196, s39, -v8
  v_fma_f32 v197, v197, s39, -v8
  v_fma_f32 v198, v198, s39, -v8
  v_fma_f32 v199, v199, s39, -v8
  v_fma_f32 v200, v200, s39, -v8
  v_fma_f32 v201, v201, s39, -v8
  v_fma_f32 v202, v202, s39, -v8
  v_fma_f32 v203, v203, s39, -v8
  v_exp_f32 v192, v192
  v_exp_f32 v193, v193
  v_exp_f32 v194, v194
  v_exp_f32 v195, v195
  v_exp_f32 v196, v196
  v_exp_f32 v197, v197
  v_exp_f32 v198, v198
  v_exp_f32 v199, v199
  v_exp_f32 v200, v200
  v_exp_f32 v201, v201
  v_exp_f32 v202, v202
  v_exp_f32 v203, v203
  s_nop 0
  v_cvt_pk_bf16_f32 v204, v192, v193
  v_cvt_pk_bf16_f32 v205, v194, v195
  v_cvt_pk_bf16_f32 v206, v196, v197
  v_cvt_pk_bf16_f32 v207, v198, v199
  v_cvt_pk_bf16_f32 v208, v200, v201
  v_cvt_pk_bf16_f32 v209, v202, v203
  v_add_f32 v10, v192, v193
  v_mfma_f32_16x16x32_bf16 v[212:215], v[144:147], v[204:207], 0
  v_add_f32 v10, v10, v194
  v_mfma_f32_16x16x32_bf16 v[216:219], v[148:151], v[204:207], 0
  v_add_f32 v10, v10, v195
  v_mfma_f32_16x16x32_bf16 v[220:223], v[152:155], v[204:207], 0
  v_add_f32 v10, v10, v196
  v_mfma_f32_16x16x32_bf16 v[224:227], v[156:159], v[204:207], 0
  v_add_f32 v10, v10, v197
  v_mfma_f32_16x16x32_bf16 v[228:231], v[160:163], v[204:207], 0
  v_add_f32 v10, v10, v198
  v_mfma_f32_16x16x32_bf16 v[232:235], v[164:167], v[204:207], 0
  v_add_f32 v10, v10, v199
  v_mfma_f32_16x16x32_bf16 v[236:239], v[168:171], v[204:207], 0
  v_add_f32 v10, v10, v200
  v_mfma_f32_16x16x32_bf16 v[240:243], v[172:175], v[204:207], 0
  v_add_f32 v10, v10, v201
  v_add_f32 v10, v10, v202
  v_add_f32 v10, v10, v203
  v_mfma_f32_16x16x16_bf16 v[212:215], v[176:177], v[208:209], v[212:215]
  v_mfma_f32_16x16x16_bf16 v[216:219], v[178:179], v[208:209], v[216:219]
  v_mfma_f32_16x16x16_bf16 v[220:223], v[180:181], v[208:209], v[220:223]
  v_mfma_f32_16x16x16_bf16 v[224:227], v[182:183], v[208:209], v[224:227]
  v_mfma_f32_16x16x16_bf16 v[228:231], v[184:185], v[208:209], v[228:231]
  v_mfma_f32_16x16x16_bf16 v[232:235], v[186:187], v[208:209], v[232:235]
  v_mfma_f32_16x16x16_bf16 v[236:239], v[188:189], v[208:209], v[236:239]
  v_mfma_f32_16x16x16_bf16 v[240:243], v[190:191], v[208:209], v[240:243]
  v_mov_b32 v9, v10
  s_nop 1
  v_permlane32_swap_b32 v9, v10
  s_nop 1
  v_add_f32 v10, v10, v9
  v_mov_b32 v9, v10
  s_nop 1
  v_permlane16_swap_b32 v9, v10
  s_nop 1
  v_add_f32 v10, v10, v9
  v_rcp_f32 v10, v10
  s_nop 3
  v_mul_f32 v212, v212, v10
  v_mul_f32 v213, v213, v10
  v_mul_f32 v214, v214, v10
  v_mul_f32 v215, v215, v10
  v_mul_f32 v216, v216, v10
  v_mul_f32 v217, v217, v10
  v_mul_f32 v218, v218, v10
  v_mul_f32 v219, v219, v10
  v_mul_f32 v220, v220, v10
  v_mul_f32 v221, v221, v10
  v_mul_f32 v222, v222, v10
  v_mul_f32 v223, v223, v10
  v_mul_f32 v224, v224, v10
  v_mul_f32 v225, v225, v10
  v_mul_f32 v226, v226, v10
  v_mul_f32 v227, v227, v10
  v_mul_f32 v228, v228, v10
  v_mul_f32 v229, v229, v10
  v_mul_f32 v230, v230, v10
  v_mul_f32 v231, v231, v10
  v_mul_f32 v232, v232, v10
  v_mul_f32 v233, v233, v10
  v_mul_f32 v234, v234, v10
  v_mul_f32 v235, v235, v10
  v_mul_f32 v236, v236, v10
  v_mul_f32 v237, v237, v10
  v_mul_f32 v238, v238, v10
  v_mul_f32 v239, v239, v10
  v_mul_f32 v240, v240, v10
  v_mul_f32 v241, v241, v10
  v_mul_f32 v242, v242, v10
  v_mul_f32 v243, v243, v10
ch_f_tq2:
  v_cvt_pk_bf16_f32 v128, v212, v213
  v_cvt_pk_bf16_f32 v129, v214, v215
  v_cvt_pk_bf16_f32 v130, v216, v217
  v_cvt_pk_bf16_f32 v131, v218, v219
  buffer_store_dwordx4 v[128:131], v2, s[8:11], s88 offen offset:0
  v_cvt_pk_bf16_f32 v132, v220, v221
  v_cvt_pk_bf16_f32 v133, v222, v223
  v_cvt_pk_bf16_f32 v134, v224, v225
  v_cvt_pk_bf16_f32 v135, v226, v227
  buffer_store_dwordx4 v[132:135], v2, s[8:11], s88 offen offset:1024
  v_cvt_pk_bf16_f32 v136, v228, v229
  v_cvt_pk_bf16_f32 v137, v230, v231
  v_cvt_pk_bf16_f32 v138, v232, v233
  v_cvt_pk_bf16_f32 v139, v234, v235
  buffer_store_dwordx4 v[136:139], v2, s[8:11], s88 offen offset:2048
  v_cvt_pk_bf16_f32 v140, v236, v237
  v_cvt_pk_bf16_f32 v141, v238, v239
  v_cvt_pk_bf16_f32 v142, v240, v241
  v_cvt_pk_bf16_f32 v143, v242, v243
  buffer_store_dwordx4 v[140:143], v2, s[8:11], s88 offen offset:3072
  s_add_u32 s88, s88, 262144
  s_add_u32 s89, s89, 1
  s_cmp_ge_u32 s89, 64
  s_cbranch_scc1 ch_f_end
  buffer_load_dwordx4 v[64:67], v2, s[8:11], s68 offen offset:0 sc1
  buffer_load_dwordx4 v[68:71], v2, s[8:11], s68 offen offset:1024 sc1
  buffer_load_dwordx4 v[72:75], v2, s[8:11], s68 offen offset:2048 sc1
  buffer_load_dwordx4 v[76:79], v2, s[8:11], s68 offen offset:3072 sc1
  s_add_u32 s12, s69, 0
  buffer_load_dwordx4 v[96:99], v2, s[8:11], s12 offen offset:0 sc1
  buffer_load_dwordx4 v[100:103], v2, s[8:11], s12 offen offset:1024 sc1
  buffer_load_dwordx4 v[104:107], v2, s[8:11], s12 offen offset:2048 sc1
  buffer_load_dwordx4 v[108:111], v2, s[8:11], s12 offen offset:3072 sc1
  s_add_u32 s12, s69, 262144
  buffer_load_dwordx4 v[112:115], v2, s[8:11], s12 offen offset:0 sc1
  buffer_load_dwordx4 v[116:119], v2, s[8:11], s12 offen offset:1024 sc1
  buffer_load_dwordx4 v[120:123], v2, s[8:11], s12 offen offset:2048 sc1
  buffer_load_dwordx4 v[124:127], v2, s[8:11], s12 offen offset:3072 sc1
  s_add_u32 s12, s70, 0
  buffer_load_dwordx4 v[144:147], v2, s[8:11], s12 offen offset:0 sc1
  buffer_load_dwordx4 v[148:151], v2, s[8:11], s12 offen offset:1024 sc1
  buffer_load_dwordx4 v[152:155], v2, s[8:11], s12 offen offset:2048 sc1
  buffer_load_dwordx4 v[156:159], v2, s[8:11], s12 offen offset:3072 sc1
  s_add_u32 s12, s70, 4096
  buffer_load_dwordx4 v[160:163], v2, s[8:11], s12 offen offset:0 sc1
  buffer_load_dwordx4 v[164:167], v2, s[8:11], s12 offen offset:1024 sc1
  buffer_load_dwordx4 v[168:171], v2, s[8:11], s12 offen offset:2048 sc1
  buffer_load_dwordx4 v[172:175], v2, s[8:11], s12 offen offset:3072 sc1
  s_add_u32 s68, s68, 524288
  s_add_u32 s69, s69, 524288
  s_add_u32 s70, s70, 262144
  s_bitset0_b32 s68, 22
  s_bitset0_b32 s69, 22
  s_bitset0_b32 s70, 21
  s_cmp_eq_u32 s60, 63
  s_cbranch_scc1 ch_f_tl
ch_f_hid:
  s_cmp_eq_u32 s60, 63
  s_cbranch_scc1 ch_f_end
  s_branch ch_f_next
ch_slow:
  s_lshr_b32 s40, s14, 5
  s_and_b32 s41, s14, 31
  v_and_b32 v8, 15, v0
  v_lshrrev_b32 v9, 4, v0
  v_lshlrev_b32 v9, 2, v9
  v_mov_b32 v10, 0xff800000
  v_add_u32 v11, 0, v9
  v_cmp_gt_u32 vcc, v11, v8
  s_nop 1
  v_cndmask_b32 v36, 0, v10, vcc
  v_add_u32 v11, 1, v9
  v_cmp_gt_u32 vcc, v11, v8
  s_nop 1
  v_cndmask_b32 v37, 0, v10, vcc
  v_add_u32 v11, 2, v9
  v_cmp_gt_u32 vcc, v11, v8
  s_nop 1
  v_cndmask_b32 v38, 0, v10, vcc
  v_add_u32 v11, 3, v9
  v_cmp_gt_u32 vcc, v11, v8
  s_nop 1
  v_cndmask_b32 v39, 0, v10, vcc
  v_cmp_le_u32 vcc, 32, v0
  s_nop 1
  v_cndmask_b32 v3, 0, v10, vcc
  v_and_b32 v12, 7, v0
  v_lshrrev_b32 v13, 4, v0
  v_lshlrev_b32 v12, 4, v12
  v_lshl_add_u32 v12, v13, 7, v12
  v_and_b32 v14, 15, v0
  v_and_b32 v15, 1, v13
  v_lshlrev_b32 v14, 4, v14
  v_lshl_add_u32 v14, v15, 8, v14
  v_lshrrev_b32 v18, 5, v0
  v_bfe_u32 v19, v0, 3, 2
  v_and_b32 v20, 7, v0
  v_lshlrev_b32 v16, 10, v18
  v_lshl_add_u32 v16, v19, 8, v16
  v_lshl_add_u32 v16, v20, 4, v16
  v_lshlrev_b32 v17, 7, v19
  v_lshl_add_u32 v17, v20, 4, v17
  v_lshl_add_u32 v17, v18, 3, v17
  v_mov_b32 v21, -2
  v_mov_b32 v56, -1
  v_mov_b32 v57, -1
  v_mov_b32 v58, -1
  v_mov_b32 v59, -1
  v_and_b32 v18, 8, v0
  v_cmp_eq_u32 s[50:51], 0, v18
  s_mov_b32 s52, -1
  s_mov_b32 s53, 0
  s_lshr_b32 s42, s41, 3
  s_and_b32 s43, s41, 7
  s_lshl_b32 s44, s40, 2
  s_add_u32 s45, s44, s42
  s_cmp_eq_u32 s3, 3
  s_cbranch_scc1 ch_s_nowa
  s_lshl_b32 s12, s3, 8
  s_lshl_b32 s13, s45, 3
  s_add_u32 s12, s12, s13
  s_add_u32 s12, s12, s43
  s_mul_i32 s12, s12, 20480
  s_add_u32 s12, s12, 0
  buffer_load_dwordx4 a[0:3], v2, s[8:11], s12 offen offset:0
  buffer_load_dwordx4 a[4:7], v2, s[8:11], s12 offen offset:1024
  buffer_load_dwordx4 a[8:11], v2, s[8:11], s12 offen offset:2048
  buffer_load_dwordx4 a[12:15], v2, s[8:11], s12 offen offset:3072
  s_add_u32 s12, s12, 4096
  buffer_load_dwordx4 a[16:19], v2, s[8:11], s12 offen offset:0
  buffer_load_dwordx4 a[20:23], v2, s[8:11], s12 offen offset:1024
  buffer_load_dwordx4 a[24:27], v2, s[8:11], s12 offen offset:2048
  buffer_load_dwordx4 a[28:31], v2, s[8:11], s12 offen offset:3072
  s_add_u32 s12, s12, 4096
  buffer_load_dwordx4 a[32:35], v2, s[8:11], s12 offen offset:0
  buffer_load_dwordx4 a[36:39], v2, s[8:11], s12 offen offset:1024
  buffer_load_dwordx4 a[40:43], v2, s[8:11], s12 offen offset:2048
  buffer_load_dwordx4 a[44:47], v2, s[8:11], s12 offen offset:3072
  s_add_u32 s12, s12, 4096
  buffer_load_dwordx4 a[48:51], v2, s[8:11], s12 offen offset:0
  buffer_load_dwordx4 a[52:55], v2, s[8:11], s12 offen offset:1024
  buffer_load_dwordx4 a[56:59], v2, s[8:11], s12 offen offset:2048
  buffer_load_dwordx4 a[60:63], v2, s[8:11], s12 offen offset:3072
  s_add_u32 s12, s12, 4096
  buffer_load_dwordx4 a[64:67], v2, s[8:11], s12 offen offset:0
  buffer_load_dwordx4 a[68:71], v2, s[8:11], s12 offen offset:1024
  buffer_load_dwordx4 a[72:75], v2, s[8:11], s12 offen offset:2048
  buffer_load_dwordx4 a[76:79], v2, s[8:11], s12 offen offset:3072
ch_s_nowa:
  s_add_u32 s46, s44, s3
  s_cmp_ge_u32 s41, 20
  s_cbranch_scc1 ch_s_nowo
  s_lshl_b32 s12, s41, 1
  s_add_u32 s12, s12, 0
  s_lshl_b32 s12, s12, 7
  s_lshl_b32 s13, s46, 2
  s_add_u32 s12, s12, s13
  s_lshl_b32 s12, s12, 10
  s_add_u32 s12, s12, 18350080
  buffer_load_dwordx4 a[80:83], v2, s[8:11], s12 offen offset:0
  buffer_load_dwordx4 a[84:87], v2, s[8:11], s12 offen offset:1024
  buffer_load_dwordx4 a[88:91], v2, s[8:11], s12 offen offset:2048
  buffer_load_dwordx4 a[92:95], v2, s[8:11], s12 offen offset:3072
  s_lshl_b32 s12, s41, 1
  s_add_u32 s12, s12, 1
  s_lshl_b32 s12, s12, 7
  s_lshl_b32 s13, s46, 2
  s_add_u32 s12, s12, s13
  s_lshl_b32 s12, s12, 10
  s_add_u32 s12, s12, 18350080
  buffer_load_dwordx4 a[96:99], v2, s[8:11], s12 offen offset:0
  buffer_load_dwordx4 a[100:103], v2, s[8:11], s12 offen offset:1024
  buffer_load_dwordx4 a[104:107], v2, s[8:11], s12 offen offset:2048
  buffer_load_dwordx4 a[108:111], v2, s[8:11], s12 offen offset:3072
  s_lshl_b32 s54, s46, 12
  s_add_u32 s54, s54, 33685504
  s_lshl_b32 s55, s46, 13
  s_add_u32 s55, s55, 67108864
ch_s_nowo:
  s_mov_b32 s20, 15728640
  s_mul_i32 s21, s3, 14336
  s_mov_b32 s24, 0
  s_mov_b32 s25, 0
  s_lshl_b32 s12, s45, 2
  s_lshr_b32 s13, s43, 1
  s_add_u32 s12, s12, s13
  s_lshl_b32 s13, s3, 7
  s_add_u32 s12, s12, s13
  s_lshl_b32 s12, s12, 10
  s_add_u32 s22, s12, 33554432
  s_lshl_b32 s12, s45, 3
  s_add_u32 s12, s12, s43
  s_lshl_b32 s12, s12, 10
  s_add_u32 s23, s12, 67108864
  s_and_b32 s12, s43, 1
  s_lshl_b32 s12, s12, 3
  v_add_u32 v42, s12, v2
  s_cmp_eq_u32 s3, 3
  s_cbranch_scc1 ch_s_p1
  s_and_b32 s26, s25, 1
  s_mul_i32 s26, s26, 40960
  s_add_u32 s26, s26, 40960
  s_add_u32 s12, s21, 0
  s_min_u32 s12, s12, 39936
  s_add_u32 m0, s12, s26
  s_add_u32 s12, s12, s20
  buffer_load_dwordx4 v2, s[8:11], s12 offen lds
  s_add_u32 s12, s21, 1024
  s_min_u32 s12, s12, 39936
  s_add_u32 m0, s12, s26
  s_add_u32 s12, s12, s20
  buffer_load_dwordx4 v2, s[8:11], s12 offen lds
  s_add_u32 s12, s21, 2048
  s_min_u32 s12, s12, 39936
  s_add_u32 m0, s12, s26
  s_add_u32 s12, s12, s20
  buffer_load_dwordx4 v2, s[8:11], s12 offen lds
  s_add_u32 s12, s21, 3072
  s_min_u32 s12, s12, 39936
  s_add_u32 m0, s12, s26
  s_add_u32 s12, s12, s20
  buffer_load_dwordx4 v2, s[8:11], s12 offen lds
  s_add_u32 s12, s21, 4096
  s_min_u32 s12, s12, 39936
  s_add_u32 m0, s12, s26
  s_add_u32 s12, s12, s20
  buffer_load_dwordx4 v2, s[8:11], s12 offen lds
  s_add_u32 s12, s21, 5120
  s_min_u32 s12, s12, 39936
  s_add_u32 m0, s12, s26
  s_add_u32 s12, s12, s20
  buffer_load_dwordx4 v2, s[8:11], s12 offen lds
  s_add_u32 s12, s21, 6144
  s_min_u32 s12, s12, 39936
  s_add_u32 m0, s12, s26
  s_add_u32 s12, s12, s20
  buffer_load_dwordx4 v2, s[8:11], s12 offen lds
  s_add_u32 s12, s21, 7168
  s_min_u32 s12, s12, 39936
  s_add_u32 m0, s12, s26
  s_add_u32 s12, s12, s20
  buffer_load_dwordx4 v2, s[8:11], s12 offen lds
  s_add_u32 s12, s21, 8192
  s_min_u32 s12, s12, 39936
  s_add_u32 m0, s12, s26
  s_add_u32 s12, s12, s20
  buffer_load_dwordx4 v2, s[8:11], s12 offen lds
  s_add_u32 s12, s21, 9216
  s_min_u32 s12, s12, 39936
  s_add_u32 m0, s12, s26
  s_add_u32 s12, s12, s20
  buffer_load_dwordx4 v2, s[8:11], s12 offen lds
  s_add_u32 s12, s21, 10240
  s_min_u32 s12, s12, 39936
  s_add_u32 m0, s12, s26
  s_add_u32 s12, s12, s20
  buffer_load_dwordx4 v2, s[8:11], s12 offen lds
  s_add_u32 s12, s21, 11264
  s_min_u32 s12, s12, 39936
  s_add_u32 m0, s12, s26
  s_add_u32 s12, s12, s20
  buffer_load_dwordx4 v2, s[8:11], s12 offen lds
  s_add_u32 s12, s21, 12288
  s_min_u32 s12, s12, 39936
  s_add_u32 m0, s12, s26
  s_add_u32 s12, s12, s20
  buffer_load_dwordx4 v2, s[8:11], s12 offen lds
  s_add_u32 s12, s21, 13312
  s_min_u32 s12, s12, 39936
  s_add_u32 m0, s12, s26
  s_add_u32 s12, s12, s20
  buffer_load_dwordx4 v2, s[8:11], s12 offen lds
  s_add_u32 s20, s20, 40960
  s_add_u32 s25, s25, 1
  s_and_b32 s26, s25, 1
  s_mul_i32 s26, s26, 40960
  s_add_u32 s26, s26, 40960
  s_add_u32 s12, s21, 0
  s_min_u32 s12, s12, 39936
  s_add_u32 m0, s12, s26
  s_add_u32 s12, s12, s20
  buffer_load_dwordx4 v2, s[8:11], s12 offen lds
  s_add_u32 s12, s21, 1024
  s_min_u32 s12, s12, 39936
  s_add_u32 m0, s12, s26
  s_add_u32 s12, s12, s20
  buffer_load_dwordx4 v2, s[8:11], s12 offen lds
  s_add_u32 s12, s21, 2048
  s_min_u32 s12, s12, 39936
  s_add_u32 m0, s12, s26
  s_add_u32 s12, s12, s20
  buffer_load_dwordx4 v2, s[8:11], s12 offen lds
  s_add_u32 s12, s21, 3072
  s_min_u32 s12, s12, 39936
  s_add_u32 m0, s12, s26
  s_add_u32 s12, s12, s20
  buffer_load_dwordx4 v2, s[8:11], s12 offen lds
  s_add_u32 s12, s21, 4096
  s_min_u32 s12, s12, 39936
  s_add_u32 m0, s12, s26
  s_add_u32 s12, s12, s20
  buffer_load_dwordx4 v2, s[8:11], s12 offen lds
  s_add_u32 s12, s21, 5120
  s_min_u32 s12, s12, 39936
  s_add_u32 m0, s12, s26
  s_add_u32 s12, s12, s20
  buffer_load_dwordx4 v2, s[8:11], s12 offen lds
  s_add_u32 s12, s21, 6144
  s_min_u32 s12, s12, 39936
  s_add_u32 m0, s12, s26
  s_add_u32 s12, s12, s20
  buffer_load_dwordx4 v2, s[8:11], s12 offen lds
  s_add_u32 s12, s21, 7168
  s_min_u32 s12, s12, 39936
  s_add_u32 m0, s12, s26
  s_add_u32 s12, s12, s20
  buffer_load_dwordx4 v2, s[8:11], s12 offen lds
  s_add_u32 s12, s21, 8192
  s_min_u32 s12, s12, 39936
  s_add_u32 m0, s12, s26
  s_add_u32 s12, s12, s20
  buffer_load_dwordx4 v2, s[8:11], s12 offen lds
  s_add_u32 s12, s21, 9216
  s_min_u32 s12, s12, 39936
  s_add_u32 m0, s12, s26
  s_add_u32 s12, s12, s20
  buffer_load_dwordx4 v2, s[8:11], s12 offen lds
  s_add_u32 s12, s21, 10240
  s_min_u32 s12, s12, 39936
  s_add_u32 m0, s12, s26
  s_add_u32 s12, s12, s20
  buffer_load_dwordx4 v2, s[8:11], s12 offen lds
  s_add_u32 s12, s21, 11264
  s_min_u32 s12, s12, 39936
  s_add_u32 m0, s12, s26
  s_add_u32 s12, s12, s20
  buffer_load_dwordx4 v2, s[8:11], s12 offen lds
  s_add_u32 s12, s21, 12288
  s_min_u32 s12, s12, 39936
  s_add_u32 m0, s12, s26
  s_add_u32 s12, s12, s20
  buffer_load_dwordx4 v2, s[8:11], s12 offen lds
  s_add_u32 s12, s21, 13312
  s_min_u32 s12, s12, 39936
  s_add_u32 m0, s12, s26
  s_add_u32 s12, s12, s20
  buffer_load_dwordx4 v2, s[8:11], s12 offen lds
  s_add_u32 s20, s20, 40960
  s_add_u32 s25, s25, 1
ch_s_p1:
  s_waitcnt vmcnt(0)
  s_barrier
  s_cmp_eq_u32 s3, 3
  s_cbranch_scc1 ch_s_p2
  s_and_b32 s12, s24, 1
  s_mul_i32 s12, s12, 40960
  s_add_u32 s12, s12, 40960
  v_add_u32 v40, s12, v2
  ds_read_b128 v[96:99], v40 offset:0
  ds_read_b128 v[100:103], v40 offset:20480
  ds_read_b128 v[104:107], v40 offset:1024
  ds_read_b128 v[108:111], v40 offset:21504
  ds_read_b128 v[112:115], v40 offset:2048
  ds_read_b128 v[116:119], v40 offset:22528
  ds_read_b128 v[120:123], v40 offset:3072
  ds_read_b128 v[124:127], v40 offset:23552
  ds_read_b128 v[128:131], v40 offset:4096
  ds_read_b128 v[132:135], v40 offset:24576
  ds_read_b128 v[136:139], v40 offset:5120
  ds_read_b128 v[140:143], v40 offset:25600
  s_cmp_eq_u32 s3, 2
  s_cbranch_scc1 ch_s_tvp0
  s_waitcnt lgkmcnt(11)
  v_mfma_f32_16x16x32_bf16 v[144:147], a[0:3], v[96:99], 0
  ds_read_b128 v[96:99], v40 offset:6144
  s_waitcnt lgkmcnt(11)
  v_mfma_f32_16x16x32_bf16 v[148:151], a[0:3], v[100:103], 0
  ds_read_b128 v[100:103], v40 offset:26624
  s_waitcnt lgkmcnt(11)
  v_mfma_f32_16x16x32_bf16 v[144:147], a[4:7], v[104:107], v[144:147]
  ds_read_b128 v[104:107], v40 offset:7168
  s_waitcnt lgkmcnt(11)
  v_mfma_f32_16x16x32_bf16 v[148:151], a[4:7], v[108:111], v[148:151]
  ds_read_b128 v[108:111], v40 offset:27648
  s_waitcnt lgkmcnt(11)
  v_mfma_f32_16x16x32_bf16 v[144:147], a[8:11], v[112:115], v[144:147]
  ds_read_b128 v[112:115], v40 offset:8192
  s_waitcnt lgkmcnt(11)
  v_mfma_f32_16x16x32_bf16 v[148:151], a[8:11], v[116:119], v[148:151]
  ds_read_b128 v[116:119], v40 offset:28672
  s_waitcnt lgkmcnt(11)
  v_mfma_f32_16x16x32_bf16 v[144:147], a[12:15], v[120:123], v[144:147]
  ds_read_b128 v[120:123], v40 offset:9216
  s_waitcnt lgkmcnt(11)
  v_mfma_f32_16x16x32_bf16 v[148:151], a[12:15], v[124:127], v[148:151]
  ds_read_b128 v[124:127], v40 offset:29696
  s_waitcnt lgkmcnt(11)
  v_mfma_f32_16x16x32_bf16 v[144:147], a[16:19], v[128:131], v[144:147]
  ds_read_b128 v[128:131], v40 offset:10240
  s_waitcnt lgkmcnt(11)
  v_mfma_f32_16x16x32_bf16 v[148:151], a[16:19], v[132:135], v[148:151]
  ds_read_b128 v[132:135], v40 offset:30720
  s_waitcnt lgkmcnt(11)
  v_mfma_f32_16x16x32_bf16 v[144:147], a[20:23], v[136:139], v[144:147]
  ds_read_b128 v[136:139], v40 offset:11264
  s_waitcnt lgkmcnt(11)
  v_mfma_f32_16x16x32_bf16 v[148:151], a[20:23], v[140:143], v[148:151]
  ds_read_b128 v[140:143], v40 offset:31744
  s_waitcnt lgkmcnt(11)
  v_mfma_f32_16x16x32_bf16 v[144:147], a[24:27], v[96:99], v[144:147]
  ds_read_b128 v[96:99], v40 offset:12288
  s_waitcnt lgkmcnt(11)
  v_mfma_f32_16x16x32_bf16 v[148:151], a[24:27], v[100:103], v[148:151]
  ds_read_b128 v[100:103], v40 offset:32768
  s_waitcnt lgkmcnt(11)
  v_mfma_f32_16x16x32_bf16 v[144:147], a[28:31], v[104:107], v[144:147]
  ds_read_b128 v[104:107], v40 offset:13312
  s_waitcnt lgkmcnt(11)
  v_mfma_f32_16x16x32_bf16 v[148:151], a[28:31], v[108:111], v[148:151]
  ds_read_b128 v[108:111], v40 offset:33792
  s_waitcnt lgkmcnt(11)
  v_mfma_f32_16x16x32_bf16 v[144:147], a[32:35], v[112:115], v[144:147]
  ds_read_b128 v[112:115], v40 offset:14336
  s_waitcnt lgkmcnt(11)
  v_mfma_f32_16x16x32_bf16 v[148:151], a[32:35], v[116:119], v[148:151]
  ds_read_b128 v[116:119], v40 offset:34816
  s_waitcnt lgkmcnt(11)
  v_mfma_f32_16x16x32_bf16 v[144:147], a[36:39], v[120:123], v[144:147]
  ds_read_b128 v[120:123], v40 offset:15360
  s_waitcnt lgkmcnt(11)
  v_mfma_f32_16x16x32_bf16 v[148:151], a[36:39], v[124:127], v[148:151]
  ds_read_b128 v[124:127], v40 offset:35840
  s_waitcnt lgkmcnt(11)
  v_mfma_f32_16x16x32_bf16 v[144:147], a[40:43], v[128:131], v[144:147]
  ds_read_b128 v[128:131], v40 offset:16384
  s_waitcnt lgkmcnt(11)
  v_mfma_f32_16x16x32_bf16 v[148:151], a[40:43], v[132:135], v[148:151]
  ds_read_b128 v[132:135], v40 offset:36864
  s_waitcnt lgkmcnt(11)
  v_mfma_f32_16x16x32_bf16 v[144:147], a[44:47], v[136:139], v[144:147]
  ds_read_b128 v[136:139], v40 offset:17408
  s_waitcnt lgkmcnt(11)
  v_mfma_f32_16x16x32_bf16 v[148:151], a[44:47], v[140:143], v[148:151]
  ds_read_b128 v[140:143], v40 offset:37888
  s_waitcnt lgkmcnt(11)
  v_mfma_f32_16x16x32_bf16 v[144:147], a[48:51], v[96:99], v[144:147]
  ds_read_b128 v[96:99], v40 offset:18432
  s_waitcnt lgkmcnt(11)
  v_mfma_f32_16x16x32_bf16 v[148:151], a[48:51], v[100:103], v[148:151]
  ds_read_b128 v[100:103], v40 offset:38912
  s_waitcnt lgkmcnt(11)
  v_mfma_f32_16x16x32_bf16 v[144:147], a[52:55], v[104:107], v[144:147]
  ds_read_b128 v[104:107], v40 offset:19456
  s_waitcnt lgkmcnt(11)
  v_mfma_f32_16x16x32_bf16 v[148:151], a[52:55], v[108:111], v[148:151]
  ds_read_b128 v[108:111], v40 offset:39936
  s_waitcnt lgkmcnt(11)
  v_mfma_f32_16x16x32_bf16 v[144:147], a[56:59], v[112:115], v[144:147]
  s_waitcnt lgkmcnt(10)
  v_mfma_f32_16x16x32_bf16 v[148:151], a[56:59], v[116:119], v[148:151]
  s_waitcnt lgkmcnt(9)
  v_mfma_f32_16x16x32_bf16 v[144:147], a[60:63], v[120:123], v[144:147]
  s_waitcnt lgkmcnt(8)
  v_mfma_f32_16x16x32_bf16 v[148:151], a[60:63], v[124:127], v[148:151]
  s_waitcnt lgkmcnt(7)
  v_mfma_f32_16x16x32_bf16 v[144:147], a[64:67], v[128:131], v[144:147]
  s_waitcnt lgkmcnt(6)
  v_mfma_f32_16x16x32_bf16 v[148:151], a[64:67], v[132:135], v[148:151]
  s_waitcnt lgkmcnt(5)
  v_mfma_f32_16x16x32_bf16 v[144:147], a[68:71], v[136:139], v[144:147]
  s_waitcnt lgkmcnt(4)
  v_mfma_f32_16x16x32_bf16 v[148:151], a[68:71], v[140:143], v[148:151]
  s_waitcnt lgkmcnt(3)
  v_mfma_f32_16x16x32_bf16 v[144:147], a[72:75], v[96:99], v[144:147]
  s_waitcnt lgkmcnt(2)
  v_mfma_f32_16x16x32_bf16 v[148:151], a[72:75], v[100:103], v[148:151]
  s_waitcnt lgkmcnt(1)
  v_mfma_f32_16x16x32_bf16 v[144:147], a[76:79], v[104:107], v[144:147]
  s_waitcnt lgkmcnt(0)
  v_mfma_f32_16x16x32_bf16 v[148:151], a[76:79], v[108:111], v[148:151]
  s_nop 7
  s_nop 7
  v_cvt_pk_bf16_f32 v152, v144, v145
  v_cvt_pk_bf16_f32 v153, v146, v147
  v_cvt_pk_bf16_f32 v154, v148, v149
  v_cvt_pk_bf16_f32 v155, v150, v151
  buffer_store_dwordx2 v[152:153], v42, s[8:11], s22 offen sc1
  s_add_u32 s12, s22, 262144
  buffer_store_dwordx2 v[154:155], v42, s[8:11], s12 offen sc1
  s_branch ch_s_tep0
ch_s_tvp0:
  s_waitcnt lgkmcnt(11)
  v_mfma_f32_16x16x32_bf16 v[144:147], v[96:99], a[0:3], 0
  ds_read_b128 v[96:99], v40 offset:6144
  s_waitcnt lgkmcnt(11)
  v_mfma_f32_16x16x32_bf16 v[148:151], v[100:103], a[0:3], 0
  ds_read_b128 v[100:103], v40 offset:26624
  s_waitcnt lgkmcnt(11)
  v_mfma_f32_16x16x32_bf16 v[144:147], v[104:107], a[4:7], v[144:147]
  ds_read_b128 v[104:107], v40 offset:7168
  s_waitcnt lgkmcnt(11)
  v_mfma_f32_16x16x32_bf16 v[148:151], v[108:111], a[4:7], v[148:151]
  ds_read_b128 v[108:111], v40 offset:27648
  s_waitcnt lgkmcnt(11)
  v_mfma_f32_16x16x32_bf16 v[144:147], v[112:115], a[8:11], v[144:147]
  ds_read_b128 v[112:115], v40 offset:8192
  s_waitcnt lgkmcnt(11)
  v_mfma_f32_16x16x32_bf16 v[148:151], v[116:119], a[8:11], v[148:151]
  ds_read_b128 v[116:119], v40 offset:28672
  s_waitcnt lgkmcnt(11)
  v_mfma_f32_16x16x32_bf16 v[144:147], v[120:123], a[12:15], v[144:147]
  ds_read_b128 v[120:123], v40 offset:9216
  s_waitcnt lgkmcnt(11)
  v_mfma_f32_16x16x32_bf16 v[148:151], v[124:127], a[12:15], v[148:151]
  ds_read_b128 v[124:127], v40 offset:29696
  s_waitcnt lgkmcnt(11)
  v_mfma_f32_16x16x32_bf16 v[144:147], v[128:131], a[16:19], v[144:147]
  ds_read_b128 v[128:131], v40 offset:10240
  s_waitcnt lgkmcnt(11)
  v_mfma_f32_16x16x32_bf16 v[148:151], v[132:135], a[16:19], v[148:151]
  ds_read_b128 v[132:135], v40 offset:30720
  s_waitcnt lgkmcnt(11)
  v_mfma_f32_16x16x32_bf16 v[144:147], v[136:139], a[20:23], v[144:147]
  ds_read_b128 v[136:139], v40 offset:11264
  s_waitcnt lgkmcnt(11)
  v_mfma_f32_16x16x32_bf16 v[148:151], v[140:143], a[20:23], v[148:151]
  ds_read_b128 v[140:143], v40 offset:31744
  s_waitcnt lgkmcnt(11)
  v_mfma_f32_16x16x32_bf16 v[144:147], v[96:99], a[24:27], v[144:147]
  ds_read_b128 v[96:99], v40 offset:12288
  s_waitcnt lgkmcnt(11)
  v_mfma_f32_16x16x32_bf16 v[148:151], v[100:103], a[24:27], v[148:151]
  ds_read_b128 v[100:103], v40 offset:32768
  s_waitcnt lgkmcnt(11)
  v_mfma_f32_16x16x32_bf16 v[144:147], v[104:107], a[28:31], v[144:147]
  ds_read_b128 v[104:107], v40 offset:13312
  s_waitcnt lgkmcnt(11)
  v_mfma_f32_16x16x32_bf16 v[148:151], v[108:111], a[28:31], v[148:151]
  ds_read_b128 v[108:111], v40 offset:33792
  s_waitcnt lgkmcnt(11)
  v_mfma_f32_16x16x32_bf16 v[144:147], v[112:115], a[32:35], v[144:147]
  ds_read_b128 v[112:115], v40 offset:14336
  s_waitcnt lgkmcnt(11)
  v_mfma_f32_16x16x32_bf16 v[148:151], v[116:119], a[32:35], v[148:151]
  ds_read_b128 v[116:119], v40 offset:34816
  s_waitcnt lgkmcnt(11)
  v_mfma_f32_16x16x32_bf16 v[144:147], v[120:123], a[36:39], v[144:147]
  ds_read_b128 v[120:123], v40 offset:15360
  s_waitcnt lgkmcnt(11)
  v_mfma_f32_16x16x32_bf16 v[148:151], v[124:127], a[36:39], v[148:151]
  ds_read_b128 v[124:127], v40 offset:35840
  s_waitcnt lgkmcnt(11)
  v_mfma_f32_16x16x32_bf16 v[144:147], v[128:131], a[40:43], v[144:147]
  ds_read_b128 v[128:131], v40 offset:16384
  s_waitcnt lgkmcnt(11)
  v_mfma_f32_16x16x32_bf16 v[148:151], v[132:135], a[40:43], v[148:151]
  ds_read_b128 v[132:135], v40 offset:36864
  s_waitcnt lgkmcnt(11)
  v_mfma_f32_16x16x32_bf16 v[144:147], v[136:139], a[44:47], v[144:147]
  ds_read_b128 v[136:139], v40 offset:17408
  s_waitcnt lgkmcnt(11)
  v_mfma_f32_16x16x32_bf16 v[148:151], v[140:143], a[44:47], v[148:151]
  ds_read_b128 v[140:143], v40 offset:37888
  s_waitcnt lgkmcnt(11)
  v_mfma_f32_16x16x32_bf16 v[144:147], v[96:99], a[48:51], v[144:147]
  ds_read_b128 v[96:99], v40 offset:18432
  s_waitcnt lgkmcnt(11)
  v_mfma_f32_16x16x32_bf16 v[148:151], v[100:103], a[48:51], v[148:151]
  ds_read_b128 v[100:103], v40 offset:38912
  s_waitcnt lgkmcnt(11)
  v_mfma_f32_16x16x32_bf16 v[144:147], v[104:107], a[52:55], v[144:147]
  ds_read_b128 v[104:107], v40 offset:19456
  s_waitcnt lgkmcnt(11)
  v_mfma_f32_16x16x32_bf16 v[148:151], v[108:111], a[52:55], v[148:151]
  ds_read_b128 v[108:111], v40 offset:39936
  s_waitcnt lgkmcnt(11)
  v_mfma_f32_16x16x32_bf16 v[144:147], v[112:115], a[56:59], v[144:147]
  s_waitcnt lgkmcnt(10)
  v_mfma_f32_16x16x32_bf16 v[148:151], v[116:119], a[56:59], v[148:151]
  s_waitcnt lgkmcnt(9)
  v_mfma_f32_16x16x32_bf16 v[144:147], v[120:123], a[60:63], v[144:147]
  s_waitcnt lgkmcnt(8)
  v_mfma_f32_16x16x32_bf16 v[148:151], v[124:127], a[60:63], v[148:151]
  s_waitcnt lgkmcnt(7)
  v_mfma_f32_16x16x32_bf16 v[144:147], v[128:131], a[64:67], v[144:147]
  s_waitcnt lgkmcnt(6)
  v_mfma_f32_16x16x32_bf16 v[148:151], v[132:135], a[64:67], v[148:151]
  s_waitcnt lgkmcnt(5)
  v_mfma_f32_16x16x32_bf16 v[144:147], v[136:139], a[68:71], v[144:147]
  s_waitcnt lgkmcnt(4)
  v_mfma_f32_16x16x32_bf16 v[148:151], v[140:143], a[68:71], v[148:151]
  s_waitcnt lgkmcnt(3)
  v_mfma_f32_16x16x32_bf16 v[144:147], v[96:99], a[72:75], v[144:147]
  s_waitcnt lgkmcnt(2)
  v_mfma_f32_16x16x32_bf16 v[148:151], v[100:103], a[72:75], v[148:151]
  s_waitcnt lgkmcnt(1)
  v_mfma_f32_16x16x32_bf16 v[144:147], v[104:107], a[76:79], v[144:147]
  s_waitcnt lgkmcnt(0)
  v_mfma_f32_16x16x32_bf16 v[148:151], v[108:111], a[76:79], v[148:151]
  s_nop 7
  s_nop 7
  v_cvt_pk_bf16_f32 v152, v144, v145
  v_cvt_pk_bf16_f32 v153, v146, v147
  v_cvt_pk_bf16_f32 v154, v148, v149
  v_cvt_pk_bf16_f32 v155, v150, v151
  buffer_store_dwordx4 v[152:155], v2, s[8:11], s23 offen sc1
ch_s_tep0:
  s_add_u32 s22, s22, 524288
  s_add_u32 s23, s23, 262144
  s_add_u32 s24, s24, 1
  s_bitset0_b32 s22, 22
  s_bitset0_b32 s23, 21
  s_and_b32 s12, s24, 1
  s_mul_i32 s12, s12, 40960
  s_add_u32 s12, s12, 40960
  v_add_u32 v40, s12, v2
  ds_read_b128 v[96:99], v40 offset:0
  ds_read_b128 v[100:103], v40 offset:20480
  ds_read_b128 v[104:107], v40 offset:1024
  ds_read_b128 v[108:111], v40 offset:21504
  ds_read_b128 v[112:115], v40 offset:2048
  ds_read_b128 v[116:119], v40 offset:22528
  ds_read_b128 v[120:123], v40 offset:3072
  ds_read_b128 v[124:127], v40 offset:23552
  ds_read_b128 v[128:131], v40 offset:4096
  ds_read_b128 v[132:135], v40 offset:24576
  ds_read_b128 v[136:139], v40 offset:5120
  ds_read_b128 v[140:143], v40 offset:25600
  s_cmp_eq_u32 s3, 2
  s_cbranch_scc1 ch_s_tvp1
  s_waitcnt lgkmcnt(11)
  v_mfma_f32_16x16x32_bf16 v[144:147], a[0:3], v[96:99], 0
  ds_read_b128 v[96:99], v40 offset:6144
  s_waitcnt lgkmcnt(11)
  v_mfma_f32_16x16x32_bf16 v[148:151], a[0:3], v[100:103], 0
  ds_read_b128 v[100:103], v40 offset:26624
  s_waitcnt lgkmcnt(11)
  v_mfma_f32_16x16x32_bf16 v[144:147], a[4:7], v[104:107], v[144:147]
  ds_read_b128 v[104:107], v40 offset:7168
  s_waitcnt lgkmcnt(11)
  v_mfma_f32_16x16x32_bf16 v[148:151], a[4:7], v[108:111], v[148:151]
  ds_read_b128 v[108:111], v40 offset:27648
  s_waitcnt lgkmcnt(11)
  v_mfma_f32_16x16x32_bf16 v[144:147], a[8:11], v[112:115], v[144:147]
  ds_read_b128 v[112:115], v40 offset:8192
  s_waitcnt lgkmcnt(11)
  v_mfma_f32_16x16x32_bf16 v[148:151], a[8:11], v[116:119], v[148:151]
  ds_read_b128 v[116:119], v40 offset:28672
  s_waitcnt lgkmcnt(11)
  v_mfma_f32_16x16x32_bf16 v[144:147], a[12:15], v[120:123], v[144:147]
  ds_read_b128 v[120:123], v40 offset:9216
  s_waitcnt lgkmcnt(11)
  v_mfma_f32_16x16x32_bf16 v[148:151], a[12:15], v[124:127], v[148:151]
  ds_read_b128 v[124:127], v40 offset:29696
  s_waitcnt lgkmcnt(11)
  v_mfma_f32_16x16x32_bf16 v[144:147], a[16:19], v[128:131], v[144:147]
  ds_read_b128 v[128:131], v40 offset:10240
  s_waitcnt lgkmcnt(11)
  v_mfma_f32_16x16x32_bf16 v[148:151], a[16:19], v[132:135], v[148:151]
  ds_read_b128 v[132:135], v40 offset:30720
  s_waitcnt lgkmcnt(11)
  v_mfma_f32_16x16x32_bf16 v[144:147], a[20:23], v[136:139], v[144:147]
  ds_read_b128 v[136:139], v40 offset:11264
  s_waitcnt lgkmcnt(11)
  v_mfma_f32_16x16x32_bf16 v[148:151], a[20:23], v[140:143], v[148:151]
  ds_read_b128 v[140:143], v40 offset:31744
  s_waitcnt lgkmcnt(11)
  v_mfma_f32_16x16x32_bf16 v[144:147], a[24:27], v[96:99], v[144:147]
  ds_read_b128 v[96:99], v40 offset:12288
  s_waitcnt lgkmcnt(11)
  v_mfma_f32_16x16x32_bf16 v[148:151], a[24:27], v[100:103], v[148:151]
  ds_read_b128 v[100:103], v40 offset:32768
  s_waitcnt lgkmcnt(11)
  v_mfma_f32_16x16x32_bf16 v[144:147], a[28:31], v[104:107], v[144:147]
  ds_read_b128 v[104:107], v40 offset:13312
  s_waitcnt lgkmcnt(11)
  v_mfma_f32_16x16x32_bf16 v[148:151], a[28:31], v[108:111], v[148:151]
  ds_read_b128 v[108:111], v40 offset:33792
  s_waitcnt lgkmcnt(11)
  v_mfma_f32_16x16x32_bf16 v[144:147], a[32:35], v[112:115], v[144:147]
  ds_read_b128 v[112:115], v40 offset:14336
  s_waitcnt lgkmcnt(11)
  v_mfma_f32_16x16x32_bf16 v[148:151], a[32:35], v[116:119], v[148:151]
  ds_read_b128 v[116:119], v40 offset:34816
  s_waitcnt lgkmcnt(11)
  v_mfma_f32_16x16x32_bf16 v[144:147], a[36:39], v[120:123], v[144:147]
  ds_read_b128 v[120:123], v40 offset:15360
  s_waitcnt lgkmcnt(11)
  v_mfma_f32_16x16x32_bf16 v[148:151], a[36:39], v[124:127], v[148:151]
  ds_read_b128 v[124:127], v40 offset:35840
  s_waitcnt lgkmcnt(11)
  v_mfma_f32_16x16x32_bf16 v[144:147], a[40:43], v[128:131], v[144:147]
  ds_read_b128 v[128:131], v40 offset:16384
  s_waitcnt lgkmcnt(11)
  v_mfma_f32_16x16x32_bf16 v[148:151], a[40:43], v[132:135], v[148:151]
  ds_read_b128 v[132:135], v40 offset:36864
  s_waitcnt lgkmcnt(11)
  v_mfma_f32_16x16x32_bf16 v[144:147], a[44:47], v[136:139], v[144:147]
  ds_read_b128 v[136:139], v40 offset:17408
  s_waitcnt lgkmcnt(11)
  v_mfma_f32_16x16x32_bf16 v[148:151], a[44:47], v[140:143], v[148:151]
  ds_read_b128 v[140:143], v40 offset:37888
  s_waitcnt lgkmcnt(11)
  v_mfma_f32_16x16x32_bf16 v[144:147], a[48:51], v[96:99], v[144:147]
  ds_read_b128 v[96:99], v40 offset:18432
  s_waitcnt lgkmcnt(11)
  v_mfma_f32_16x16x32_bf16 v[148:151], a[48:51], v[100:103], v[148:151]
  ds_read_b128 v[100:103], v40 offset:38912
  s_waitcnt lgkmcnt(11)
  v_mfma_f32_16x16x32_bf16 v[144:147], a[52:55], v[104:107], v[144:147]
  ds_read_b128 v[104:107], v40 offset:19456
  s_waitcnt lgkmcnt(11)
  v_mfma_f32_16x16x32_bf16 v[148:151], a[52:55], v[108:111], v[148:151]
  ds_read_b128 v[108:111], v40 offset:39936
  s_waitcnt lgkmcnt(11)
  v_mfma_f32_16x16x32_bf16 v[144:147], a[56:59], v[112:115], v[144:147]
  s_waitcnt lgkmcnt(10)
  v_mfma_f32_16x16x32_bf16 v[148:151], a[56:59], v[116:119], v[148:151]
  s_waitcnt lgkmcnt(9)
  v_mfma_f32_16x16x32_bf16 v[144:147], a[60:63], v[120:123], v[144:147]
  s_waitcnt lgkmcnt(8)
  v_mfma_f32_16x16x32_bf16 v[148:151], a[60:63], v[124:127], v[148:151]
  s_waitcnt lgkmcnt(7)
  v_mfma_f32_16x16x32_bf16 v[144:147], a[64:67], v[128:131], v[144:147]
  s_waitcnt lgkmcnt(6)
  v_mfma_f32_16x16x32_bf16 v[148:151], a[64:67], v[132:135], v[148:151]
  s_waitcnt lgkmcnt(5)
  v_mfma_f32_16x16x32_bf16 v[144:147], a[68:71], v[136:139], v[144:147]
  s_waitcnt lgkmcnt(4)
  v_mfma_f32_16x16x32_bf16 v[148:151], a[68:71], v[140:143], v[148:151]
  s_waitcnt lgkmcnt(3)
  v_mfma_f32_16x16x32_bf16 v[144:147], a[72:75], v[96:99], v[144:147]
  s_waitcnt lgkmcnt(2)
  v_mfma_f32_16x16x32_bf16 v[148:151], a[72:75], v[100:103], v[148:151]
  s_waitcnt lgkmcnt(1)
  v_mfma_f32_16x16x32_bf16 v[144:147], a[76:79], v[104:107], v[144:147]
  s_waitcnt lgkmcnt(0)
  v_mfma_f32_16x16x32_bf16 v[148:151], a[76:79], v[108:111], v[148:151]
  s_nop 7
  s_nop 7
  v_cvt_pk_bf16_f32 v152, v144, v145
  v_cvt_pk_bf16_f32 v153, v146, v147
  v_cvt_pk_bf16_f32 v154, v148, v149
  v_cvt_pk_bf16_f32 v155, v150, v151
  buffer_store_dwordx2 v[152:153], v42, s[8:11], s22 offen sc1
  s_add_u32 s12, s22, 262144
  buffer_store_dwordx2 v[154:155], v42, s[8:11], s12 offen sc1
  s_branch ch_s_tep1
ch_s_tvp1:
  s_waitcnt lgkmcnt(11)
  v_mfma_f32_16x16x32_bf16 v[144:147], v[96:99], a[0:3], 0
  ds_read_b128 v[96:99], v40 offset:6144
  s_waitcnt lgkmcnt(11)
  v_mfma_f32_16x16x32_bf16 v[148:151], v[100:103], a[0:3], 0
  ds_read_b128 v[100:103], v40 offset:26624
  s_waitcnt lgkmcnt(11)
  v_mfma_f32_16x16x32_bf16 v[144:147], v[104:107], a[4:7], v[144:147]
  ds_read_b128 v[104:107], v40 offset:7168
  s_waitcnt lgkmcnt(11)
  v_mfma_f32_16x16x32_bf16 v[148:151], v[108:111], a[4:7], v[148:151]
  ds_read_b128 v[108:111], v40 offset:27648
  s_waitcnt lgkmcnt(11)
  v_mfma_f32_16x16x32_bf16 v[144:147], v[112:115], a[8:11], v[144:147]
  ds_read_b128 v[112:115], v40 offset:8192
  s_waitcnt lgkmcnt(11)
  v_mfma_f32_16x16x32_bf16 v[148:151], v[116:119], a[8:11], v[148:151]
  ds_read_b128 v[116:119], v40 offset:28672
  s_waitcnt lgkmcnt(11)
  v_mfma_f32_16x16x32_bf16 v[144:147], v[120:123], a[12:15], v[144:147]
  ds_read_b128 v[120:123], v40 offset:9216
  s_waitcnt lgkmcnt(11)
  v_mfma_f32_16x16x32_bf16 v[148:151], v[124:127], a[12:15], v[148:151]
  ds_read_b128 v[124:127], v40 offset:29696
  s_waitcnt lgkmcnt(11)
  v_mfma_f32_16x16x32_bf16 v[144:147], v[128:131], a[16:19], v[144:147]
  ds_read_b128 v[128:131], v40 offset:10240
  s_waitcnt lgkmcnt(11)
  v_mfma_f32_16x16x32_bf16 v[148:151], v[132:135], a[16:19], v[148:151]
  ds_read_b128 v[132:135], v40 offset:30720
  s_waitcnt lgkmcnt(11)
  v_mfma_f32_16x16x32_bf16 v[144:147], v[136:139], a[20:23], v[144:147]
  ds_read_b128 v[136:139], v40 offset:11264
  s_waitcnt lgkmcnt(11)
  v_mfma_f32_16x16x32_bf16 v[148:151], v[140:143], a[20:23], v[148:151]
  ds_read_b128 v[140:143], v40 offset:31744
  s_waitcnt lgkmcnt(11)
  v_mfma_f32_16x16x32_bf16 v[144:147], v[96:99], a[24:27], v[144:147]
  ds_read_b128 v[96:99], v40 offset:12288
  s_waitcnt lgkmcnt(11)
  v_mfma_f32_16x16x32_bf16 v[148:151], v[100:103], a[24:27], v[148:151]
  ds_read_b128 v[100:103], v40 offset:32768
  s_waitcnt lgkmcnt(11)
  v_mfma_f32_16x16x32_bf16 v[144:147], v[104:107], a[28:31], v[144:147]
  ds_read_b128 v[104:107], v40 offset:13312
  s_waitcnt lgkmcnt(11)
  v_mfma_f32_16x16x32_bf16 v[148:151], v[108:111], a[28:31], v[148:151]
  ds_read_b128 v[108:111], v40 offset:33792
  s_waitcnt lgkmcnt(11)
  v_mfma_f32_16x16x32_bf16 v[144:147], v[112:115], a[32:35], v[144:147]
  ds_read_b128 v[112:115], v40 offset:14336
  s_waitcnt lgkmcnt(11)
  v_mfma_f32_16x16x32_bf16 v[148:151], v[116:119], a[32:35], v[148:151]
  ds_read_b128 v[116:119], v40 offset:34816
  s_waitcnt lgkmcnt(11)
  v_mfma_f32_16x16x32_bf16 v[144:147], v[120:123], a[36:39], v[144:147]
  ds_read_b128 v[120:123], v40 offset:15360
  s_waitcnt lgkmcnt(11)
  v_mfma_f32_16x16x32_bf16 v[148:151], v[124:127], a[36:39], v[148:151]
  ds_read_b128 v[124:127], v40 offset:35840
  s_waitcnt lgkmcnt(11)
  v_mfma_f32_16x16x32_bf16 v[144:147], v[128:131], a[40:43], v[144:147]
  ds_read_b128 v[128:131], v40 offset:16384
  s_waitcnt lgkmcnt(11)
  v_mfma_f32_16x16x32_bf16 v[148:151], v[132:135], a[40:43], v[148:151]
  ds_read_b128 v[132:135], v40 offset:36864
  s_waitcnt lgkmcnt(11)
  v_mfma_f32_16x16x32_bf16 v[144:147], v[136:139], a[44:47], v[144:147]
  ds_read_b128 v[136:139], v40 offset:17408
  s_waitcnt lgkmcnt(11)
  v_mfma_f32_16x16x32_bf16 v[148:151], v[140:143], a[44:47], v[148:151]
  ds_read_b128 v[140:143], v40 offset:37888
  s_waitcnt lgkmcnt(11)
  v_mfma_f32_16x16x32_bf16 v[144:147], v[96:99], a[48:51], v[144:147]
  ds_read_b128 v[96:99], v40 offset:18432
  s_waitcnt lgkmcnt(11)
  v_mfma_f32_16x16x32_bf16 v[148:151], v[100:103], a[48:51], v[148:151]
  ds_read_b128 v[100:103], v40 offset:38912
  s_waitcnt lgkmcnt(11)
  v_mfma_f32_16x16x32_bf16 v[144:147], v[104:107], a[52:55], v[144:147]
  ds_read_b128 v[104:107], v40 offset:19456
  s_waitcnt lgkmcnt(11)
  v_mfma_f32_16x16x32_bf16 v[148:151], v[108:111], a[52:55], v[148:151]
  ds_read_b128 v[108:111], v40 offset:39936
  s_waitcnt lgkmcnt(11)
  v_mfma_f32_16x16x32_bf16 v[144:147], v[112:115], a[56:59], v[144:147]
  s_waitcnt lgkmcnt(10)
  v_mfma_f32_16x16x32_bf16 v[148:151], v[116:119], a[56:59], v[148:151]
  s_waitcnt lgkmcnt(9)
  v_mfma_f32_16x16x32_bf16 v[144:147], v[120:123], a[60:63], v[144:147]
  s_waitcnt lgkmcnt(8)
  v_mfma_f32_16x16x32_bf16 v[148:151], v[124:127], a[60:63], v[148:151]
  s_waitcnt lgkmcnt(7)
  v_mfma_f32_16x16x32_bf16 v[144:147], v[128:131], a[64:67], v[144:147]
  s_waitcnt lgkmcnt(6)
  v_mfma_f32_16x16x32_bf16 v[148:151], v[132:135], a[64:67], v[148:151]
  s_waitcnt lgkmcnt(5)
  v_mfma_f32_16x16x32_bf16 v[144:147], v[136:139], a[68:71], v[144:147]
  s_waitcnt lgkmcnt(4)
  v_mfma_f32_16x16x32_bf16 v[148:151], v[140:143], a[68:71], v[148:151]
  s_waitcnt lgkmcnt(3)
  v_mfma_f32_16x16x32_bf16 v[144:147], v[96:99], a[72:75], v[144:147]
  s_waitcnt lgkmcnt(2)
  v_mfma_f32_16x16x32_bf16 v[148:151], v[100:103], a[72:75], v[148:151]
  s_waitcnt lgkmcnt(1)
  v_mfma_f32_16x16x32_bf16 v[144:147], v[104:107], a[76:79], v[144:147]
  s_waitcnt lgkmcnt(0)
  v_mfma_f32_16x16x32_bf16 v[148:151], v[108:111], a[76:79], v[148:151]
  s_nop 7
  s_nop 7
  v_cvt_pk_bf16_f32 v152, v144, v145
  v_cvt_pk_bf16_f32 v153, v146, v147
  v_cvt_pk_bf16_f32 v154, v148, v149
  v_cvt_pk_bf16_f32 v155, v150, v151
  buffer_store_dwordx4 v[152:155], v2, s[8:11], s23 offen sc1
ch_s_tep1:
  s_add_u32 s22, s22, 524288
  s_add_u32 s23, s23, 262144
  s_add_u32 s24, s24, 1
  s_bitset0_b32 s22, 22
  s_bitset0_b32 s23, 21
ch_s_p2:
  s_waitcnt vmcnt(0)
  s_barrier
  s_cmp_eq_u32 s3, 3
  s_cbranch_scc1 ch_s_p3
  s_and_b32 s26, s25, 1
  s_mul_i32 s26, s26, 40960
  s_add_u32 s26, s26, 40960
  s_add_u32 s12, s21, 0
  s_min_u32 s12, s12, 39936
  s_add_u32 m0, s12, s26
  s_add_u32 s12, s12, s20
  buffer_load_dwordx4 v2, s[8:11], s12 offen lds
  s_add_u32 s12, s21, 1024
  s_min_u32 s12, s12, 39936
  s_add_u32 m0, s12, s26
  s_add_u32 s12, s12, s20
  buffer_load_dwordx4 v2, s[8:11], s12 offen lds
  s_add_u32 s12, s21, 2048
  s_min_u32 s12, s12, 39936
  s_add_u32 m0, s12, s26
  s_add_u32 s12, s12, s20
  buffer_load_dwordx4 v2, s[8:11], s12 offen lds
  s_add_u32 s12, s21, 3072
  s_min_u32 s12, s12, 39936
  s_add_u32 m0, s12, s26
  s_add_u32 s12, s12, s20
  buffer_load_dwordx4 v2, s[8:11], s12 offen lds
  s_add_u32 s12, s21, 4096
  s_min_u32 s12, s12, 39936
  s_add_u32 m0, s12, s26
  s_add_u32 s12, s12, s20
  buffer_load_dwordx4 v2, s[8:11], s12 offen lds
  s_add_u32 s12, s21, 5120
  s_min_u32 s12, s12, 39936
  s_add_u32 m0, s12, s26
  s_add_u32 s12, s12, s20
  buffer_load_dwordx4 v2, s[8:11], s12 offen lds
  s_add_u32 s12, s21, 6144
  s_min_u32 s12, s12, 39936
  s_add_u32 m0, s12, s26
  s_add_u32 s12, s12, s20
  buffer_load_dwordx4 v2, s[8:11], s12 offen lds
  s_add_u32 s12, s21, 7168
  s_min_u32 s12, s12, 39936
  s_add_u32 m0, s12, s26
  s_add_u32 s12, s12, s20
  buffer_load_dwordx4 v2, s[8:11], s12 offen lds
  s_add_u32 s12, s21, 8192
  s_min_u32 s12, s12, 39936
  s_add_u32 m0, s12, s26
  s_add_u32 s12, s12, s20
  buffer_load_dwordx4 v2, s[8:11], s12 offen lds
  s_add_u32 s12, s21, 9216
  s_min_u32 s12, s12, 39936
  s_add_u32 m0, s12, s26
  s_add_u32 s12, s12, s20
  buffer_load_dwordx4 v2, s[8:11], s12 offen lds
  s_add_u32 s12, s21, 10240
  s_min_u32 s12, s12, 39936
  s_add_u32 m0, s12, s26
  s_add_u32 s12, s12, s20
  buffer_load_dwordx4 v2, s[8:11], s12 offen lds
  s_add_u32 s12, s21, 11264
  s_min_u32 s12, s12, 39936
  s_add_u32 m0, s12, s26
  s_add_u32 s12, s12, s20
  buffer_load_dwordx4 v2, s[8:11], s12 offen lds
  s_add_u32 s12, s21, 12288
  s_min_u32 s12, s12, 39936
  s_add_u32 m0, s12, s26
  s_add_u32 s12, s12, s20
  buffer_load_dwordx4 v2, s[8:11], s12 offen lds
  s_add_u32 s12, s21, 13312
  s_min_u32 s12, s12, 39936
  s_add_u32 m0, s12, s26
  s_add_u32 s12, s12, s20
  buffer_load_dwordx4 v2, s[8:11], s12 offen lds
  s_add_u32 s20, s20, 40960
  s_add_u32 s25, s25, 1
  s_cmp_eq_u32 s3, 0
  s_cbranch_scc0 ch_s_p3
  s_lshl_b32 s12, s40, 2
  s_add_u32 s12, s12, 64
  v_mov_b32 v44, 1
  v_mov_b32 v45, s12
  s_mov_b64 exec, 1
  buffer_atomic_add v44, v45, s[64:67], 0 offen sc1
  s_mov_b32 s61, 65536
ch_s_sy:
  buffer_load_dword v46, v45, s[64:67], 0 offen sc1
  s_waitcnt vmcnt(0)
  v_readfirstlane_b32 s12, v46
  s_sub_u32 s61, s61, 1
  s_cmp_eq_u32 s61, 0
  s_cbranch_scc1 ch_s_sy2
  s_cmp_lt_u32 s12, 32
  s_cbranch_scc1 ch_s_sy
ch_s_sy2:
  s_mov_b64 exec, -1
ch_s_p3:
  s_barrier
  s_cmp_ge_u32 s41, 20
  s_cbranch_scc1 ch_s_nopf0
  s_add_u32 s12, s54, 0
  buffer_load_dwordx4 a[112:115], v2, s[8:11], s12 offen offset:0 sc1
  buffer_load_dwordx4 a[116:119], v2, s[8:11], s12 offen offset:1024 sc1
  buffer_load_dwordx4 a[120:123], v2, s[8:11], s12 offen offset:2048 sc1
  buffer_load_dwordx4 a[124:127], v2, s[8:11], s12 offen offset:3072 sc1
  s_add_u32 s12, s54, 262144
  buffer_load_dwordx4 a[128:131], v2, s[8:11], s12 offen offset:0 sc1
  buffer_load_dwordx4 a[132:135], v2, s[8:11], s12 offen offset:1024 sc1
  buffer_load_dwordx4 a[136:139], v2, s[8:11], s12 offen offset:2048 sc1
  buffer_load_dwordx4 a[140:143], v2, s[8:11], s12 offen offset:3072 sc1
  s_add_u32 s54, s54, 524288
  s_bitset0_b32 s54, 22
  s_add_u32 s12, s55, 0
  buffer_load_dwordx4 a[144:147], v2, s[8:11], s12 offen offset:0 sc1
  buffer_load_dwordx4 a[148:151], v2, s[8:11], s12 offen offset:1024 sc1
  buffer_load_dwordx4 a[152:155], v2, s[8:11], s12 offen offset:2048 sc1
  buffer_load_dwordx4 a[156:159], v2, s[8:11], s12 offen offset:3072 sc1
  s_add_u32 s12, s55, 4096
  buffer_load_dwordx4 a[160:163], v2, s[8:11], s12 offen offset:0 sc1
  buffer_load_dwordx4 a[164:167], v2, s[8:11], s12 offen offset:1024 sc1
  buffer_load_dwordx4 a[168:171], v2, s[8:11], s12 offen offset:2048 sc1
  buffer_load_dwordx4 a[172:175], v2, s[8:11], s12 offen offset:3072 sc1
  s_add_u32 s55, s55, 262144
  s_bitset0_b32 s55, 21
ch_s_nopf0:
  s_mul_i32 s92, s40, 10240
  s_add_u32 s92, s92, 83886080
  s_mul_i32 s93, s45, 6144
  s_add_u32 s93, s93, 89210880
  s_mul_i32 s94, s46, 6144
  s_add_u32 s94, s94, 89210880
  s_lshl_b32 s95, s41, 10
  s_add_u32 s95, s95, 101793792
  s_sub_u32 s12, s41, 20
  s_lshr_b32 s12, s12, 1
  s_add_u32 s12, s12, s44
  s_and_b32 s91, s41, 1
  s_lshl_b32 s13, s12, 12
  s_lshl_b32 s14, s91, 18
  s_add_u32 s68, s13, s14
  s_add_u32 s68, s68, 33554432
  s_add_u32 s69, s13, 33685504
  s_lshl_b32 s70, s12, 13
  s_add_u32 s70, s70, 67108864
  s_mul_i32 s71, s12, 6144
  s_add_u32 s71, s71, 89210880
  s_lshl_b32 s14, s91, 17
  s_add_u32 s88, s13, s14
  s_add_u32 s88, s88, 112283648
  s_mov_b32 s89, 0
  s_mov_b32 s90, 0
  s_cmp_eq_u32 s3, 3
  s_cbranch_scc0 ch_s_not
  s_cmp_lt_u32 s41, 20
  s_cbranch_scc1 ch_s_not
  s_cmp_ge_u32 s41, 28
  s_cbranch_scc1 ch_s_not
  s_mov_b32 s90, 1
  buffer_load_dwordx4 v[64:67], v2, s[8:11], s68 offen offset:0 sc1
  buffer_load_dwordx4 v[68:71], v2, s[8:11], s68 offen offset:1024 sc1
  buffer_load_dwordx4 v[72:75], v2, s[8:11], s68 offen offset:2048 sc1
  buffer_load_dwordx4 v[76:79], v2, s[8:11], s68 offen offset:3072 sc1
  s_add_u32 s12, s69, 0
  buffer_load_dwordx4 v[96:99], v2, s[8:11], s12 offen offset:0 sc1
  buffer_load_dwordx4 v[100:103], v2, s[8:11], s12 offen offset:1024 sc1
  buffer_load_dwordx4 v[104:107], v2, s[8:11], s12 offen offset:2048 sc1
  buffer_load_dwordx4 v[108:111], v2, s[8:11], s12 offen offset:3072 sc1
  s_add_u32 s12, s69, 262144
  buffer_load_dwordx4 v[112:115], v2, s[8:11], s12 offen offset:0 sc1
  buffer_load_dwordx4 v[116:119], v2, s[8:11], s12 offen offset:1024 sc1
  buffer_load_dwordx4 v[120:123], v2, s[8:11], s12 offen offset:2048 sc1
  buffer_load_dwordx4 v[124:127], v2, s[8:11], s12 offen offset:3072 sc1
  s_add_u32 s12, s70, 0
  buffer_load_dwordx4 v[144:147], v2, s[8:11], s12 offen offset:0 sc1
  buffer_load_dwordx4 v[148:151], v2, s[8:11], s12 offen offset:1024 sc1
  buffer_load_dwordx4 v[152:155], v2, s[8:11], s12 offen offset:2048 sc1
  buffer_load_dwordx4 v[156:159], v2, s[8:11], s12 offen offset:3072 sc1
  s_add_u32 s12, s70, 4096
  buffer_load_dwordx4 v[160:163], v2, s[8:11], s12 offen offset:0 sc1
  buffer_load_dwordx4 v[164:167], v2, s[8:11], s12 offen offset:1024 sc1
  buffer_load_dwordx4 v[168:171], v2, s[8:11], s12 offen offset:2048 sc1
  buffer_load_dwordx4 v[172:175], v2, s[8:11], s12 offen offset:3072 sc1
  s_add_u32 s68, s68, 524288
  s_add_u32 s69, s69, 524288
  s_add_u32 s70, s70, 262144
  s_bitset0_b32 s68, 22
  s_bitset0_b32 s69, 22
  s_bitset0_b32 s70, 21
ch_s_not:
  s_lshr_b32 s12, s43, 1
  s_lshl_b32 s12, s12, 9
  s_and_b32 s13, s43, 1
  s_lshl_b32 s13, s13, 3
  s_add_u32 s12, s12, s13
  s_lshl_b32 s13, s3, 11
  s_add_u32 s12, s12, s13
  s_cmp_eq_u32 s3, 2
  s_cbranch_scc1 ch_s_vo
  v_add_u32 v22, s12, v12
  s_branch ch_s_vo2
ch_s_vo:
  v_add_u32 v22, s12, v14
ch_s_vo2:
  s_mov_b32 s60, 0
  v_mov_b32 v192, 0
  v_mov_b32 v193, 0
  v_mov_b32 v194, 0
  v_mov_b32 v195, 0
  v_mov_b32 v196, 0
  v_mov_b32 v197, 0
  v_mov_b32 v198, 0
  v_mov_b32 v199, 0
  v_mov_b32 v200, 0
  v_mov_b32 v201, 0
  v_mov_b32 v202, 0
  v_mov_b32 v203, 0
  v_mov_b32 v204, 0
  v_mov_b32 v205, 0
  v_mov_b32 v206, 0
  v_mov_b32 v207, 0
  v_mov_b32 v208, 0
  v_mov_b32 v209, 0
  v_mov_b32 v210, 0
  v_mov_b32 v211, 0
  v_mov_b32 v212, 0
  v_mov_b32 v213, 0
  v_mov_b32 v214, 0
  v_mov_b32 v215, 0
  v_mov_b32 v216, 0
  v_mov_b32 v217, 0
  v_mov_b32 v218, 0
  v_mov_b32 v219, 0
  v_mov_b32 v220, 0
  v_mov_b32 v221, 0
  v_mov_b32 v222, 0
  v_mov_b32 v223, 0
  v_mov_b32 v224, 0
  v_mov_b32 v225, 0
  v_mov_b32 v226, 0
  v_mov_b32 v227, 0
  v_mov_b32 v228, 0
  v_mov_b32 v229, 0
  v_mov_b32 v230, 0
  v_mov_b32 v231, 0
  v_mov_b32 v232, 0
  v_mov_b32 v233, 0
  v_mov_b32 v234, 0
  v_mov_b32 v235, 0
  v_mov_b32 v236, 0
  v_mov_b32 v237, 0
  v_mov_b32 v238, 0
  v_mov_b32 v239, 0
  v_mov_b32 v240, 0x3f803f80
  v_mov_b32 v241, 0x3f803f80
  v_mov_b32 v242, 0x3f803f80
  v_mov_b32 v243, 0x3f803f80
  s_lshl_b32 s62, s3, 10
  v_add_u32 v23, s62, v2
  s_cmp_eq_u32 s3, 0
  s_cselect_b32 s67, 9216, 0
  s_waitcnt vmcnt(0)
ch_s_loop:
  s_and_b32 s12, s60, 7
  s_mul_i32 s13, s12, 81920
  s_add_u32 s56, s92, s13
  s_mul_i32 s13, s12, 196608
  s_add_u32 s57, s93, s13
  s_add_u32 s58, s94, s13
  s_mul_i32 s13, s12, 163840
  s_add_u32 s59, s95, s13
  s_add_u32 s47, s60, 2
  s_and_b32 s47, s47, 7
  s_and_b32 s12, s60, 1
  s_mul_i32 s63, s12, 10240
  s_add_u32 s63, s63, 16448
  v_add_u32 v18, s63, v23
  s_cmp_eq_u32 s3, 3
  s_cbranch_scc0 ch_s_nw
  s_cmp_gt_u32 s60, 61
  s_cbranch_scc1 ch_s_nw
  s_cmp_lt_u32 s41, 20
  s_cbranch_scc1 ch_s_nw
  s_mul_i32 s12, s47, 196608
  s_mul_i32 s13, s44, 6144
  s_add_u32 s12, s12, s13
  s_add_u32 s12, s12, 89210880
  s_lshl_b32 s13, s41, 10
  s_add_u32 s12, s12, s13
  s_mul_i32 s15, s47, 81920
  s_add_u32 s15, s15, s92
  s_sub_u32 s14, s15, 24576
  s_add_u32 s14, s14, s13
  s_cmp_lt_u32 s41, 24
  s_cselect_b32 s12, s12, s14
  buffer_store_dwordx4 v[56:59], v2, s[8:11], s12 offen sc1
  s_add_u32 s14, s15, 8192
  s_and_b32 s13, s13, 1024
  s_add_u32 s14, s14, s13
  buffer_store_dwordx4 v[56:59], v2, s[8:11], s14 offen sc1
  s_waitcnt vmcnt(0)
ch_s_nw:
  s_cmp_eq_u32 s3, 3
  s_cbranch_scc1 ch_s_A3
  s_add_u32 s64, s56, 3072
  s_add_u32 s65, s56, 6144
  s_add_u32 s66, s56, s67
  s_mov_b32 s61, 65536
ch_s_Ap:
  buffer_load_dwordx4 v[64:67], v23, s[8:11], s56 offen sc1
  buffer_load_dwordx4 v[68:71], v23, s[8:11], s64 offen sc1
  buffer_load_dwordx4 v[72:75], v23, s[8:11], s65 offen sc1
  buffer_load_dwordx4 v[76:79], v23, s[8:11], s66 offen sc1
  s_waitcnt vmcnt(0)
  v_max3_u32 v8, v64, v66, v68
  v_max3_u32 v9, v70, v72, v74
  v_max3_u32 v8, v8, v76, v78
  v_max_u32 v8, v8, v9
  v_cmp_eq_u32 vcc, -1, v8
  s_sub_u32 s61, s61, 1
  s_cmp_eq_u32 s61, 0
  s_cbranch_scc1 ch_s_Ad0
  s_cbranch_vccz ch_s_Ad0
  buffer_load_dwordx4 v[80:83], v23, s[8:11], s56 offen sc1
  buffer_load_dwordx4 v[84:87], v23, s[8:11], s64 offen sc1
  buffer_load_dwordx4 v[88:91], v23, s[8:11], s65 offen sc1
  buffer_load_dwordx4 v[92:95], v23, s[8:11], s66 offen sc1
  s_waitcnt vmcnt(0)
  v_max3_u32 v8, v80, v82, v84
  v_max3_u32 v9, v86, v88, v90
  v_max3_u32 v8, v8, v92, v94
  v_max_u32 v8, v8, v9
  v_cmp_eq_u32 vcc, -1, v8
  s_sub_u32 s61, s61, 1
  s_cmp_eq_u32 s61, 0
  s_cbranch_scc1 ch_s_Ad1
  s_cbranch_vccz ch_s_Ad1
  s_branch ch_s_Ap
ch_s_Ad0:
  ds_write_b128 v18, v[64:67]
  ds_write_b128 v18, v[68:71] offset:3072
  ds_write_b128 v18, v[72:75] offset:6144
  s_cmp_eq_u32 s3, 0
  s_cbranch_scc0 ch_s_A3
  ds_write_b128 v18, v[76:79] offset:9216
  s_branch ch_s_A3
ch_s_Ad1:
  ds_write_b128 v18, v[80:83]
  ds_write_b128 v18, v[84:87] offset:3072
  ds_write_b128 v18, v[88:91] offset:6144
  s_cmp_eq_u32 s3, 0
  s_cbranch_scc0 ch_s_A3
  ds_write_b128 v18, v[92:95] offset:9216
  s_branch ch_s_A3
ch_s_A3:
  v_add_u32 v18, s63, v12
  s_waitcnt lgkmcnt(0)
  s_barrier
  s_cmp_eq_u32 s3, 3
  s_cbranch_scc1 ch_s_B
  ds_read_b128 v[96:99], v18 offset:0
  ds_read_b128 v[100:103], v18 offset:512
  ds_read_b128 v[104:107], v18 offset:1024
  ds_read_b128 v[108:111], v18 offset:1536
  ds_read_b128 v[112:115], v18 offset:2048
  ds_read_b128 v[116:119], v18 offset:2560
  ds_read_b128 v[120:123], v18 offset:3072
  ds_read_b128 v[124:127], v18 offset:3584
  ds_read_b128 v[128:131], v18 offset:4096
  ds_read_b128 v[132:135], v18 offset:4608
  ds_read_b128 v[136:139], v18 offset:5120
  ds_read_b128 v[140:143], v18 offset:5632
  s_cmp_eq_u32 s3, 2
  s_cbranch_scc1 ch_s_Av
  s_waitcnt lgkmcnt(11)
  v_mfma_f32_16x16x32_bf16 v[180:183], a[0:3], v[96:99], 0
  ds_read_b128 v[96:99], v18 offset:6144
  s_waitcnt lgkmcnt(11)
  v_mfma_f32_16x16x32_bf16 v[180:183], a[4:7], v[100:103], v[180:183]
  ds_read_b128 v[100:103], v18 offset:6656
  s_waitcnt lgkmcnt(11)
  v_mfma_f32_16x16x32_bf16 v[180:183], a[8:11], v[104:107], v[180:183]
  ds_read_b128 v[104:107], v18 offset:7168
  s_waitcnt lgkmcnt(11)
  v_mfma_f32_16x16x32_bf16 v[180:183], a[12:15], v[108:111], v[180:183]
  ds_read_b128 v[108:111], v18 offset:7680
  s_waitcnt lgkmcnt(11)
  v_mfma_f32_16x16x32_bf16 v[180:183], a[16:19], v[112:115], v[180:183]
  ds_read_b128 v[112:115], v18 offset:8192
  s_waitcnt lgkmcnt(11)
  v_mfma_f32_16x16x32_bf16 v[180:183], a[20:23], v[116:119], v[180:183]
  ds_read_b128 v[116:119], v18 offset:8704
  s_waitcnt lgkmcnt(11)
  v_mfma_f32_16x16x32_bf16 v[180:183], a[24:27], v[120:123], v[180:183]
  ds_read_b128 v[120:123], v18 offset:9216
  s_waitcnt lgkmcnt(11)
  v_mfma_f32_16x16x32_bf16 v[180:183], a[28:31], v[124:127], v[180:183]
  ds_read_b128 v[124:127], v18 offset:9728
  s_waitcnt lgkmcnt(11)
  v_mfma_f32_16x16x32_bf16 v[180:183], a[32:35], v[128:131], v[180:183]
  s_waitcnt lgkmcnt(10)
  v_mfma_f32_16x16x32_bf16 v[180:183], a[36:39], v[132:135], v[180:183]
  s_waitcnt lgkmcnt(9)
  v_mfma_f32_16x16x32_bf16 v[180:183], a[40:43], v[136:139], v[180:183]
  s_waitcnt lgkmcnt(8)
  v_mfma_f32_16x16x32_bf16 v[180:183], a[44:47], v[140:143], v[180:183]
  s_waitcnt lgkmcnt(7)
  v_mfma_f32_16x16x32_bf16 v[180:183], a[48:51], v[96:99], v[180:183]
  s_waitcnt lgkmcnt(6)
  v_mfma_f32_16x16x32_bf16 v[180:183], a[52:55], v[100:103], v[180:183]
  s_waitcnt lgkmcnt(5)
  v_mfma_f32_16x16x32_bf16 v[180:183], a[56:59], v[104:107], v[180:183]
  s_waitcnt lgkmcnt(4)
  v_mfma_f32_16x16x32_bf16 v[180:183], a[60:63], v[108:111], v[180:183]
  s_waitcnt lgkmcnt(3)
  v_mfma_f32_16x16x32_bf16 v[180:183], a[64:67], v[112:115], v[180:183]
  s_waitcnt lgkmcnt(2)
  v_mfma_f32_16x16x32_bf16 v[180:183], a[68:71], v[116:119], v[180:183]
  s_waitcnt lgkmcnt(1)
  v_mfma_f32_16x16x32_bf16 v[180:183], a[72:75], v[120:123], v[180:183]
  s_waitcnt lgkmcnt(0)
  v_mfma_f32_16x16x32_bf16 v[180:183], a[76:79], v[124:127], v[180:183]
  s_nop 7
  v_cvt_pk_bf16_f32 v188, v180, v181
  v_cvt_pk_bf16_f32 v189, v182, v183
  v_min_u32 v188, v188, v21
  s_mov_b64 exec, s[50:51]
  buffer_store_dwordx2 v[188:189], v22, s[8:11], s57 offen sc1
  s_mov_b64 exec, -1
  s_branch ch_s_B
ch_s_Av:
  s_waitcnt lgkmcnt(11)
  v_mfma_f32_16x16x32_bf16 v[180:183], v[96:99], a[0:3], 0
  ds_read_b128 v[96:99], v18 offset:6144
  s_waitcnt lgkmcnt(11)
  v_mfma_f32_16x16x32_bf16 v[180:183], v[100:103], a[4:7], v[180:183]
  ds_read_b128 v[100:103], v18 offset:6656
  s_waitcnt lgkmcnt(11)
  v_mfma_f32_16x16x32_bf16 v[180:183], v[104:107], a[8:11], v[180:183]
  ds_read_b128 v[104:107], v18 offset:7168
  s_waitcnt lgkmcnt(11)
  v_mfma_f32_16x16x32_bf16 v[180:183], v[108:111], a[12:15], v[180:183]
  ds_read_b128 v[108:111], v18 offset:7680
  s_waitcnt lgkmcnt(11)
  v_mfma_f32_16x16x32_bf16 v[180:183], v[112:115], a[16:19], v[180:183]
  ds_read_b128 v[112:115], v18 offset:8192
  s_waitcnt lgkmcnt(11)
  v_mfma_f32_16x16x32_bf16 v[180:183], v[116:119], a[20:23], v[180:183]
  ds_read_b128 v[116:119], v18 offset:8704
  s_waitcnt lgkmcnt(11)
  v_mfma_f32_16x16x32_bf16 v[180:183], v[120:123], a[24:27], v[180:183]
  ds_read_b128 v[120:123], v18 offset:9216
  s_waitcnt lgkmcnt(11)
  v_mfma_f32_16x16x32_bf16 v[180:183], v[124:127], a[28:31], v[180:183]
  ds_read_b128 v[124:127], v18 offset:9728
  s_waitcnt lgkmcnt(11)
  v_mfma_f32_16x16x32_bf16 v[180:183], v[128:131], a[32:35], v[180:183]
  s_waitcnt lgkmcnt(10)
  v_mfma_f32_16x16x32_bf16 v[180:183], v[132:135], a[36:39], v[180:183]
  s_waitcnt lgkmcnt(9)
  v_mfma_f32_16x16x32_bf16 v[180:183], v[136:139], a[40:43], v[180:183]
  s_waitcnt lgkmcnt(8)
  v_mfma_f32_16x16x32_bf16 v[180:183], v[140:143], a[44:47], v[180:183]
  s_waitcnt lgkmcnt(7)
  v_mfma_f32_16x16x32_bf16 v[180:183], v[96:99], a[48:51], v[180:183]
  s_waitcnt lgkmcnt(6)
  v_mfma_f32_16x16x32_bf16 v[180:183], v[100:103], a[52:55], v[180:183]
  s_waitcnt lgkmcnt(5)
  v_mfma_f32_16x16x32_bf16 v[180:183], v[104:107], a[56:59], v[180:183]
  s_waitcnt lgkmcnt(4)
  v_mfma_f32_16x16x32_bf16 v[180:183], v[108:111], a[60:63], v[180:183]
  s_waitcnt lgkmcnt(3)
  v_mfma_f32_16x16x32_bf16 v[180:183], v[112:115], a[64:67], v[180:183]
  s_waitcnt lgkmcnt(2)
  v_mfma_f32_16x16x32_bf16 v[180:183], v[116:119], a[68:71], v[180:183]
  s_waitcnt lgkmcnt(1)
  v_mfma_f32_16x16x32_bf16 v[180:183], v[120:123], a[72:75], v[180:183]
  s_waitcnt lgkmcnt(0)
  v_mfma_f32_16x16x32_bf16 v[180:183], v[124:127], a[76:79], v[180:183]
  s_nop 7
  v_cvt_pk_bf16_f32 v188, v180, v181
  v_cvt_pk_bf16_f32 v189, v182, v183
  v_min_u32 v188, v188, v21
  s_mov_b64 exec, s[52:53]
  buffer_store_dwordx2 v[188:189], v22, s[8:11], s57 offen sc1
  s_mov_b64 exec, -1
ch_s_B:
  s_cmp_ge_u32 s41, 20
  s_cbranch_scc1 ch_s_hi
  s_cmp_eq_u32 s60, 63
  s_cbranch_scc1 ch_s_end
  s_sleep 4
ch_s_bsd:
  s_mov_b32 s61, 65536
ch_s_Bp:
  s_mov_b64 exec, s[50:51]
  buffer_load_dwordx4 v[192:195], v12, s[8:11], s58 offen offset:0 sc1
  buffer_load_dwordx4 v[196:199], v12, s[8:11], s58 offen offset:512 sc1
  buffer_load_dwordx4 v[200:203], v12, s[8:11], s58 offen offset:1024 sc1
  buffer_load_dwordx4 v[204:207], v12, s[8:11], s58 offen offset:1536 sc1
  buffer_load_dwordx4 v[208:211], v12, s[8:11], s58 offen offset:2048 sc1
  buffer_load_dwordx4 v[212:215], v12, s[8:11], s58 offen offset:2560 sc1
  buffer_load_dwordx4 v[216:219], v12, s[8:11], s58 offen offset:3072 sc1
  buffer_load_dwordx4 v[220:223], v12, s[8:11], s58 offen offset:3584 sc1
  s_add_u32 s12, s58, 4096
  s_mov_b64 exec, s[52:53]
  buffer_load_dwordx4 v[224:227], v14, s[8:11], s12 offen offset:0 sc1
  buffer_load_dwordx4 v[228:231], v14, s[8:11], s12 offen offset:512 sc1
  buffer_load_dwordx4 v[232:235], v14, s[8:11], s12 offen offset:1024 sc1
  buffer_load_dwordx4 v[236:239], v14, s[8:11], s12 offen offset:1536 sc1
  s_mov_b64 exec, -1
  s_waitcnt vmcnt(11)
  v_max_u32 v8, v192, v194
  v_mfma_f32_16x16x32_bf16 v[112:115], a[112:115], v[192:195], 0
  v_mfma_f32_16x16x32_bf16 v[116:119], a[128:131], v[192:195], 0
  s_waitcnt vmcnt(10)
  v_max3_u32 v8, v8, v196, v198
  v_mfma_f32_16x16x32_bf16 v[112:115], a[116:119], v[196:199], v[112:115]
  v_mfma_f32_16x16x32_bf16 v[116:119], a[132:135], v[196:199], v[116:119]
  s_waitcnt vmcnt(9)
  v_max3_u32 v8, v8, v200, v202
  v_mfma_f32_16x16x32_bf16 v[112:115], a[120:123], v[200:203], v[112:115]
  v_mfma_f32_16x16x32_bf16 v[116:119], a[136:139], v[200:203], v[116:119]
  s_waitcnt vmcnt(8)
  v_max3_u32 v8, v8, v204, v206
  v_mfma_f32_16x16x32_bf16 v[112:115], a[124:127], v[204:207], v[112:115]
  v_mfma_f32_16x16x32_bf16 v[116:119], a[140:143], v[204:207], v[116:119]
  s_waitcnt vmcnt(7)
  v_max3_u32 v8, v8, v208, v210
  v_mfma_f32_16x16x32_bf16 v[120:123], v[208:211], v[192:195], 0
  s_waitcnt vmcnt(6)
  v_max3_u32 v8, v8, v212, v214
  v_mfma_f32_16x16x32_bf16 v[120:123], v[212:215], v[196:199], v[120:123]
  s_waitcnt vmcnt(5)
  v_max3_u32 v8, v8, v216, v218
  v_mfma_f32_16x16x32_bf16 v[120:123], v[216:219], v[200:203], v[120:123]
  s_waitcnt vmcnt(4)
  v_max3_u32 v8, v8, v220, v222
  v_mfma_f32_16x16x32_bf16 v[120:123], v[220:223], v[204:207], v[120:123]
  s_waitcnt vmcnt(3)
  v_max3_u32 v8, v8, v224, v226
  s_waitcnt vmcnt(2)
  v_max3_u32 v8, v8, v228, v230
  s_waitcnt vmcnt(1)
  v_max3_u32 v8, v8, v232, v234
  s_waitcnt vmcnt(0)
  v_max3_u32 v8, v8, v236, v238
  v_cmp_eq_u32 vcc, -1, v8
  s_sub_u32 s61, s61, 1
  s_cmp_eq_u32 s61, 0
  s_cbranch_scc1 ch_s_Bd
  s_cbranch_vccnz ch_s_Bp
ch_s_Bd:
  s_add_u32 s12, s54, 0
  buffer_load_dwordx4 a[112:115], v2, s[8:11], s12 offen offset:0 sc1
  buffer_load_dwordx4 a[116:119], v2, s[8:11], s12 offen offset:1024 sc1
  buffer_load_dwordx4 a[120:123], v2, s[8:11], s12 offen offset:2048 sc1
  buffer_load_dwordx4 a[124:127], v2, s[8:11], s12 offen offset:3072 sc1
  s_add_u32 s12, s54, 262144
  buffer_load_dwordx4 a[128:131], v2, s[8:11], s12 offen offset:0 sc1
  buffer_load_dwordx4 a[132:135], v2, s[8:11], s12 offen offset:1024 sc1
  buffer_load_dwordx4 a[136:139], v2, s[8:11], s12 offen offset:2048 sc1
  buffer_load_dwordx4 a[140:143], v2, s[8:11], s12 offen offset:3072 sc1
  s_add_u32 s54, s54, 524288
  s_bitset0_b32 s54, 22
  v_add_f32 v120, v120, v3
  v_add_f32 v121, v121, v3
  v_add_f32 v122, v122, v3
  v_add_f32 v123, v123, v3
  v_max3_f32 v8, v112, v113, v114
  v_max3_f32 v9, v115, v116, v117
  v_max3_f32 v8, v8, v118, v119
  v_max3_f32 v9, v9, v120, v121
  v_max3_f32 v8, v8, v122, v123
  v_max_f32 v8, v8, v9
  v_mov_b32 v9, v8
  s_nop 1
  v_permlane32_swap_b32 v9, v8
  s_nop 1
  v_max_f32 v8, v8, v9
  v_mov_b32 v9, v8
  s_nop 1
  v_permlane16_swap_b32 v9, v8
  s_nop 1
  v_max_f32 v8, v8, v9
  v_mul_f32 v8, 0x3e0293ee, v8
  s_mov_b32 s39, 0x3e0293ee
  v_fma_f32 v112, v112, s39, -v8
  v_fma_f32 v113, v113, s39, -v8
  v_fma_f32 v114, v114, s39, -v8
  v_fma_f32 v115, v115, s39, -v8
  v_fma_f32 v116, v116, s39, -v8
  v_fma_f32 v117, v117, s39, -v8
  v_fma_f32 v118, v118, s39, -v8
  v_fma_f32 v119, v119, s39, -v8
  v_fma_f32 v120, v120, s39, -v8
  v_fma_f32 v121, v121, s39, -v8
  v_fma_f32 v122, v122, s39, -v8
  v_fma_f32 v123, v123, s39, -v8
  v_exp_f32 v112, v112
  v_exp_f32 v113, v113
  v_exp_f32 v114, v114
  v_exp_f32 v115, v115
  v_exp_f32 v116, v116
  v_exp_f32 v117, v117
  v_exp_f32 v118, v118
  v_exp_f32 v119, v119
  v_exp_f32 v120, v120
  v_exp_f32 v121, v121
  v_exp_f32 v122, v122
  v_exp_f32 v123, v123
  s_nop 0
  v_cvt_pk_bf16_f32 v124, v112, v113
  v_cvt_pk_bf16_f32 v125, v114, v115
  v_cvt_pk_bf16_f32 v126, v116, v117
  v_cvt_pk_bf16_f32 v127, v118, v119
  v_cvt_pk_bf16_f32 v128, v120, v121
  v_cvt_pk_bf16_f32 v129, v122, v123
  s_nop 1
  v_mfma_f32_16x16x32_bf16 v[132:135], a[144:147], v[124:127], 0
  v_mfma_f32_16x16x32_bf16 v[136:139], a[148:151], v[124:127], 0
  v_mfma_f32_16x16x32_bf16 v[140:143], a[152:155], v[124:127], 0
  v_mfma_f32_16x16x32_bf16 v[144:147], a[156:159], v[124:127], 0
  v_mfma_f32_16x16x32_bf16 v[148:151], a[160:163], v[124:127], 0
  v_mfma_f32_16x16x32_bf16 v[152:155], a[164:167], v[124:127], 0
  v_mfma_f32_16x16x32_bf16 v[156:159], a[168:171], v[124:127], 0
  v_mfma_f32_16x16x32_bf16 v[160:163], a[172:175], v[124:127], 0
  v_mfma_f32_16x16x32_bf16 v[244:247], v[240:243], v[124:127], 0
  v_mfma_f32_16x16x16_bf16 v[132:135], v[224:225], v[128:129], v[132:135]
  v_mfma_f32_16x16x16_bf16 v[136:139], v[226:227], v[128:129], v[136:139]
  v_mfma_f32_16x16x16_bf16 v[140:143], v[228:229], v[128:129], v[140:143]
  v_mfma_f32_16x16x16_bf16 v[144:147], v[230:231], v[128:129], v[144:147]
  v_mfma_f32_16x16x16_bf16 v[148:151], v[232:233], v[128:129], v[148:151]
  v_mfma_f32_16x16x16_bf16 v[152:155], v[234:235], v[128:129], v[152:155]
  v_mfma_f32_16x16x16_bf16 v[156:159], v[236:237], v[128:129], v[156:159]
  v_mfma_f32_16x16x16_bf16 v[160:163], v[238:239], v[128:129], v[160:163]
  v_mfma_f32_16x16x16_bf16 v[244:247], v[240:241], v[128:129], v[244:247]
  s_nop 1
  v_cvt_pk_bf16_f32 v164, v132, v133
  v_cvt_pk_bf16_f32 v165, v134, v135
  v_cvt_pk_bf16_f32 v166, v136, v137
  v_cvt_pk_bf16_f32 v167, v138, v139
  v_cvt_pk_bf16_f32 v168, v140, v141
  v_cvt_pk_bf16_f32 v169, v142, v143
  v_cvt_pk_bf16_f32 v170, v144, v145
  v_cvt_pk_bf16_f32 v171, v146, v147
  v_mfma_f32_16x16x32_bf16 v[180:183], a[80:83], v[164:167], 0
  v_mfma_f32_16x16x32_bf16 v[184:187], a[96:99], v[164:167], 0
  v_cvt_pk_bf16_f32 v172, v148, v149
  v_cvt_pk_bf16_f32 v173, v150, v151
  v_cvt_pk_bf16_f32 v174, v152, v153
  v_cvt_pk_bf16_f32 v175, v154, v155
  v_mfma_f32_16x16x32_bf16 v[180:183], a[84:87], v[168:171], v[180:183]
  v_mfma_f32_16x16x32_bf16 v[184:187], a[100:103], v[168:171], v[184:187]
  v_rcp_f32 v8, v244
  v_cvt_pk_bf16_f32 v176, v156, v157
  v_cvt_pk_bf16_f32 v177, v158, v159
  v_cvt_pk_bf16_f32 v178, v160, v161
  v_cvt_pk_bf16_f32 v179, v162, v163
  v_mfma_f32_16x16x32_bf16 v[180:183], a[88:91], v[172:175], v[180:183]
  v_mfma_f32_16x16x32_bf16 v[184:187], a[104:107], v[172:175], v[184:187]
  s_nop 0
  v_mfma_f32_16x16x32_bf16 v[180:183], a[92:95], v[176:179], v[180:183]
  v_mfma_f32_16x16x32_bf16 v[184:187], a[108:111], v[176:179], v[184:187]
  s_nop 7
  v_mul_f32 v180, v180, v8
  v_mul_f32 v181, v181, v8
  v_mul_f32 v182, v182, v8
  v_mul_f32 v183, v183, v8
  v_mul_f32 v184, v184, v8
  v_mul_f32 v185, v185, v8
  v_mul_f32 v186, v186, v8
  v_mul_f32 v187, v187, v8
  s_and_b32 s12, s60, 1
  s_lshl_b32 s12, s12, 13
  s_lshl_b32 s13, s3, 11
  s_add_u32 s13, s13, s12
  v_add_u32 v18, s13, v2
  ds_write_b128 v18, v[180:183]
  ds_write_b128 v18, v[184:187] offset:1024
  s_waitcnt lgkmcnt(0)
  s_barrier
  s_cmp_eq_u32 s3, 3
  s_cbranch_scc0 ch_s_pf
  v_add_u32 v18, s12, v16
  ds_read_b128 v[64:67], v18 offset:0
  ds_read_b128 v[68:71], v18 offset:2048
  ds_read_b128 v[72:75], v18 offset:4096
  ds_read_b128 v[76:79], v18 offset:6144
  s_waitcnt lgkmcnt(0)
  v_add_f32 v64, v64, v68
  v_add_f32 v72, v72, v76
  v_add_f32 v64, v64, v72
  v_add_f32 v65, v65, v69
  v_add_f32 v73, v73, v77
  v_add_f32 v65, v65, v73
  v_add_f32 v66, v66, v70
  v_add_f32 v74, v74, v78
  v_add_f32 v66, v66, v74
  v_add_f32 v67, v67, v71
  v_add_f32 v75, v75, v79
  v_add_f32 v67, v67, v75
  v_min_u32 v64, v64, v21
  s_mul_i32 s12, s40, 20480
  s_add_u32 s12, s12, s59
  buffer_store_dwordx4 v[64:67], v2, s[8:11], s12 offen sc1
  s_add_u32 s48, s60, 1
  s_and_b32 s48, s48, 7
  s_mul_i32 s48, s48, 81920
  s_add_u32 s48, s48, s92
  s_add_u32 s12, s55, 0
  buffer_load_dwordx4 a[144:147], v2, s[8:11], s12 offen offset:0 sc1
  buffer_load_dwordx4 a[148:151], v2, s[8:11], s12 offen offset:1024 sc1
  buffer_load_dwordx4 a[152:155], v2, s[8:11], s12 offen offset:2048 sc1
  buffer_load_dwordx4 a[156:159], v2, s[8:11], s12 offen offset:3072 sc1
  s_add_u32 s12, s55, 4096
  buffer_load_dwordx4 a[160:163], v2, s[8:11], s12 offen offset:0 sc1
  buffer_load_dwordx4 a[164:167], v2, s[8:11], s12 offen offset:1024 sc1
  buffer_load_dwordx4 a[168:171], v2, s[8:11], s12 offen offset:2048 sc1
  buffer_load_dwordx4 a[172:175], v2, s[8:11], s12 offen offset:3072 sc1
  s_add_u32 s55, s55, 262144
  s_bitset0_b32 s55, 21
  s_mov_b32 s61, 65536
ch_s_Cp:
  s_mov_b32 s12, s59
  buffer_load_dwordx4 v[80:83], v2, s[8:11], s12 offen sc1
  s_add_u32 s12, s12, 20480
  buffer_load_dwordx4 v[84:87], v2, s[8:11], s12 offen sc1
  s_add_u32 s12, s12, 20480
  buffer_load_dwordx4 v[88:91], v2, s[8:11], s12 offen sc1
  s_add_u32 s12, s12, 20480
  buffer_load_dwordx4 v[92:95], v2, s[8:11], s12 offen sc1
  s_add_u32 s12, s12, 20480
  buffer_load_dwordx4 v[96:99], v2, s[8:11], s12 offen sc1
  s_add_u32 s12, s12, 20480
  buffer_load_dwordx4 v[100:103], v2, s[8:11], s12 offen sc1
  s_add_u32 s12, s12, 20480
  buffer_load_dwordx4 v[104:107], v2, s[8:11], s12 offen sc1
  s_add_u32 s12, s12, 20480
  buffer_load_dwordx4 v[108:111], v2, s[8:11], s12 offen sc1
  s_add_u32 s12, s12, 20480
  s_waitcnt vmcnt(0)
  v_max3_u32 v8, v80, v84, v88
  v_max3_u32 v9, v92, v96, v100
  v_max3_u32 v8, v8, v104, v108
  v_max_u32 v8, v8, v9
  v_cmp_eq_u32 vcc, -1, v8
  s_sub_u32 s61, s61, 1
  s_cmp_eq_u32 s61, 0
  s_cbranch_scc1 ch_s_Cd0
  s_cbranch_vccz ch_s_Cd0
  s_mov_b32 s12, s59
  buffer_load_dwordx4 v[112:115], v2, s[8:11], s12 offen sc1
  s_add_u32 s12, s12, 20480
  buffer_load_dwordx4 v[116:119], v2, s[8:11], s12 offen sc1
  s_add_u32 s12, s12, 20480
  buffer_load_dwordx4 v[120:123], v2, s[8:11], s12 offen sc1
  s_add_u32 s12, s12, 20480
  buffer_load_dwordx4 v[124:127], v2, s[8:11], s12 offen sc1
  s_add_u32 s12, s12, 20480
  buffer_load_dwordx4 v[128:131], v2, s[8:11], s12 offen sc1
  s_add_u32 s12, s12, 20480
  buffer_load_dwordx4 v[132:135], v2, s[8:11], s12 offen sc1
  s_add_u32 s12, s12, 20480
  buffer_load_dwordx4 v[136:139], v2, s[8:11], s12 offen sc1
  s_add_u32 s12, s12, 20480
  buffer_load_dwordx4 v[140:143], v2, s[8:11], s12 offen sc1
  s_add_u32 s12, s12, 20480
  s_waitcnt vmcnt(0)
  v_max3_u32 v8, v112, v116, v120
  v_max3_u32 v9, v124, v128, v132
  v_max3_u32 v8, v8, v136, v140
  v_max_u32 v8, v8, v9
  v_cmp_eq_u32 vcc, -1, v8
  s_sub_u32 s61, s61, 1
  s_cmp_eq_u32 s61, 0
  s_cbranch_scc1 ch_s_Cd1
  s_cbranch_vccz ch_s_Cd1
  s_branch ch_s_Cp
ch_s_Cd0:
  v_add_f32 v80, v80, v84
  v_add_f32 v88, v88, v92
  v_add_f32 v96, v96, v100
  v_add_f32 v104, v104, v108
  v_add_f32 v80, v80, v88
  v_add_f32 v96, v96, v104
  v_add_f32 v80, v80, v96
  v_add_f32 v81, v81, v85
  v_add_f32 v89, v89, v93
  v_add_f32 v97, v97, v101
  v_add_f32 v105, v105, v109
  v_add_f32 v81, v81, v89
  v_add_f32 v97, v97, v105
  v_add_f32 v81, v81, v97
  v_add_f32 v82, v82, v86
  v_add_f32 v90, v90, v94
  v_add_f32 v98, v98, v102
  v_add_f32 v106, v106, v110
  v_add_f32 v82, v82, v90
  v_add_f32 v98, v98, v106
  v_add_f32 v82, v82, v98
  v_add_f32 v83, v83, v87
  v_add_f32 v91, v91, v95
  v_add_f32 v99, v99, v103
  v_add_f32 v107, v107, v111
  v_add_f32 v83, v83, v91
  v_add_f32 v99, v99, v107
  v_add_f32 v83, v83, v99
  v_cvt_pk_bf16_f32 v188, v80, v81
  v_cvt_pk_bf16_f32 v189, v82, v83
  v_min_u32 v188, v188, v21
  s_branch ch_s_Ce
ch_s_Cd1:
  v_add_f32 v112, v112, v116
  v_add_f32 v120, v120, v124
  v_add_f32 v128, v128, v132
  v_add_f32 v136, v136, v140
  v_add_f32 v112, v112, v120
  v_add_f32 v128, v128, v136
  v_add_f32 v112, v112, v128
  v_add_f32 v113, v113, v117
  v_add_f32 v121, v121, v125
  v_add_f32 v129, v129, v133
  v_add_f32 v137, v137, v141
  v_add_f32 v113, v113, v121
  v_add_f32 v129, v129, v137
  v_add_f32 v113, v113, v129
  v_add_f32 v114, v114, v118
  v_add_f32 v122, v122, v126
  v_add_f32 v130, v130, v134
  v_add_f32 v138, v138, v142
  v_add_f32 v114, v114, v122
  v_add_f32 v130, v130, v138
  v_add_f32 v114, v114, v130
  v_add_f32 v115, v115, v119
  v_add_f32 v123, v123, v127
  v_add_f32 v131, v131, v135
  v_add_f32 v139, v139, v143
  v_add_f32 v115, v115, v123
  v_add_f32 v131, v131, v139
  v_add_f32 v115, v115, v131
  v_cvt_pk_bf16_f32 v188, v112, v113
  v_cvt_pk_bf16_f32 v189, v114, v115
  v_min_u32 v188, v188, v21
ch_s_Ce:
  s_lshl_b32 s12, s41, 9
  s_add_u32 s12, s12, s48
  buffer_store_dwordx2 v[188:189], v17, s[8:11], s12 offen sc1
  s_branch ch_s_next
ch_s_pf:
  s_cmp_eq_u32 s3, 1
  s_cbranch_scc0 ch_s_nwl
  s_cmp_gt_u32 s60, 61
  s_cbranch_scc1 ch_s_nwl
  s_mul_i32 s12, s47, 196608
  s_mul_i32 s13, s44, 6144
  s_add_u32 s12, s12, s13
  s_add_u32 s12, s12, 89210880
  s_lshl_b32 s13, s41, 10
  s_add_u32 s12, s12, s13
  s_mul_i32 s15, s47, 81920
  s_add_u32 s15, s15, s92
  s_sub_u32 s14, s15, 24576
  s_add_u32 s14, s14, s13
  s_cmp_lt_u32 s41, 24
  s_cselect_b32 s12, s12, s14
  buffer_store_dwordx4 v[56:59], v2, s[8:11], s12 offen sc1
  s_add_u32 s14, s15, 8192
  s_and_b32 s13, s13, 1024
  s_add_u32 s14, s14, s13
  buffer_store_dwordx4 v[56:59], v2, s[8:11], s14 offen sc1
ch_s_nwl:
  s_cmp_eq_u32 s3, 0
  s_cbranch_scc0 ch_s_npf
  s_cmp_gt_u32 s60, 61
  s_cbranch_scc1 ch_s_npf
  s_mul_i32 s12, s40, 20480
  s_add_u32 s12, s12, s95
  s_mul_i32 s13, s47, 163840
  s_add_u32 s12, s12, s13
  buffer_store_dwordx4 v[56:59], v2, s[8:11], s12 offen sc1
ch_s_npf:
  s_add_u32 s12, s55, 0
  buffer_load_dwordx4 a[144:147], v2, s[8:11], s12 offen offset:0 sc1
  buffer_load_dwordx4 a[148:151], v2, s[8:11], s12 offen offset:1024 sc1
  buffer_load_dwordx4 a[152:155], v2, s[8:11], s12 offen offset:2048 sc1
  buffer_load_dwordx4 a[156:159], v2, s[8:11], s12 offen offset:3072 sc1
  s_add_u32 s12, s55, 4096
  buffer_load_dwordx4 a[160:163], v2, s[8:11], s12 offen offset:0 sc1
  buffer_load_dwordx4 a[164:167], v2, s[8:11], s12 offen offset:1024 sc1
  buffer_load_dwordx4 a[168:171], v2, s[8:11], s12 offen offset:2048 sc1
  buffer_load_dwordx4 a[172:175], v2, s[8:11], s12 offen offset:3072 sc1
  s_add_u32 s55, s55, 262144
  s_bitset0_b32 s55, 21
  s_cmp_gt_u32 s60, 61
  s_cbranch_scc1 ch_s_wxlo
  s_cmp_eq_u32 s60, 61
  s_cbranch_scc1 ch_s_wnlo
  s_and_b32 s12, s24, 1
  s_mul_i32 s12, s12, 40960
  s_add_u32 s12, s12, 40960
  v_add_u32 v40, s12, v2
  s_and_b32 s26, s25, 1
  s_mul_i32 s26, s26, 40960
  s_add_u32 s26, s26, 40960
  ds_read_b128 v[96:99], v40 offset:0
  ds_read_b128 v[100:103], v40 offset:20480
  ds_read_b128 v[104:107], v40 offset:1024
  ds_read_b128 v[108:111], v40 offset:21504
  ds_read_b128 v[112:115], v40 offset:2048
  ds_read_b128 v[116:119], v40 offset:22528
  ds_read_b128 v[120:123], v40 offset:3072
  ds_read_b128 v[124:127], v40 offset:23552
  ds_read_b128 v[128:131], v40 offset:4096
  ds_read_b128 v[132:135], v40 offset:24576
  ds_read_b128 v[136:139], v40 offset:5120
  ds_read_b128 v[140:143], v40 offset:25600
  s_cmp_eq_u32 s3, 2
  s_cbranch_scc1 ch_s_tvloa
  s_waitcnt lgkmcnt(11)
  v_mfma_f32_16x16x32_bf16 v[144:147], a[0:3], v[96:99], 0
  ds_read_b128 v[96:99], v40 offset:6144
  s_waitcnt lgkmcnt(11)
  v_mfma_f32_16x16x32_bf16 v[148:151], a[0:3], v[100:103], 0
  ds_read_b128 v[100:103], v40 offset:26624
  s_add_u32 s12, s21, 0
  s_min_u32 s12, s12, 39936
  s_add_u32 m0, s12, s26
  s_add_u32 s12, s12, s20
  buffer_load_dwordx4 v2, s[8:11], s12 offen lds
  s_waitcnt lgkmcnt(11)
  v_mfma_f32_16x16x32_bf16 v[144:147], a[4:7], v[104:107], v[144:147]
  ds_read_b128 v[104:107], v40 offset:7168
  s_waitcnt lgkmcnt(11)
  v_mfma_f32_16x16x32_bf16 v[148:151], a[4:7], v[108:111], v[148:151]
  ds_read_b128 v[108:111], v40 offset:27648
  s_add_u32 s12, s21, 1024
  s_min_u32 s12, s12, 39936
  s_add_u32 m0, s12, s26
  s_add_u32 s12, s12, s20
  buffer_load_dwordx4 v2, s[8:11], s12 offen lds
  s_waitcnt lgkmcnt(11)
  v_mfma_f32_16x16x32_bf16 v[144:147], a[8:11], v[112:115], v[144:147]
  ds_read_b128 v[112:115], v40 offset:8192
  s_waitcnt lgkmcnt(11)
  v_mfma_f32_16x16x32_bf16 v[148:151], a[8:11], v[116:119], v[148:151]
  ds_read_b128 v[116:119], v40 offset:28672
  s_add_u32 s12, s21, 2048
  s_min_u32 s12, s12, 39936
  s_add_u32 m0, s12, s26
  s_add_u32 s12, s12, s20
  buffer_load_dwordx4 v2, s[8:11], s12 offen lds
  s_waitcnt lgkmcnt(11)
  v_mfma_f32_16x16x32_bf16 v[144:147], a[12:15], v[120:123], v[144:147]
  ds_read_b128 v[120:123], v40 offset:9216
  s_waitcnt lgkmcnt(11)
  v_mfma_f32_16x16x32_bf16 v[148:151], a[12:15], v[124:127], v[148:151]
  ds_read_b128 v[124:127], v40 offset:29696
  s_add_u32 s12, s21, 3072
  s_min_u32 s12, s12, 39936
  s_add_u32 m0, s12, s26
  s_add_u32 s12, s12, s20
  buffer_load_dwordx4 v2, s[8:11], s12 offen lds
  s_waitcnt lgkmcnt(11)
  v_mfma_f32_16x16x32_bf16 v[144:147], a[16:19], v[128:131], v[144:147]
  ds_read_b128 v[128:131], v40 offset:10240
  s_waitcnt lgkmcnt(11)
  v_mfma_f32_16x16x32_bf16 v[148:151], a[16:19], v[132:135], v[148:151]
  ds_read_b128 v[132:135], v40 offset:30720
  s_add_u32 s12, s21, 4096
  s_min_u32 s12, s12, 39936
  s_add_u32 m0, s12, s26
  s_add_u32 s12, s12, s20
  buffer_load_dwordx4 v2, s[8:11], s12 offen lds
  s_waitcnt lgkmcnt(11)
  v_mfma_f32_16x16x32_bf16 v[144:147], a[20:23], v[136:139], v[144:147]
  ds_read_b128 v[136:139], v40 offset:11264
  s_waitcnt lgkmcnt(11)
  v_mfma_f32_16x16x32_bf16 v[148:151], a[20:23], v[140:143], v[148:151]
  ds_read_b128 v[140:143], v40 offset:31744
  s_add_u32 s12, s21, 5120
  s_min_u32 s12, s12, 39936
  s_add_u32 m0, s12, s26
  s_add_u32 s12, s12, s20
  buffer_load_dwordx4 v2, s[8:11], s12 offen lds
  s_waitcnt lgkmcnt(11)
  v_mfma_f32_16x16x32_bf16 v[144:147], a[24:27], v[96:99], v[144:147]
  ds_read_b128 v[96:99], v40 offset:12288
  s_waitcnt lgkmcnt(11)
  v_mfma_f32_16x16x32_bf16 v[148:151], a[24:27], v[100:103], v[148:151]
  ds_read_b128 v[100:103], v40 offset:32768
  s_add_u32 s12, s21, 6144
  s_min_u32 s12, s12, 39936
  s_add_u32 m0, s12, s26
  s_add_u32 s12, s12, s20
  buffer_load_dwordx4 v2, s[8:11], s12 offen lds
  s_waitcnt lgkmcnt(11)
  v_mfma_f32_16x16x32_bf16 v[144:147], a[28:31], v[104:107], v[144:147]
  ds_read_b128 v[104:107], v40 offset:13312
  s_waitcnt lgkmcnt(11)
  v_mfma_f32_16x16x32_bf16 v[148:151], a[28:31], v[108:111], v[148:151]
  ds_read_b128 v[108:111], v40 offset:33792
  s_add_u32 s12, s21, 7168
  s_min_u32 s12, s12, 39936
  s_add_u32 m0, s12, s26
  s_add_u32 s12, s12, s20
  buffer_load_dwordx4 v2, s[8:11], s12 offen lds
  s_waitcnt lgkmcnt(11)
  v_mfma_f32_16x16x32_bf16 v[144:147], a[32:35], v[112:115], v[144:147]
  ds_read_b128 v[112:115], v40 offset:14336
  s_waitcnt lgkmcnt(11)
  v_mfma_f32_16x16x32_bf16 v[148:151], a[32:35], v[116:119], v[148:151]
  ds_read_b128 v[116:119], v40 offset:34816
  s_add_u32 s12, s21, 8192
  s_min_u32 s12, s12, 39936
  s_add_u32 m0, s12, s26
  s_add_u32 s12, s12, s20
  buffer_load_dwordx4 v2, s[8:11], s12 offen lds
  s_waitcnt lgkmcnt(11)
  v_mfma_f32_16x16x32_bf16 v[144:147], a[36:39], v[120:123], v[144:147]
  ds_read_b128 v[120:123], v40 offset:15360
  s_waitcnt lgkmcnt(11)
  v_mfma_f32_16x16x32_bf16 v[148:151], a[36:39], v[124:127], v[148:151]
  ds_read_b128 v[124:127], v40 offset:35840
  s_add_u32 s12, s21, 9216
  s_min_u32 s12, s12, 39936
  s_add_u32 m0, s12, s26
  s_add_u32 s12, s12, s20
  buffer_load_dwordx4 v2, s[8:11], s12 offen lds
  s_waitcnt lgkmcnt(11)
  v_mfma_f32_16x16x32_bf16 v[144:147], a[40:43], v[128:131], v[144:147]
  ds_read_b128 v[128:131], v40 offset:16384
  s_waitcnt lgkmcnt(11)
  v_mfma_f32_16x16x32_bf16 v[148:151], a[40:43], v[132:135], v[148:151]
  ds_read_b128 v[132:135], v40 offset:36864
  s_add_u32 s12, s21, 10240
  s_min_u32 s12, s12, 39936
  s_add_u32 m0, s12, s26
  s_add_u32 s12, s12, s20
  buffer_load_dwordx4 v2, s[8:11], s12 offen lds
  s_waitcnt lgkmcnt(11)
  v_mfma_f32_16x16x32_bf16 v[144:147], a[44:47], v[136:139], v[144:147]
  ds_read_b128 v[136:139], v40 offset:17408
  s_waitcnt lgkmcnt(11)
  v_mfma_f32_16x16x32_bf16 v[148:151], a[44:47], v[140:143], v[148:151]
  ds_read_b128 v[140:143], v40 offset:37888
  s_add_u32 s12, s21, 11264
  s_min_u32 s12, s12, 39936
  s_add_u32 m0, s12, s26
  s_add_u32 s12, s12, s20
  buffer_load_dwordx4 v2, s[8:11], s12 offen lds
  s_waitcnt lgkmcnt(11)
  v_mfma_f32_16x16x32_bf16 v[144:147], a[48:51], v[96:99], v[144:147]
  ds_read_b128 v[96:99], v40 offset:18432
  s_waitcnt lgkmcnt(11)
  v_mfma_f32_16x16x32_bf16 v[148:151], a[48:51], v[100:103], v[148:151]
  ds_read_b128 v[100:103], v40 offset:38912
  s_add_u32 s12, s21, 12288
  s_min_u32 s12, s12, 39936
  s_add_u32 m0, s12, s26
  s_add_u32 s12, s12, s20
  buffer_load_dwordx4 v2, s[8:11], s12 offen lds
  s_waitcnt lgkmcnt(11)
  v_mfma_f32_16x16x32_bf16 v[144:147], a[52:55], v[104:107], v[144:147]
  ds_read_b128 v[104:107], v40 offset:19456
  s_waitcnt lgkmcnt(11)
  v_mfma_f32_16x16x32_bf16 v[148:151], a[52:55], v[108:111], v[148:151]
  ds_read_b128 v[108:111], v40 offset:39936
  s_add_u32 s12, s21, 13312
  s_min_u32 s12, s12, 39936
  s_add_u32 m0, s12, s26
  s_add_u32 s12, s12, s20
  buffer_load_dwordx4 v2, s[8:11], s12 offen lds
  s_waitcnt lgkmcnt(11)
  v_mfma_f32_16x16x32_bf16 v[144:147], a[56:59], v[112:115], v[144:147]
  s_waitcnt lgkmcnt(10)
  v_mfma_f32_16x16x32_bf16 v[148:151], a[56:59], v[116:119], v[148:151]
  s_waitcnt lgkmcnt(9)
  v_mfma_f32_16x16x32_bf16 v[144:147], a[60:63], v[120:123], v[144:147]
  s_waitcnt lgkmcnt(8)
  v_mfma_f32_16x16x32_bf16 v[148:151], a[60:63], v[124:127], v[148:151]
  s_waitcnt lgkmcnt(7)
  v_mfma_f32_16x16x32_bf16 v[144:147], a[64:67], v[128:131], v[144:147]
  s_waitcnt lgkmcnt(6)
  v_mfma_f32_16x16x32_bf16 v[148:151], a[64:67], v[132:135], v[148:151]
  s_waitcnt lgkmcnt(5)
  v_mfma_f32_16x16x32_bf16 v[144:147], a[68:71], v[136:139], v[144:147]
  s_waitcnt lgkmcnt(4)
  v_mfma_f32_16x16x32_bf16 v[148:151], a[68:71], v[140:143], v[148:151]
  s_waitcnt lgkmcnt(3)
  v_mfma_f32_16x16x32_bf16 v[144:147], a[72:75], v[96:99], v[144:147]
  s_waitcnt lgkmcnt(2)
  v_mfma_f32_16x16x32_bf16 v[148:151], a[72:75], v[100:103], v[148:151]
  s_waitcnt lgkmcnt(1)
  v_mfma_f32_16x16x32_bf16 v[144:147], a[76:79], v[104:107], v[144:147]
  s_waitcnt lgkmcnt(0)
  v_mfma_f32_16x16x32_bf16 v[148:151], a[76:79], v[108:111], v[148:151]
  s_nop 7
  s_nop 7
  v_cvt_pk_bf16_f32 v152, v144, v145
  v_cvt_pk_bf16_f32 v153, v146, v147
  v_cvt_pk_bf16_f32 v154, v148, v149
  v_cvt_pk_bf16_f32 v155, v150, v151
  buffer_store_dwordx2 v[152:153], v42, s[8:11], s22 offen sc1
  s_add_u32 s12, s22, 262144
  buffer_store_dwordx2 v[154:155], v42, s[8:11], s12 offen sc1
  s_branch ch_s_teloa
ch_s_tvloa:
  s_waitcnt lgkmcnt(11)
  v_mfma_f32_16x16x32_bf16 v[144:147], v[96:99], a[0:3], 0
  ds_read_b128 v[96:99], v40 offset:6144
  s_waitcnt lgkmcnt(11)
  v_mfma_f32_16x16x32_bf16 v[148:151], v[100:103], a[0:3], 0
  ds_read_b128 v[100:103], v40 offset:26624
  s_add_u32 s12, s21, 0
  s_min_u32 s12, s12, 39936
  s_add_u32 m0, s12, s26
  s_add_u32 s12, s12, s20
  buffer_load_dwordx4 v2, s[8:11], s12 offen lds
  s_waitcnt lgkmcnt(11)
  v_mfma_f32_16x16x32_bf16 v[144:147], v[104:107], a[4:7], v[144:147]
  ds_read_b128 v[104:107], v40 offset:7168
  s_waitcnt lgkmcnt(11)
  v_mfma_f32_16x16x32_bf16 v[148:151], v[108:111], a[4:7], v[148:151]
  ds_read_b128 v[108:111], v40 offset:27648
  s_add_u32 s12, s21, 1024
  s_min_u32 s12, s12, 39936
  s_add_u32 m0, s12, s26
  s_add_u32 s12, s12, s20
  buffer_load_dwordx4 v2, s[8:11], s12 offen lds
  s_waitcnt lgkmcnt(11)
  v_mfma_f32_16x16x32_bf16 v[144:147], v[112:115], a[8:11], v[144:147]
  ds_read_b128 v[112:115], v40 offset:8192
  s_waitcnt lgkmcnt(11)
  v_mfma_f32_16x16x32_bf16 v[148:151], v[116:119], a[8:11], v[148:151]
  ds_read_b128 v[116:119], v40 offset:28672
  s_add_u32 s12, s21, 2048
  s_min_u32 s12, s12, 39936
  s_add_u32 m0, s12, s26
  s_add_u32 s12, s12, s20
  buffer_load_dwordx4 v2, s[8:11], s12 offen lds
  s_waitcnt lgkmcnt(11)
  v_mfma_f32_16x16x32_bf16 v[144:147], v[120:123], a[12:15], v[144:147]
  ds_read_b128 v[120:123], v40 offset:9216
  s_waitcnt lgkmcnt(11)
  v_mfma_f32_16x16x32_bf16 v[148:151], v[124:127], a[12:15], v[148:151]
  ds_read_b128 v[124:127], v40 offset:29696
  s_add_u32 s12, s21, 3072
  s_min_u32 s12, s12, 39936
  s_add_u32 m0, s12, s26
  s_add_u32 s12, s12, s20
  buffer_load_dwordx4 v2, s[8:11], s12 offen lds
  s_waitcnt lgkmcnt(11)
  v_mfma_f32_16x16x32_bf16 v[144:147], v[128:131], a[16:19], v[144:147]
  ds_read_b128 v[128:131], v40 offset:10240
  s_waitcnt lgkmcnt(11)
  v_mfma_f32_16x16x32_bf16 v[148:151], v[132:135], a[16:19], v[148:151]
  ds_read_b128 v[132:135], v40 offset:30720
  s_add_u32 s12, s21, 4096
  s_min_u32 s12, s12, 39936
  s_add_u32 m0, s12, s26
  s_add_u32 s12, s12, s20
  buffer_load_dwordx4 v2, s[8:11], s12 offen lds
  s_waitcnt lgkmcnt(11)
  v_mfma_f32_16x16x32_bf16 v[144:147], v[136:139], a[20:23], v[144:147]
  ds_read_b128 v[136:139], v40 offset:11264
  s_waitcnt lgkmcnt(11)
  v_mfma_f32_16x16x32_bf16 v[148:151], v[140:143], a[20:23], v[148:151]
  ds_read_b128 v[140:143], v40 offset:31744
  s_add_u32 s12, s21, 5120
  s_min_u32 s12, s12, 39936
  s_add_u32 m0, s12, s26
  s_add_u32 s12, s12, s20
  buffer_load_dwordx4 v2, s[8:11], s12 offen lds
  s_waitcnt lgkmcnt(11)
  v_mfma_f32_16x16x32_bf16 v[144:147], v[96:99], a[24:27], v[144:147]
  ds_read_b128 v[96:99], v40 offset:12288
  s_waitcnt lgkmcnt(11)
  v_mfma_f32_16x16x32_bf16 v[148:151], v[100:103], a[24:27], v[148:151]
  ds_read_b128 v[100:103], v40 offset:32768
  s_add_u32 s12, s21, 6144
  s_min_u32 s12, s12, 39936
  s_add_u32 m0, s12, s26
  s_add_u32 s12, s12, s20
  buffer_load_dwordx4 v2, s[8:11], s12 offen lds
  s_waitcnt lgkmcnt(11)
  v_mfma_f32_16x16x32_bf16 v[144:147], v[104:107], a[28:31], v[144:147]
  ds_read_b128 v[104:107], v40 offset:13312
  s_waitcnt lgkmcnt(11)
  v_mfma_f32_16x16x32_bf16 v[148:151], v[108:111], a[28:31], v[148:151]
  ds_read_b128 v[108:111], v40 offset:33792
  s_add_u32 s12, s21, 7168
  s_min_u32 s12, s12, 39936
  s_add_u32 m0, s12, s26
  s_add_u32 s12, s12, s20
  buffer_load_dwordx4 v2, s[8:11], s12 offen lds
  s_waitcnt lgkmcnt(11)
  v_mfma_f32_16x16x32_bf16 v[144:147], v[112:115], a[32:35], v[144:147]
  ds_read_b128 v[112:115], v40 offset:14336
  s_waitcnt lgkmcnt(11)
  v_mfma_f32_16x16x32_bf16 v[148:151], v[116:119], a[32:35], v[148:151]
  ds_read_b128 v[116:119], v40 offset:34816
  s_add_u32 s12, s21, 8192
  s_min_u32 s12, s12, 39936
  s_add_u32 m0, s12, s26
  s_add_u32 s12, s12, s20
  buffer_load_dwordx4 v2, s[8:11], s12 offen lds
  s_waitcnt lgkmcnt(11)
  v_mfma_f32_16x16x32_bf16 v[144:147], v[120:123], a[36:39], v[144:147]
  ds_read_b128 v[120:123], v40 offset:15360
  s_waitcnt lgkmcnt(11)
  v_mfma_f32_16x16x32_bf16 v[148:151], v[124:127], a[36:39], v[148:151]
  ds_read_b128 v[124:127], v40 offset:35840
  s_add_u32 s12, s21, 9216
  s_min_u32 s12, s12, 39936
  s_add_u32 m0, s12, s26
  s_add_u32 s12, s12, s20
  buffer_load_dwordx4 v2, s[8:11], s12 offen lds
  s_waitcnt lgkmcnt(11)
  v_mfma_f32_16x16x32_bf16 v[144:147], v[128:131], a[40:43], v[144:147]
  ds_read_b128 v[128:131], v40 offset:16384
  s_waitcnt lgkmcnt(11)
  v_mfma_f32_16x16x32_bf16 v[148:151], v[132:135], a[40:43], v[148:151]
  ds_read_b128 v[132:135], v40 offset:36864
  s_add_u32 s12, s21, 10240
  s_min_u32 s12, s12, 39936
  s_add_u32 m0, s12, s26
  s_add_u32 s12, s12, s20
  buffer_load_dwordx4 v2, s[8:11], s12 offen lds
  s_waitcnt lgkmcnt(11)
  v_mfma_f32_16x16x32_bf16 v[144:147], v[136:139], a[44:47], v[144:147]
  ds_read_b128 v[136:139], v40 offset:17408
  s_waitcnt lgkmcnt(11)
  v_mfma_f32_16x16x32_bf16 v[148:151], v[140:143], a[44:47], v[148:151]
  ds_read_b128 v[140:143], v40 offset:37888
  s_add_u32 s12, s21, 11264
  s_min_u32 s12, s12, 39936
  s_add_u32 m0, s12, s26
  s_add_u32 s12, s12, s20
  buffer_load_dwordx4 v2, s[8:11], s12 offen lds
  s_waitcnt lgkmcnt(11)
  v_mfma_f32_16x16x32_bf16 v[144:147], v[96:99], a[48:51], v[144:147]
  ds_read_b128 v[96:99], v40 offset:18432
  s_waitcnt lgkmcnt(11)
  v_mfma_f32_16x16x32_bf16 v[148:151], v[100:103], a[48:51], v[148:151]
  ds_read_b128 v[100:103], v40 offset:38912
  s_add_u32 s12, s21, 12288
  s_min_u32 s12, s12, 39936
  s_add_u32 m0, s12, s26
  s_add_u32 s12, s12, s20
  buffer_load_dwordx4 v2, s[8:11], s12 offen lds
  s_waitcnt lgkmcnt(11)
  v_mfma_f32_16x16x32_bf16 v[144:147], v[104:107], a[52:55], v[144:147]
  ds_read_b128 v[104:107], v40 offset:19456
  s_waitcnt lgkmcnt(11)
  v_mfma_f32_16x16x32_bf16 v[148:151], v[108:111], a[52:55], v[148:151]
  ds_read_b128 v[108:111], v40 offset:39936
  s_add_u32 s12, s21, 13312
  s_min_u32 s12, s12, 39936
  s_add_u32 m0, s12, s26
  s_add_u32 s12, s12, s20
  buffer_load_dwordx4 v2, s[8:11], s12 offen lds
  s_waitcnt lgkmcnt(11)
  v_mfma_f32_16x16x32_bf16 v[144:147], v[112:115], a[56:59], v[144:147]
  s_waitcnt lgkmcnt(10)
  v_mfma_f32_16x16x32_bf16 v[148:151], v[116:119], a[56:59], v[148:151]
  s_waitcnt lgkmcnt(9)
  v_mfma_f32_16x16x32_bf16 v[144:147], v[120:123], a[60:63], v[144:147]
  s_waitcnt lgkmcnt(8)
  v_mfma_f32_16x16x32_bf16 v[148:151], v[124:127], a[60:63], v[148:151]
  s_waitcnt lgkmcnt(7)
  v_mfma_f32_16x16x32_bf16 v[144:147], v[128:131], a[64:67], v[144:147]
  s_waitcnt lgkmcnt(6)
  v_mfma_f32_16x16x32_bf16 v[148:151], v[132:135], a[64:67], v[148:151]
  s_waitcnt lgkmcnt(5)
  v_mfma_f32_16x16x32_bf16 v[144:147], v[136:139], a[68:71], v[144:147]
  s_waitcnt lgkmcnt(4)
  v_mfma_f32_16x16x32_bf16 v[148:151], v[140:143], a[68:71], v[148:151]
  s_waitcnt lgkmcnt(3)
  v_mfma_f32_16x16x32_bf16 v[144:147], v[96:99], a[72:75], v[144:147]
  s_waitcnt lgkmcnt(2)
  v_mfma_f32_16x16x32_bf16 v[148:151], v[100:103], a[72:75], v[148:151]
  s_waitcnt lgkmcnt(1)
  v_mfma_f32_16x16x32_bf16 v[144:147], v[104:107], a[76:79], v[144:147]
  s_waitcnt lgkmcnt(0)
  v_mfma_f32_16x16x32_bf16 v[148:151], v[108:111], a[76:79], v[148:151]
  s_nop 7
  s_nop 7
  v_cvt_pk_bf16_f32 v152, v144, v145
  v_cvt_pk_bf16_f32 v153, v146, v147
  v_cvt_pk_bf16_f32 v154, v148, v149
  v_cvt_pk_bf16_f32 v155, v150, v151
  buffer_store_dwordx4 v[152:155], v2, s[8:11], s23 offen sc1
ch_s_teloa:
  s_add_u32 s22, s22, 524288
  s_add_u32 s23, s23, 262144
  s_add_u32 s24, s24, 1
  s_bitset0_b32 s22, 22
  s_bitset0_b32 s23, 21
  s_add_u32 s20, s20, 40960
  s_add_u32 s25, s25, 1
  s_branch ch_s_wxlo
ch_s_wnlo:
  s_and_b32 s12, s24, 1
  s_mul_i32 s12, s12, 40960
  s_add_u32 s12, s12, 40960
  v_add_u32 v40, s12, v2
  ds_read_b128 v[96:99], v40 offset:0
  ds_read_b128 v[100:103], v40 offset:20480
  ds_read_b128 v[104:107], v40 offset:1024
  ds_read_b128 v[108:111], v40 offset:21504
  ds_read_b128 v[112:115], v40 offset:2048
  ds_read_b128 v[116:119], v40 offset:22528
  ds_read_b128 v[120:123], v40 offset:3072
  ds_read_b128 v[124:127], v40 offset:23552
  ds_read_b128 v[128:131], v40 offset:4096
  ds_read_b128 v[132:135], v40 offset:24576
  ds_read_b128 v[136:139], v40 offset:5120
  ds_read_b128 v[140:143], v40 offset:25600
  s_cmp_eq_u32 s3, 2
  s_cbranch_scc1 ch_s_tvlob
  s_waitcnt lgkmcnt(11)
  v_mfma_f32_16x16x32_bf16 v[144:147], a[0:3], v[96:99], 0
  ds_read_b128 v[96:99], v40 offset:6144
  s_waitcnt lgkmcnt(11)
  v_mfma_f32_16x16x32_bf16 v[148:151], a[0:3], v[100:103], 0
  ds_read_b128 v[100:103], v40 offset:26624
  s_waitcnt lgkmcnt(11)
  v_mfma_f32_16x16x32_bf16 v[144:147], a[4:7], v[104:107], v[144:147]
  ds_read_b128 v[104:107], v40 offset:7168
  s_waitcnt lgkmcnt(11)
  v_mfma_f32_16x16x32_bf16 v[148:151], a[4:7], v[108:111], v[148:151]
  ds_read_b128 v[108:111], v40 offset:27648
  s_waitcnt lgkmcnt(11)
  v_mfma_f32_16x16x32_bf16 v[144:147], a[8:11], v[112:115], v[144:147]
  ds_read_b128 v[112:115], v40 offset:8192
  s_waitcnt lgkmcnt(11)
  v_mfma_f32_16x16x32_bf16 v[148:151], a[8:11], v[116:119], v[148:151]
  ds_read_b128 v[116:119], v40 offset:28672
  s_waitcnt lgkmcnt(11)
  v_mfma_f32_16x16x32_bf16 v[144:147], a[12:15], v[120:123], v[144:147]
  ds_read_b128 v[120:123], v40 offset:9216
  s_waitcnt lgkmcnt(11)
  v_mfma_f32_16x16x32_bf16 v[148:151], a[12:15], v[124:127], v[148:151]
  ds_read_b128 v[124:127], v40 offset:29696
  s_waitcnt lgkmcnt(11)
  v_mfma_f32_16x16x32_bf16 v[144:147], a[16:19], v[128:131], v[144:147]
  ds_read_b128 v[128:131], v40 offset:10240
  s_waitcnt lgkmcnt(11)
  v_mfma_f32_16x16x32_bf16 v[148:151], a[16:19], v[132:135], v[148:151]
  ds_read_b128 v[132:135], v40 offset:30720
  s_waitcnt lgkmcnt(11)
  v_mfma_f32_16x16x32_bf16 v[144:147], a[20:23], v[136:139], v[144:147]
  ds_read_b128 v[136:139], v40 offset:11264
  s_waitcnt lgkmcnt(11)
  v_mfma_f32_16x16x32_bf16 v[148:151], a[20:23], v[140:143], v[148:151]
  ds_read_b128 v[140:143], v40 offset:31744
  s_waitcnt lgkmcnt(11)
  v_mfma_f32_16x16x32_bf16 v[144:147], a[24:27], v[96:99], v[144:147]
  ds_read_b128 v[96:99], v40 offset:12288
  s_waitcnt lgkmcnt(11)
  v_mfma_f32_16x16x32_bf16 v[148:151], a[24:27], v[100:103], v[148:151]
  ds_read_b128 v[100:103], v40 offset:32768
  s_waitcnt lgkmcnt(11)
  v_mfma_f32_16x16x32_bf16 v[144:147], a[28:31], v[104:107], v[144:147]
  ds_read_b128 v[104:107], v40 offset:13312
  s_waitcnt lgkmcnt(11)
  v_mfma_f32_16x16x32_bf16 v[148:151], a[28:31], v[108:111], v[148:151]
  ds_read_b128 v[108:111], v40 offset:33792
  s_waitcnt lgkmcnt(11)
  v_mfma_f32_16x16x32_bf16 v[144:147], a[32:35], v[112:115], v[144:147]
  ds_read_b128 v[112:115], v40 offset:14336
  s_waitcnt lgkmcnt(11)
  v_mfma_f32_16x16x32_bf16 v[148:151], a[32:35], v[116:119], v[148:151]
  ds_read_b128 v[116:119], v40 offset:34816
  s_waitcnt lgkmcnt(11)
  v_mfma_f32_16x16x32_bf16 v[144:147], a[36:39], v[120:123], v[144:147]
  ds_read_b128 v[120:123], v40 offset:15360
  s_waitcnt lgkmcnt(11)
  v_mfma_f32_16x16x32_bf16 v[148:151], a[36:39], v[124:127], v[148:151]
  ds_read_b128 v[124:127], v40 offset:35840
  s_waitcnt lgkmcnt(11)
  v_mfma_f32_16x16x32_bf16 v[144:147], a[40:43], v[128:131], v[144:147]
  ds_read_b128 v[128:131], v40 offset:16384
  s_waitcnt lgkmcnt(11)
  v_mfma_f32_16x16x32_bf16 v[148:151], a[40:43], v[132:135], v[148:151]
  ds_read_b128 v[132:135], v40 offset:36864
  s_waitcnt lgkmcnt(11)
  v_mfma_f32_16x16x32_bf16 v[144:147], a[44:47], v[136:139], v[144:147]
  ds_read_b128 v[136:139], v40 offset:17408
  s_waitcnt lgkmcnt(11)
  v_mfma_f32_16x16x32_bf16 v[148:151], a[44:47], v[140:143], v[148:151]
  ds_read_b128 v[140:143], v40 offset:37888
  s_waitcnt lgkmcnt(11)
  v_mfma_f32_16x16x32_bf16 v[144:147], a[48:51], v[96:99], v[144:147]
  ds_read_b128 v[96:99], v40 offset:18432
  s_waitcnt lgkmcnt(11)
  v_mfma_f32_16x16x32_bf16 v[148:151], a[48:51], v[100:103], v[148:151]
  ds_read_b128 v[100:103], v40 offset:38912
  s_waitcnt lgkmcnt(11)
  v_mfma_f32_16x16x32_bf16 v[144:147], a[52:55], v[104:107], v[144:147]
  ds_read_b128 v[104:107], v40 offset:19456
  s_waitcnt lgkmcnt(11)
  v_mfma_f32_16x16x32_bf16 v[148:151], a[52:55], v[108:111], v[148:151]
  ds_read_b128 v[108:111], v40 offset:39936
  s_waitcnt lgkmcnt(11)
  v_mfma_f32_16x16x32_bf16 v[144:147], a[56:59], v[112:115], v[144:147]
  s_waitcnt lgkmcnt(10)
  v_mfma_f32_16x16x32_bf16 v[148:151], a[56:59], v[116:119], v[148:151]
  s_waitcnt lgkmcnt(9)
  v_mfma_f32_16x16x32_bf16 v[144:147], a[60:63], v[120:123], v[144:147]
  s_waitcnt lgkmcnt(8)
  v_mfma_f32_16x16x32_bf16 v[148:151], a[60:63], v[124:127], v[148:151]
  s_waitcnt lgkmcnt(7)
  v_mfma_f32_16x16x32_bf16 v[144:147], a[64:67], v[128:131], v[144:147]
  s_waitcnt lgkmcnt(6)
  v_mfma_f32_16x16x32_bf16 v[148:151], a[64:67], v[132:135], v[148:151]
  s_waitcnt lgkmcnt(5)
  v_mfma_f32_16x16x32_bf16 v[144:147], a[68:71], v[136:139], v[144:147]
  s_waitcnt lgkmcnt(4)
  v_mfma_f32_16x16x32_bf16 v[148:151], a[68:71], v[140:143], v[148:151]
  s_waitcnt lgkmcnt(3)
  v_mfma_f32_16x16x32_bf16 v[144:147], a[72:75], v[96:99], v[144:147]
  s_waitcnt lgkmcnt(2)
  v_mfma_f32_16x16x32_bf16 v[148:151], a[72:75], v[100:103], v[148:151]
  s_waitcnt lgkmcnt(1)
  v_mfma_f32_16x16x32_bf16 v[144:147], a[76:79], v[104:107], v[144:147]
  s_waitcnt lgkmcnt(0)
  v_mfma_f32_16x16x32_bf16 v[148:151], a[76:79], v[108:111], v[148:151]
  s_nop 7
  s_nop 7
  v_cvt_pk_bf16_f32 v152, v144, v145
  v_cvt_pk_bf16_f32 v153, v146, v147
  v_cvt_pk_bf16_f32 v154, v148, v149
  v_cvt_pk_bf16_f32 v155, v150, v151
  buffer_store_dwordx2 v[152:153], v42, s[8:11], s22 offen sc1
  s_add_u32 s12, s22, 262144
  buffer_store_dwordx2 v[154:155], v42, s[8:11], s12 offen sc1
  s_branch ch_s_telob
ch_s_tvlob:
  s_waitcnt lgkmcnt(11)
  v_mfma_f32_16x16x32_bf16 v[144:147], v[96:99], a[0:3], 0
  ds_read_b128 v[96:99], v40 offset:6144
  s_waitcnt lgkmcnt(11)
  v_mfma_f32_16x16x32_bf16 v[148:151], v[100:103], a[0:3], 0
  ds_read_b128 v[100:103], v40 offset:26624
  s_waitcnt lgkmcnt(11)
  v_mfma_f32_16x16x32_bf16 v[144:147], v[104:107], a[4:7], v[144:147]
  ds_read_b128 v[104:107], v40 offset:7168
  s_waitcnt lgkmcnt(11)
  v_mfma_f32_16x16x32_bf16 v[148:151], v[108:111], a[4:7], v[148:151]
  ds_read_b128 v[108:111], v40 offset:27648
  s_waitcnt lgkmcnt(11)
  v_mfma_f32_16x16x32_bf16 v[144:147], v[112:115], a[8:11], v[144:147]
  ds_read_b128 v[112:115], v40 offset:8192
  s_waitcnt lgkmcnt(11)
  v_mfma_f32_16x16x32_bf16 v[148:151], v[116:119], a[8:11], v[148:151]
  ds_read_b128 v[116:119], v40 offset:28672
  s_waitcnt lgkmcnt(11)
  v_mfma_f32_16x16x32_bf16 v[144:147], v[120:123], a[12:15], v[144:147]
  ds_read_b128 v[120:123], v40 offset:9216
  s_waitcnt lgkmcnt(11)
  v_mfma_f32_16x16x32_bf16 v[148:151], v[124:127], a[12:15], v[148:151]
  ds_read_b128 v[124:127], v40 offset:29696
  s_waitcnt lgkmcnt(11)
  v_mfma_f32_16x16x32_bf16 v[144:147], v[128:131], a[16:19], v[144:147]
  ds_read_b128 v[128:131], v40 offset:10240
  s_waitcnt lgkmcnt(11)
  v_mfma_f32_16x16x32_bf16 v[148:151], v[132:135], a[16:19], v[148:151]
  ds_read_b128 v[132:135], v40 offset:30720
  s_waitcnt lgkmcnt(11)
  v_mfma_f32_16x16x32_bf16 v[144:147], v[136:139], a[20:23], v[144:147]
  ds_read_b128 v[136:139], v40 offset:11264
  s_waitcnt lgkmcnt(11)
  v_mfma_f32_16x16x32_bf16 v[148:151], v[140:143], a[20:23], v[148:151]
  ds_read_b128 v[140:143], v40 offset:31744
  s_waitcnt lgkmcnt(11)
  v_mfma_f32_16x16x32_bf16 v[144:147], v[96:99], a[24:27], v[144:147]
  ds_read_b128 v[96:99], v40 offset:12288
  s_waitcnt lgkmcnt(11)
  v_mfma_f32_16x16x32_bf16 v[148:151], v[100:103], a[24:27], v[148:151]
  ds_read_b128 v[100:103], v40 offset:32768
  s_waitcnt lgkmcnt(11)
  v_mfma_f32_16x16x32_bf16 v[144:147], v[104:107], a[28:31], v[144:147]
  ds_read_b128 v[104:107], v40 offset:13312
  s_waitcnt lgkmcnt(11)
  v_mfma_f32_16x16x32_bf16 v[148:151], v[108:111], a[28:31], v[148:151]
  ds_read_b128 v[108:111], v40 offset:33792
  s_waitcnt lgkmcnt(11)
  v_mfma_f32_16x16x32_bf16 v[144:147], v[112:115], a[32:35], v[144:147]
  ds_read_b128 v[112:115], v40 offset:14336
  s_waitcnt lgkmcnt(11)
  v_mfma_f32_16x16x32_bf16 v[148:151], v[116:119], a[32:35], v[148:151]
  ds_read_b128 v[116:119], v40 offset:34816
  s_waitcnt lgkmcnt(11)
  v_mfma_f32_16x16x32_bf16 v[144:147], v[120:123], a[36:39], v[144:147]
  ds_read_b128 v[120:123], v40 offset:15360
  s_waitcnt lgkmcnt(11)
  v_mfma_f32_16x16x32_bf16 v[148:151], v[124:127], a[36:39], v[148:151]
  ds_read_b128 v[124:127], v40 offset:35840
  s_waitcnt lgkmcnt(11)
  v_mfma_f32_16x16x32_bf16 v[144:147], v[128:131], a[40:43], v[144:147]
  ds_read_b128 v[128:131], v40 offset:16384
  s_waitcnt lgkmcnt(11)
  v_mfma_f32_16x16x32_bf16 v[148:151], v[132:135], a[40:43], v[148:151]
  ds_read_b128 v[132:135], v40 offset:36864
  s_waitcnt lgkmcnt(11)
  v_mfma_f32_16x16x32_bf16 v[144:147], v[136:139], a[44:47], v[144:147]
  ds_read_b128 v[136:139], v40 offset:17408
  s_waitcnt lgkmcnt(11)
  v_mfma_f32_16x16x32_bf16 v[148:151], v[140:143], a[44:47], v[148:151]
  ds_read_b128 v[140:143], v40 offset:37888
  s_waitcnt lgkmcnt(11)
  v_mfma_f32_16x16x32_bf16 v[144:147], v[96:99], a[48:51], v[144:147]
  ds_read_b128 v[96:99], v40 offset:18432
  s_waitcnt lgkmcnt(11)
  v_mfma_f32_16x16x32_bf16 v[148:151], v[100:103], a[48:51], v[148:151]
  ds_read_b128 v[100:103], v40 offset:38912
  s_waitcnt lgkmcnt(11)
  v_mfma_f32_16x16x32_bf16 v[144:147], v[104:107], a[52:55], v[144:147]
  ds_read_b128 v[104:107], v40 offset:19456
  s_waitcnt lgkmcnt(11)
  v_mfma_f32_16x16x32_bf16 v[148:151], v[108:111], a[52:55], v[148:151]
  ds_read_b128 v[108:111], v40 offset:39936
  s_waitcnt lgkmcnt(11)
  v_mfma_f32_16x16x32_bf16 v[144:147], v[112:115], a[56:59], v[144:147]
  s_waitcnt lgkmcnt(10)
  v_mfma_f32_16x16x32_bf16 v[148:151], v[116:119], a[56:59], v[148:151]
  s_waitcnt lgkmcnt(9)
  v_mfma_f32_16x16x32_bf16 v[144:147], v[120:123], a[60:63], v[144:147]
  s_waitcnt lgkmcnt(8)
  v_mfma_f32_16x16x32_bf16 v[148:151], v[124:127], a[60:63], v[148:151]
  s_waitcnt lgkmcnt(7)
  v_mfma_f32_16x16x32_bf16 v[144:147], v[128:131], a[64:67], v[144:147]
  s_waitcnt lgkmcnt(6)
  v_mfma_f32_16x16x32_bf16 v[148:151], v[132:135], a[64:67], v[148:151]
  s_waitcnt lgkmcnt(5)
  v_mfma_f32_16x16x32_bf16 v[144:147], v[136:139], a[68:71], v[144:147]
  s_waitcnt lgkmcnt(4)
  v_mfma_f32_16x16x32_bf16 v[148:151], v[140:143], a[68:71], v[148:151]
  s_waitcnt lgkmcnt(3)
  v_mfma_f32_16x16x32_bf16 v[144:147], v[96:99], a[72:75], v[144:147]
  s_waitcnt lgkmcnt(2)
  v_mfma_f32_16x16x32_bf16 v[148:151], v[100:103], a[72:75], v[148:151]
  s_waitcnt lgkmcnt(1)
  v_mfma_f32_16x16x32_bf16 v[144:147], v[104:107], a[76:79], v[144:147]
  s_waitcnt lgkmcnt(0)
  v_mfma_f32_16x16x32_bf16 v[148:151], v[108:111], a[76:79], v[148:151]
  s_nop 7
  s_nop 7
  v_cvt_pk_bf16_f32 v152, v144, v145
  v_cvt_pk_bf16_f32 v153, v146, v147
  v_cvt_pk_bf16_f32 v154, v148, v149
  v_cvt_pk_bf16_f32 v155, v150, v151
  buffer_store_dwordx4 v[152:155], v2, s[8:11], s23 offen sc1
ch_s_telob:
  s_add_u32 s22, s22, 524288
  s_add_u32 s23, s23, 262144
  s_add_u32 s24, s24, 1
  s_bitset0_b32 s22, 22
  s_bitset0_b32 s23, 21
ch_s_wxlo:
ch_s_next:
  s_add_u32 s60, s60, 1
  s_branch ch_s_loop
ch_s_end:
  s_endpgm
ch_s_hi:
  s_cmp_eq_u32 s3, 3
  s_cbranch_scc1 ch_s_hi3
  s_sleep 32
  s_cmp_gt_u32 s60, 61
  s_cbranch_scc1 ch_s_wxhi
  s_cmp_eq_u32 s60, 61
  s_cbranch_scc1 ch_s_wnhi
  s_and_b32 s12, s24, 1
  s_mul_i32 s12, s12, 40960
  s_add_u32 s12, s12, 40960
  v_add_u32 v40, s12, v2
  s_and_b32 s26, s25, 1
  s_mul_i32 s26, s26, 40960
  s_add_u32 s26, s26, 40960
  ds_read_b128 v[96:99], v40 offset:0
  ds_read_b128 v[100:103], v40 offset:20480
  ds_read_b128 v[104:107], v40 offset:1024
  ds_read_b128 v[108:111], v40 offset:21504
  ds_read_b128 v[112:115], v40 offset:2048
  ds_read_b128 v[116:119], v40 offset:22528
  ds_read_b128 v[120:123], v40 offset:3072
  ds_read_b128 v[124:127], v40 offset:23552
  ds_read_b128 v[128:131], v40 offset:4096
  ds_read_b128 v[132:135], v40 offset:24576
  ds_read_b128 v[136:139], v40 offset:5120
  ds_read_b128 v[140:143], v40 offset:25600
  s_cmp_eq_u32 s3, 2
  s_cbranch_scc1 ch_s_tvhia
  s_waitcnt lgkmcnt(11)
  v_mfma_f32_16x16x32_bf16 v[144:147], a[0:3], v[96:99], 0
  ds_read_b128 v[96:99], v40 offset:6144
  s_waitcnt lgkmcnt(11)
  v_mfma_f32_16x16x32_bf16 v[148:151], a[0:3], v[100:103], 0
  ds_read_b128 v[100:103], v40 offset:26624
  s_add_u32 s12, s21, 0
  s_min_u32 s12, s12, 39936
  s_add_u32 m0, s12, s26
  s_add_u32 s12, s12, s20
  buffer_load_dwordx4 v2, s[8:11], s12 offen lds
  s_waitcnt lgkmcnt(11)
  v_mfma_f32_16x16x32_bf16 v[144:147], a[4:7], v[104:107], v[144:147]
  ds_read_b128 v[104:107], v40 offset:7168
  s_waitcnt lgkmcnt(11)
  v_mfma_f32_16x16x32_bf16 v[148:151], a[4:7], v[108:111], v[148:151]
  ds_read_b128 v[108:111], v40 offset:27648
  s_add_u32 s12, s21, 1024
  s_min_u32 s12, s12, 39936
  s_add_u32 m0, s12, s26
  s_add_u32 s12, s12, s20
  buffer_load_dwordx4 v2, s[8:11], s12 offen lds
  s_waitcnt lgkmcnt(11)
  v_mfma_f32_16x16x32_bf16 v[144:147], a[8:11], v[112:115], v[144:147]
  ds_read_b128 v[112:115], v40 offset:8192
  s_waitcnt lgkmcnt(11)
  v_mfma_f32_16x16x32_bf16 v[148:151], a[8:11], v[116:119], v[148:151]
  ds_read_b128 v[116:119], v40 offset:28672
  s_add_u32 s12, s21, 2048
  s_min_u32 s12, s12, 39936
  s_add_u32 m0, s12, s26
  s_add_u32 s12, s12, s20
  buffer_load_dwordx4 v2, s[8:11], s12 offen lds
  s_waitcnt lgkmcnt(11)
  v_mfma_f32_16x16x32_bf16 v[144:147], a[12:15], v[120:123], v[144:147]
  ds_read_b128 v[120:123], v40 offset:9216
  s_waitcnt lgkmcnt(11)
  v_mfma_f32_16x16x32_bf16 v[148:151], a[12:15], v[124:127], v[148:151]
  ds_read_b128 v[124:127], v40 offset:29696
  s_add_u32 s12, s21, 3072
  s_min_u32 s12, s12, 39936
  s_add_u32 m0, s12, s26
  s_add_u32 s12, s12, s20
  buffer_load_dwordx4 v2, s[8:11], s12 offen lds
  s_waitcnt lgkmcnt(11)
  v_mfma_f32_16x16x32_bf16 v[144:147], a[16:19], v[128:131], v[144:147]
  ds_read_b128 v[128:131], v40 offset:10240
  s_waitcnt lgkmcnt(11)
  v_mfma_f32_16x16x32_bf16 v[148:151], a[16:19], v[132:135], v[148:151]
  ds_read_b128 v[132:135], v40 offset:30720
  s_add_u32 s12, s21, 4096
  s_min_u32 s12, s12, 39936
  s_add_u32 m0, s12, s26
  s_add_u32 s12, s12, s20
  buffer_load_dwordx4 v2, s[8:11], s12 offen lds
  s_waitcnt lgkmcnt(11)
  v_mfma_f32_16x16x32_bf16 v[144:147], a[20:23], v[136:139], v[144:147]
  ds_read_b128 v[136:139], v40 offset:11264
  s_waitcnt lgkmcnt(11)
  v_mfma_f32_16x16x32_bf16 v[148:151], a[20:23], v[140:143], v[148:151]
  ds_read_b128 v[140:143], v40 offset:31744
  s_add_u32 s12, s21, 5120
  s_min_u32 s12, s12, 39936
  s_add_u32 m0, s12, s26
  s_add_u32 s12, s12, s20
  buffer_load_dwordx4 v2, s[8:11], s12 offen lds
  s_waitcnt lgkmcnt(11)
  v_mfma_f32_16x16x32_bf16 v[144:147], a[24:27], v[96:99], v[144:147]
  ds_read_b128 v[96:99], v40 offset:12288
  s_waitcnt lgkmcnt(11)
  v_mfma_f32_16x16x32_bf16 v[148:151], a[24:27], v[100:103], v[148:151]
  ds_read_b128 v[100:103], v40 offset:32768
  s_add_u32 s12, s21, 6144
  s_min_u32 s12, s12, 39936
  s_add_u32 m0, s12, s26
  s_add_u32 s12, s12, s20
  buffer_load_dwordx4 v2, s[8:11], s12 offen lds
  s_waitcnt lgkmcnt(11)
  v_mfma_f32_16x16x32_bf16 v[144:147], a[28:31], v[104:107], v[144:147]
  ds_read_b128 v[104:107], v40 offset:13312
  s_waitcnt lgkmcnt(11)
  v_mfma_f32_16x16x32_bf16 v[148:151], a[28:31], v[108:111], v[148:151]
  ds_read_b128 v[108:111], v40 offset:33792
  s_add_u32 s12, s21, 7168
  s_min_u32 s12, s12, 39936
  s_add_u32 m0, s12, s26
  s_add_u32 s12, s12, s20
  buffer_load_dwordx4 v2, s[8:11], s12 offen lds
  s_waitcnt lgkmcnt(11)
  v_mfma_f32_16x16x32_bf16 v[144:147], a[32:35], v[112:115], v[144:147]
  ds_read_b128 v[112:115], v40 offset:14336
  s_waitcnt lgkmcnt(11)
  v_mfma_f32_16x16x32_bf16 v[148:151], a[32:35], v[116:119], v[148:151]
  ds_read_b128 v[116:119], v40 offset:34816
  s_add_u32 s12, s21, 8192
  s_min_u32 s12, s12, 39936
  s_add_u32 m0, s12, s26
  s_add_u32 s12, s12, s20
  buffer_load_dwordx4 v2, s[8:11], s12 offen lds
  s_waitcnt lgkmcnt(11)
  v_mfma_f32_16x16x32_bf16 v[144:147], a[36:39], v[120:123], v[144:147]
  ds_read_b128 v[120:123], v40 offset:15360
  s_waitcnt lgkmcnt(11)
  v_mfma_f32_16x16x32_bf16 v[148:151], a[36:39], v[124:127], v[148:151]
  ds_read_b128 v[124:127], v40 offset:35840
  s_add_u32 s12, s21, 9216
  s_min_u32 s12, s12, 39936
  s_add_u32 m0, s12, s26
  s_add_u32 s12, s12, s20
  buffer_load_dwordx4 v2, s[8:11], s12 offen lds
  s_waitcnt lgkmcnt(11)
  v_mfma_f32_16x16x32_bf16 v[144:147], a[40:43], v[128:131], v[144:147]
  ds_read_b128 v[128:131], v40 offset:16384
  s_waitcnt lgkmcnt(11)
  v_mfma_f32_16x16x32_bf16 v[148:151], a[40:43], v[132:135], v[148:151]
  ds_read_b128 v[132:135], v40 offset:36864
  s_add_u32 s12, s21, 10240
  s_min_u32 s12, s12, 39936
  s_add_u32 m0, s12, s26
  s_add_u32 s12, s12, s20
  buffer_load_dwordx4 v2, s[8:11], s12 offen lds
  s_waitcnt lgkmcnt(11)
  v_mfma_f32_16x16x32_bf16 v[144:147], a[44:47], v[136:139], v[144:147]
  ds_read_b128 v[136:139], v40 offset:17408
  s_waitcnt lgkmcnt(11)
  v_mfma_f32_16x16x32_bf16 v[148:151], a[44:47], v[140:143], v[148:151]
  ds_read_b128 v[140:143], v40 offset:37888
  s_add_u32 s12, s21, 11264
  s_min_u32 s12, s12, 39936
  s_add_u32 m0, s12, s26
  s_add_u32 s12, s12, s20
  buffer_load_dwordx4 v2, s[8:11], s12 offen lds
  s_waitcnt lgkmcnt(11)
  v_mfma_f32_16x16x32_bf16 v[144:147], a[48:51], v[96:99], v[144:147]
  ds_read_b128 v[96:99], v40 offset:18432
  s_waitcnt lgkmcnt(11)
  v_mfma_f32_16x16x32_bf16 v[148:151], a[48:51], v[100:103], v[148:151]
  ds_read_b128 v[100:103], v40 offset:38912
  s_add_u32 s12, s21, 12288
  s_min_u32 s12, s12, 39936
  s_add_u32 m0, s12, s26
  s_add_u32 s12, s12, s20
  buffer_load_dwordx4 v2, s[8:11], s12 offen lds
  s_waitcnt lgkmcnt(11)
  v_mfma_f32_16x16x32_bf16 v[144:147], a[52:55], v[104:107], v[144:147]
  ds_read_b128 v[104:107], v40 offset:19456
  s_waitcnt lgkmcnt(11)
  v_mfma_f32_16x16x32_bf16 v[148:151], a[52:55], v[108:111], v[148:151]
  ds_read_b128 v[108:111], v40 offset:39936
  s_add_u32 s12, s21, 13312
  s_min_u32 s12, s12, 39936
  s_add_u32 m0, s12, s26
  s_add_u32 s12, s12, s20
  buffer_load_dwordx4 v2, s[8:11], s12 offen lds
  s_waitcnt lgkmcnt(11)
  v_mfma_f32_16x16x32_bf16 v[144:147], a[56:59], v[112:115], v[144:147]
  s_waitcnt lgkmcnt(10)
  v_mfma_f32_16x16x32_bf16 v[148:151], a[56:59], v[116:119], v[148:151]
  s_waitcnt lgkmcnt(9)
  v_mfma_f32_16x16x32_bf16 v[144:147], a[60:63], v[120:123], v[144:147]
  s_waitcnt lgkmcnt(8)
  v_mfma_f32_16x16x32_bf16 v[148:151], a[60:63], v[124:127], v[148:151]
  s_waitcnt lgkmcnt(7)
  v_mfma_f32_16x16x32_bf16 v[144:147], a[64:67], v[128:131], v[144:147]
  s_waitcnt lgkmcnt(6)
  v_mfma_f32_16x16x32_bf16 v[148:151], a[64:67], v[132:135], v[148:151]
  s_waitcnt lgkmcnt(5)
  v_mfma_f32_16x16x32_bf16 v[144:147], a[68:71], v[136:139], v[144:147]
  s_waitcnt lgkmcnt(4)
  v_mfma_f32_16x16x32_bf16 v[148:151], a[68:71], v[140:143], v[148:151]
  s_waitcnt lgkmcnt(3)
  v_mfma_f32_16x16x32_bf16 v[144:147], a[72:75], v[96:99], v[144:147]
  s_waitcnt lgkmcnt(2)
  v_mfma_f32_16x16x32_bf16 v[148:151], a[72:75], v[100:103], v[148:151]
  s_waitcnt lgkmcnt(1)
  v_mfma_f32_16x16x32_bf16 v[144:147], a[76:79], v[104:107], v[144:147]
  s_waitcnt lgkmcnt(0)
  v_mfma_f32_16x16x32_bf16 v[148:151], a[76:79], v[108:111], v[148:151]
  s_nop 7
  s_nop 7
  v_cvt_pk_bf16_f32 v152, v144, v145
  v_cvt_pk_bf16_f32 v153, v146, v147
  v_cvt_pk_bf16_f32 v154, v148, v149
  v_cvt_pk_bf16_f32 v155, v150, v151
  buffer_store_dwordx2 v[152:153], v42, s[8:11], s22 offen sc1
  s_add_u32 s12, s22, 262144
  buffer_store_dwordx2 v[154:155], v42, s[8:11], s12 offen sc1
  s_branch ch_s_tehia
ch_s_tvhia:
  s_waitcnt lgkmcnt(11)
  v_mfma_f32_16x16x32_bf16 v[144:147], v[96:99], a[0:3], 0
  ds_read_b128 v[96:99], v40 offset:6144
  s_waitcnt lgkmcnt(11)
  v_mfma_f32_16x16x32_bf16 v[148:151], v[100:103], a[0:3], 0
  ds_read_b128 v[100:103], v40 offset:26624
  s_add_u32 s12, s21, 0
  s_min_u32 s12, s12, 39936
  s_add_u32 m0, s12, s26
  s_add_u32 s12, s12, s20
  buffer_load_dwordx4 v2, s[8:11], s12 offen lds
  s_waitcnt lgkmcnt(11)
  v_mfma_f32_16x16x32_bf16 v[144:147], v[104:107], a[4:7], v[144:147]
  ds_read_b128 v[104:107], v40 offset:7168
  s_waitcnt lgkmcnt(11)
  v_mfma_f32_16x16x32_bf16 v[148:151], v[108:111], a[4:7], v[148:151]
  ds_read_b128 v[108:111], v40 offset:27648
  s_add_u32 s12, s21, 1024
  s_min_u32 s12, s12, 39936
  s_add_u32 m0, s12, s26
  s_add_u32 s12, s12, s20
  buffer_load_dwordx4 v2, s[8:11], s12 offen lds
  s_waitcnt lgkmcnt(11)
  v_mfma_f32_16x16x32_bf16 v[144:147], v[112:115], a[8:11], v[144:147]
  ds_read_b128 v[112:115], v40 offset:8192
  s_waitcnt lgkmcnt(11)
  v_mfma_f32_16x16x32_bf16 v[148:151], v[116:119], a[8:11], v[148:151]
  ds_read_b128 v[116:119], v40 offset:28672
  s_add_u32 s12, s21, 2048
  s_min_u32 s12, s12, 39936
  s_add_u32 m0, s12, s26
  s_add_u32 s12, s12, s20
  buffer_load_dwordx4 v2, s[8:11], s12 offen lds
  s_waitcnt lgkmcnt(11)
  v_mfma_f32_16x16x32_bf16 v[144:147], v[120:123], a[12:15], v[144:147]
  ds_read_b128 v[120:123], v40 offset:9216
  s_waitcnt lgkmcnt(11)
  v_mfma_f32_16x16x32_bf16 v[148:151], v[124:127], a[12:15], v[148:151]
  ds_read_b128 v[124:127], v40 offset:29696
  s_add_u32 s12, s21, 3072
  s_min_u32 s12, s12, 39936
  s_add_u32 m0, s12, s26
  s_add_u32 s12, s12, s20
  buffer_load_dwordx4 v2, s[8:11], s12 offen lds
  s_waitcnt lgkmcnt(11)
  v_mfma_f32_16x16x32_bf16 v[144:147], v[128:131], a[16:19], v[144:147]
  ds_read_b128 v[128:131], v40 offset:10240
  s_waitcnt lgkmcnt(11)
  v_mfma_f32_16x16x32_bf16 v[148:151], v[132:135], a[16:19], v[148:151]
  ds_read_b128 v[132:135], v40 offset:30720
  s_add_u32 s12, s21, 4096
  s_min_u32 s12, s12, 39936
  s_add_u32 m0, s12, s26
  s_add_u32 s12, s12, s20
  buffer_load_dwordx4 v2, s[8:11], s12 offen lds
  s_waitcnt lgkmcnt(11)
  v_mfma_f32_16x16x32_bf16 v[144:147], v[136:139], a[20:23], v[144:147]
  ds_read_b128 v[136:139], v40 offset:11264
  s_waitcnt lgkmcnt(11)
  v_mfma_f32_16x16x32_bf16 v[148:151], v[140:143], a[20:23], v[148:151]
  ds_read_b128 v[140:143], v40 offset:31744
  s_add_u32 s12, s21, 5120
  s_min_u32 s12, s12, 39936
  s_add_u32 m0, s12, s26
  s_add_u32 s12, s12, s20
  buffer_load_dwordx4 v2, s[8:11], s12 offen lds
  s_waitcnt lgkmcnt(11)
  v_mfma_f32_16x16x32_bf16 v[144:147], v[96:99], a[24:27], v[144:147]
  ds_read_b128 v[96:99], v40 offset:12288
  s_waitcnt lgkmcnt(11)
  v_mfma_f32_16x16x32_bf16 v[148:151], v[100:103], a[24:27], v[148:151]
  ds_read_b128 v[100:103], v40 offset:32768
  s_add_u32 s12, s21, 6144
  s_min_u32 s12, s12, 39936
  s_add_u32 m0, s12, s26
  s_add_u32 s12, s12, s20
  buffer_load_dwordx4 v2, s[8:11], s12 offen lds
  s_waitcnt lgkmcnt(11)
  v_mfma_f32_16x16x32_bf16 v[144:147], v[104:107], a[28:31], v[144:147]
  ds_read_b128 v[104:107], v40 offset:13312
  s_waitcnt lgkmcnt(11)
  v_mfma_f32_16x16x32_bf16 v[148:151], v[108:111], a[28:31], v[148:151]
  ds_read_b128 v[108:111], v40 offset:33792
  s_add_u32 s12, s21, 7168
  s_min_u32 s12, s12, 39936
  s_add_u32 m0, s12, s26
  s_add_u32 s12, s12, s20
  buffer_load_dwordx4 v2, s[8:11], s12 offen lds
  s_waitcnt lgkmcnt(11)
  v_mfma_f32_16x16x32_bf16 v[144:147], v[112:115], a[32:35], v[144:147]
  ds_read_b128 v[112:115], v40 offset:14336
  s_waitcnt lgkmcnt(11)
  v_mfma_f32_16x16x32_bf16 v[148:151], v[116:119], a[32:35], v[148:151]
  ds_read_b128 v[116:119], v40 offset:34816
  s_add_u32 s12, s21, 8192
  s_min_u32 s12, s12, 39936
  s_add_u32 m0, s12, s26
  s_add_u32 s12, s12, s20
  buffer_load_dwordx4 v2, s[8:11], s12 offen lds
  s_waitcnt lgkmcnt(11)
  v_mfma_f32_16x16x32_bf16 v[144:147], v[120:123], a[36:39], v[144:147]
  ds_read_b128 v[120:123], v40 offset:15360
  s_waitcnt lgkmcnt(11)
  v_mfma_f32_16x16x32_bf16 v[148:151], v[124:127], a[36:39], v[148:151]
  ds_read_b128 v[124:127], v40 offset:35840
  s_add_u32 s12, s21, 9216
  s_min_u32 s12, s12, 39936
  s_add_u32 m0, s12, s26
  s_add_u32 s12, s12, s20
  buffer_load_dwordx4 v2, s[8:11], s12 offen lds
  s_waitcnt lgkmcnt(11)
  v_mfma_f32_16x16x32_bf16 v[144:147], v[128:131], a[40:43], v[144:147]
  ds_read_b128 v[128:131], v40 offset:16384
  s_waitcnt lgkmcnt(11)
  v_mfma_f32_16x16x32_bf16 v[148:151], v[132:135], a[40:43], v[148:151]
  ds_read_b128 v[132:135], v40 offset:36864
  s_add_u32 s12, s21, 10240
  s_min_u32 s12, s12, 39936
  s_add_u32 m0, s12, s26
  s_add_u32 s12, s12, s20
  buffer_load_dwordx4 v2, s[8:11], s12 offen lds
  s_waitcnt lgkmcnt(11)
  v_mfma_f32_16x16x32_bf16 v[144:147], v[136:139], a[44:47], v[144:147]
  ds_read_b128 v[136:139], v40 offset:17408
  s_waitcnt lgkmcnt(11)
  v_mfma_f32_16x16x32_bf16 v[148:151], v[140:143], a[44:47], v[148:151]
  ds_read_b128 v[140:143], v40 offset:37888
  s_add_u32 s12, s21, 11264
  s_min_u32 s12, s12, 39936
  s_add_u32 m0, s12, s26
  s_add_u32 s12, s12, s20
  buffer_load_dwordx4 v2, s[8:11], s12 offen lds
  s_waitcnt lgkmcnt(11)
  v_mfma_f32_16x16x32_bf16 v[144:147], v[96:99], a[48:51], v[144:147]
  ds_read_b128 v[96:99], v40 offset:18432
  s_waitcnt lgkmcnt(11)
  v_mfma_f32_16x16x32_bf16 v[148:151], v[100:103], a[48:51], v[148:151]
  ds_read_b128 v[100:103], v40 offset:38912
  s_add_u32 s12, s21, 12288
  s_min_u32 s12, s12, 39936
  s_add_u32 m0, s12, s26
  s_add_u32 s12, s12, s20
  buffer_load_dwordx4 v2, s[8:11], s12 offen lds
  s_waitcnt lgkmcnt(11)
  v_mfma_f32_16x16x32_bf16 v[144:147], v[104:107], a[52:55], v[144:147]
  ds_read_b128 v[104:107], v40 offset:19456
  s_waitcnt lgkmcnt(11)
  v_mfma_f32_16x16x32_bf16 v[148:151], v[108:111], a[52:55], v[148:151]
  ds_read_b128 v[108:111], v40 offset:39936
  s_add_u32 s12, s21, 13312
  s_min_u32 s12, s12, 39936
  s_add_u32 m0, s12, s26
  s_add_u32 s12, s12, s20
  buffer_load_dwordx4 v2, s[8:11], s12 offen lds
  s_waitcnt lgkmcnt(11)
  v_mfma_f32_16x16x32_bf16 v[144:147], v[112:115], a[56:59], v[144:147]
  s_waitcnt lgkmcnt(10)
  v_mfma_f32_16x16x32_bf16 v[148:151], v[116:119], a[56:59], v[148:151]
  s_waitcnt lgkmcnt(9)
  v_mfma_f32_16x16x32_bf16 v[144:147], v[120:123], a[60:63], v[144:147]
  s_waitcnt lgkmcnt(8)
  v_mfma_f32_16x16x32_bf16 v[148:151], v[124:127], a[60:63], v[148:151]
  s_waitcnt lgkmcnt(7)
  v_mfma_f32_16x16x32_bf16 v[144:147], v[128:131], a[64:67], v[144:147]
  s_waitcnt lgkmcnt(6)
  v_mfma_f32_16x16x32_bf16 v[148:151], v[132:135], a[64:67], v[148:151]
  s_waitcnt lgkmcnt(5)
  v_mfma_f32_16x16x32_bf16 v[144:147], v[136:139], a[68:71], v[144:147]
  s_waitcnt lgkmcnt(4)
  v_mfma_f32_16x16x32_bf16 v[148:151], v[140:143], a[68:71], v[148:151]
  s_waitcnt lgkmcnt(3)
  v_mfma_f32_16x16x32_bf16 v[144:147], v[96:99], a[72:75], v[144:147]
  s_waitcnt lgkmcnt(2)
  v_mfma_f32_16x16x32_bf16 v[148:151], v[100:103], a[72:75], v[148:151]
  s_waitcnt lgkmcnt(1)
  v_mfma_f32_16x16x32_bf16 v[144:147], v[104:107], a[76:79], v[144:147]
  s_waitcnt lgkmcnt(0)
  v_mfma_f32_16x16x32_bf16 v[148:151], v[108:111], a[76:79], v[148:151]
  s_nop 7
  s_nop 7
  v_cvt_pk_bf16_f32 v152, v144, v145
  v_cvt_pk_bf16_f32 v153, v146, v147
  v_cvt_pk_bf16_f32 v154, v148, v149
  v_cvt_pk_bf16_f32 v155, v150, v151
  buffer_store_dwordx4 v[152:155], v2, s[8:11], s23 offen sc1
ch_s_tehia:
  s_add_u32 s22, s22, 524288
  s_add_u32 s23, s23, 262144
  s_add_u32 s24, s24, 1
  s_bitset0_b32 s22, 22
  s_bitset0_b32 s23, 21
  s_add_u32 s20, s20, 40960
  s_add_u32 s25, s25, 1
  s_branch ch_s_wxhi
ch_s_wnhi:
  s_and_b32 s12, s24, 1
  s_mul_i32 s12, s12, 40960
  s_add_u32 s12, s12, 40960
  v_add_u32 v40, s12, v2
  ds_read_b128 v[96:99], v40 offset:0
  ds_read_b128 v[100:103], v40 offset:20480
  ds_read_b128 v[104:107], v40 offset:1024
  ds_read_b128 v[108:111], v40 offset:21504
  ds_read_b128 v[112:115], v40 offset:2048
  ds_read_b128 v[116:119], v40 offset:22528
  ds_read_b128 v[120:123], v40 offset:3072
  ds_read_b128 v[124:127], v40 offset:23552
  ds_read_b128 v[128:131], v40 offset:4096
  ds_read_b128 v[132:135], v40 offset:24576
  ds_read_b128 v[136:139], v40 offset:5120
  ds_read_b128 v[140:143], v40 offset:25600
  s_cmp_eq_u32 s3, 2
  s_cbranch_scc1 ch_s_tvhib
  s_waitcnt lgkmcnt(11)
  v_mfma_f32_16x16x32_bf16 v[144:147], a[0:3], v[96:99], 0
  ds_read_b128 v[96:99], v40 offset:6144
  s_waitcnt lgkmcnt(11)
  v_mfma_f32_16x16x32_bf16 v[148:151], a[0:3], v[100:103], 0
  ds_read_b128 v[100:103], v40 offset:26624
  s_waitcnt lgkmcnt(11)
  v_mfma_f32_16x16x32_bf16 v[144:147], a[4:7], v[104:107], v[144:147]
  ds_read_b128 v[104:107], v40 offset:7168
  s_waitcnt lgkmcnt(11)
  v_mfma_f32_16x16x32_bf16 v[148:151], a[4:7], v[108:111], v[148:151]
  ds_read_b128 v[108:111], v40 offset:27648
  s_waitcnt lgkmcnt(11)
  v_mfma_f32_16x16x32_bf16 v[144:147], a[8:11], v[112:115], v[144:147]
  ds_read_b128 v[112:115], v40 offset:8192
  s_waitcnt lgkmcnt(11)
  v_mfma_f32_16x16x32_bf16 v[148:151], a[8:11], v[116:119], v[148:151]
  ds_read_b128 v[116:119], v40 offset:28672
  s_waitcnt lgkmcnt(11)
  v_mfma_f32_16x16x32_bf16 v[144:147], a[12:15], v[120:123], v[144:147]
  ds_read_b128 v[120:123], v40 offset:9216
  s_waitcnt lgkmcnt(11)
  v_mfma_f32_16x16x32_bf16 v[148:151], a[12:15], v[124:127], v[148:151]
  ds_read_b128 v[124:127], v40 offset:29696
  s_waitcnt lgkmcnt(11)
  v_mfma_f32_16x16x32_bf16 v[144:147], a[16:19], v[128:131], v[144:147]
  ds_read_b128 v[128:131], v40 offset:10240
  s_waitcnt lgkmcnt(11)
  v_mfma_f32_16x16x32_bf16 v[148:151], a[16:19], v[132:135], v[148:151]
  ds_read_b128 v[132:135], v40 offset:30720
  s_waitcnt lgkmcnt(11)
  v_mfma_f32_16x16x32_bf16 v[144:147], a[20:23], v[136:139], v[144:147]
  ds_read_b128 v[136:139], v40 offset:11264
  s_waitcnt lgkmcnt(11)
  v_mfma_f32_16x16x32_bf16 v[148:151], a[20:23], v[140:143], v[148:151]
  ds_read_b128 v[140:143], v40 offset:31744
  s_waitcnt lgkmcnt(11)
  v_mfma_f32_16x16x32_bf16 v[144:147], a[24:27], v[96:99], v[144:147]
  ds_read_b128 v[96:99], v40 offset:12288
  s_waitcnt lgkmcnt(11)
  v_mfma_f32_16x16x32_bf16 v[148:151], a[24:27], v[100:103], v[148:151]
  ds_read_b128 v[100:103], v40 offset:32768
  s_waitcnt lgkmcnt(11)
  v_mfma_f32_16x16x32_bf16 v[144:147], a[28:31], v[104:107], v[144:147]
  ds_read_b128 v[104:107], v40 offset:13312
  s_waitcnt lgkmcnt(11)
  v_mfma_f32_16x16x32_bf16 v[148:151], a[28:31], v[108:111], v[148:151]
  ds_read_b128 v[108:111], v40 offset:33792
  s_waitcnt lgkmcnt(11)
  v_mfma_f32_16x16x32_bf16 v[144:147], a[32:35], v[112:115], v[144:147]
  ds_read_b128 v[112:115], v40 offset:14336
  s_waitcnt lgkmcnt(11)
  v_mfma_f32_16x16x32_bf16 v[148:151], a[32:35], v[116:119], v[148:151]
  ds_read_b128 v[116:119], v40 offset:34816
  s_waitcnt lgkmcnt(11)
  v_mfma_f32_16x16x32_bf16 v[144:147], a[36:39], v[120:123], v[144:147]
  ds_read_b128 v[120:123], v40 offset:15360
  s_waitcnt lgkmcnt(11)
  v_mfma_f32_16x16x32_bf16 v[148:151], a[36:39], v[124:127], v[148:151]
  ds_read_b128 v[124:127], v40 offset:35840
  s_waitcnt lgkmcnt(11)
  v_mfma_f32_16x16x32_bf16 v[144:147], a[40:43], v[128:131], v[144:147]
  ds_read_b128 v[128:131], v40 offset:16384
  s_waitcnt lgkmcnt(11)
  v_mfma_f32_16x16x32_bf16 v[148:151], a[40:43], v[132:135], v[148:151]
  ds_read_b128 v[132:135], v40 offset:36864
  s_waitcnt lgkmcnt(11)
  v_mfma_f32_16x16x32_bf16 v[144:147], a[44:47], v[136:139], v[144:147]
  ds_read_b128 v[136:139], v40 offset:17408
  s_waitcnt lgkmcnt(11)
  v_mfma_f32_16x16x32_bf16 v[148:151], a[44:47], v[140:143], v[148:151]
  ds_read_b128 v[140:143], v40 offset:37888
  s_waitcnt lgkmcnt(11)
  v_mfma_f32_16x16x32_bf16 v[144:147], a[48:51], v[96:99], v[144:147]
  ds_read_b128 v[96:99], v40 offset:18432
  s_waitcnt lgkmcnt(11)
  v_mfma_f32_16x16x32_bf16 v[148:151], a[48:51], v[100:103], v[148:151]
  ds_read_b128 v[100:103], v40 offset:38912
  s_waitcnt lgkmcnt(11)
  v_mfma_f32_16x16x32_bf16 v[144:147], a[52:55], v[104:107], v[144:147]
  ds_read_b128 v[104:107], v40 offset:19456
  s_waitcnt lgkmcnt(11)
  v_mfma_f32_16x16x32_bf16 v[148:151], a[52:55], v[108:111], v[148:151]
  ds_read_b128 v[108:111], v40 offset:39936
  s_waitcnt lgkmcnt(11)
  v_mfma_f32_16x16x32_bf16 v[144:147], a[56:59], v[112:115], v[144:147]
  s_waitcnt lgkmcnt(10)
  v_mfma_f32_16x16x32_bf16 v[148:151], a[56:59], v[116:119], v[148:151]
  s_waitcnt lgkmcnt(9)
  v_mfma_f32_16x16x32_bf16 v[144:147], a[60:63], v[120:123], v[144:147]
  s_waitcnt lgkmcnt(8)
  v_mfma_f32_16x16x32_bf16 v[148:151], a[60:63], v[124:127], v[148:151]
  s_waitcnt lgkmcnt(7)
  v_mfma_f32_16x16x32_bf16 v[144:147], a[64:67], v[128:131], v[144:147]
  s_waitcnt lgkmcnt(6)
  v_mfma_f32_16x16x32_bf16 v[148:151], a[64:67], v[132:135], v[148:151]
  s_waitcnt lgkmcnt(5)
  v_mfma_f32_16x16x32_bf16 v[144:147], a[68:71], v[136:139], v[144:147]
  s_waitcnt lgkmcnt(4)
  v_mfma_f32_16x16x32_bf16 v[148:151], a[68:71], v[140:143], v[148:151]
  s_waitcnt lgkmcnt(3)
  v_mfma_f32_16x16x32_bf16 v[144:147], a[72:75], v[96:99], v[144:147]
  s_waitcnt lgkmcnt(2)
  v_mfma_f32_16x16x32_bf16 v[148:151], a[72:75], v[100:103], v[148:151]
  s_waitcnt lgkmcnt(1)
  v_mfma_f32_16x16x32_bf16 v[144:147], a[76:79], v[104:107], v[144:147]
  s_waitcnt lgkmcnt(0)
  v_mfma_f32_16x16x32_bf16 v[148:151], a[76:79], v[108:111], v[148:151]
  s_nop 7
  s_nop 7
  v_cvt_pk_bf16_f32 v152, v144, v145
  v_cvt_pk_bf16_f32 v153, v146, v147
  v_cvt_pk_bf16_f32 v154, v148, v149
  v_cvt_pk_bf16_f32 v155, v150, v151
  buffer_store_dwordx2 v[152:153], v42, s[8:11], s22 offen sc1
  s_add_u32 s12, s22, 262144
  buffer_store_dwordx2 v[154:155], v42, s[8:11], s12 offen sc1
  s_branch ch_s_tehib
ch_s_tvhib:
  s_waitcnt lgkmcnt(11)
  v_mfma_f32_16x16x32_bf16 v[144:147], v[96:99], a[0:3], 0
  ds_read_b128 v[96:99], v40 offset:6144
  s_waitcnt lgkmcnt(11)
  v_mfma_f32_16x16x32_bf16 v[148:151], v[100:103], a[0:3], 0
  ds_read_b128 v[100:103], v40 offset:26624
  s_waitcnt lgkmcnt(11)
  v_mfma_f32_16x16x32_bf16 v[144:147], v[104:107], a[4:7], v[144:147]
  ds_read_b128 v[104:107], v40 offset:7168
  s_waitcnt lgkmcnt(11)
  v_mfma_f32_16x16x32_bf16 v[148:151], v[108:111], a[4:7], v[148:151]
  ds_read_b128 v[108:111], v40 offset:27648
  s_waitcnt lgkmcnt(11)
  v_mfma_f32_16x16x32_bf16 v[144:147], v[112:115], a[8:11], v[144:147]
  ds_read_b128 v[112:115], v40 offset:8192
  s_waitcnt lgkmcnt(11)
  v_mfma_f32_16x16x32_bf16 v[148:151], v[116:119], a[8:11], v[148:151]
  ds_read_b128 v[116:119], v40 offset:28672
  s_waitcnt lgkmcnt(11)
  v_mfma_f32_16x16x32_bf16 v[144:147], v[120:123], a[12:15], v[144:147]
  ds_read_b128 v[120:123], v40 offset:9216
  s_waitcnt lgkmcnt(11)
  v_mfma_f32_16x16x32_bf16 v[148:151], v[124:127], a[12:15], v[148:151]
  ds_read_b128 v[124:127], v40 offset:29696
  s_waitcnt lgkmcnt(11)
  v_mfma_f32_16x16x32_bf16 v[144:147], v[128:131], a[16:19], v[144:147]
  ds_read_b128 v[128:131], v40 offset:10240
  s_waitcnt lgkmcnt(11)
  v_mfma_f32_16x16x32_bf16 v[148:151], v[132:135], a[16:19], v[148:151]
  ds_read_b128 v[132:135], v40 offset:30720
  s_waitcnt lgkmcnt(11)
  v_mfma_f32_16x16x32_bf16 v[144:147], v[136:139], a[20:23], v[144:147]
  ds_read_b128 v[136:139], v40 offset:11264
  s_waitcnt lgkmcnt(11)
  v_mfma_f32_16x16x32_bf16 v[148:151], v[140:143], a[20:23], v[148:151]
  ds_read_b128 v[140:143], v40 offset:31744
  s_waitcnt lgkmcnt(11)
  v_mfma_f32_16x16x32_bf16 v[144:147], v[96:99], a[24:27], v[144:147]
  ds_read_b128 v[96:99], v40 offset:12288
  s_waitcnt lgkmcnt(11)
  v_mfma_f32_16x16x32_bf16 v[148:151], v[100:103], a[24:27], v[148:151]
  ds_read_b128 v[100:103], v40 offset:32768
  s_waitcnt lgkmcnt(11)
  v_mfma_f32_16x16x32_bf16 v[144:147], v[104:107], a[28:31], v[144:147]
  ds_read_b128 v[104:107], v40 offset:13312
  s_waitcnt lgkmcnt(11)
  v_mfma_f32_16x16x32_bf16 v[148:151], v[108:111], a[28:31], v[148:151]
  ds_read_b128 v[108:111], v40 offset:33792
  s_waitcnt lgkmcnt(11)
  v_mfma_f32_16x16x32_bf16 v[144:147], v[112:115], a[32:35], v[144:147]
  ds_read_b128 v[112:115], v40 offset:14336
  s_waitcnt lgkmcnt(11)
  v_mfma_f32_16x16x32_bf16 v[148:151], v[116:119], a[32:35], v[148:151]
  ds_read_b128 v[116:119], v40 offset:34816
  s_waitcnt lgkmcnt(11)
  v_mfma_f32_16x16x32_bf16 v[144:147], v[120:123], a[36:39], v[144:147]
  ds_read_b128 v[120:123], v40 offset:15360
  s_waitcnt lgkmcnt(11)
  v_mfma_f32_16x16x32_bf16 v[148:151], v[124:127], a[36:39], v[148:151]
  ds_read_b128 v[124:127], v40 offset:35840
  s_waitcnt lgkmcnt(11)
  v_mfma_f32_16x16x32_bf16 v[144:147], v[128:131], a[40:43], v[144:147]
  ds_read_b128 v[128:131], v40 offset:16384
  s_waitcnt lgkmcnt(11)
  v_mfma_f32_16x16x32_bf16 v[148:151], v[132:135], a[40:43], v[148:151]
  ds_read_b128 v[132:135], v40 offset:36864
  s_waitcnt lgkmcnt(11)
  v_mfma_f32_16x16x32_bf16 v[144:147], v[136:139], a[44:47], v[144:147]
  ds_read_b128 v[136:139], v40 offset:17408
  s_waitcnt lgkmcnt(11)
  v_mfma_f32_16x16x32_bf16 v[148:151], v[140:143], a[44:47], v[148:151]
  ds_read_b128 v[140:143], v40 offset:37888
  s_waitcnt lgkmcnt(11)
  v_mfma_f32_16x16x32_bf16 v[144:147], v[96:99], a[48:51], v[144:147]
  ds_read_b128 v[96:99], v40 offset:18432
  s_waitcnt lgkmcnt(11)
  v_mfma_f32_16x16x32_bf16 v[148:151], v[100:103], a[48:51], v[148:151]
  ds_read_b128 v[100:103], v40 offset:38912
  s_waitcnt lgkmcnt(11)
  v_mfma_f32_16x16x32_bf16 v[144:147], v[104:107], a[52:55], v[144:147]
  ds_read_b128 v[104:107], v40 offset:19456
  s_waitcnt lgkmcnt(11)
  v_mfma_f32_16x16x32_bf16 v[148:151], v[108:111], a[52:55], v[148:151]
  ds_read_b128 v[108:111], v40 offset:39936
  s_waitcnt lgkmcnt(11)
  v_mfma_f32_16x16x32_bf16 v[144:147], v[112:115], a[56:59], v[144:147]
  s_waitcnt lgkmcnt(10)
  v_mfma_f32_16x16x32_bf16 v[148:151], v[116:119], a[56:59], v[148:151]
  s_waitcnt lgkmcnt(9)
  v_mfma_f32_16x16x32_bf16 v[144:147], v[120:123], a[60:63], v[144:147]
  s_waitcnt lgkmcnt(8)
  v_mfma_f32_16x16x32_bf16 v[148:151], v[124:127], a[60:63], v[148:151]
  s_waitcnt lgkmcnt(7)
  v_mfma_f32_16x16x32_bf16 v[144:147], v[128:131], a[64:67], v[144:147]
  s_waitcnt lgkmcnt(6)
  v_mfma_f32_16x16x32_bf16 v[148:151], v[132:135], a[64:67], v[148:151]
  s_waitcnt lgkmcnt(5)
  v_mfma_f32_16x16x32_bf16 v[144:147], v[136:139], a[68:71], v[144:147]
  s_waitcnt lgkmcnt(4)
  v_mfma_f32_16x16x32_bf16 v[148:151], v[140:143], a[68:71], v[148:151]
  s_waitcnt lgkmcnt(3)
  v_mfma_f32_16x16x32_bf16 v[144:147], v[96:99], a[72:75], v[144:147]
  s_waitcnt lgkmcnt(2)
  v_mfma_f32_16x16x32_bf16 v[148:151], v[100:103], a[72:75], v[148:151]
  s_waitcnt lgkmcnt(1)
  v_mfma_f32_16x16x32_bf16 v[144:147], v[104:107], a[76:79], v[144:147]
  s_waitcnt lgkmcnt(0)
  v_mfma_f32_16x16x32_bf16 v[148:151], v[108:111], a[76:79], v[148:151]
  s_nop 7
  s_nop 7
  v_cvt_pk_bf16_f32 v152, v144, v145
  v_cvt_pk_bf16_f32 v153, v146, v147
  v_cvt_pk_bf16_f32 v154, v148, v149
  v_cvt_pk_bf16_f32 v155, v150, v151
  buffer_store_dwordx4 v[152:155], v2, s[8:11], s23 offen sc1
ch_s_tehib:
  s_add_u32 s22, s22, 524288
  s_add_u32 s23, s23, 262144
  s_add_u32 s24, s24, 1
  s_bitset0_b32 s22, 22
  s_bitset0_b32 s23, 21
ch_s_wxhi:
  s_branch ch_s_hid
ch_s_hi3:
  s_cmp_eq_u32 s90, 0
  s_cbranch_scc1 ch_s_hid
  s_cmp_eq_u32 s60, 0
  s_cbranch_scc1 ch_s_hid
ch_s_tl:
  s_mov_b32 s61, 65536
  s_and_b32 s49, s89, 7
  s_mul_i32 s49, s49, 196608
  s_add_u32 s49, s49, s71
ch_s_tp:
  buffer_load_dwordx4 v[128:131], v12, s[8:11], s49 offen offset:2048 sc1
  buffer_load_dwordx4 v[132:135], v12, s[8:11], s49 offen offset:2560 sc1
  buffer_load_dwordx4 v[136:139], v12, s[8:11], s49 offen offset:3072 sc1
  buffer_load_dwordx4 v[140:143], v12, s[8:11], s49 offen offset:3584 sc1
  s_add_u32 s12, s49, 4096
  buffer_load_dwordx4 v[176:179], v14, s[8:11], s12 offen offset:0 sc1
  buffer_load_dwordx4 v[180:183], v14, s[8:11], s12 offen offset:512 sc1
  buffer_load_dwordx4 v[184:187], v14, s[8:11], s12 offen offset:1024 sc1
  buffer_load_dwordx4 v[188:191], v14, s[8:11], s12 offen offset:1536 sc1
  s_waitcnt vmcnt(0)
  v_max_u32 v8, v128, v130
  v_max3_u32 v8, v8, v132, v134
  v_max3_u32 v8, v8, v136, v138
  v_max3_u32 v8, v8, v140, v142
  v_max3_u32 v8, v8, v176, v178
  v_max3_u32 v8, v8, v180, v182
  v_max3_u32 v8, v8, v184, v186
  v_max3_u32 v8, v8, v188, v190
  v_cmp_eq_u32 vcc, -1, v8
  s_sub_u32 s61, s61, 1
  s_cmp_eq_u32 s61, 0
  s_cbranch_scc1 ch_s_td
  s_cbranch_vccnz ch_s_tp
ch_s_td:
  s_cmp_eq_u32 s91, 0
  s_cbranch_scc0 ch_s_tq1
  v_mfma_f32_16x16x32_bf16 v[200:203], v[128:131], v[64:67], 0
  v_mfma_f32_16x16x32_bf16 v[192:195], v[96:99], v[64:67], 0
  v_mfma_f32_16x16x32_bf16 v[200:203], v[132:135], v[68:71], v[200:203]
  v_mfma_f32_16x16x32_bf16 v[192:195], v[100:103], v[68:71], v[192:195]
  v_mfma_f32_16x16x32_bf16 v[200:203], v[136:139], v[72:75], v[200:203]
  v_mfma_f32_16x16x32_bf16 v[192:195], v[104:107], v[72:75], v[192:195]
  v_mfma_f32_16x16x32_bf16 v[200:203], v[140:143], v[76:79], v[200:203]
  v_mfma_f32_16x16x32_bf16 v[192:195], v[108:111], v[76:79], v[192:195]
  s_nop 7
  v_add_f32 v192, v192, v36
  v_add_f32 v193, v193, v37
  v_add_f32 v194, v194, v38
  v_add_f32 v195, v195, v39
  v_add_f32 v200, v200, v3
  v_add_f32 v201, v201, v3
  v_add_f32 v202, v202, v3
  v_add_f32 v203, v203, v3
  v_max3_f32 v8, v192, v193, v194
  v_max3_f32 v8, v8, v195, v200
  v_max3_f32 v8, v8, v201, v202
  v_max_f32 v8, v8, v203
  v_mov_b32 v9, v8
  s_nop 1
  v_permlane32_swap_b32 v9, v8
  s_nop 1
  v_max_f32 v8, v8, v9
  v_mov_b32 v9, v8
  s_nop 1
  v_permlane16_swap_b32 v9, v8
  s_nop 1
  v_max_f32 v8, v8, v9
  v_mul_f32 v8, 0x3e0293ee, v8
  s_mov_b32 s39, 0x3e0293ee
  v_fma_f32 v192, v192, s39, -v8
  v_fma_f32 v193, v193, s39, -v8
  v_fma_f32 v194, v194, s39, -v8
  v_fma_f32 v195, v195, s39, -v8
  v_fma_f32 v200, v200, s39, -v8
  v_fma_f32 v201, v201, s39, -v8
  v_fma_f32 v202, v202, s39, -v8
  v_fma_f32 v203, v203, s39, -v8
  v_exp_f32 v192, v192
  v_exp_f32 v193, v193
  v_exp_f32 v194, v194
  v_exp_f32 v195, v195
  v_exp_f32 v200, v200
  v_exp_f32 v201, v201
  v_exp_f32 v202, v202
  v_exp_f32 v203, v203
  s_nop 0
  v_cvt_pk_bf16_f32 v204, v192, v193
  v_cvt_pk_bf16_f32 v205, v194, v195
  v_mov_b32 v206, 0
  v_mov_b32 v207, 0
  v_cvt_pk_bf16_f32 v208, v200, v201
  v_cvt_pk_bf16_f32 v209, v202, v203
  v_add_f32 v10, v192, v193
  v_mfma_f32_16x16x32_bf16 v[212:215], v[144:147], v[204:207], 0
  v_add_f32 v10, v10, v194
  v_mfma_f32_16x16x32_bf16 v[216:219], v[148:151], v[204:207], 0
  v_add_f32 v10, v10, v195
  v_mfma_f32_16x16x32_bf16 v[220:223], v[152:155], v[204:207], 0
  v_add_f32 v10, v10, v200
  v_mfma_f32_16x16x32_bf16 v[224:227], v[156:159], v[204:207], 0
  v_add_f32 v10, v10, v201
  v_mfma_f32_16x16x32_bf16 v[228:231], v[160:163], v[204:207], 0
  v_add_f32 v10, v10, v202
  v_mfma_f32_16x16x32_bf16 v[232:235], v[164:167], v[204:207], 0
  v_add_f32 v10, v10, v203
  v_mfma_f32_16x16x32_bf16 v[236:239], v[168:171], v[204:207], 0
  v_mfma_f32_16x16x32_bf16 v[240:243], v[172:175], v[204:207], 0
  v_mfma_f32_16x16x16_bf16 v[212:215], v[176:177], v[208:209], v[212:215]
  v_mfma_f32_16x16x16_bf16 v[216:219], v[178:179], v[208:209], v[216:219]
  v_mfma_f32_16x16x16_bf16 v[220:223], v[180:181], v[208:209], v[220:223]
  v_mfma_f32_16x16x16_bf16 v[224:227], v[182:183], v[208:209], v[224:227]
  v_mfma_f32_16x16x16_bf16 v[228:231], v[184:185], v[208:209], v[228:231]
  v_mfma_f32_16x16x16_bf16 v[232:235], v[186:187], v[208:209], v[232:235]
  v_mfma_f32_16x16x16_bf16 v[236:239], v[188:189], v[208:209], v[236:239]
  v_mfma_f32_16x16x16_bf16 v[240:243], v[190:191], v[208:209], v[240:243]
  v_mov_b32 v9, v10
  s_nop 1
  v_permlane32_swap_b32 v9, v10
  s_nop 1
  v_add_f32 v10, v10, v9
  v_mov_b32 v9, v10
  s_nop 1
  v_permlane16_swap_b32 v9, v10
  s_nop 1
  v_add_f32 v10, v10, v9
  v_rcp_f32 v10, v10
  s_nop 3
  v_mul_f32 v212, v212, v10
  v_mul_f32 v213, v213, v10
  v_mul_f32 v214, v214, v10
  v_mul_f32 v215, v215, v10
  v_mul_f32 v216, v216, v10
  v_mul_f32 v217, v217, v10
  v_mul_f32 v218, v218, v10
  v_mul_f32 v219, v219, v10
  v_mul_f32 v220, v220, v10
  v_mul_f32 v221, v221, v10
  v_mul_f32 v222, v222, v10
  v_mul_f32 v223, v223, v10
  v_mul_f32 v224, v224, v10
  v_mul_f32 v225, v225, v10
  v_mul_f32 v226, v226, v10
  v_mul_f32 v227, v227, v10
  v_mul_f32 v228, v228, v10
  v_mul_f32 v229, v229, v10
  v_mul_f32 v230, v230, v10
  v_mul_f32 v231, v231, v10
  v_mul_f32 v232, v232, v10
  v_mul_f32 v233, v233, v10
  v_mul_f32 v234, v234, v10
  v_mul_f32 v235, v235, v10
  v_mul_f32 v236, v236, v10
  v_mul_f32 v237, v237, v10
  v_mul_f32 v238, v238, v10
  v_mul_f32 v239, v239, v10
  v_mul_f32 v240, v240, v10
  v_mul_f32 v241, v241, v10
  v_mul_f32 v242, v242, v10
  v_mul_f32 v243, v243, v10
  s_branch ch_s_tq2
ch_s_tq1:
  v_mfma_f32_16x16x32_bf16 v[200:203], v[128:131], v[64:67], 0
  v_mfma_f32_16x16x32_bf16 v[192:195], v[96:99], v[64:67], 0
  v_mfma_f32_16x16x32_bf16 v[196:199], v[112:115], v[64:67], 0
  v_mfma_f32_16x16x32_bf16 v[200:203], v[132:135], v[68:71], v[200:203]
  v_mfma_f32_16x16x32_bf16 v[192:195], v[100:103], v[68:71], v[192:195]
  v_mfma_f32_16x16x32_bf16 v[196:199], v[116:119], v[68:71], v[196:199]
  v_mfma_f32_16x16x32_bf16 v[200:203], v[136:139], v[72:75], v[200:203]
  v_mfma_f32_16x16x32_bf16 v[192:195], v[104:107], v[72:75], v[192:195]
  v_mfma_f32_16x16x32_bf16 v[196:199], v[120:123], v[72:75], v[196:199]
  v_mfma_f32_16x16x32_bf16 v[200:203], v[140:143], v[76:79], v[200:203]
  v_mfma_f32_16x16x32_bf16 v[192:195], v[108:111], v[76:79], v[192:195]
  v_mfma_f32_16x16x32_bf16 v[196:199], v[124:127], v[76:79], v[196:199]
  s_nop 7
  v_add_f32 v196, v196, v36
  v_add_f32 v197, v197, v37
  v_add_f32 v198, v198, v38
  v_add_f32 v199, v199, v39
  v_add_f32 v200, v200, v3
  v_add_f32 v201, v201, v3
  v_add_f32 v202, v202, v3
  v_add_f32 v203, v203, v3
  v_max3_f32 v8, v192, v193, v194
  v_max3_f32 v8, v8, v195, v196
  v_max3_f32 v8, v8, v197, v198
  v_max3_f32 v8, v8, v199, v200
  v_max3_f32 v8, v8, v201, v202
  v_max_f32 v8, v8, v203
  v_mov_b32 v9, v8
  s_nop 1
  v_permlane32_swap_b32 v9, v8
  s_nop 1
  v_max_f32 v8, v8, v9
  v_mov_b32 v9, v8
  s_nop 1
  v_permlane16_swap_b32 v9, v8
  s_nop 1
  v_max_f32 v8, v8, v9
  v_mul_f32 v8, 0x3e0293ee, v8
  s_mov_b32 s39, 0x3e0293ee
  v_fma_f32 v192, v192, s39, -v8
  v_fma_f32 v193, v193, s39, -v8
  v_fma_f32 v194, v194, s39, -v8
  v_fma_f32 v195, v195, s39, -v8
  v_fma_f32 v196, v196, s39, -v8
  v_fma_f32 v197, v197, s39, -v8
  v_fma_f32 v198, v198, s39, -v8
  v_fma_f32 v199, v199, s39, -v8
  v_fma_f32 v200, v200, s39, -v8
  v_fma_f32 v201, v201, s39, -v8
  v_fma_f32 v202, v202, s39, -v8
  v_fma_f32 v203, v203, s39, -v8
  v_exp_f32 v192, v192
  v_exp_f32 v193, v193
  v_exp_f32 v194, v194
  v_exp_f32 v195, v195
  v_exp_f32 v196, v196
  v_exp_f32 v197, v197
  v_exp_f32 v198, v198
  v_exp_f32 v199, v199
  v_exp_f32 v200, v200
  v_exp_f32 v201, v201
  v_exp_f32 v202, v202
  v_exp_f32 v203, v203
  s_nop 0
  v_cvt_pk_bf16_f32 v204, v192, v193
  v_cvt_pk_bf16_f32 v205, v194, v195
  v_cvt_pk_bf16_f32 v206, v196, v197
  v_cvt_pk_bf16_f32 v207, v198, v199
  v_cvt_pk_bf16_f32 v208, v200, v201
  v_cvt_pk_bf16_f32 v209, v202, v203
  v_add_f32 v10, v192, v193
  v_mfma_f32_16x16x32_bf16 v[212:215], v[144:147], v[204:207], 0
  v_add_f32 v10, v10, v194
  v_mfma_f32_16x16x32_bf16 v[216:219], v[148:151], v[204:207], 0
  v_add_f32 v10, v10, v195
  v_mfma_f32_16x16x32_bf16 v[220:223], v[152:155], v[204:207], 0
  v_add_f32 v10, v10, v196
  v_mfma_f32_16x16x32_bf16 v[224:227], v[156:159], v[204:207], 0
  v_add_f32 v10, v10, v197
  v_mfma_f32_16x16x32_bf16 v[228:231], v[160:163], v[204:207], 0
  v_add_f32 v10, v10, v198
  v_mfma_f32_16x16x32_bf16 v[232:235], v[164:167], v[204:207], 0
  v_add_f32 v10, v10, v199
  v_mfma_f32_16x16x32_bf16 v[236:239], v[168:171], v[204:207], 0
  v_add_f32 v10, v10, v200
  v_mfma_f32_16x16x32_bf16 v[240:243], v[172:175], v[204:207], 0
  v_add_f32 v10, v10, v201
  v_add_f32 v10, v10, v202
  v_add_f32 v10, v10, v203
  v_mfma_f32_16x16x16_bf16 v[212:215], v[176:177], v[208:209], v[212:215]
  v_mfma_f32_16x16x16_bf16 v[216:219], v[178:179], v[208:209], v[216:219]
  v_mfma_f32_16x16x16_bf16 v[220:223], v[180:181], v[208:209], v[220:223]
  v_mfma_f32_16x16x16_bf16 v[224:227], v[182:183], v[208:209], v[224:227]
  v_mfma_f32_16x16x16_bf16 v[228:231], v[184:185], v[208:209], v[228:231]
  v_mfma_f32_16x16x16_bf16 v[232:235], v[186:187], v[208:209], v[232:235]
  v_mfma_f32_16x16x16_bf16 v[236:239], v[188:189], v[208:209], v[236:239]
  v_mfma_f32_16x16x16_bf16 v[240:243], v[190:191], v[208:209], v[240:243]
  v_mov_b32 v9, v10
  s_nop 1
  v_permlane32_swap_b32 v9, v10
  s_nop 1
  v_add_f32 v10, v10, v9
  v_mov_b32 v9, v10
  s_nop 1
  v_permlane16_swap_b32 v9, v10
  s_nop 1
  v_add_f32 v10, v10, v9
  v_rcp_f32 v10, v10
  s_nop 3
  v_mul_f32 v212, v212, v10
  v_mul_f32 v213, v213, v10
  v_mul_f32 v214, v214, v10
  v_mul_f32 v215, v215, v10
  v_mul_f32 v216, v216, v10
  v_mul_f32 v217, v217, v10
  v_mul_f32 v218, v218, v10
  v_mul_f32 v219, v219, v10
  v_mul_f32 v220, v220, v10
  v_mul_f32 v221, v221, v10
  v_mul_f32 v222, v222, v10
  v_mul_f32 v223, v223, v10
  v_mul_f32 v224, v224, v10
  v_mul_f32 v225, v225, v10
  v_mul_f32 v226, v226, v10
  v_mul_f32 v227, v227, v10
  v_mul_f32 v228, v228, v10
  v_mul_f32 v229, v229, v10
  v_mul_f32 v230, v230, v10
  v_mul_f32 v231, v231, v10
  v_mul_f32 v232, v232, v10
  v_mul_f32 v233, v233, v10
  v_mul_f32 v234, v234, v10
  v_mul_f32 v235, v235, v10
  v_mul_f32 v236, v236, v10
  v_mul_f32 v237, v237, v10
  v_mul_f32 v238, v238, v10
  v_mul_f32 v239, v239, v10
  v_mul_f32 v240, v240, v10
  v_mul_f32 v241, v241, v10
  v_mul_f32 v242, v242, v10
  v_mul_f32 v243, v243, v10
ch_s_tq2:
  v_cvt_pk_bf16_f32 v128, v212, v213
  v_cvt_pk_bf16_f32 v129, v214, v215
  v_cvt_pk_bf16_f32 v130, v216, v217
  v_cvt_pk_bf16_f32 v131, v218, v219
  buffer_store_dwordx4 v[128:131], v2, s[8:11], s88 offen offset:0
  v_cvt_pk_bf16_f32 v132, v220, v221
  v_cvt_pk_bf16_f32 v133, v222, v223
  v_cvt_pk_bf16_f32 v134, v224, v225
  v_cvt_pk_bf16_f32 v135, v226, v227
  buffer_store_dwordx4 v[132:135], v2, s[8:11], s88 offen offset:1024
  v_cvt_pk_bf16_f32 v136, v228, v229
  v_cvt_pk_bf16_f32 v137, v230, v231
  v_cvt_pk_bf16_f32 v138, v232, v233
  v_cvt_pk_bf16_f32 v139, v234, v235
  buffer_store_dwordx4 v[136:139], v2, s[8:11], s88 offen offset:2048
  v_cvt_pk_bf16_f32 v140, v236, v237
  v_cvt_pk_bf16_f32 v141, v238, v239
  v_cvt_pk_bf16_f32 v142, v240, v241
  v_cvt_pk_bf16_f32 v143, v242, v243
  buffer_store_dwordx4 v[140:143], v2, s[8:11], s88 offen offset:3072
  s_add_u32 s88, s88, 262144
  s_add_u32 s89, s89, 1
  s_cmp_ge_u32 s89, 64
  s_cbranch_scc1 ch_s_end
  buffer_load_dwordx4 v[64:67], v2, s[8:11], s68 offen offset:0 sc1
  buffer_load_dwordx4 v[68:71], v2, s[8:11], s68 offen offset:1024 sc1
  buffer_load_dwordx4 v[72:75], v2, s[8:11], s68 offen offset:2048 sc1
  buffer_load_dwordx4 v[76:79], v2, s[8:11], s68 offen offset:3072 sc1
  s_add_u32 s12, s69, 0
  buffer_load_dwordx4 v[96:99], v2, s[8:11], s12 offen offset:0 sc1
  buffer_load_dwordx4 v[100:103], v2, s[8:11], s12 offen offset:1024 sc1
  buffer_load_dwordx4 v[104:107], v2, s[8:11], s12 offen offset:2048 sc1
  buffer_load_dwordx4 v[108:111], v2, s[8:11], s12 offen offset:3072 sc1
  s_add_u32 s12, s69, 262144
  buffer_load_dwordx4 v[112:115], v2, s[8:11], s12 offen offset:0 sc1
  buffer_load_dwordx4 v[116:119], v2, s[8:11], s12 offen offset:1024 sc1
  buffer_load_dwordx4 v[120:123], v2, s[8:11], s12 offen offset:2048 sc1
  buffer_load_dwordx4 v[124:127], v2, s[8:11], s12 offen offset:3072 sc1
  s_add_u32 s12, s70, 0
  buffer_load_dwordx4 v[144:147], v2, s[8:11], s12 offen offset:0 sc1
  buffer_load_dwordx4 v[148:151], v2, s[8:11], s12 offen offset:1024 sc1
  buffer_load_dwordx4 v[152:155], v2, s[8:11], s12 offen offset:2048 sc1
  buffer_load_dwordx4 v[156:159], v2, s[8:11], s12 offen offset:3072 sc1
  s_add_u32 s12, s70, 4096
  buffer_load_dwordx4 v[160:163], v2, s[8:11], s12 offen offset:0 sc1
  buffer_load_dwordx4 v[164:167], v2, s[8:11], s12 offen offset:1024 sc1
  buffer_load_dwordx4 v[168:171], v2, s[8:11], s12 offen offset:2048 sc1
  buffer_load_dwordx4 v[172:175], v2, s[8:11], s12 offen offset:3072 sc1
  s_add_u32 s68, s68, 524288
  s_add_u32 s69, s69, 524288
  s_add_u32 s70, s70, 262144
  s_bitset0_b32 s68, 22
  s_bitset0_b32 s69, 22
  s_bitset0_b32 s70, 21
  s_cmp_eq_u32 s60, 63
  s_cbranch_scc1 ch_s_tl
ch_s_hid:
  s_cmp_eq_u32 s60, 63
  s_cbranch_scc1 ch_s_end
  s_branch ch_s_next
chain_done:
  s_endpgm
.section .rodata,"a"
.p2align 6
.amdhsa_kernel chain_kernel
  .amdhsa_next_free_vgpr 424
  .amdhsa_next_free_sgpr 96
  .amdhsa_accum_offset 248
  .amdhsa_group_segment_fixed_size 0
  .amdhsa_kernarg_size 112
  .amdhsa_user_sgpr_count 2
  .amdhsa_user_sgpr_kernarg_segment_ptr 1
  .amdhsa_system_sgpr_workgroup_id_x 1
.end_amdhsa_kernel

.text
.globl wo_kernel
.p2align 8
.type wo_kernel,@function
wo_kernel:
  s_cmp_ge_u32 s2, 256
  s_cbranch_scc1 wo_kernel_done
  s_load_dwordx2 s[8:9], s[0:1], 104
  s_waitcnt lgkmcnt(0)
  s_and_b32 s9, s9, 0xffff
  s_mov_b32 s10, 268435456
  s_mov_b32 s11, 0x20000
  s_and_b32 s5, s2, 7
  s_lshl_b32 s5, s5, 2
  s_lshr_b32 s6, s2, 3
  s_and_b32 s6, s6, 3
  s_add_u32 s6, s5, s6
  s_lshr_b32 s5, s2, 5
  v_lshrrev_b32 v1, 6, v0
  s_nop 0
  v_readfirstlane_b32 s3, v1
  v_and_b32 v0, 63, v0
  v_lshlrev_b32 v2, 4, v0
  s_mul_i32 s12, s5, 5
  s_add_u32 s12, s12, 0
  s_mul_i32 s12, s12, 131072
  s_add_u32 s24, s12, 18350080
  s_mul_i32 s12, s5, 5
  s_add_u32 s12, s12, 1
  s_mul_i32 s12, s12, 131072
  s_add_u32 s25, s12, 18350080
  s_mul_i32 s12, s5, 5
  s_add_u32 s12, s12, 2
  s_mul_i32 s12, s12, 131072
  s_add_u32 s26, s12, 18350080
  s_mul_i32 s12, s5, 5
  s_add_u32 s12, s12, 3
  s_mul_i32 s12, s12, 131072
  s_add_u32 s27, s12, 18350080
  s_mul_i32 s12, s5, 5
  s_add_u32 s12, s12, 4
  s_mul_i32 s12, s12, 131072
  s_add_u32 s28, s12, 18350080
  s_mul_i32 s12, s6, 4
  s_add_u32 s12, s12, 0
  s_mul_i32 s12, s12, 131072
  s_add_u32 s29, s12, 112283648
  s_mul_i32 s12, s6, 4
  s_add_u32 s12, s12, 1
  s_mul_i32 s12, s12, 131072
  s_add_u32 s30, s12, 112283648
  s_mul_i32 s12, s6, 4
  s_add_u32 s12, s12, 2
  s_mul_i32 s12, s12, 131072
  s_add_u32 s31, s12, 112283648
  s_mul_i32 s12, s6, 4
  s_add_u32 s12, s12, 3
  s_mul_i32 s12, s12, 131072
  s_add_u32 s32, s12, 112283648
  s_lshl_b32 s12, s3, 10
  v_add_u32 v5, s12, v2
  s_sub_u32 s13, 131, s3
  s_lshr_b32 s13, s13, 2
  v_mov_b32 v152, 0
  v_mov_b32 v153, 0
  v_mov_b32 v154, 0
  v_mov_b32 v155, 0
  v_mov_b32 v156, 0
  v_mov_b32 v157, 0
  v_mov_b32 v158, 0
  v_mov_b32 v159, 0
  v_mov_b32 v160, 0
  v_mov_b32 v161, 0
  v_mov_b32 v162, 0
  v_mov_b32 v163, 0
  v_mov_b32 v164, 0
  v_mov_b32 v165, 0
  v_mov_b32 v166, 0
  v_mov_b32 v167, 0
  v_mov_b32 v168, 0
  v_mov_b32 v169, 0
  v_mov_b32 v170, 0
  v_mov_b32 v171, 0
  v_mov_b32 v172, 0
  v_mov_b32 v173, 0
  v_mov_b32 v174, 0
  v_mov_b32 v175, 0
  v_mov_b32 v176, 0
  v_mov_b32 v177, 0
  v_mov_b32 v178, 0
  v_mov_b32 v179, 0
  v_mov_b32 v180, 0
  v_mov_b32 v181, 0
  v_mov_b32 v182, 0
  v_mov_b32 v183, 0
  v_mov_b32 v184, 0
  v_mov_b32 v185, 0
  v_mov_b32 v186, 0
  v_mov_b32 v187, 0
  v_mov_b32 v188, 0
  v_mov_b32 v189, 0
  v_mov_b32 v190, 0
  v_mov_b32 v191, 0
  v_mov_b32 v192, 0
  v_mov_b32 v193, 0
  v_mov_b32 v194, 0
  v_mov_b32 v195, 0
  v_mov_b32 v196, 0
  v_mov_b32 v197, 0
  v_mov_b32 v198, 0
  v_mov_b32 v199, 0
  v_mov_b32 v200, 0
  v_mov_b32 v201, 0
  v_mov_b32 v202, 0
  v_mov_b32 v203, 0
  v_mov_b32 v204, 0
  v_mov_b32 v205, 0
  v_mov_b32 v206, 0
  v_mov_b32 v207, 0
  v_mov_b32 v208, 0
  v_mov_b32 v209, 0
  v_mov_b32 v210, 0
  v_mov_b32 v211, 0
  v_mov_b32 v212, 0
  v_mov_b32 v213, 0
  v_mov_b32 v214, 0
  v_mov_b32 v215, 0
  v_mov_b32 v216, 0
  v_mov_b32 v217, 0
  v_mov_b32 v218, 0
  v_mov_b32 v219, 0
  v_mov_b32 v220, 0
  v_mov_b32 v221, 0
  v_mov_b32 v222, 0
  v_mov_b32 v223, 0
  v_mov_b32 v224, 0
  v_mov_b32 v225, 0
  v_mov_b32 v226, 0
  v_mov_b32 v227, 0
  v_mov_b32 v228, 0
  v_mov_b32 v229, 0
  v_mov_b32 v230, 0
  v_mov_b32 v231, 0
  buffer_load_dwordx4 v[8:11], v5, s[8:11], s24 offen
  buffer_load_dwordx4 v[12:15], v5, s[8:11], s25 offen
  buffer_load_dwordx4 v[16:19], v5, s[8:11], s26 offen
  buffer_load_dwordx4 v[20:23], v5, s[8:11], s27 offen
  buffer_load_dwordx4 v[24:27], v5, s[8:11], s28 offen
  buffer_load_dwordx4 v[28:31], v5, s[8:11], s29 offen
  buffer_load_dwordx4 v[32:35], v5, s[8:11], s30 offen
  buffer_load_dwordx4 v[36:39], v5, s[8:11], s31 offen
  buffer_load_dwordx4 v[40:43], v5, s[8:11], s32 offen
  v_add_u32 v5, 4096, v5
  buffer_load_dwordx4 v[44:47], v5, s[8:11], s24 offen
  buffer_load_dwordx4 v[48:51], v5, s[8:11], s25 offen
  buffer_load_dwordx4 v[52:55], v5, s[8:11], s26 offen
  buffer_load_dwordx4 v[56:59], v5, s[8:11], s27 offen
  buffer_load_dwordx4 v[60:63], v5, s[8:11], s28 offen
  buffer_load_dwordx4 v[64:67], v5, s[8:11], s29 offen
  buffer_load_dwordx4 v[68:71], v5, s[8:11], s30 offen
  buffer_load_dwordx4 v[72:75], v5, s[8:11], s31 offen
  buffer_load_dwordx4 v[76:79], v5, s[8:11], s32 offen
  v_add_u32 v5, 4096, v5
  buffer_load_dwordx4 v[80:83], v5, s[8:11], s24 offen
  buffer_load_dwordx4 v[84:87], v5, s[8:11], s25 offen
  buffer_load_dwordx4 v[88:91], v5, s[8:11], s26 offen
  buffer_load_dwordx4 v[92:95], v5, s[8:11], s27 offen
  buffer_load_dwordx4 v[96:99], v5, s[8:11], s28 offen
  buffer_load_dwordx4 v[100:103], v5, s[8:11], s29 offen
  buffer_load_dwordx4 v[104:107], v5, s[8:11], s30 offen
  buffer_load_dwordx4 v[108:111], v5, s[8:11], s31 offen
  buffer_load_dwordx4 v[112:115], v5, s[8:11], s32 offen
  v_add_u32 v5, 4096, v5
wo_kernel_lp:
  buffer_load_dwordx4 v[116:119], v5, s[8:11], s24 offen
  buffer_load_dwordx4 v[120:123], v5, s[8:11], s25 offen
  buffer_load_dwordx4 v[124:127], v5, s[8:11], s26 offen
  buffer_load_dwordx4 v[128:131], v5, s[8:11], s27 offen
  buffer_load_dwordx4 v[132:135], v5, s[8:11], s28 offen
  buffer_load_dwordx4 v[136:139], v5, s[8:11], s29 offen
  buffer_load_dwordx4 v[140:143], v5, s[8:11], s30 offen
  buffer_load_dwordx4 v[144:147], v5, s[8:11], s31 offen
  buffer_load_dwordx4 v[148:151], v5, s[8:11], s32 offen
  v_add_u32 v5, 4096, v5
  s_waitcnt vmcnt(27)
  v_mfma_f32_16x16x32_bf16 v[152:155], v[8:11], v[28:31], v[152:155]
  v_mfma_f32_16x16x32_bf16 v[156:159], v[8:11], v[32:35], v[156:159]
  v_mfma_f32_16x16x32_bf16 v[160:163], v[8:11], v[36:39], v[160:163]
  v_mfma_f32_16x16x32_bf16 v[164:167], v[8:11], v[40:43], v[164:167]
  v_mfma_f32_16x16x32_bf16 v[168:171], v[12:15], v[28:31], v[168:171]
  v_mfma_f32_16x16x32_bf16 v[172:175], v[12:15], v[32:35], v[172:175]
  v_mfma_f32_16x16x32_bf16 v[176:179], v[12:15], v[36:39], v[176:179]
  v_mfma_f32_16x16x32_bf16 v[180:183], v[12:15], v[40:43], v[180:183]
  v_mfma_f32_16x16x32_bf16 v[184:187], v[16:19], v[28:31], v[184:187]
  v_mfma_f32_16x16x32_bf16 v[188:191], v[16:19], v[32:35], v[188:191]
  v_mfma_f32_16x16x32_bf16 v[192:195], v[16:19], v[36:39], v[192:195]
  v_mfma_f32_16x16x32_bf16 v[196:199], v[16:19], v[40:43], v[196:199]
  v_mfma_f32_16x16x32_bf16 v[200:203], v[20:23], v[28:31], v[200:203]
  v_mfma_f32_16x16x32_bf16 v[204:207], v[20:23], v[32:35], v[204:207]
  v_mfma_f32_16x16x32_bf16 v[208:211], v[20:23], v[36:39], v[208:211]
  v_mfma_f32_16x16x32_bf16 v[212:215], v[20:23], v[40:43], v[212:215]
  v_mfma_f32_16x16x32_bf16 v[216:219], v[24:27], v[28:31], v[216:219]
  v_mfma_f32_16x16x32_bf16 v[220:223], v[24:27], v[32:35], v[220:223]
  v_mfma_f32_16x16x32_bf16 v[224:227], v[24:27], v[36:39], v[224:227]
  v_mfma_f32_16x16x32_bf16 v[228:231], v[24:27], v[40:43], v[228:231]
  s_sub_u32 s13, s13, 1
  s_cmp_eq_u32 s13, 0
  s_cbranch_scc1 wo_kernel_fin
  buffer_load_dwordx4 v[8:11], v5, s[8:11], s24 offen
  buffer_load_dwordx4 v[12:15], v5, s[8:11], s25 offen
  buffer_load_dwordx4 v[16:19], v5, s[8:11], s26 offen
  buffer_load_dwordx4 v[20:23], v5, s[8:11], s27 offen
  buffer_load_dwordx4 v[24:27], v5, s[8:11], s28 offen
  buffer_load_dwordx4 v[28:31], v5, s[8:11], s29 offen
  buffer_load_dwordx4 v[32:35], v5, s[8:11], s30 offen
  buffer_load_dwordx4 v[36:39], v5, s[8:11], s31 offen
  buffer_load_dwordx4 v[40:43], v5, s[8:11], s32 offen
  v_add_u32 v5, 4096, v5
  s_waitcnt vmcnt(27)
  v_mfma_f32_16x16x32_bf16 v[152:155], v[44:47], v[64:67], v[152:155]
  v_mfma_f32_16x16x32_bf16 v[156:159], v[44:47], v[68:71], v[156:159]
  v_mfma_f32_16x16x32_bf16 v[160:163], v[44:47], v[72:75], v[160:163]
  v_mfma_f32_16x16x32_bf16 v[164:167], v[44:47], v[76:79], v[164:167]
  v_mfma_f32_16x16x32_bf16 v[168:171], v[48:51], v[64:67], v[168:171]
  v_mfma_f32_16x16x32_bf16 v[172:175], v[48:51], v[68:71], v[172:175]
  v_mfma_f32_16x16x32_bf16 v[176:179], v[48:51], v[72:75], v[176:179]
  v_mfma_f32_16x16x32_bf16 v[180:183], v[48:51], v[76:79], v[180:183]
  v_mfma_f32_16x16x32_bf16 v[184:187], v[52:55], v[64:67], v[184:187]
  v_mfma_f32_16x16x32_bf16 v[188:191], v[52:55], v[68:71], v[188:191]
  v_mfma_f32_16x16x32_bf16 v[192:195], v[52:55], v[72:75], v[192:195]
  v_mfma_f32_16x16x32_bf16 v[196:199], v[52:55], v[76:79], v[196:199]
  v_mfma_f32_16x16x32_bf16 v[200:203], v[56:59], v[64:67], v[200:203]
  v_mfma_f32_16x16x32_bf16 v[204:207], v[56:59], v[68:71], v[204:207]
  v_mfma_f32_16x16x32_bf16 v[208:211], v[56:59], v[72:75], v[208:211]
  v_mfma_f32_16x16x32_bf16 v[212:215], v[56:59], v[76:79], v[212:215]
  v_mfma_f32_16x16x32_bf16 v[216:219], v[60:63], v[64:67], v[216:219]
  v_mfma_f32_16x16x32_bf16 v[220:223], v[60:63], v[68:71], v[220:223]
  v_mfma_f32_16x16x32_bf16 v[224:227], v[60:63], v[72:75], v[224:227]
  v_mfma_f32_16x16x32_bf16 v[228:231], v[60:63], v[76:79], v[228:231]
  s_sub_u32 s13, s13, 1
  s_cmp_eq_u32 s13, 0
  s_cbranch_scc1 wo_kernel_fin
  buffer_load_dwordx4 v[44:47], v5, s[8:11], s24 offen
  buffer_load_dwordx4 v[48:51], v5, s[8:11], s25 offen
  buffer_load_dwordx4 v[52:55], v5, s[8:11], s26 offen
  buffer_load_dwordx4 v[56:59], v5, s[8:11], s27 offen
  buffer_load_dwordx4 v[60:63], v5, s[8:11], s28 offen
  buffer_load_dwordx4 v[64:67], v5, s[8:11], s29 offen
  buffer_load_dwordx4 v[68:71], v5, s[8:11], s30 offen
  buffer_load_dwordx4 v[72:75], v5, s[8:11], s31 offen
  buffer_load_dwordx4 v[76:79], v5, s[8:11], s32 offen
  v_add_u32 v5, 4096, v5
  s_waitcnt vmcnt(27)
  v_mfma_f32_16x16x32_bf16 v[152:155], v[80:83], v[100:103], v[152:155]
  v_mfma_f32_16x16x32_bf16 v[156:159], v[80:83], v[104:107], v[156:159]
  v_mfma_f32_16x16x32_bf16 v[160:163], v[80:83], v[108:111], v[160:163]
  v_mfma_f32_16x16x32_bf16 v[164:167], v[80:83], v[112:115], v[164:167]
  v_mfma_f32_16x16x32_bf16 v[168:171], v[84:87], v[100:103], v[168:171]
  v_mfma_f32_16x16x32_bf16 v[172:175], v[84:87], v[104:107], v[172:175]
  v_mfma_f32_16x16x32_bf16 v[176:179], v[84:87], v[108:111], v[176:179]
  v_mfma_f32_16x16x32_bf16 v[180:183], v[84:87], v[112:115], v[180:183]
  v_mfma_f32_16x16x32_bf16 v[184:187], v[88:91], v[100:103], v[184:187]
  v_mfma_f32_16x16x32_bf16 v[188:191], v[88:91], v[104:107], v[188:191]
  v_mfma_f32_16x16x32_bf16 v[192:195], v[88:91], v[108:111], v[192:195]
  v_mfma_f32_16x16x32_bf16 v[196:199], v[88:91], v[112:115], v[196:199]
  v_mfma_f32_16x16x32_bf16 v[200:203], v[92:95], v[100:103], v[200:203]
  v_mfma_f32_16x16x32_bf16 v[204:207], v[92:95], v[104:107], v[204:207]
  v_mfma_f32_16x16x32_bf16 v[208:211], v[92:95], v[108:111], v[208:211]
  v_mfma_f32_16x16x32_bf16 v[212:215], v[92:95], v[112:115], v[212:215]
  v_mfma_f32_16x16x32_bf16 v[216:219], v[96:99], v[100:103], v[216:219]
  v_mfma_f32_16x16x32_bf16 v[220:223], v[96:99], v[104:107], v[220:223]
  v_mfma_f32_16x16x32_bf16 v[224:227], v[96:99], v[108:111], v[224:227]
  v_mfma_f32_16x16x32_bf16 v[228:231], v[96:99], v[112:115], v[228:231]
  s_sub_u32 s13, s13, 1
  s_cmp_eq_u32 s13, 0
  s_cbranch_scc1 wo_kernel_fin
  buffer_load_dwordx4 v[80:83], v5, s[8:11], s24 offen
  buffer_load_dwordx4 v[84:87], v5, s[8:11], s25 offen
  buffer_load_dwordx4 v[88:91], v5, s[8:11], s26 offen
  buffer_load_dwordx4 v[92:95], v5, s[8:11], s27 offen
  buffer_load_dwordx4 v[96:99], v5, s[8:11], s28 offen
  buffer_load_dwordx4 v[100:103], v5, s[8:11], s29 offen
  buffer_load_dwordx4 v[104:107], v5, s[8:11], s30 offen
  buffer_load_dwordx4 v[108:111], v5, s[8:11], s31 offen
  buffer_load_dwordx4 v[112:115], v5, s[8:11], s32 offen
  v_add_u32 v5, 4096, v5
  s_waitcnt vmcnt(27)
  v_mfma_f32_16x16x32_bf16 v[152:155], v[116:119], v[136:139], v[152:155]
  v_mfma_f32_16x16x32_bf16 v[156:159], v[116:119], v[140:143], v[156:159]
  v_mfma_f32_16x16x32_bf16 v[160:163], v[116:119], v[144:147], v[160:163]
  v_mfma_f32_16x16x32_bf16 v[164:167], v[116:119], v[148:151], v[164:167]
  v_mfma_f32_16x16x32_bf16 v[168:171], v[120:123], v[136:139], v[168:171]
  v_mfma_f32_16x16x32_bf16 v[172:175], v[120:123], v[140:143], v[172:175]
  v_mfma_f32_16x16x32_bf16 v[176:179], v[120:123], v[144:147], v[176:179]
  v_mfma_f32_16x16x32_bf16 v[180:183], v[120:123], v[148:151], v[180:183]
  v_mfma_f32_16x16x32_bf16 v[184:187], v[124:127], v[136:139], v[184:187]
  v_mfma_f32_16x16x32_bf16 v[188:191], v[124:127], v[140:143], v[188:191]
  v_mfma_f32_16x16x32_bf16 v[192:195], v[124:127], v[144:147], v[192:195]
  v_mfma_f32_16x16x32_bf16 v[196:199], v[124:127], v[148:151], v[196:199]
  v_mfma_f32_16x16x32_bf16 v[200:203], v[128:131], v[136:139], v[200:203]
  v_mfma_f32_16x16x32_bf16 v[204:207], v[128:131], v[140:143], v[204:207]
  v_mfma_f32_16x16x32_bf16 v[208:211], v[128:131], v[144:147], v[208:211]
  v_mfma_f32_16x16x32_bf16 v[212:215], v[128:131], v[148:151], v[212:215]
  v_mfma_f32_16x16x32_bf16 v[216:219], v[132:135], v[136:139], v[216:219]
  v_mfma_f32_16x16x32_bf16 v[220:223], v[132:135], v[140:143], v[220:223]
  v_mfma_f32_16x16x32_bf16 v[224:227], v[132:135], v[144:147], v[224:227]
  v_mfma_f32_16x16x32_bf16 v[228:231], v[132:135], v[148:151], v[228:231]
  s_sub_u32 s13, s13, 1
  s_cmp_eq_u32 s13, 0
  s_cbranch_scc1 wo_kernel_fin
  s_branch wo_kernel_lp
wo_kernel_fin:
  s_nop 15
  s_waitcnt vmcnt(0)
  s_cmp_eq_u32 s3, 0
  s_cbranch_scc1 wo_kernel_sk1
  s_sub_u32 s12, s3, 1
  s_and_b32 s12, s12, 3
  s_add_u32 s12, s12, 0
  s_mul_i32 s12, s12, 5120
  v_add_u32 v3, s12, v2
  ds_write_b128 v3, v[152:155] offset:0
  ds_write_b128 v3, v[168:171] offset:1024
  ds_write_b128 v3, v[184:187] offset:2048
  ds_write_b128 v3, v[200:203] offset:3072
  ds_write_b128 v3, v[216:219] offset:4096
wo_kernel_sk1:
  s_cmp_eq_u32 s3, 1
  s_cbranch_scc1 wo_kernel_sk2
  s_sub_u32 s12, s3, 2
  s_and_b32 s12, s12, 3
  s_add_u32 s12, s12, 3
  s_mul_i32 s12, s12, 5120
  v_add_u32 v3, s12, v2
  ds_write_b128 v3, v[156:159] offset:0
  ds_write_b128 v3, v[172:175] offset:1024
  ds_write_b128 v3, v[188:191] offset:2048
  ds_write_b128 v3, v[204:207] offset:3072
  ds_write_b128 v3, v[220:223] offset:4096
wo_kernel_sk2:
  s_cmp_eq_u32 s3, 2
  s_cbranch_scc1 wo_kernel_sk3
  s_sub_u32 s12, s3, 3
  s_and_b32 s12, s12, 3
  s_add_u32 s12, s12, 6
  s_mul_i32 s12, s12, 5120
  v_add_u32 v3, s12, v2
  ds_write_b128 v3, v[160:163] offset:0
  ds_write_b128 v3, v[176:179] offset:1024
  ds_write_b128 v3, v[192:195] offset:2048
  ds_write_b128 v3, v[208:211] offset:3072
  ds_write_b128 v3, v[224:227] offset:4096
wo_kernel_sk3:
  s_cmp_eq_u32 s3, 3
  s_cbranch_scc1 wo_kernel_sk4
  s_sub_u32 s12, s3, 4
  s_and_b32 s12, s12, 3
  s_add_u32 s12, s12, 9
  s_mul_i32 s12, s12, 5120
  v_add_u32 v3, s12, v2
  ds_write_b128 v3, v[164:167] offset:0
  ds_write_b128 v3, v[180:183] offset:1024
  ds_write_b128 v3, v[196:199] offset:2048
  ds_write_b128 v3, v[212:215] offset:3072
  ds_write_b128 v3, v[228:231] offset:4096
wo_kernel_sk4:
  s_waitcnt lgkmcnt(0)
  s_barrier
  s_cmp_eq_u32 s3, 0
  s_cbranch_scc0 wo_kernel_sk5
  v_mov_b32 v8, v152
  v_mov_b32 v9, v153
  v_mov_b32 v10, v154
  v_mov_b32 v11, v155
  v_mov_b32 v12, v168
  v_mov_b32 v13, v169
  v_mov_b32 v14, v170
  v_mov_b32 v15, v171
  v_mov_b32 v16, v184
  v_mov_b32 v17, v185
  v_mov_b32 v18, v186
  v_mov_b32 v19, v187
  v_mov_b32 v20, v200
  v_mov_b32 v21, v201
  v_mov_b32 v22, v202
  v_mov_b32 v23, v203
  v_mov_b32 v24, v216
  v_mov_b32 v25, v217
  v_mov_b32 v26, v218
  v_mov_b32 v27, v219
wo_kernel_sk5:
  s_cmp_eq_u32 s3, 1
  s_cbranch_scc0 wo_kernel_sk6
  v_mov_b32 v8, v156
  v_mov_b32 v9, v157
  v_mov_b32 v10, v158
  v_mov_b32 v11, v159
  v_mov_b32 v12, v172
  v_mov_b32 v13, v173
  v_mov_b32 v14, v174
  v_mov_b32 v15, v175
  v_mov_b32 v16, v188
  v_mov_b32 v17, v189
  v_mov_b32 v18, v190
  v_mov_b32 v19, v191
  v_mov_b32 v20, v204
  v_mov_b32 v21, v205
  v_mov_b32 v22, v206
  v_mov_b32 v23, v207
  v_mov_b32 v24, v220
  v_mov_b32 v25, v221
  v_mov_b32 v26, v222
  v_mov_b32 v27, v223
wo_kernel_sk6:
  s_cmp_eq_u32 s3, 2
  s_cbranch_scc0 wo_kernel_sk7
  v_mov_b32 v8, v160
  v_mov_b32 v9, v161
  v_mov_b32 v10, v162
  v_mov_b32 v11, v163
  v_mov_b32 v12, v176
  v_mov_b32 v13, v177
  v_mov_b32 v14, v178
  v_mov_b32 v15, v179
  v_mov_b32 v16, v192
  v_mov_b32 v17, v193
  v_mov_b32 v18, v194
  v_mov_b32 v19, v195
  v_mov_b32 v20, v208
  v_mov_b32 v21, v209
  v_mov_b32 v22, v210
  v_mov_b32 v23, v211
  v_mov_b32 v24, v224
  v_mov_b32 v25, v225
  v_mov_b32 v26, v226
  v_mov_b32 v27, v227
wo_kernel_sk7:
  s_cmp_eq_u32 s3, 3
  s_cbranch_scc0 wo_kernel_sk8
  v_mov_b32 v8, v164
  v_mov_b32 v9, v165
  v_mov_b32 v10, v166
  v_mov_b32 v11, v167
  v_mov_b32 v12, v180
  v_mov_b32 v13, v181
  v_mov_b32 v14, v182
  v_mov_b32 v15, v183
  v_mov_b32 v16, v196
  v_mov_b32 v17, v197
  v_mov_b32 v18, v198
  v_mov_b32 v19, v199
  v_mov_b32 v20, v212
  v_mov_b32 v21, v213
  v_mov_b32 v22, v214
  v_mov_b32 v23, v215
  v_mov_b32 v24, v228
  v_mov_b32 v25, v229
  v_mov_b32 v26, v230
  v_mov_b32 v27, v231
wo_kernel_sk8:
  s_mul_i32 s12, s3, 15360
  v_add_u32 v3, s12, v2
  ds_read_b128 v[28:31], v3 offset:0
  ds_read_b128 v[32:35], v3 offset:1024
  ds_read_b128 v[36:39], v3 offset:2048
  ds_read_b128 v[40:43], v3 offset:3072
  ds_read_b128 v[44:47], v3 offset:4096
  ds_read_b128 v[48:51], v3 offset:5120
  ds_read_b128 v[52:55], v3 offset:6144
  ds_read_b128 v[56:59], v3 offset:7168
  ds_read_b128 v[60:63], v3 offset:8192
  ds_read_b128 v[64:67], v3 offset:9216
  ds_read_b128 v[68:71], v3 offset:10240
  ds_read_b128 v[72:75], v3 offset:11264
  ds_read_b128 v[76:79], v3 offset:12288
  ds_read_b128 v[80:83], v3 offset:13312
  ds_read_b128 v[84:87], v3 offset:14336
  s_load_dwordx2 s[12:13], s[0:1], 0
  s_waitcnt lgkmcnt(0)
  s_and_b32 s13, s13, 0xffff
  s_mov_b32 s14, 2621440
  s_mov_b32 s15, 0x20000
  s_load_dwordx2 s[16:17], s[0:1], 104
  s_waitcnt lgkmcnt(0)
  s_add_u32 s16, s16, 129060864
  s_addc_u32 s17, s17, 0
  s_and_b32 s17, s17, 0xffff
  s_mov_b32 s18, 2621440
  s_mov_b32 s19, 0x20000
  s_lshl_b32 s22, s6, 2
  s_add_u32 s22, s22, s3
  s_mul_i32 s22, s22, 20480
  v_and_b32 v3, 15, v0
  v_mul_u32_u24 v3, 1280, v3
  v_lshrrev_b32 v4, 4, v0
  v_lshl_add_u32 v3, v4, 4, v3
  v_add_u32 v3, s22, v3
  s_mul_i32 s20, s5, 5
  s_add_u32 s20, s20, 0
  s_lshr_b32 s21, s20, 1
  s_lshl_b32 s21, s21, 6
  s_and_b32 s20, s20, 1
  s_lshl_b32 s20, s20, 3
  s_add_u32 s24, s20, s21
  buffer_load_dwordx2 v[88:89], v3, s[12:15], s24 offen
  s_mul_i32 s20, s5, 5
  s_add_u32 s20, s20, 1
  s_lshr_b32 s21, s20, 1
  s_lshl_b32 s21, s21, 6
  s_and_b32 s20, s20, 1
  s_lshl_b32 s20, s20, 3
  s_add_u32 s25, s20, s21
  buffer_load_dwordx2 v[90:91], v3, s[12:15], s25 offen
  s_mul_i32 s20, s5, 5
  s_add_u32 s20, s20, 2
  s_lshr_b32 s21, s20, 1
  s_lshl_b32 s21, s21, 6
  s_and_b32 s20, s20, 1
  s_lshl_b32 s20, s20, 3
  s_add_u32 s26, s20, s21
  buffer_load_dwordx2 v[92:93], v3, s[12:15], s26 offen
  s_mul_i32 s20, s5, 5
  s_add_u32 s20, s20, 3
  s_lshr_b32 s21, s20, 1
  s_lshl_b32 s21, s21, 6
  s_and_b32 s20, s20, 1
  s_lshl_b32 s20, s20, 3
  s_add_u32 s27, s20, s21
  buffer_load_dwordx2 v[94:95], v3, s[12:15], s27 offen
  s_mul_i32 s20, s5, 5
  s_add_u32 s20, s20, 4
  s_lshr_b32 s21, s20, 1
  s_lshl_b32 s21, s21, 6
  s_and_b32 s20, s20, 1
  s_lshl_b32 s20, s20, 3
  s_add_u32 s28, s20, s21
  buffer_load_dwordx2 v[96:97], v3, s[12:15], s28 offen
  s_waitcnt lgkmcnt(0)
  v_add_f32 v8, v8, v28
  v_add_f32 v9, v9, v29
  v_add_f32 v10, v10, v30
  v_add_f32 v11, v11, v31
  v_add_f32 v12, v12, v32
  v_add_f32 v13, v13, v33
  v_add_f32 v14, v14, v34
  v_add_f32 v15, v15, v35
  v_add_f32 v16, v16, v36
  v_add_f32 v17, v17, v37
  v_add_f32 v18, v18, v38
  v_add_f32 v19, v19, v39
  v_add_f32 v20, v20, v40
  v_add_f32 v21, v21, v41
  v_add_f32 v22, v22, v42
  v_add_f32 v23, v23, v43
  v_add_f32 v24, v24, v44
  v_add_f32 v25, v25, v45
  v_add_f32 v26, v26, v46
  v_add_f32 v27, v27, v47
  v_add_f32 v8, v8, v48
  v_add_f32 v9, v9, v49
  v_add_f32 v10, v10, v50
  v_add_f32 v11, v11, v51
  v_add_f32 v12, v12, v52
  v_add_f32 v13, v13, v53
  v_add_f32 v14, v14, v54
  v_add_f32 v15, v15, v55
  v_add_f32 v16, v16, v56
  v_add_f32 v17, v17, v57
  v_add_f32 v18, v18, v58
  v_add_f32 v19, v19, v59
  v_add_f32 v20, v20, v60
  v_add_f32 v21, v21, v61
  v_add_f32 v22, v22, v62
  v_add_f32 v23, v23, v63
  v_add_f32 v24, v24, v64
  v_add_f32 v25, v25, v65
  v_add_f32 v26, v26, v66
  v_add_f32 v27, v27, v67
  v_add_f32 v8, v8, v68
  v_add_f32 v9, v9, v69
  v_add_f32 v10, v10, v70
  v_add_f32 v11, v11, v71
  v_add_f32 v12, v12, v72
  v_add_f32 v13, v13, v73
  v_add_f32 v14, v14, v74
  v_add_f32 v15, v15, v75
  v_add_f32 v16, v16, v76
  v_add_f32 v17, v17, v77
  v_add_f32 v18, v18, v78
  v_add_f32 v19, v19, v79
  v_add_f32 v20, v20, v80
  v_add_f32 v21, v21, v81
  v_add_f32 v22, v22, v82
  v_add_f32 v23, v23, v83
  v_add_f32 v24, v24, v84
  v_add_f32 v25, v25, v85
  v_add_f32 v26, v26, v86
  v_add_f32 v27, v27, v87
  s_waitcnt vmcnt(0)
  v_cvt_pk_bf16_f32 v8, v8, v9
  v_cvt_pk_bf16_f32 v9, v10, v11
  v_lshlrev_b32 v4, 16, v8
  v_and_b32 v5, 0xffff0000, v8
  v_lshlrev_b32 v6, 16, v88
  v_and_b32 v7, 0xffff0000, v88
  v_add_f32 v4, v4, v6
  v_add_f32 v5, v5, v7
  v_cvt_pk_bf16_f32 v88, v4, v5
  v_lshlrev_b32 v4, 16, v9
  v_and_b32 v5, 0xffff0000, v9
  v_lshlrev_b32 v6, 16, v89
  v_and_b32 v7, 0xffff0000, v89
  v_add_f32 v4, v4, v6
  v_add_f32 v5, v5, v7
  v_cvt_pk_bf16_f32 v89, v4, v5
  buffer_store_dwordx2 v[88:89], v3, s[16:19], s24 offen
  v_cvt_pk_bf16_f32 v12, v12, v13
  v_cvt_pk_bf16_f32 v13, v14, v15
  v_lshlrev_b32 v4, 16, v12
  v_and_b32 v5, 0xffff0000, v12
  v_lshlrev_b32 v6, 16, v90
  v_and_b32 v7, 0xffff0000, v90
  v_add_f32 v4, v4, v6
  v_add_f32 v5, v5, v7
  v_cvt_pk_bf16_f32 v90, v4, v5
  v_lshlrev_b32 v4, 16, v13
  v_and_b32 v5, 0xffff0000, v13
  v_lshlrev_b32 v6, 16, v91
  v_and_b32 v7, 0xffff0000, v91
  v_add_f32 v4, v4, v6
  v_add_f32 v5, v5, v7
  v_cvt_pk_bf16_f32 v91, v4, v5
  buffer_store_dwordx2 v[90:91], v3, s[16:19], s25 offen
  v_cvt_pk_bf16_f32 v16, v16, v17
  v_cvt_pk_bf16_f32 v17, v18, v19
  v_lshlrev_b32 v4, 16, v16
  v_and_b32 v5, 0xffff0000, v16
  v_lshlrev_b32 v6, 16, v92
  v_and_b32 v7, 0xffff0000, v92
  v_add_f32 v4, v4, v6
  v_add_f32 v5, v5, v7
  v_cvt_pk_bf16_f32 v92, v4, v5
  v_lshlrev_b32 v4, 16, v17
  v_and_b32 v5, 0xffff0000, v17
  v_lshlrev_b32 v6, 16, v93
  v_and_b32 v7, 0xffff0000, v93
  v_add_f32 v4, v4, v6
  v_add_f32 v5, v5, v7
  v_cvt_pk_bf16_f32 v93, v4, v5
  buffer_store_dwordx2 v[92:93], v3, s[16:19], s26 offen
  v_cvt_pk_bf16_f32 v20, v20, v21
  v_cvt_pk_bf16_f32 v21, v22, v23
  v_lshlrev_b32 v4, 16, v20
  v_and_b32 v5, 0xffff0000, v20
  v_lshlrev_b32 v6, 16, v94
  v_and_b32 v7, 0xffff0000, v94
  v_add_f32 v4, v4, v6
  v_add_f32 v5, v5, v7
  v_cvt_pk_bf16_f32 v94, v4, v5
  v_lshlrev_b32 v4, 16, v21
  v_and_b32 v5, 0xffff0000, v21
  v_lshlrev_b32 v6, 16, v95
  v_and_b32 v7, 0xffff0000, v95
  v_add_f32 v4, v4, v6
  v_add_f32 v5, v5, v7
  v_cvt_pk_bf16_f32 v95, v4, v5
  buffer_store_dwordx2 v[94:95], v3, s[16:19], s27 offen
  v_cvt_pk_bf16_f32 v24, v24, v25
  v_cvt_pk_bf16_f32 v25, v26, v27
  v_lshlrev_b32 v4, 16, v24
  v_and_b32 v5, 0xffff0000, v24
  v_lshlrev_b32 v6, 16, v96
  v_and_b32 v7, 0xffff0000, v96
  v_add_f32 v4, v4, v6
  v_add_f32 v5, v5, v7
  v_cvt_pk_bf16_f32 v96, v4, v5
  v_lshlrev_b32 v4, 16, v25
  v_and_b32 v5, 0xffff0000, v25
  v_lshlrev_b32 v6, 16, v97
  v_and_b32 v7, 0xffff0000, v97
  v_add_f32 v4, v4, v6
  v_add_f32 v5, v5, v7
  v_cvt_pk_bf16_f32 v97, v4, v5
  buffer_store_dwordx2 v[96:97], v3, s[16:19], s28 offen
wo_kernel_done:
  s_endpgm
.section .rodata,"a"
.p2align 6
.amdhsa_kernel wo_kernel
  .amdhsa_next_free_vgpr 256
  .amdhsa_next_free_sgpr 40
  .amdhsa_accum_offset 256
  .amdhsa_group_segment_fixed_size 0
  .amdhsa_kernarg_size 112
  .amdhsa_user_sgpr_count 2
  .amdhsa_user_sgpr_kernarg_segment_ptr 1
  .amdhsa_system_sgpr_workgroup_id_x 1
.end_amdhsa_kernel

.text
.globl ln_kernel
.p2align 8
.type ln_kernel,@function
ln_kernel:
  s_cmp_ge_u32 s2, 128
  s_cbranch_scc1 ln_done
  s_load_dwordx2 s[8:9], s[0:1], 104
  s_waitcnt lgkmcnt(0)
  s_and_b32 s9, s9, 0xffff
  s_mov_b32 s10, 268435456
  s_mov_b32 s11, 0x20000
  s_mul_i32 s6, s2, 20480
  s_add_u32 s6, s6, 129060864
  s_mul_i32 s7, s2, 20480
  s_add_u32 s7, s7, 131682304
  v_and_b32 v1, 15, v0
  v_lshrrev_b32 v2, 4, v0
  v_mul_u32_u24 v3, 1280, v1
  v_lshl_add_u32 v3, v2, 4, v3
  v_lshlrev_b32 v4, 4, v0
  buffer_load_dwordx4 v[8:11], v3, s[8:11], s6 offen offset:0
  buffer_load_dwordx4 v[12:15], v3, s[8:11], s6 offen offset:64
  buffer_load_dwordx4 v[16:19], v3, s[8:11], s6 offen offset:128
  buffer_load_dwordx4 v[20:23], v3, s[8:11], s6 offen offset:192
  buffer_load_dwordx4 v[24:27], v3, s[8:11], s6 offen offset:256
  buffer_load_dwordx4 v[28:31], v3, s[8:11], s6 offen offset:320
  buffer_load_dwordx4 v[32:35], v3, s[8:11], s6 offen offset:384
  buffer_load_dwordx4 v[36:39], v3, s[8:11], s6 offen offset:448
  buffer_load_dwordx4 v[40:43], v3, s[8:11], s6 offen offset:512
  buffer_load_dwordx4 v[44:47], v3, s[8:11], s6 offen offset:576
  buffer_load_dwordx4 v[48:51], v3, s[8:11], s6 offen offset:640
  buffer_load_dwordx4 v[52:55], v3, s[8:11], s6 offen offset:704
  buffer_load_dwordx4 v[56:59], v3, s[8:11], s6 offen offset:768
  buffer_load_dwordx4 v[60:63], v3, s[8:11], s6 offen offset:832
  buffer_load_dwordx4 v[64:67], v3, s[8:11], s6 offen offset:896
  buffer_load_dwordx4 v[68:71], v3, s[8:11], s6 offen offset:960
  buffer_load_dwordx4 v[72:75], v3, s[8:11], s6 offen offset:1024
  buffer_load_dwordx4 v[76:79], v3, s[8:11], s6 offen offset:1088
  buffer_load_dwordx4 v[80:83], v3, s[8:11], s6 offen offset:1152
  buffer_load_dwordx4 v[84:87], v3, s[8:11], s6 offen offset:1216
  v_mov_b32 v88, 0
  v_mov_b32 v89, 0
  v_mov_b32 v92, 0
  v_mov_b32 v93, 0
  s_waitcnt vmcnt(19)
  v_lshlrev_b32 v90, 16, v8
  v_and_b32 v91, 0xffff0000, v8
  v_pk_add_f32 v[88:89], v[88:89], v[90:91]
  v_pk_fma_f32 v[92:93], v[90:91], v[90:91], v[92:93]
  v_lshlrev_b32 v94, 16, v9
  v_and_b32 v95, 0xffff0000, v9
  v_pk_add_f32 v[88:89], v[88:89], v[94:95]
  v_pk_fma_f32 v[92:93], v[94:95], v[94:95], v[92:93]
  v_lshlrev_b32 v90, 16, v10
  v_and_b32 v91, 0xffff0000, v10
  v_pk_add_f32 v[88:89], v[88:89], v[90:91]
  v_pk_fma_f32 v[92:93], v[90:91], v[90:91], v[92:93]
  v_lshlrev_b32 v94, 16, v11
  v_and_b32 v95, 0xffff0000, v11
  v_pk_add_f32 v[88:89], v[88:89], v[94:95]
  v_pk_fma_f32 v[92:93], v[94:95], v[94:95], v[92:93]
  s_waitcnt vmcnt(18)
  v_lshlrev_b32 v90, 16, v12
  v_and_b32 v91, 0xffff0000, v12
  v_pk_add_f32 v[88:89], v[88:89], v[90:91]
  v_pk_fma_f32 v[92:93], v[90:91], v[90:91], v[92:93]
  v_lshlrev_b32 v94, 16, v13
  v_and_b32 v95, 0xffff0000, v13
  v_pk_add_f32 v[88:89], v[88:89], v[94:95]
  v_pk_fma_f32 v[92:93], v[94:95], v[94:95], v[92:93]
  v_lshlrev_b32 v90, 16, v14
  v_and_b32 v91, 0xffff0000, v14
  v_pk_add_f32 v[88:89], v[88:89], v[90:91]
  v_pk_fma_f32 v[92:93], v[90:91], v[90:91], v[92:93]
  v_lshlrev_b32 v94, 16, v15
  v_and_b32 v95, 0xffff0000, v15
  v_pk_add_f32 v[88:89], v[88:89], v[94:95]
  v_pk_fma_f32 v[92:93], v[94:95], v[94:95], v[92:93]
  s_waitcnt vmcnt(17)
  v_lshlrev_b32 v90, 16, v16
  v_and_b32 v91, 0xffff0000, v16
  v_pk_add_f32 v[88:89], v[88:89], v[90:91]
  v_pk_fma_f32 v[92:93], v[90:91], v[90:91], v[92:93]
  v_lshlrev_b32 v94, 16, v17
  v_and_b32 v95, 0xffff0000, v17
  v_pk_add_f32 v[88:89], v[88:89], v[94:95]
  v_pk_fma_f32 v[92:93], v[94:95], v[94:95], v[92:93]
  v_lshlrev_b32 v90, 16, v18
  v_and_b32 v91, 0xffff0000, v18
  v_pk_add_f32 v[88:89], v[88:89], v[90:91]
  v_pk_fma_f32 v[92:93], v[90:91], v[90:91], v[92:93]
  v_lshlrev_b32 v94, 16, v19
  v_and_b32 v95, 0xffff0000, v19
  v_pk_add_f32 v[88:89], v[88:89], v[94:95]
  v_pk_fma_f32 v[92:93], v[94:95], v[94:95], v[92:93]
  s_waitcnt vmcnt(16)
  v_lshlrev_b32 v90, 16, v20
  v_and_b32 v91, 0xffff0000, v20
  v_pk_add_f32 v[88:89], v[88:89], v[90:91]
  v_pk_fma_f32 v[92:93], v[90:91], v[90:91], v[92:93]
  v_lshlrev_b32 v94, 16, v21
  v_and_b32 v95, 0xffff0000, v21
  v_pk_add_f32 v[88:89], v[88:89], v[94:95]
  v_pk_fma_f32 v[92:93], v[94:95], v[94:95], v[92:93]
  v_lshlrev_b32 v90, 16, v22
  v_and_b32 v91, 0xffff0000, v22
  v_pk_add_f32 v[88:89], v[88:89], v[90:91]
  v_pk_fma_f32 v[92:93], v[90:91], v[90:91], v[92:93]
  v_lshlrev_b32 v94, 16, v23
  v_and_b32 v95, 0xffff0000, v23
  v_pk_add_f32 v[88:89], v[88:89], v[94:95]
  v_pk_fma_f32 v[92:93], v[94:95], v[94:95], v[92:93]
  s_waitcnt vmcnt(15)
  v_lshlrev_b32 v90, 16, v24
  v_and_b32 v91, 0xffff0000, v24
  v_pk_add_f32 v[88:89], v[88:89], v[90:91]
  v_pk_fma_f32 v[92:93], v[90:91], v[90:91], v[92:93]
  v_lshlrev_b32 v94, 16, v25
  v_and_b32 v95, 0xffff0000, v25
  v_pk_add_f32 v[88:89], v[88:89], v[94:95]
  v_pk_fma_f32 v[92:93], v[94:95], v[94:95], v[92:93]
  v_lshlrev_b32 v90, 16, v26
  v_and_b32 v91, 0xffff0000, v26
  v_pk_add_f32 v[88:89], v[88:89], v[90:91]
  v_pk_fma_f32 v[92:93], v[90:91], v[90:91], v[92:93]
  v_lshlrev_b32 v94, 16, v27
  v_and_b32 v95, 0xffff0000, v27
  v_pk_add_f32 v[88:89], v[88:89], v[94:95]
  v_pk_fma_f32 v[92:93], v[94:95], v[94:95], v[92:93]
  s_waitcnt vmcnt(14)
  v_lshlrev_b32 v90, 16, v28
  v_and_b32 v91, 0xffff0000, v28
  v_pk_add_f32 v[88:89], v[88:89], v[90:91]
  v_pk_fma_f32 v[92:93], v[90:91], v[90:91], v[92:93]
  v_lshlrev_b32 v94, 16, v29
  v_and_b32 v95, 0xffff0000, v29
  v_pk_add_f32 v[88:89], v[88:89], v[94:95]
  v_pk_fma_f32 v[92:93], v[94:95], v[94:95], v[92:93]
  v_lshlrev_b32 v90, 16, v30
  v_and_b32 v91, 0xffff0000, v30
  v_pk_add_f32 v[88:89], v[88:89], v[90:91]
  v_pk_fma_f32 v[92:93], v[90:91], v[90:91], v[92:93]
  v_lshlrev_b32 v94, 16, v31
  v_and_b32 v95, 0xffff0000, v31
  v_pk_add_f32 v[88:89], v[88:89], v[94:95]
  v_pk_fma_f32 v[92:93], v[94:95], v[94:95], v[92:93]
  s_waitcnt vmcnt(13)
  v_lshlrev_b32 v90, 16, v32
  v_and_b32 v91, 0xffff0000, v32
  v_pk_add_f32 v[88:89], v[88:89], v[90:91]
  v_pk_fma_f32 v[92:93], v[90:91], v[90:91], v[92:93]
  v_lshlrev_b32 v94, 16, v33
  v_and_b32 v95, 0xffff0000, v33
  v_pk_add_f32 v[88:89], v[88:89], v[94:95]
  v_pk_fma_f32 v[92:93], v[94:95], v[94:95], v[92:93]
  v_lshlrev_b32 v90, 16, v34
  v_and_b32 v91, 0xffff0000, v34
  v_pk_add_f32 v[88:89], v[88:89], v[90:91]
  v_pk_fma_f32 v[92:93], v[90:91], v[90:91], v[92:93]
  v_lshlrev_b32 v94, 16, v35
  v_and_b32 v95, 0xffff0000, v35
  v_pk_add_f32 v[88:89], v[88:89], v[94:95]
  v_pk_fma_f32 v[92:93], v[94:95], v[94:95], v[92:93]
  s_waitcnt vmcnt(12)
  v_lshlrev_b32 v90, 16, v36
  v_and_b32 v91, 0xffff0000, v36
  v_pk_add_f32 v[88:89], v[88:89], v[90:91]
  v_pk_fma_f32 v[92:93], v[90:91], v[90:91], v[92:93]
  v_lshlrev_b32 v94, 16, v37
  v_and_b32 v95, 0xffff0000, v37
  v_pk_add_f32 v[88:89], v[88:89], v[94:95]
  v_pk_fma_f32 v[92:93], v[94:95], v[94:95], v[92:93]
  v_lshlrev_b32 v90, 16, v38
  v_and_b32 v91, 0xffff0000, v38
  v_pk_add_f32 v[88:89], v[88:89], v[90:91]
  v_pk_fma_f32 v[92:93], v[90:91], v[90:91], v[92:93]
  v_lshlrev_b32 v94, 16, v39
  v_and_b32 v95, 0xffff0000, v39
  v_pk_add_f32 v[88:89], v[88:89], v[94:95]
  v_pk_fma_f32 v[92:93], v[94:95], v[94:95], v[92:93]
  s_waitcnt vmcnt(11)
  v_lshlrev_b32 v90, 16, v40
  v_and_b32 v91, 0xffff0000, v40
  v_pk_add_f32 v[88:89], v[88:89], v[90:91]
  v_pk_fma_f32 v[92:93], v[90:91], v[90:91], v[92:93]
  v_lshlrev_b32 v94, 16, v41
  v_and_b32 v95, 0xffff0000, v41
  v_pk_add_f32 v[88:89], v[88:89], v[94:95]
  v_pk_fma_f32 v[92:93], v[94:95], v[94:95], v[92:93]
  v_lshlrev_b32 v90, 16, v42
  v_and_b32 v91, 0xffff0000, v42
  v_pk_add_f32 v[88:89], v[88:89], v[90:91]
  v_pk_fma_f32 v[92:93], v[90:91], v[90:91], v[92:93]
  v_lshlrev_b32 v94, 16, v43
  v_and_b32 v95, 0xffff0000, v43
  v_pk_add_f32 v[88:89], v[88:89], v[94:95]
  v_pk_fma_f32 v[92:93], v[94:95], v[94:95], v[92:93]
  s_waitcnt vmcnt(10)
  v_lshlrev_b32 v90, 16, v44
  v_and_b32 v91, 0xffff0000, v44
  v_pk_add_f32 v[88:89], v[88:89], v[90:91]
  v_pk_fma_f32 v[92:93], v[90:91], v[90:91], v[92:93]
  v_lshlrev_b32 v94, 16, v45
  v_and_b32 v95, 0xffff0000, v45
  v_pk_add_f32 v[88:89], v[88:89], v[94:95]
  v_pk_fma_f32 v[92:93], v[94:95], v[94:95], v[92:93]
  v_lshlrev_b32 v90, 16, v46
  v_and_b32 v91, 0xffff0000, v46
  v_pk_add_f32 v[88:89], v[88:89], v[90:91]
  v_pk_fma_f32 v[92:93], v[90:91], v[90:91], v[92:93]
  v_lshlrev_b32 v94, 16, v47
  v_and_b32 v95, 0xffff0000, v47
  v_pk_add_f32 v[88:89], v[88:89], v[94:95]
  v_pk_fma_f32 v[92:93], v[94:95], v[94:95], v[92:93]
  s_waitcnt vmcnt(9)
  v_lshlrev_b32 v90, 16, v48
  v_and_b32 v91, 0xffff0000, v48
  v_pk_add_f32 v[88:89], v[88:89], v[90:91]
  v_pk_fma_f32 v[92:93], v[90:91], v[90:91], v[92:93]
  v_lshlrev_b32 v94, 16, v49
  v_and_b32 v95, 0xffff0000, v49
  v_pk_add_f32 v[88:89], v[88:89], v[94:95]
  v_pk_fma_f32 v[92:93], v[94:95], v[94:95], v[92:93]
  v_lshlrev_b32 v90, 16, v50
  v_and_b32 v91, 0xffff0000, v50
  v_pk_add_f32 v[88:89], v[88:89], v[90:91]
  v_pk_fma_f32 v[92:93], v[90:91], v[90:91], v[92:93]
  v_lshlrev_b32 v94, 16, v51
  v_and_b32 v95, 0xffff0000, v51
  v_pk_add_f32 v[88:89], v[88:89], v[94:95]
  v_pk_fma_f32 v[92:93], v[94:95], v[94:95], v[92:93]
  s_waitcnt vmcnt(8)
  v_lshlrev_b32 v90, 16, v52
  v_and_b32 v91, 0xffff0000, v52
  v_pk_add_f32 v[88:89], v[88:89], v[90:91]
  v_pk_fma_f32 v[92:93], v[90:91], v[90:91], v[92:93]
  v_lshlrev_b32 v94, 16, v53
  v_and_b32 v95, 0xffff0000, v53
  v_pk_add_f32 v[88:89], v[88:89], v[94:95]
  v_pk_fma_f32 v[92:93], v[94:95], v[94:95], v[92:93]
  v_lshlrev_b32 v90, 16, v54
  v_and_b32 v91, 0xffff0000, v54
  v_pk_add_f32 v[88:89], v[88:89], v[90:91]
  v_pk_fma_f32 v[92:93], v[90:91], v[90:91], v[92:93]
  v_lshlrev_b32 v94, 16, v55
  v_and_b32 v95, 0xffff0000, v55
  v_pk_add_f32 v[88:89], v[88:89], v[94:95]
  v_pk_fma_f32 v[92:93], v[94:95], v[94:95], v[92:93]
  s_waitcnt vmcnt(7)
  v_lshlrev_b32 v90, 16, v56
  v_and_b32 v91, 0xffff0000, v56
  v_pk_add_f32 v[88:89], v[88:89], v[90:91]
  v_pk_fma_f32 v[92:93], v[90:91], v[90:91], v[92:93]
  v_lshlrev_b32 v94, 16, v57
  v_and_b32 v95, 0xffff0000, v57
  v_pk_add_f32 v[88:89], v[88:89], v[94:95]
  v_pk_fma_f32 v[92:93], v[94:95], v[94:95], v[92:93]
  v_lshlrev_b32 v90, 16, v58
  v_and_b32 v91, 0xffff0000, v58
  v_pk_add_f32 v[88:89], v[88:89], v[90:91]
  v_pk_fma_f32 v[92:93], v[90:91], v[90:91], v[92:93]
  v_lshlrev_b32 v94, 16, v59
  v_and_b32 v95, 0xffff0000, v59
  v_pk_add_f32 v[88:89], v[88:89], v[94:95]
  v_pk_fma_f32 v[92:93], v[94:95], v[94:95], v[92:93]
  s_waitcnt vmcnt(6)
  v_lshlrev_b32 v90, 16, v60
  v_and_b32 v91, 0xffff0000, v60
  v_pk_add_f32 v[88:89], v[88:89], v[90:91]
  v_pk_fma_f32 v[92:93], v[90:91], v[90:91], v[92:93]
  v_lshlrev_b32 v94, 16, v61
  v_and_b32 v95, 0xffff0000, v61
  v_pk_add_f32 v[88:89], v[88:89], v[94:95]
  v_pk_fma_f32 v[92:93], v[94:95], v[94:95], v[92:93]
  v_lshlrev_b32 v90, 16, v62
  v_and_b32 v91, 0xffff0000, v62
  v_pk_add_f32 v[88:89], v[88:89], v[90:91]
  v_pk_fma_f32 v[92:93], v[90:91], v[90:91], v[92:93]
  v_lshlrev_b32 v94, 16, v63
  v_and_b32 v95, 0xffff0000, v63
  v_pk_add_f32 v[88:89], v[88:89], v[94:95]
  v_pk_fma_f32 v[92:93], v[94:95], v[94:95], v[92:93]
  s_waitcnt vmcnt(5)
  v_lshlrev_b32 v90, 16, v64
  v_and_b32 v91, 0xffff0000, v64
  v_pk_add_f32 v[88:89], v[88:89], v[90:91]
  v_pk_fma_f32 v[92:93], v[90:91], v[90:91], v[92:93]
  v_lshlrev_b32 v94, 16, v65
  v_and_b32 v95, 0xffff0000, v65
  v_pk_add_f32 v[88:89], v[88:89], v[94:95]
  v_pk_fma_f32 v[92:93], v[94:95], v[94:95], v[92:93]
  v_lshlrev_b32 v90, 16, v66
  v_and_b32 v91, 0xffff0000, v66
  v_pk_add_f32 v[88:89], v[88:89], v[90:91]
  v_pk_fma_f32 v[92:93], v[90:91], v[90:91], v[92:93]
  v_lshlrev_b32 v94, 16, v67
  v_and_b32 v95, 0xffff0000, v67
  v_pk_add_f32 v[88:89], v[88:89], v[94:95]
  v_pk_fma_f32 v[92:93], v[94:95], v[94:95], v[92:93]
  s_waitcnt vmcnt(4)
  v_lshlrev_b32 v90, 16, v68
  v_and_b32 v91, 0xffff0000, v68
  v_pk_add_f32 v[88:89], v[88:89], v[90:91]
  v_pk_fma_f32 v[92:93], v[90:91], v[90:91], v[92:93]
  v_lshlrev_b32 v94, 16, v69
  v_and_b32 v95, 0xffff0000, v69
  v_pk_add_f32 v[88:89], v[88:89], v[94:95]
  v_pk_fma_f32 v[92:93], v[94:95], v[94:95], v[92:93]
  v_lshlrev_b32 v90, 16, v70
  v_and_b32 v91, 0xffff0000, v70
  v_pk_add_f32 v[88:89], v[88:89], v[90:91]
  v_pk_fma_f32 v[92:93], v[90:91], v[90:91], v[92:93]
  v_lshlrev_b32 v94, 16, v71
  v_and_b32 v95, 0xffff0000, v71
  v_pk_add_f32 v[88:89], v[88:89], v[94:95]
  v_pk_fma_f32 v[92:93], v[94:95], v[94:95], v[92:93]
  s_waitcnt vmcnt(3)
  v_lshlrev_b32 v90, 16, v72
  v_and_b32 v91, 0xffff0000, v72
  v_pk_add_f32 v[88:89], v[88:89], v[90:91]
  v_pk_fma_f32 v[92:93], v[90:91], v[90:91], v[92:93]
  v_lshlrev_b32 v94, 16, v73
  v_and_b32 v95, 0xffff0000, v73
  v_pk_add_f32 v[88:89], v[88:89], v[94:95]
  v_pk_fma_f32 v[92:93], v[94:95], v[94:95], v[92:93]
  v_lshlrev_b32 v90, 16, v74
  v_and_b32 v91, 0xffff0000, v74
  v_pk_add_f32 v[88:89], v[88:89], v[90:91]
  v_pk_fma_f32 v[92:93], v[90:91], v[90:91], v[92:93]
  v_lshlrev_b32 v94, 16, v75
  v_and_b32 v95, 0xffff0000, v75
  v_pk_add_f32 v[88:89], v[88:89], v[94:95]
  v_pk_fma_f32 v[92:93], v[94:95], v[94:95], v[92:93]
  s_waitcnt vmcnt(2)
  v_lshlrev_b32 v90, 16, v76
  v_and_b32 v91, 0xffff0000, v76
  v_pk_add_f32 v[88:89], v[88:89], v[90:91]
  v_pk_fma_f32 v[92:93], v[90:91], v[90:91], v[92:93]
  v_lshlrev_b32 v94, 16, v77
  v_and_b32 v95, 0xffff0000, v77
  v_pk_add_f32 v[88:89], v[88:89], v[94:95]
  v_pk_fma_f32 v[92:93], v[94:95], v[94:95], v[92:93]
  v_lshlrev_b32 v90, 16, v78
  v_and_b32 v91, 0xffff0000, v78
  v_pk_add_f32 v[88:89], v[88:89], v[90:91]
  v_pk_fma_f32 v[92:93], v[90:91], v[90:91], v[92:93]
  v_lshlrev_b32 v94, 16, v79
  v_and_b32 v95, 0xffff0000, v79
  v_pk_add_f32 v[88:89], v[88:89], v[94:95]
  v_pk_fma_f32 v[92:93], v[94:95], v[94:95], v[92:93]
  s_waitcnt vmcnt(1)
  v_lshlrev_b32 v90, 16, v80
  v_and_b32 v91, 0xffff0000, v80
  v_pk_add_f32 v[88:89], v[88:89], v[90:91]
  v_pk_fma_f32 v[92:93], v[90:91], v[90:91], v[92:93]
  v_lshlrev_b32 v94, 16, v81
  v_and_b32 v95, 0xffff0000, v81
  v_pk_add_f32 v[88:89], v[88:89], v[94:95]
  v_pk_fma_f32 v[92:93], v[94:95], v[94:95], v[92:93]
  v_lshlrev_b32 v90, 16, v82
  v_and_b32 v91, 0xffff0000, v82
  v_pk_add_f32 v[88:89], v[88:89], v[90:91]
  v_pk_fma_f32 v[92:93], v[90:91], v[90:91], v[92:93]
  v_lshlrev_b32 v94, 16, v83
  v_and_b32 v95, 0xffff0000, v83
  v_pk_add_f32 v[88:89], v[88:89], v[94:95]
  v_pk_fma_f32 v[92:93], v[94:95], v[94:95], v[92:93]
  s_waitcnt vmcnt(0)
  v_lshlrev_b32 v90, 16, v84
  v_and_b32 v91, 0xffff0000, v84
  v_pk_add_f32 v[88:89], v[88:89], v[90:91]
  v_pk_fma_f32 v[92:93], v[90:91], v[90:91], v[92:93]
  v_lshlrev_b32 v94, 16, v85
  v_and_b32 v95, 0xffff0000, v85
  v_pk_add_f32 v[88:89], v[88:89], v[94:95]
  v_pk_fma_f32 v[92:93], v[94:95], v[94:95], v[92:93]
  v_lshlrev_b32 v90, 16, v86
  v_and_b32 v91, 0xffff0000, v86
  v_pk_add_f32 v[88:89], v[88:89], v[90:91]
  v_pk_fma_f32 v[92:93], v[90:91], v[90:91], v[92:93]
  v_lshlrev_b32 v94, 16, v87
  v_and_b32 v95, 0xffff0000, v87
  v_pk_add_f32 v[88:89], v[88:89], v[94:95]
  v_pk_fma_f32 v[92:93], v[94:95], v[94:95], v[92:93]
  v_add_f32 v5, v88, v89
  v_add_f32 v6, v92, v93
  v_mov_b32 v90, v5
  s_nop 1
  v_permlane32_swap_b32 v90, v5
  s_nop 1
  v_add_f32 v5, v5, v90
  v_mov_b32 v90, v5
  s_nop 1
  v_permlane16_swap_b32 v90, v5
  s_nop 1
  v_add_f32 v5, v5, v90
  v_mov_b32 v90, v6
  s_nop 1
  v_permlane32_swap_b32 v90, v6
  s_nop 1
  v_add_f32 v6, v6, v90
  v_mov_b32 v90, v6
  s_nop 1
  v_permlane16_swap_b32 v90, v6
  s_nop 1
  v_add_f32 v6, v6, v90
  v_mul_f32 v5, 0x3acccccd, v5
  v_mul_f32 v6, 0x3acccccd, v6
  v_fma_f32 v6, -v5, v5, v6
  v_max_f32 v6, 0, v6
  v_add_f32 v6, 0x3727c5ac, v6
  v_rsq_f32 v7, v6
  s_nop 0
  v_mul_f32 v88, v5, v7
  v_sub_f32 v88, 0, v88
  v_mov_b32 v89, v88
  v_mov_b32 v92, v7
  v_mov_b32 v93, v7
  v_lshlrev_b32 v90, 16, v8
  v_and_b32 v91, 0xffff0000, v8
  v_pk_fma_f32 v[90:91], v[90:91], v[92:93], v[88:89]
  v_cvt_pk_bf16_f32 v8, v90, v91
  v_lshlrev_b32 v94, 16, v9
  v_and_b32 v95, 0xffff0000, v9
  v_pk_fma_f32 v[94:95], v[94:95], v[92:93], v[88:89]
  v_cvt_pk_bf16_f32 v9, v94, v95
  v_lshlrev_b32 v90, 16, v10
  v_and_b32 v91, 0xffff0000, v10
  v_pk_fma_f32 v[90:91], v[90:91], v[92:93], v[88:89]
  v_cvt_pk_bf16_f32 v10, v90, v91
  v_lshlrev_b32 v94, 16, v11
  v_and_b32 v95, 0xffff0000, v11
  v_pk_fma_f32 v[94:95], v[94:95], v[92:93], v[88:89]
  v_cvt_pk_bf16_f32 v11, v94, v95
  s_add_u32 s20, s7, 0
  buffer_store_dwordx4 v[8:11], v4, s[8:11], s20 offen
  v_lshlrev_b32 v90, 16, v12
  v_and_b32 v91, 0xffff0000, v12
  v_pk_fma_f32 v[90:91], v[90:91], v[92:93], v[88:89]
  v_cvt_pk_bf16_f32 v12, v90, v91
  v_lshlrev_b32 v94, 16, v13
  v_and_b32 v95, 0xffff0000, v13
  v_pk_fma_f32 v[94:95], v[94:95], v[92:93], v[88:89]
  v_cvt_pk_bf16_f32 v13, v94, v95
  v_lshlrev_b32 v90, 16, v14
  v_and_b32 v91, 0xffff0000, v14
  v_pk_fma_f32 v[90:91], v[90:91], v[92:93], v[88:89]
  v_cvt_pk_bf16_f32 v14, v90, v91
  v_lshlrev_b32 v94, 16, v15
  v_and_b32 v95, 0xffff0000, v15
  v_pk_fma_f32 v[94:95], v[94:95], v[92:93], v[88:89]
  v_cvt_pk_bf16_f32 v15, v94, v95
  s_add_u32 s20, s7, 1024
  buffer_store_dwordx4 v[12:15], v4, s[8:11], s20 offen
  v_lshlrev_b32 v90, 16, v16
  v_and_b32 v91, 0xffff0000, v16
  v_pk_fma_f32 v[90:91], v[90:91], v[92:93], v[88:89]
  v_cvt_pk_bf16_f32 v16, v90, v91
  v_lshlrev_b32 v94, 16, v17
  v_and_b32 v95, 0xffff0000, v17
  v_pk_fma_f32 v[94:95], v[94:95], v[92:93], v[88:89]
  v_cvt_pk_bf16_f32 v17, v94, v95
  v_lshlrev_b32 v90, 16, v18
  v_and_b32 v91, 0xffff0000, v18
  v_pk_fma_f32 v[90:91], v[90:91], v[92:93], v[88:89]
  v_cvt_pk_bf16_f32 v18, v90, v91
  v_lshlrev_b32 v94, 16, v19
  v_and_b32 v95, 0xffff0000, v19
  v_pk_fma_f32 v[94:95], v[94:95], v[92:93], v[88:89]
  v_cvt_pk_bf16_f32 v19, v94, v95
  s_add_u32 s20, s7, 2048
  buffer_store_dwordx4 v[16:19], v4, s[8:11], s20 offen
  v_lshlrev_b32 v90, 16, v20
  v_and_b32 v91, 0xffff0000, v20
  v_pk_fma_f32 v[90:91], v[90:91], v[92:93], v[88:89]
  v_cvt_pk_bf16_f32 v20, v90, v91
  v_lshlrev_b32 v94, 16, v21
  v_and_b32 v95, 0xffff0000, v21
  v_pk_fma_f32 v[94:95], v[94:95], v[92:93], v[88:89]
  v_cvt_pk_bf16_f32 v21, v94, v95
  v_lshlrev_b32 v90, 16, v22
  v_and_b32 v91, 0xffff0000, v22
  v_pk_fma_f32 v[90:91], v[90:91], v[92:93], v[88:89]
  v_cvt_pk_bf16_f32 v22, v90, v91
  v_lshlrev_b32 v94, 16, v23
  v_and_b32 v95, 0xffff0000, v23
  v_pk_fma_f32 v[94:95], v[94:95], v[92:93], v[88:89]
  v_cvt_pk_bf16_f32 v23, v94, v95
  s_add_u32 s20, s7, 3072
  buffer_store_dwordx4 v[20:23], v4, s[8:11], s20 offen
  v_lshlrev_b32 v90, 16, v24
  v_and_b32 v91, 0xffff0000, v24
  v_pk_fma_f32 v[90:91], v[90:91], v[92:93], v[88:89]
  v_cvt_pk_bf16_f32 v24, v90, v91
  v_lshlrev_b32 v94, 16, v25
  v_and_b32 v95, 0xffff0000, v25
  v_pk_fma_f32 v[94:95], v[94:95], v[92:93], v[88:89]
  v_cvt_pk_bf16_f32 v25, v94, v95
  v_lshlrev_b32 v90, 16, v26
  v_and_b32 v91, 0xffff0000, v26
  v_pk_fma_f32 v[90:91], v[90:91], v[92:93], v[88:89]
  v_cvt_pk_bf16_f32 v26, v90, v91
  v_lshlrev_b32 v94, 16, v27
  v_and_b32 v95, 0xffff0000, v27
  v_pk_fma_f32 v[94:95], v[94:95], v[92:93], v[88:89]
  v_cvt_pk_bf16_f32 v27, v94, v95
  s_add_u32 s20, s7, 4096
  buffer_store_dwordx4 v[24:27], v4, s[8:11], s20 offen
  v_lshlrev_b32 v90, 16, v28
  v_and_b32 v91, 0xffff0000, v28
  v_pk_fma_f32 v[90:91], v[90:91], v[92:93], v[88:89]
  v_cvt_pk_bf16_f32 v28, v90, v91
  v_lshlrev_b32 v94, 16, v29
  v_and_b32 v95, 0xffff0000, v29
  v_pk_fma_f32 v[94:95], v[94:95], v[92:93], v[88:89]
  v_cvt_pk_bf16_f32 v29, v94, v95
  v_lshlrev_b32 v90, 16, v30
  v_and_b32 v91, 0xffff0000, v30
  v_pk_fma_f32 v[90:91], v[90:91], v[92:93], v[88:89]
  v_cvt_pk_bf16_f32 v30, v90, v91
  v_lshlrev_b32 v94, 16, v31
  v_and_b32 v95, 0xffff0000, v31
  v_pk_fma_f32 v[94:95], v[94:95], v[92:93], v[88:89]
  v_cvt_pk_bf16_f32 v31, v94, v95
  s_add_u32 s20, s7, 5120
  buffer_store_dwordx4 v[28:31], v4, s[8:11], s20 offen
  v_lshlrev_b32 v90, 16, v32
  v_and_b32 v91, 0xffff0000, v32
  v_pk_fma_f32 v[90:91], v[90:91], v[92:93], v[88:89]
  v_cvt_pk_bf16_f32 v32, v90, v91
  v_lshlrev_b32 v94, 16, v33
  v_and_b32 v95, 0xffff0000, v33
  v_pk_fma_f32 v[94:95], v[94:95], v[92:93], v[88:89]
  v_cvt_pk_bf16_f32 v33, v94, v95
  v_lshlrev_b32 v90, 16, v34
  v_and_b32 v91, 0xffff0000, v34
  v_pk_fma_f32 v[90:91], v[90:91], v[92:93], v[88:89]
  v_cvt_pk_bf16_f32 v34, v90, v91
  v_lshlrev_b32 v94, 16, v35
  v_and_b32 v95, 0xffff0000, v35
  v_pk_fma_f32 v[94:95], v[94:95], v[92:93], v[88:89]
  v_cvt_pk_bf16_f32 v35, v94, v95
  s_add_u32 s20, s7, 6144
  buffer_store_dwordx4 v[32:35], v4, s[8:11], s20 offen
  v_lshlrev_b32 v90, 16, v36
  v_and_b32 v91, 0xffff0000, v36
  v_pk_fma_f32 v[90:91], v[90:91], v[92:93], v[88:89]
  v_cvt_pk_bf16_f32 v36, v90, v91
  v_lshlrev_b32 v94, 16, v37
  v_and_b32 v95, 0xffff0000, v37
  v_pk_fma_f32 v[94:95], v[94:95], v[92:93], v[88:89]
  v_cvt_pk_bf16_f32 v37, v94, v95
  v_lshlrev_b32 v90, 16, v38
  v_and_b32 v91, 0xffff0000, v38
  v_pk_fma_f32 v[90:91], v[90:91], v[92:93], v[88:89]
  v_cvt_pk_bf16_f32 v38, v90, v91
  v_lshlrev_b32 v94, 16, v39
  v_and_b32 v95, 0xffff0000, v39
  v_pk_fma_f32 v[94:95], v[94:95], v[92:93], v[88:89]
  v_cvt_pk_bf16_f32 v39, v94, v95
  s_add_u32 s20, s7, 7168
  buffer_store_dwordx4 v[36:39], v4, s[8:11], s20 offen
  v_lshlrev_b32 v90, 16, v40
  v_and_b32 v91, 0xffff0000, v40
  v_pk_fma_f32 v[90:91], v[90:91], v[92:93], v[88:89]
  v_cvt_pk_bf16_f32 v40, v90, v91
  v_lshlrev_b32 v94, 16, v41
  v_and_b32 v95, 0xffff0000, v41
  v_pk_fma_f32 v[94:95], v[94:95], v[92:93], v[88:89]
  v_cvt_pk_bf16_f32 v41, v94, v95
  v_lshlrev_b32 v90, 16, v42
  v_and_b32 v91, 0xffff0000, v42
  v_pk_fma_f32 v[90:91], v[90:91], v[92:93], v[88:89]
  v_cvt_pk_bf16_f32 v42, v90, v91
  v_lshlrev_b32 v94, 16, v43
  v_and_b32 v95, 0xffff0000, v43
  v_pk_fma_f32 v[94:95], v[94:95], v[92:93], v[88:89]
  v_cvt_pk_bf16_f32 v43, v94, v95
  s_add_u32 s20, s7, 8192
  buffer_store_dwordx4 v[40:43], v4, s[8:11], s20 offen
  v_lshlrev_b32 v90, 16, v44
  v_and_b32 v91, 0xffff0000, v44
  v_pk_fma_f32 v[90:91], v[90:91], v[92:93], v[88:89]
  v_cvt_pk_bf16_f32 v44, v90, v91
  v_lshlrev_b32 v94, 16, v45
  v_and_b32 v95, 0xffff0000, v45
  v_pk_fma_f32 v[94:95], v[94:95], v[92:93], v[88:89]
  v_cvt_pk_bf16_f32 v45, v94, v95
  v_lshlrev_b32 v90, 16, v46
  v_and_b32 v91, 0xffff0000, v46
  v_pk_fma_f32 v[90:91], v[90:91], v[92:93], v[88:89]
  v_cvt_pk_bf16_f32 v46, v90, v91
  v_lshlrev_b32 v94, 16, v47
  v_and_b32 v95, 0xffff0000, v47
  v_pk_fma_f32 v[94:95], v[94:95], v[92:93], v[88:89]
  v_cvt_pk_bf16_f32 v47, v94, v95
  s_add_u32 s20, s7, 9216
  buffer_store_dwordx4 v[44:47], v4, s[8:11], s20 offen
  v_lshlrev_b32 v90, 16, v48
  v_and_b32 v91, 0xffff0000, v48
  v_pk_fma_f32 v[90:91], v[90:91], v[92:93], v[88:89]
  v_cvt_pk_bf16_f32 v48, v90, v91
  v_lshlrev_b32 v94, 16, v49
  v_and_b32 v95, 0xffff0000, v49
  v_pk_fma_f32 v[94:95], v[94:95], v[92:93], v[88:89]
  v_cvt_pk_bf16_f32 v49, v94, v95
  v_lshlrev_b32 v90, 16, v50
  v_and_b32 v91, 0xffff0000, v50
  v_pk_fma_f32 v[90:91], v[90:91], v[92:93], v[88:89]
  v_cvt_pk_bf16_f32 v50, v90, v91
  v_lshlrev_b32 v94, 16, v51
  v_and_b32 v95, 0xffff0000, v51
  v_pk_fma_f32 v[94:95], v[94:95], v[92:93], v[88:89]
  v_cvt_pk_bf16_f32 v51, v94, v95
  s_add_u32 s20, s7, 10240
  buffer_store_dwordx4 v[48:51], v4, s[8:11], s20 offen
  v_lshlrev_b32 v90, 16, v52
  v_and_b32 v91, 0xffff0000, v52
  v_pk_fma_f32 v[90:91], v[90:91], v[92:93], v[88:89]
  v_cvt_pk_bf16_f32 v52, v90, v91
  v_lshlrev_b32 v94, 16, v53
  v_and_b32 v95, 0xffff0000, v53
  v_pk_fma_f32 v[94:95], v[94:95], v[92:93], v[88:89]
  v_cvt_pk_bf16_f32 v53, v94, v95
  v_lshlrev_b32 v90, 16, v54
  v_and_b32 v91, 0xffff0000, v54
  v_pk_fma_f32 v[90:91], v[90:91], v[92:93], v[88:89]
  v_cvt_pk_bf16_f32 v54, v90, v91
  v_lshlrev_b32 v94, 16, v55
  v_and_b32 v95, 0xffff0000, v55
  v_pk_fma_f32 v[94:95], v[94:95], v[92:93], v[88:89]
  v_cvt_pk_bf16_f32 v55, v94, v95
  s_add_u32 s20, s7, 11264
  buffer_store_dwordx4 v[52:55], v4, s[8:11], s20 offen
  v_lshlrev_b32 v90, 16, v56
  v_and_b32 v91, 0xffff0000, v56
  v_pk_fma_f32 v[90:91], v[90:91], v[92:93], v[88:89]
  v_cvt_pk_bf16_f32 v56, v90, v91
  v_lshlrev_b32 v94, 16, v57
  v_and_b32 v95, 0xffff0000, v57
  v_pk_fma_f32 v[94:95], v[94:95], v[92:93], v[88:89]
  v_cvt_pk_bf16_f32 v57, v94, v95
  v_lshlrev_b32 v90, 16, v58
  v_and_b32 v91, 0xffff0000, v58
  v_pk_fma_f32 v[90:91], v[90:91], v[92:93], v[88:89]
  v_cvt_pk_bf16_f32 v58, v90, v91
  v_lshlrev_b32 v94, 16, v59
  v_and_b32 v95, 0xffff0000, v59
  v_pk_fma_f32 v[94:95], v[94:95], v[92:93], v[88:89]
  v_cvt_pk_bf16_f32 v59, v94, v95
  s_add_u32 s20, s7, 12288
  buffer_store_dwordx4 v[56:59], v4, s[8:11], s20 offen
  v_lshlrev_b32 v90, 16, v60
  v_and_b32 v91, 0xffff0000, v60
  v_pk_fma_f32 v[90:91], v[90:91], v[92:93], v[88:89]
  v_cvt_pk_bf16_f32 v60, v90, v91
  v_lshlrev_b32 v94, 16, v61
  v_and_b32 v95, 0xffff0000, v61
  v_pk_fma_f32 v[94:95], v[94:95], v[92:93], v[88:89]
  v_cvt_pk_bf16_f32 v61, v94, v95
  v_lshlrev_b32 v90, 16, v62
  v_and_b32 v91, 0xffff0000, v62
  v_pk_fma_f32 v[90:91], v[90:91], v[92:93], v[88:89]
  v_cvt_pk_bf16_f32 v62, v90, v91
  v_lshlrev_b32 v94, 16, v63
  v_and_b32 v95, 0xffff0000, v63
  v_pk_fma_f32 v[94:95], v[94:95], v[92:93], v[88:89]
  v_cvt_pk_bf16_f32 v63, v94, v95
  s_add_u32 s20, s7, 13312
  buffer_store_dwordx4 v[60:63], v4, s[8:11], s20 offen
  v_lshlrev_b32 v90, 16, v64
  v_and_b32 v91, 0xffff0000, v64
  v_pk_fma_f32 v[90:91], v[90:91], v[92:93], v[88:89]
  v_cvt_pk_bf16_f32 v64, v90, v91
  v_lshlrev_b32 v94, 16, v65
  v_and_b32 v95, 0xffff0000, v65
  v_pk_fma_f32 v[94:95], v[94:95], v[92:93], v[88:89]
  v_cvt_pk_bf16_f32 v65, v94, v95
  v_lshlrev_b32 v90, 16, v66
  v_and_b32 v91, 0xffff0000, v66
  v_pk_fma_f32 v[90:91], v[90:91], v[92:93], v[88:89]
  v_cvt_pk_bf16_f32 v66, v90, v91
  v_lshlrev_b32 v94, 16, v67
  v_and_b32 v95, 0xffff0000, v67
  v_pk_fma_f32 v[94:95], v[94:95], v[92:93], v[88:89]
  v_cvt_pk_bf16_f32 v67, v94, v95
  s_add_u32 s20, s7, 14336
  buffer_store_dwordx4 v[64:67], v4, s[8:11], s20 offen
  v_lshlrev_b32 v90, 16, v68
  v_and_b32 v91, 0xffff0000, v68
  v_pk_fma_f32 v[90:91], v[90:91], v[92:93], v[88:89]
  v_cvt_pk_bf16_f32 v68, v90, v91
  v_lshlrev_b32 v94, 16, v69
  v_and_b32 v95, 0xffff0000, v69
  v_pk_fma_f32 v[94:95], v[94:95], v[92:93], v[88:89]
  v_cvt_pk_bf16_f32 v69, v94, v95
  v_lshlrev_b32 v90, 16, v70
  v_and_b32 v91, 0xffff0000, v70
  v_pk_fma_f32 v[90:91], v[90:91], v[92:93], v[88:89]
  v_cvt_pk_bf16_f32 v70, v90, v91
  v_lshlrev_b32 v94, 16, v71
  v_and_b32 v95, 0xffff0000, v71
  v_pk_fma_f32 v[94:95], v[94:95], v[92:93], v[88:89]
  v_cvt_pk_bf16_f32 v71, v94, v95
  s_add_u32 s20, s7, 15360
  buffer_store_dwordx4 v[68:71], v4, s[8:11], s20 offen
  v_lshlrev_b32 v90, 16, v72
  v_and_b32 v91, 0xffff0000, v72
  v_pk_fma_f32 v[90:91], v[90:91], v[92:93], v[88:89]
  v_cvt_pk_bf16_f32 v72, v90, v91
  v_lshlrev_b32 v94, 16, v73
  v_and_b32 v95, 0xffff0000, v73
  v_pk_fma_f32 v[94:95], v[94:95], v[92:93], v[88:89]
  v_cvt_pk_bf16_f32 v73, v94, v95
  v_lshlrev_b32 v90, 16, v74
  v_and_b32 v91, 0xffff0000, v74
  v_pk_fma_f32 v[90:91], v[90:91], v[92:93], v[88:89]
  v_cvt_pk_bf16_f32 v74, v90, v91
  v_lshlrev_b32 v94, 16, v75
  v_and_b32 v95, 0xffff0000, v75
  v_pk_fma_f32 v[94:95], v[94:95], v[92:93], v[88:89]
  v_cvt_pk_bf16_f32 v75, v94, v95
  s_add_u32 s20, s7, 16384
  buffer_store_dwordx4 v[72:75], v4, s[8:11], s20 offen
  v_lshlrev_b32 v90, 16, v76
  v_and_b32 v91, 0xffff0000, v76
  v_pk_fma_f32 v[90:91], v[90:91], v[92:93], v[88:89]
  v_cvt_pk_bf16_f32 v76, v90, v91
  v_lshlrev_b32 v94, 16, v77
  v_and_b32 v95, 0xffff0000, v77
  v_pk_fma_f32 v[94:95], v[94:95], v[92:93], v[88:89]
  v_cvt_pk_bf16_f32 v77, v94, v95
  v_lshlrev_b32 v90, 16, v78
  v_and_b32 v91, 0xffff0000, v78
  v_pk_fma_f32 v[90:91], v[90:91], v[92:93], v[88:89]
  v_cvt_pk_bf16_f32 v78, v90, v91
  v_lshlrev_b32 v94, 16, v79
  v_and_b32 v95, 0xffff0000, v79
  v_pk_fma_f32 v[94:95], v[94:95], v[92:93], v[88:89]
  v_cvt_pk_bf16_f32 v79, v94, v95
  s_add_u32 s20, s7, 17408
  buffer_store_dwordx4 v[76:79], v4, s[8:11], s20 offen
  v_lshlrev_b32 v90, 16, v80
  v_and_b32 v91, 0xffff0000, v80
  v_pk_fma_f32 v[90:91], v[90:91], v[92:93], v[88:89]
  v_cvt_pk_bf16_f32 v80, v90, v91
  v_lshlrev_b32 v94, 16, v81
  v_and_b32 v95, 0xffff0000, v81
  v_pk_fma_f32 v[94:95], v[94:95], v[92:93], v[88:89]
  v_cvt_pk_bf16_f32 v81, v94, v95
  v_lshlrev_b32 v90, 16, v82
  v_and_b32 v91, 0xffff0000, v82
  v_pk_fma_f32 v[90:91], v[90:91], v[92:93], v[88:89]
  v_cvt_pk_bf16_f32 v82, v90, v91
  v_lshlrev_b32 v94, 16, v83
  v_and_b32 v95, 0xffff0000, v83
  v_pk_fma_f32 v[94:95], v[94:95], v[92:93], v[88:89]
  v_cvt_pk_bf16_f32 v83, v94, v95
  s_add_u32 s20, s7, 18432
  buffer_store_dwordx4 v[80:83], v4, s[8:11], s20 offen
  v_lshlrev_b32 v90, 16, v84
  v_and_b32 v91, 0xffff0000, v84
  v_pk_fma_f32 v[90:91], v[90:91], v[92:93], v[88:89]
  v_cvt_pk_bf16_f32 v84, v90, v91
  v_lshlrev_b32 v94, 16, v85
  v_and_b32 v95, 0xffff0000, v85
  v_pk_fma_f32 v[94:95], v[94:95], v[92:93], v[88:89]
  v_cvt_pk_bf16_f32 v85, v94, v95
  v_lshlrev_b32 v90, 16, v86
  v_and_b32 v91, 0xffff0000, v86
  v_pk_fma_f32 v[90:91], v[90:91], v[92:93], v[88:89]
  v_cvt_pk_bf16_f32 v86, v90, v91
  v_lshlrev_b32 v94, 16, v87
  v_and_b32 v95, 0xffff0000, v87
  v_pk_fma_f32 v[94:95], v[94:95], v[92:93], v[88:89]
  v_cvt_pk_bf16_f32 v87, v94, v95
  s_add_u32 s20, s7, 19456
  buffer_store_dwordx4 v[84:87], v4, s[8:11], s20 offen
ln_done:
  s_endpgm
.section .rodata,"a"
.p2align 6
.amdhsa_kernel ln_kernel
  .amdhsa_next_free_vgpr 96
  .amdhsa_next_free_sgpr 40
  .amdhsa_accum_offset 96
  .amdhsa_group_segment_fixed_size 0
  .amdhsa_kernarg_size 112
  .amdhsa_user_sgpr_count 2
  .amdhsa_user_sgpr_kernarg_segment_ptr 1
  .amdhsa_system_sgpr_workgroup_id_x 1
.end_amdhsa_kernel

.text
.globl ffn1_kernel
.p2align 8
.type ffn1_kernel,@function
ffn1_kernel:
  s_cmp_ge_u32 s2, 216
  s_cbranch_scc1 ffn1_done
  s_load_dwordx2 s[8:9], s[0:1], 104
  s_waitcnt lgkmcnt(0)
  s_and_b32 s9, s9, 0xffff
  s_mov_b32 s10, 268435456
  s_mov_b32 s11, 0x20000
  s_sub_u32 s4, s2, 0
  s_mul_i32 s6, s4, 2428
  s_lshr_b32 s6, s6, 16
  s_mul_i32 s5, s6, 27
  s_sub_u32 s5, s4, s5
  v_lshrrev_b32 v1, 6, v0
  s_nop 0
  v_readfirstlane_b32 s3, v1
  v_and_b32 v0, 63, v0
  v_lshlrev_b32 v2, 4, v0
  s_mul_i32 s7, s3, 3
  s_add_u32 s7, s7, 0
  s_cmp_lt_u32 s7, 8
  s_cbranch_scc0 ffn1_kernel_L1
  s_mul_i32 s12, s5, 8
  s_add_u32 s12, s12, s7
  s_mul_i32 s12, s12, 20480
  s_add_u32 s24, s12, 23592960
  s_branch ffn1_kernel_L2
ffn1_kernel_L1:
  s_mul_i32 s12, s6, 16
  s_add_u32 s12, s12, s7
  s_sub_u32 s12, s12, 8
  s_mul_i32 s12, s12, 20480
  s_add_u32 s24, s12, 131682304
ffn1_kernel_L2:
  s_mul_i32 s7, s3, 3
  s_add_u32 s7, s7, 1
  s_cmp_lt_u32 s7, 8
  s_cbranch_scc0 ffn1_kernel_L3
  s_mul_i32 s12, s5, 8
  s_add_u32 s12, s12, s7
  s_mul_i32 s12, s12, 20480
  s_add_u32 s25, s12, 23592960
  s_branch ffn1_kernel_L4
ffn1_kernel_L3:
  s_mul_i32 s12, s6, 16
  s_add_u32 s12, s12, s7
  s_sub_u32 s12, s12, 8
  s_mul_i32 s12, s12, 20480
  s_add_u32 s25, s12, 131682304
ffn1_kernel_L4:
  s_mul_i32 s7, s3, 3
  s_add_u32 s7, s7, 2
  s_cmp_lt_u32 s7, 8
  s_cbranch_scc0 ffn1_kernel_L5
  s_mul_i32 s12, s5, 8
  s_add_u32 s12, s12, s7
  s_mul_i32 s12, s12, 20480
  s_add_u32 s26, s12, 23592960
  s_branch ffn1_kernel_L6
ffn1_kernel_L5:
  s_mul_i32 s12, s6, 16
  s_add_u32 s12, s12, s7
  s_sub_u32 s12, s12, 8
  s_mul_i32 s12, s12, 20480
  s_add_u32 s26, s12, 131682304
ffn1_kernel_L6:
  s_mul_i32 s13, s3, 3072
  s_lshr_b32 s14, s3, 2
  s_and_b32 s15, s3, 3
  s_mul_i32 s16, s14, 4096
  s_mul_i32 s17, s15, 4096
  s_add_u32 s17, s17, 8192
  v_add_u32 v3, s16, v2
  v_add_u32 v4, s17, v2
  v_mov_b32 v5, v2
  v_add_u32 v6, 0x10000, v3
  v_add_u32 v7, 0x10000, v4
  s_add_u32 m0, s13, 0
  s_nop 0
  buffer_load_dwordx4 v5, s[8:11], s24 offen lds
  s_add_u32 m0, s13, 1024
  s_nop 0
  buffer_load_dwordx4 v5, s[8:11], s25 offen lds
  s_add_u32 m0, s13, 2048
  s_nop 0
  buffer_load_dwordx4 v5, s[8:11], s26 offen lds
  v_add_u32 v5, 1024, v5
  s_add_u32 m0, s13, 24576
  s_nop 0
  buffer_load_dwordx4 v5, s[8:11], s24 offen lds
  s_add_u32 m0, s13, 25600
  s_nop 0
  buffer_load_dwordx4 v5, s[8:11], s25 offen lds
  s_add_u32 m0, s13, 26624
  s_nop 0
  buffer_load_dwordx4 v5, s[8:11], s26 offen lds
  v_add_u32 v5, 1024, v5
  s_add_u32 m0, s13, 49152
  s_nop 0
  buffer_load_dwordx4 v5, s[8:11], s24 offen lds
  s_add_u32 m0, s13, 50176
  s_nop 0
  buffer_load_dwordx4 v5, s[8:11], s25 offen lds
  s_add_u32 m0, s13, 51200
  s_nop 0
  buffer_load_dwordx4 v5, s[8:11], s26 offen lds
  v_add_u32 v5, 1024, v5
  s_waitcnt vmcnt(6)
  s_barrier
  s_add_u32 m0, s13, 73728
  s_nop 0
  buffer_load_dwordx4 v5, s[8:11], s24 offen lds
  s_add_u32 m0, s13, 74752
  s_nop 0
  buffer_load_dwordx4 v5, s[8:11], s25 offen lds
  s_add_u32 m0, s13, 75776
  s_nop 0
  buffer_load_dwordx4 v5, s[8:11], s26 offen lds
  v_add_u32 v5, 1024, v5
  ds_read_b128 v[32:35], v4 offset:0
  ds_read_b128 v[16:19], v3 offset:0
  ds_read_b128 v[36:39], v4 offset:1024
  ds_read_b128 v[40:43], v4 offset:2048
  ds_read_b128 v[44:47], v4 offset:3072
  ds_read_b128 v[20:23], v3 offset:1024
  ds_read_b128 v[24:27], v3 offset:2048
  ds_read_b128 v[28:31], v3 offset:3072
  s_waitcnt lgkmcnt(6)
  v_mfma_f32_16x16x32_bf16 v[48:51], v[16:19], v[32:35], 0
  s_waitcnt lgkmcnt(5)
  v_mfma_f32_16x16x32_bf16 v[52:55], v[16:19], v[36:39], 0
  s_waitcnt lgkmcnt(4)
  v_mfma_f32_16x16x32_bf16 v[56:59], v[16:19], v[40:43], 0
  s_waitcnt lgkmcnt(3)
  v_mfma_f32_16x16x32_bf16 v[60:63], v[16:19], v[44:47], 0
  s_waitcnt lgkmcnt(2)
  v_mfma_f32_16x16x32_bf16 v[64:67], v[20:23], v[32:35], 0
  v_mfma_f32_16x16x32_bf16 v[68:71], v[20:23], v[36:39], 0
  v_mfma_f32_16x16x32_bf16 v[72:75], v[20:23], v[40:43], 0
  v_mfma_f32_16x16x32_bf16 v[76:79], v[20:23], v[44:47], 0
  s_waitcnt lgkmcnt(1)
  v_mfma_f32_16x16x32_bf16 v[80:83], v[24:27], v[32:35], 0
  v_mfma_f32_16x16x32_bf16 v[84:87], v[24:27], v[36:39], 0
  v_mfma_f32_16x16x32_bf16 v[88:91], v[24:27], v[40:43], 0
  v_mfma_f32_16x16x32_bf16 v[92:95], v[24:27], v[44:47], 0
  s_waitcnt lgkmcnt(0)
  v_mfma_f32_16x16x32_bf16 v[96:99], v[28:31], v[32:35], 0
  v_mfma_f32_16x16x32_bf16 v[100:103], v[28:31], v[36:39], 0
  v_mfma_f32_16x16x32_bf16 v[104:107], v[28:31], v[40:43], 0
  v_mfma_f32_16x16x32_bf16 v[108:111], v[28:31], v[44:47], 0
  s_waitcnt vmcnt(6)
  s_barrier
  s_add_u32 m0, s13, 0
  s_nop 0
  buffer_load_dwordx4 v5, s[8:11], s24 offen lds
  s_add_u32 m0, s13, 1024
  s_nop 0
  buffer_load_dwordx4 v5, s[8:11], s25 offen lds
  s_add_u32 m0, s13, 2048
  s_nop 0
  buffer_load_dwordx4 v5, s[8:11], s26 offen lds
  v_add_u32 v5, 1024, v5
  ds_read_b128 v[32:35], v4 offset:24576
  ds_read_b128 v[16:19], v3 offset:24576
  ds_read_b128 v[36:39], v4 offset:25600
  ds_read_b128 v[40:43], v4 offset:26624
  ds_read_b128 v[44:47], v4 offset:27648
  ds_read_b128 v[20:23], v3 offset:25600
  ds_read_b128 v[24:27], v3 offset:26624
  ds_read_b128 v[28:31], v3 offset:27648
  s_waitcnt lgkmcnt(6)
  v_mfma_f32_16x16x32_bf16 v[48:51], v[16:19], v[32:35], v[48:51]
  s_waitcnt lgkmcnt(5)
  v_mfma_f32_16x16x32_bf16 v[52:55], v[16:19], v[36:39], v[52:55]
  s_waitcnt lgkmcnt(4)
  v_mfma_f32_16x16x32_bf16 v[56:59], v[16:19], v[40:43], v[56:59]
  s_waitcnt lgkmcnt(3)
  v_mfma_f32_16x16x32_bf16 v[60:63], v[16:19], v[44:47], v[60:63]
  s_waitcnt lgkmcnt(2)
  v_mfma_f32_16x16x32_bf16 v[64:67], v[20:23], v[32:35], v[64:67]
  v_mfma_f32_16x16x32_bf16 v[68:71], v[20:23], v[36:39], v[68:71]
  v_mfma_f32_16x16x32_bf16 v[72:75], v[20:23], v[40:43], v[72:75]
  v_mfma_f32_16x16x32_bf16 v[76:79], v[20:23], v[44:47], v[76:79]
  s_waitcnt lgkmcnt(1)
  v_mfma_f32_16x16x32_bf16 v[80:83], v[24:27], v[32:35], v[80:83]
  v_mfma_f32_16x16x32_bf16 v[84:87], v[24:27], v[36:39], v[84:87]
  v_mfma_f32_16x16x32_bf16 v[88:91], v[24:27], v[40:43], v[88:91]
  v_mfma_f32_16x16x32_bf16 v[92:95], v[24:27], v[44:47], v[92:95]
  s_waitcnt lgkmcnt(0)
  v_mfma_f32_16x16x32_bf16 v[96:99], v[28:31], v[32:35], v[96:99]
  v_mfma_f32_16x16x32_bf16 v[100:103], v[28:31], v[36:39], v[100:103]
  v_mfma_f32_16x16x32_bf16 v[104:107], v[28:31], v[40:43], v[104:107]
  v_mfma_f32_16x16x32_bf16 v[108:111], v[28:31], v[44:47], v[108:111]
  s_waitcnt vmcnt(6)
  s_barrier
  s_add_u32 m0, s13, 24576
  s_nop 0
  buffer_load_dwordx4 v5, s[8:11], s24 offen lds
  s_add_u32 m0, s13, 25600
  s_nop 0
  buffer_load_dwordx4 v5, s[8:11], s25 offen lds
  s_add_u32 m0, s13, 26624
  s_nop 0
  buffer_load_dwordx4 v5, s[8:11], s26 offen lds
  v_add_u32 v5, 1024, v5
  ds_read_b128 v[32:35], v4 offset:49152
  ds_read_b128 v[16:19], v3 offset:49152
  ds_read_b128 v[36:39], v4 offset:50176
  ds_read_b128 v[40:43], v4 offset:51200
  ds_read_b128 v[44:47], v4 offset:52224
  ds_read_b128 v[20:23], v3 offset:50176
  ds_read_b128 v[24:27], v3 offset:51200
  ds_read_b128 v[28:31], v3 offset:52224
  s_waitcnt lgkmcnt(6)
  v_mfma_f32_16x16x32_bf16 v[48:51], v[16:19], v[32:35], v[48:51]
  s_waitcnt lgkmcnt(5)
  v_mfma_f32_16x16x32_bf16 v[52:55], v[16:19], v[36:39], v[52:55]
  s_waitcnt lgkmcnt(4)
  v_mfma_f32_16x16x32_bf16 v[56:59], v[16:19], v[40:43], v[56:59]
  s_waitcnt lgkmcnt(3)
  v_mfma_f32_16x16x32_bf16 v[60:63], v[16:19], v[44:47], v[60:63]
  s_waitcnt lgkmcnt(2)
  v_mfma_f32_16x16x32_bf16 v[64:67], v[20:23], v[32:35], v[64:67]
  v_mfma_f32_16x16x32_bf16 v[68:71], v[20:23], v[36:39], v[68:71]
  v_mfma_f32_16x16x32_bf16 v[72:75], v[20:23], v[40:43], v[72:75]
  v_mfma_f32_16x16x32_bf16 v[76:79], v[20:23], v[44:47], v[76:79]
  s_waitcnt lgkmcnt(1)
  v_mfma_f32_16x16x32_bf16 v[80:83], v[24:27], v[32:35], v[80:83]
  v_mfma_f32_16x16x32_bf16 v[84:87], v[24:27], v[36:39], v[84:87]
  v_mfma_f32_16x16x32_bf16 v[88:91], v[24:27], v[40:43], v[88:91]
  v_mfma_f32_16x16x32_bf16 v[92:95], v[24:27], v[44:47], v[92:95]
  s_waitcnt lgkmcnt(0)
  v_mfma_f32_16x16x32_bf16 v[96:99], v[28:31], v[32:35], v[96:99]
  v_mfma_f32_16x16x32_bf16 v[100:103], v[28:31], v[36:39], v[100:103]
  v_mfma_f32_16x16x32_bf16 v[104:107], v[28:31], v[40:43], v[104:107]
  v_mfma_f32_16x16x32_bf16 v[108:111], v[28:31], v[44:47], v[108:111]
  s_waitcnt vmcnt(6)
  s_barrier
  s_add_u32 m0, s13, 49152
  s_nop 0
  buffer_load_dwordx4 v5, s[8:11], s24 offen lds
  s_add_u32 m0, s13, 50176
  s_nop 0
  buffer_load_dwordx4 v5, s[8:11], s25 offen lds
  s_add_u32 m0, s13, 51200
  s_nop 0
  buffer_load_dwordx4 v5, s[8:11], s26 offen lds
  v_add_u32 v5, 1024, v5
  ds_read_b128 v[32:35], v7 offset:8192
  ds_read_b128 v[16:19], v6 offset:8192
  ds_read_b128 v[36:39], v7 offset:9216
  ds_read_b128 v[40:43], v7 offset:10240
  ds_read_b128 v[44:47], v7 offset:11264
  ds_read_b128 v[20:23], v6 offset:9216
  ds_read_b128 v[24:27], v6 offset:10240
  ds_read_b128 v[28:31], v6 offset:11264
  s_waitcnt lgkmcnt(6)
  v_mfma_f32_16x16x32_bf16 v[48:51], v[16:19], v[32:35], v[48:51]
  s_waitcnt lgkmcnt(5)
  v_mfma_f32_16x16x32_bf16 v[52:55], v[16:19], v[36:39], v[52:55]
  s_waitcnt lgkmcnt(4)
  v_mfma_f32_16x16x32_bf16 v[56:59], v[16:19], v[40:43], v[56:59]
  s_waitcnt lgkmcnt(3)
  v_mfma_f32_16x16x32_bf16 v[60:63], v[16:19], v[44:47], v[60:63]
  s_waitcnt lgkmcnt(2)
  v_mfma_f32_16x16x32_bf16 v[64:67], v[20:23], v[32:35], v[64:67]
  v_mfma_f32_16x16x32_bf16 v[68:71], v[20:23], v[36:39], v[68:71]
  v_mfma_f32_16x16x32_bf16 v[72:75], v[20:23], v[40:43], v[72:75]
  v_mfma_f32_16x16x32_bf16 v[76:79], v[20:23], v[44:47], v[76:79]
  s_waitcnt lgkmcnt(1)
  v_mfma_f32_16x16x32_bf16 v[80:83], v[24:27], v[32:35], v[80:83]
  v_mfma_f32_16x16x32_bf16 v[84:87], v[24:27], v[36:39], v[84:87]
  v_mfma_f32_16x16x32_bf16 v[88:91], v[24:27], v[40:43], v[88:91]
  v_mfma_f32_16x16x32_bf16 v[92:95], v[24:27], v[44:47], v[92:95]
  s_waitcnt lgkmcnt(0)
  v_mfma_f32_16x16x32_bf16 v[96:99], v[28:31], v[32:35], v[96:99]
  v_mfma_f32_16x16x32_bf16 v[100:103], v[28:31], v[36:39], v[100:103]
  v_mfma_f32_16x16x32_bf16 v[104:107], v[28:31], v[40:43], v[104:107]
  v_mfma_f32_16x16x32_bf16 v[108:111], v[28:31], v[44:47], v[108:111]
  s_waitcnt vmcnt(6)
  s_barrier
  s_add_u32 m0, s13, 73728
  s_nop 0
  buffer_load_dwordx4 v5, s[8:11], s24 offen lds
  s_add_u32 m0, s13, 74752
  s_nop 0
  buffer_load_dwordx4 v5, s[8:11], s25 offen lds
  s_add_u32 m0, s13, 75776
  s_nop 0
  buffer_load_dwordx4 v5, s[8:11], s26 offen lds
  v_add_u32 v5, 1024, v5
  ds_read_b128 v[32:35], v4 offset:0
  ds_read_b128 v[16:19], v3 offset:0
  ds_read_b128 v[36:39], v4 offset:1024
  ds_read_b128 v[40:43], v4 offset:2048
  ds_read_b128 v[44:47], v4 offset:3072
  ds_read_b128 v[20:23], v3 offset:1024
  ds_read_b128 v[24:27], v3 offset:2048
  ds_read_b128 v[28:31], v3 offset:3072
  s_waitcnt lgkmcnt(6)
  v_mfma_f32_16x16x32_bf16 v[48:51], v[16:19], v[32:35], v[48:51]
  s_waitcnt lgkmcnt(5)
  v_mfma_f32_16x16x32_bf16 v[52:55], v[16:19], v[36:39], v[52:55]
  s_waitcnt lgkmcnt(4)
  v_mfma_f32_16x16x32_bf16 v[56:59], v[16:19], v[40:43], v[56:59]
  s_waitcnt lgkmcnt(3)
  v_mfma_f32_16x16x32_bf16 v[60:63], v[16:19], v[44:47], v[60:63]
  s_waitcnt lgkmcnt(2)
  v_mfma_f32_16x16x32_bf16 v[64:67], v[20:23], v[32:35], v[64:67]
  v_mfma_f32_16x16x32_bf16 v[68:71], v[20:23], v[36:39], v[68:71]
  v_mfma_f32_16x16x32_bf16 v[72:75], v[20:23], v[40:43], v[72:75]
  v_mfma_f32_16x16x32_bf16 v[76:79], v[20:23], v[44:47], v[76:79]
  s_waitcnt lgkmcnt(1)
  v_mfma_f32_16x16x32_bf16 v[80:83], v[24:27], v[32:35], v[80:83]
  v_mfma_f32_16x16x32_bf16 v[84:87], v[24:27], v[36:39], v[84:87]
  v_mfma_f32_16x16x32_bf16 v[88:91], v[24:27], v[40:43], v[88:91]
  v_mfma_f32_16x16x32_bf16 v[92:95], v[24:27], v[44:47], v[92:95]
  s_waitcnt lgkmcnt(0)
  v_mfma_f32_16x16x32_bf16 v[96:99], v[28:31], v[32:35], v[96:99]
  v_mfma_f32_16x16x32_bf16 v[100:103], v[28:31], v[36:39], v[100:103]
  v_mfma_f32_16x16x32_bf16 v[104:107], v[28:31], v[40:43], v[104:107]
  v_mfma_f32_16x16x32_bf16 v[108:111], v[28:31], v[44:47], v[108:111]
  s_waitcnt vmcnt(6)
  s_barrier
  s_add_u32 m0, s13, 0
  s_nop 0
  buffer_load_dwordx4 v5, s[8:11], s24 offen lds
  s_add_u32 m0, s13, 1024
  s_nop 0
  buffer_load_dwordx4 v5, s[8:11], s25 offen lds
  s_add_u32 m0, s13, 2048
  s_nop 0
  buffer_load_dwordx4 v5, s[8:11], s26 offen lds
  v_add_u32 v5, 1024, v5
  ds_read_b128 v[32:35], v4 offset:24576
  ds_read_b128 v[16:19], v3 offset:24576
  ds_read_b128 v[36:39], v4 offset:25600
  ds_read_b128 v[40:43], v4 offset:26624
  ds_read_b128 v[44:47], v4 offset:27648
  ds_read_b128 v[20:23], v3 offset:25600
  ds_read_b128 v[24:27], v3 offset:26624
  ds_read_b128 v[28:31], v3 offset:27648
  s_waitcnt lgkmcnt(6)
  v_mfma_f32_16x16x32_bf16 v[48:51], v[16:19], v[32:35], v[48:51]
  s_waitcnt lgkmcnt(5)
  v_mfma_f32_16x16x32_bf16 v[52:55], v[16:19], v[36:39], v[52:55]
  s_waitcnt lgkmcnt(4)
  v_mfma_f32_16x16x32_bf16 v[56:59], v[16:19], v[40:43], v[56:59]
  s_waitcnt lgkmcnt(3)
  v_mfma_f32_16x16x32_bf16 v[60:63], v[16:19], v[44:47], v[60:63]
  s_waitcnt lgkmcnt(2)
  v_mfma_f32_16x16x32_bf16 v[64:67], v[20:23], v[32:35], v[64:67]
  v_mfma_f32_16x16x32_bf16 v[68:71], v[20:23], v[36:39], v[68:71]
  v_mfma_f32_16x16x32_bf16 v[72:75], v[20:23], v[40:43], v[72:75]
  v_mfma_f32_16x16x32_bf16 v[76:79], v[20:23], v[44:47], v[76:79]
  s_waitcnt lgkmcnt(1)
  v_mfma_f32_16x16x32_bf16 v[80:83], v[24:27], v[32:35], v[80:83]
  v_mfma_f32_16x16x32_bf16 v[84:87], v[24:27], v[36:39], v[84:87]
  v_mfma_f32_16x16x32_bf16 v[88:91], v[24:27], v[40:43], v[88:91]
  v_mfma_f32_16x16x32_bf16 v[92:95], v[24:27], v[44:47], v[92:95]
  s_waitcnt lgkmcnt(0)
  v_mfma_f32_16x16x32_bf16 v[96:99], v[28:31], v[32:35], v[96:99]
  v_mfma_f32_16x16x32_bf16 v[100:103], v[28:31], v[36:39], v[100:103]
  v_mfma_f32_16x16x32_bf16 v[104:107], v[28:31], v[40:43], v[104:107]
  v_mfma_f32_16x16x32_bf16 v[108:111], v[28:31], v[44:47], v[108:111]
  s_waitcnt vmcnt(6)
  s_barrier
  s_add_u32 m0, s13, 24576
  s_nop 0
  buffer_load_dwordx4 v5, s[8:11], s24 offen lds
  s_add_u32 m0, s13, 25600
  s_nop 0
  buffer_load_dwordx4 v5, s[8:11], s25 offen lds
  s_add_u32 m0, s13, 26624
  s_nop 0
  buffer_load_dwordx4 v5, s[8:11], s26 offen lds
  v_add_u32 v5, 1024, v5
  ds_read_b128 v[32:35], v4 offset:49152
  ds_read_b128 v[16:19], v3 offset:49152
  ds_read_b128 v[36:39], v4 offset:50176
  ds_read_b128 v[40:43], v4 offset:51200
  ds_read_b128 v[44:47], v4 offset:52224
  ds_read_b128 v[20:23], v3 offset:50176
  ds_read_b128 v[24:27], v3 offset:51200
  ds_read_b128 v[28:31], v3 offset:52224
  s_waitcnt lgkmcnt(6)
  v_mfma_f32_16x16x32_bf16 v[48:51], v[16:19], v[32:35], v[48:51]
  s_waitcnt lgkmcnt(5)
  v_mfma_f32_16x16x32_bf16 v[52:55], v[16:19], v[36:39], v[52:55]
  s_waitcnt lgkmcnt(4)
  v_mfma_f32_16x16x32_bf16 v[56:59], v[16:19], v[40:43], v[56:59]
  s_waitcnt lgkmcnt(3)
  v_mfma_f32_16x16x32_bf16 v[60:63], v[16:19], v[44:47], v[60:63]
  s_waitcnt lgkmcnt(2)
  v_mfma_f32_16x16x32_bf16 v[64:67], v[20:23], v[32:35], v[64:67]
  v_mfma_f32_16x16x32_bf16 v[68:71], v[20:23], v[36:39], v[68:71]
  v_mfma_f32_16x16x32_bf16 v[72:75], v[20:23], v[40:43], v[72:75]
  v_mfma_f32_16x16x32_bf16 v[76:79], v[20:23], v[44:47], v[76:79]
  s_waitcnt lgkmcnt(1)
  v_mfma_f32_16x16x32_bf16 v[80:83], v[24:27], v[32:35], v[80:83]
  v_mfma_f32_16x16x32_bf16 v[84:87], v[24:27], v[36:39], v[84:87]
  v_mfma_f32_16x16x32_bf16 v[88:91], v[24:27], v[40:43], v[88:91]
  v_mfma_f32_16x16x32_bf16 v[92:95], v[24:27], v[44:47], v[92:95]
  s_waitcnt lgkmcnt(0)
  v_mfma_f32_16x16x32_bf16 v[96:99], v[28:31], v[32:35], v[96:99]
  v_mfma_f32_16x16x32_bf16 v[100:103], v[28:31], v[36:39], v[100:103]
  v_mfma_f32_16x16x32_bf16 v[104:107], v[28:31], v[40:43], v[104:107]
  v_mfma_f32_16x16x32_bf16 v[108:111], v[28:31], v[44:47], v[108:111]
  s_waitcnt vmcnt(6)
  s_barrier
  s_add_u32 m0, s13, 49152
  s_nop 0
  buffer_load_dwordx4 v5, s[8:11], s24 offen lds
  s_add_u32 m0, s13, 50176
  s_nop 0
  buffer_load_dwordx4 v5, s[8:11], s25 offen lds
  s_add_u32 m0, s13, 51200
  s_nop 0
  buffer_load_dwordx4 v5, s[8:11], s26 offen lds
  v_add_u32 v5, 1024, v5
  ds_read_b128 v[32:35], v7 offset:8192
  ds_read_b128 v[16:19], v6 offset:8192
  ds_read_b128 v[36:39], v7 offset:9216
  ds_read_b128 v[40:43], v7 offset:10240
  ds_read_b128 v[44:47], v7 offset:11264
  ds_read_b128 v[20:23], v6 offset:9216
  ds_read_b128 v[24:27], v6 offset:10240
  ds_read_b128 v[28:31], v6 offset:11264
  s_waitcnt lgkmcnt(6)
  v_mfma_f32_16x16x32_bf16 v[48:51], v[16:19], v[32:35], v[48:51]
  s_waitcnt lgkmcnt(5)
  v_mfma_f32_16x16x32_bf16 v[52:55], v[16:19], v[36:39], v[52:55]
  s_waitcnt lgkmcnt(4)
  v_mfma_f32_16x16x32_bf16 v[56:59], v[16:19], v[40:43], v[56:59]
  s_waitcnt lgkmcnt(3)
  v_mfma_f32_16x16x32_bf16 v[60:63], v[16:19], v[44:47], v[60:63]
  s_waitcnt lgkmcnt(2)
  v_mfma_f32_16x16x32_bf16 v[64:67], v[20:23], v[32:35], v[64:67]
  v_mfma_f32_16x16x32_bf16 v[68:71], v[20:23], v[36:39], v[68:71]
  v_mfma_f32_16x16x32_bf16 v[72:75], v[20:23], v[40:43], v[72:75]
  v_mfma_f32_16x16x32_bf16 v[76:79], v[20:23], v[44:47], v[76:79]
  s_waitcnt lgkmcnt(1)
  v_mfma_f32_16x16x32_bf16 v[80:83], v[24:27], v[32:35], v[80:83]
  v_mfma_f32_16x16x32_bf16 v[84:87], v[24:27], v[36:39], v[84:87]
  v_mfma_f32_16x16x32_bf16 v[88:91], v[24:27], v[40:43], v[88:91]
  v_mfma_f32_16x16x32_bf16 v[92:95], v[24:27], v[44:47], v[92:95]
  s_waitcnt lgkmcnt(0)
  v_mfma_f32_16x16x32_bf16 v[96:99], v[28:31], v[32:35], v[96:99]
  v_mfma_f32_16x16x32_bf16 v[100:103], v[28:31], v[36:39], v[100:103]
  v_mfma_f32_16x16x32_bf16 v[104:107], v[28:31], v[40:43], v[104:107]
  v_mfma_f32_16x16x32_bf16 v[108:111], v[28:31], v[44:47], v[108:111]
  s_waitcnt vmcnt(6)
  s_barrier
  s_add_u32 m0, s13, 73728
  s_nop 0
  buffer_load_dwordx4 v5, s[8:11], s24 offen lds
  s_add_u32 m0, s13, 74752
  s_nop 0
  buffer_load_dwordx4 v5, s[8:11], s25 offen lds
  s_add_u32 m0, s13, 75776
  s_nop 0
  buffer_load_dwordx4 v5, s[8:11], s26 offen lds
  v_add_u32 v5, 1024, v5
  ds_read_b128 v[32:35], v4 offset:0
  ds_read_b128 v[16:19], v3 offset:0
  ds_read_b128 v[36:39], v4 offset:1024
  ds_read_b128 v[40:43], v4 offset:2048
  ds_read_b128 v[44:47], v4 offset:3072
  ds_read_b128 v[20:23], v3 offset:1024
  ds_read_b128 v[24:27], v3 offset:2048
  ds_read_b128 v[28:31], v3 offset:3072
  s_waitcnt lgkmcnt(6)
  v_mfma_f32_16x16x32_bf16 v[48:51], v[16:19], v[32:35], v[48:51]
  s_waitcnt lgkmcnt(5)
  v_mfma_f32_16x16x32_bf16 v[52:55], v[16:19], v[36:39], v[52:55]
  s_waitcnt lgkmcnt(4)
  v_mfma_f32_16x16x32_bf16 v[56:59], v[16:19], v[40:43], v[56:59]
  s_waitcnt lgkmcnt(3)
  v_mfma_f32_16x16x32_bf16 v[60:63], v[16:19], v[44:47], v[60:63]
  s_waitcnt lgkmcnt(2)
  v_mfma_f32_16x16x32_bf16 v[64:67], v[20:23], v[32:35], v[64:67]
  v_mfma_f32_16x16x32_bf16 v[68:71], v[20:23], v[36:39], v[68:71]
  v_mfma_f32_16x16x32_bf16 v[72:75], v[20:23], v[40:43], v[72:75]
  v_mfma_f32_16x16x32_bf16 v[76:79], v[20:23], v[44:47], v[76:79]
  s_waitcnt lgkmcnt(1)
  v_mfma_f32_16x16x32_bf16 v[80:83], v[24:27], v[32:35], v[80:83]
  v_mfma_f32_16x16x32_bf16 v[84:87], v[24:27], v[36:39], v[84:87]
  v_mfma_f32_16x16x32_bf16 v[88:91], v[24:27], v[40:43], v[88:91]
  v_mfma_f32_16x16x32_bf16 v[92:95], v[24:27], v[44:47], v[92:95]
  s_waitcnt lgkmcnt(0)
  v_mfma_f32_16x16x32_bf16 v[96:99], v[28:31], v[32:35], v[96:99]
  v_mfma_f32_16x16x32_bf16 v[100:103], v[28:31], v[36:39], v[100:103]
  v_mfma_f32_16x16x32_bf16 v[104:107], v[28:31], v[40:43], v[104:107]
  v_mfma_f32_16x16x32_bf16 v[108:111], v[28:31], v[44:47], v[108:111]
  s_waitcnt vmcnt(6)
  s_barrier
  s_add_u32 m0, s13, 0
  s_nop 0
  buffer_load_dwordx4 v5, s[8:11], s24 offen lds
  s_add_u32 m0, s13, 1024
  s_nop 0
  buffer_load_dwordx4 v5, s[8:11], s25 offen lds
  s_add_u32 m0, s13, 2048
  s_nop 0
  buffer_load_dwordx4 v5, s[8:11], s26 offen lds
  v_add_u32 v5, 1024, v5
  ds_read_b128 v[32:35], v4 offset:24576
  ds_read_b128 v[16:19], v3 offset:24576
  ds_read_b128 v[36:39], v4 offset:25600
  ds_read_b128 v[40:43], v4 offset:26624
  ds_read_b128 v[44:47], v4 offset:27648
  ds_read_b128 v[20:23], v3 offset:25600
  ds_read_b128 v[24:27], v3 offset:26624
  ds_read_b128 v[28:31], v3 offset:27648
  s_waitcnt lgkmcnt(6)
  v_mfma_f32_16x16x32_bf16 v[48:51], v[16:19], v[32:35], v[48:51]
  s_waitcnt lgkmcnt(5)
  v_mfma_f32_16x16x32_bf16 v[52:55], v[16:19], v[36:39], v[52:55]
  s_waitcnt lgkmcnt(4)
  v_mfma_f32_16x16x32_bf16 v[56:59], v[16:19], v[40:43], v[56:59]
  s_waitcnt lgkmcnt(3)
  v_mfma_f32_16x16x32_bf16 v[60:63], v[16:19], v[44:47], v[60:63]
  s_waitcnt lgkmcnt(2)
  v_mfma_f32_16x16x32_bf16 v[64:67], v[20:23], v[32:35], v[64:67]
  v_mfma_f32_16x16x32_bf16 v[68:71], v[20:23], v[36:39], v[68:71]
  v_mfma_f32_16x16x32_bf16 v[72:75], v[20:23], v[40:43], v[72:75]
  v_mfma_f32_16x16x32_bf16 v[76:79], v[20:23], v[44:47], v[76:79]
  s_waitcnt lgkmcnt(1)
  v_mfma_f32_16x16x32_bf16 v[80:83], v[24:27], v[32:35], v[80:83]
  v_mfma_f32_16x16x32_bf16 v[84:87], v[24:27], v[36:39], v[84:87]
  v_mfma_f32_16x16x32_bf16 v[88:91], v[24:27], v[40:43], v[88:91]
  v_mfma_f32_16x16x32_bf16 v[92:95], v[24:27], v[44:47], v[92:95]
  s_waitcnt lgkmcnt(0)
  v_mfma_f32_16x16x32_bf16 v[96:99], v[28:31], v[32:35], v[96:99]
  v_mfma_f32_16x16x32_bf16 v[100:103], v[28:31], v[36:39], v[100:103]
  v_mfma_f32_16x16x32_bf16 v[104:107], v[28:31], v[40:43], v[104:107]
  v_mfma_f32_16x16x32_bf16 v[108:111], v[28:31], v[44:47], v[108:111]
  s_waitcnt vmcnt(6)
  s_barrier
  s_add_u32 m0, s13, 24576
  s_nop 0
  buffer_load_dwordx4 v5, s[8:11], s24 offen lds
  s_add_u32 m0, s13, 25600
  s_nop 0
  buffer_load_dwordx4 v5, s[8:11], s25 offen lds
  s_add_u32 m0, s13, 26624
  s_nop 0
  buffer_load_dwordx4 v5, s[8:11], s26 offen lds
  v_add_u32 v5, 1024, v5
  ds_read_b128 v[32:35], v4 offset:49152
  ds_read_b128 v[16:19], v3 offset:49152
  ds_read_b128 v[36:39], v4 offset:50176
  ds_read_b128 v[40:43], v4 offset:51200
  ds_read_b128 v[44:47], v4 offset:52224
  ds_read_b128 v[20:23], v3 offset:50176
  ds_read_b128 v[24:27], v3 offset:51200
  ds_read_b128 v[28:31], v3 offset:52224
  s_waitcnt lgkmcnt(6)
  v_mfma_f32_16x16x32_bf16 v[48:51], v[16:19], v[32:35], v[48:51]
  s_waitcnt lgkmcnt(5)
  v_mfma_f32_16x16x32_bf16 v[52:55], v[16:19], v[36:39], v[52:55]
  s_waitcnt lgkmcnt(4)
  v_mfma_f32_16x16x32_bf16 v[56:59], v[16:19], v[40:43], v[56:59]
  s_waitcnt lgkmcnt(3)
  v_mfma_f32_16x16x32_bf16 v[60:63], v[16:19], v[44:47], v[60:63]
  s_waitcnt lgkmcnt(2)
  v_mfma_f32_16x16x32_bf16 v[64:67], v[20:23], v[32:35], v[64:67]
  v_mfma_f32_16x16x32_bf16 v[68:71], v[20:23], v[36:39], v[68:71]
  v_mfma_f32_16x16x32_bf16 v[72:75], v[20:23], v[40:43], v[72:75]
  v_mfma_f32_16x16x32_bf16 v[76:79], v[20:23], v[44:47], v[76:79]
  s_waitcnt lgkmcnt(1)
  v_mfma_f32_16x16x32_bf16 v[80:83], v[24:27], v[32:35], v[80:83]
  v_mfma_f32_16x16x32_bf16 v[84:87], v[24:27], v[36:39], v[84:87]
  v_mfma_f32_16x16x32_bf16 v[88:91], v[24:27], v[40:43], v[88:91]
  v_mfma_f32_16x16x32_bf16 v[92:95], v[24:27], v[44:47], v[92:95]
  s_waitcnt lgkmcnt(0)
  v_mfma_f32_16x16x32_bf16 v[96:99], v[28:31], v[32:35], v[96:99]
  v_mfma_f32_16x16x32_bf16 v[100:103], v[28:31], v[36:39], v[100:103]
  v_mfma_f32_16x16x32_bf16 v[104:107], v[28:31], v[40:43], v[104:107]
  v_mfma_f32_16x16x32_bf16 v[108:111], v[28:31], v[44:47], v[108:111]
  s_waitcnt vmcnt(6)
  s_barrier
  s_add_u32 m0, s13, 49152
  s_nop 0
  buffer_load_dwordx4 v5, s[8:11], s24 offen lds
  s_add_u32 m0, s13, 50176
  s_nop 0
  buffer_load_dwordx4 v5, s[8:11], s25 offen lds
  s_add_u32 m0, s13, 51200
  s_nop 0
  buffer_load_dwordx4 v5, s[8:11], s26 offen lds
  v_add_u32 v5, 1024, v5
  ds_read_b128 v[32:35], v7 offset:8192
  ds_read_b128 v[16:19], v6 offset:8192
  ds_read_b128 v[36:39], v7 offset:9216
  ds_read_b128 v[40:43], v7 offset:10240
  ds_read_b128 v[44:47], v7 offset:11264
  ds_read_b128 v[20:23], v6 offset:9216
  ds_read_b128 v[24:27], v6 offset:10240
  ds_read_b128 v[28:31], v6 offset:11264
  s_waitcnt lgkmcnt(6)
  v_mfma_f32_16x16x32_bf16 v[48:51], v[16:19], v[32:35], v[48:51]
  s_waitcnt lgkmcnt(5)
  v_mfma_f32_16x16x32_bf16 v[52:55], v[16:19], v[36:39], v[52:55]
  s_waitcnt lgkmcnt(4)
  v_mfma_f32_16x16x32_bf16 v[56:59], v[16:19], v[40:43], v[56:59]
  s_waitcnt lgkmcnt(3)
  v_mfma_f32_16x16x32_bf16 v[60:63], v[16:19], v[44:47], v[60:63]
  s_waitcnt lgkmcnt(2)
  v_mfma_f32_16x16x32_bf16 v[64:67], v[20:23], v[32:35], v[64:67]
  v_mfma_f32_16x16x32_bf16 v[68:71], v[20:23], v[36:39], v[68:71]
  v_mfma_f32_16x16x32_bf16 v[72:75], v[20:23], v[40:43], v[72:75]
  v_mfma_f32_16x16x32_bf16 v[76:79], v[20:23], v[44:47], v[76:79]
  s_waitcnt lgkmcnt(1)
  v_mfma_f32_16x16x32_bf16 v[80:83], v[24:27], v[32:35], v[80:83]
  v_mfma_f32_16x16x32_bf16 v[84:87], v[24:27], v[36:39], v[84:87]
  v_mfma_f32_16x16x32_bf16 v[88:91], v[24:27], v[40:43], v[88:91]
  v_mfma_f32_16x16x32_bf16 v[92:95], v[24:27], v[44:47], v[92:95]
  s_waitcnt lgkmcnt(0)
  v_mfma_f32_16x16x32_bf16 v[96:99], v[28:31], v[32:35], v[96:99]
  v_mfma_f32_16x16x32_bf16 v[100:103], v[28:31], v[36:39], v[100:103]
  v_mfma_f32_16x16x32_bf16 v[104:107], v[28:31], v[40:43], v[104:107]
  v_mfma_f32_16x16x32_bf16 v[108:111], v[28:31], v[44:47], v[108:111]
  s_waitcnt vmcnt(6)
  s_barrier
  s_add_u32 m0, s13, 73728
  s_nop 0
  buffer_load_dwordx4 v5, s[8:11], s24 offen lds
  s_add_u32 m0, s13, 74752
  s_nop 0
  buffer_load_dwordx4 v5, s[8:11], s25 offen lds
  s_add_u32 m0, s13, 75776
  s_nop 0
  buffer_load_dwordx4 v5, s[8:11], s26 offen lds
  v_add_u32 v5, 1024, v5
  ds_read_b128 v[32:35], v4 offset:0
  ds_read_b128 v[16:19], v3 offset:0
  ds_read_b128 v[36:39], v4 offset:1024
  ds_read_b128 v[40:43], v4 offset:2048
  ds_read_b128 v[44:47], v4 offset:3072
  ds_read_b128 v[20:23], v3 offset:1024
  ds_read_b128 v[24:27], v3 offset:2048
  ds_read_b128 v[28:31], v3 offset:3072
  s_waitcnt lgkmcnt(6)
  v_mfma_f32_16x16x32_bf16 v[48:51], v[16:19], v[32:35], v[48:51]
  s_waitcnt lgkmcnt(5)
  v_mfma_f32_16x16x32_bf16 v[52:55], v[16:19], v[36:39], v[52:55]
  s_waitcnt lgkmcnt(4)
  v_mfma_f32_16x16x32_bf16 v[56:59], v[16:19], v[40:43], v[56:59]
  s_waitcnt lgkmcnt(3)
  v_mfma_f32_16x16x32_bf16 v[60:63], v[16:19], v[44:47], v[60:63]
  s_waitcnt lgkmcnt(2)
  v_mfma_f32_16x16x32_bf16 v[64:67], v[20:23], v[32:35], v[64:67]
  v_mfma_f32_16x16x32_bf16 v[68:71], v[20:23], v[36:39], v[68:71]
  v_mfma_f32_16x16x32_bf16 v[72:75], v[20:23], v[40:43], v[72:75]
  v_mfma_f32_16x16x32_bf16 v[76:79], v[20:23], v[44:47], v[76:79]
  s_waitcnt lgkmcnt(1)
  v_mfma_f32_16x16x32_bf16 v[80:83], v[24:27], v[32:35], v[80:83]
  v_mfma_f32_16x16x32_bf16 v[84:87], v[24:27], v[36:39], v[84:87]
  v_mfma_f32_16x16x32_bf16 v[88:91], v[24:27], v[40:43], v[88:91]
  v_mfma_f32_16x16x32_bf16 v[92:95], v[24:27], v[44:47], v[92:95]
  s_waitcnt lgkmcnt(0)
  v_mfma_f32_16x16x32_bf16 v[96:99], v[28:31], v[32:35], v[96:99]
  v_mfma_f32_16x16x32_bf16 v[100:103], v[28:31], v[36:39], v[100:103]
  v_mfma_f32_16x16x32_bf16 v[104:107], v[28:31], v[40:43], v[104:107]
  v_mfma_f32_16x16x32_bf16 v[108:111], v[28:31], v[44:47], v[108:111]
  s_waitcnt vmcnt(6)
  s_barrier
  s_add_u32 m0, s13, 0
  s_nop 0
  buffer_load_dwordx4 v5, s[8:11], s24 offen lds
  s_add_u32 m0, s13, 1024
  s_nop 0
  buffer_load_dwordx4 v5, s[8:11], s25 offen lds
  s_add_u32 m0, s13, 2048
  s_nop 0
  buffer_load_dwordx4 v5, s[8:11], s26 offen lds
  v_add_u32 v5, 1024, v5
  ds_read_b128 v[32:35], v4 offset:24576
  ds_read_b128 v[16:19], v3 offset:24576
  ds_read_b128 v[36:39], v4 offset:25600
  ds_read_b128 v[40:43], v4 offset:26624
  ds_read_b128 v[44:47], v4 offset:27648
  ds_read_b128 v[20:23], v3 offset:25600
  ds_read_b128 v[24:27], v3 offset:26624
  ds_read_b128 v[28:31], v3 offset:27648
  s_waitcnt lgkmcnt(6)
  v_mfma_f32_16x16x32_bf16 v[48:51], v[16:19], v[32:35], v[48:51]
  s_waitcnt lgkmcnt(5)
  v_mfma_f32_16x16x32_bf16 v[52:55], v[16:19], v[36:39], v[52:55]
  s_waitcnt lgkmcnt(4)
  v_mfma_f32_16x16x32_bf16 v[56:59], v[16:19], v[40:43], v[56:59]
  s_waitcnt lgkmcnt(3)
  v_mfma_f32_16x16x32_bf16 v[60:63], v[16:19], v[44:47], v[60:63]
  s_waitcnt lgkmcnt(2)
  v_mfma_f32_16x16x32_bf16 v[64:67], v[20:23], v[32:35], v[64:67]
  v_mfma_f32_16x16x32_bf16 v[68:71], v[20:23], v[36:39], v[68:71]
  v_mfma_f32_16x16x32_bf16 v[72:75], v[20:23], v[40:43], v[72:75]
  v_mfma_f32_16x16x32_bf16 v[76:79], v[20:23], v[44:47], v[76:79]
  s_waitcnt lgkmcnt(1)
  v_mfma_f32_16x16x32_bf16 v[80:83], v[24:27], v[32:35], v[80:83]
  v_mfma_f32_16x16x32_bf16 v[84:87], v[24:27], v[36:39], v[84:87]
  v_mfma_f32_16x16x32_bf16 v[88:91], v[24:27], v[40:43], v[88:91]
  v_mfma_f32_16x16x32_bf16 v[92:95], v[24:27], v[44:47], v[92:95]
  s_waitcnt lgkmcnt(0)
  v_mfma_f32_16x16x32_bf16 v[96:99], v[28:31], v[32:35], v[96:99]
  v_mfma_f32_16x16x32_bf16 v[100:103], v[28:31], v[36:39], v[100:103]
  v_mfma_f32_16x16x32_bf16 v[104:107], v[28:31], v[40:43], v[104:107]
  v_mfma_f32_16x16x32_bf16 v[108:111], v[28:31], v[44:47], v[108:111]
  s_waitcnt vmcnt(6)
  s_barrier
  s_add_u32 m0, s13, 24576
  s_nop 0
  buffer_load_dwordx4 v5, s[8:11], s24 offen lds
  s_add_u32 m0, s13, 25600
  s_nop 0
  buffer_load_dwordx4 v5, s[8:11], s25 offen lds
  s_add_u32 m0, s13, 26624
  s_nop 0
  buffer_load_dwordx4 v5, s[8:11], s26 offen lds
  v_add_u32 v5, 1024, v5
  ds_read_b128 v[32:35], v4 offset:49152
  ds_read_b128 v[16:19], v3 offset:49152
  ds_read_b128 v[36:39], v4 offset:50176
  ds_read_b128 v[40:43], v4 offset:51200
  ds_read_b128 v[44:47], v4 offset:52224
  ds_read_b128 v[20:23], v3 offset:50176
  ds_read_b128 v[24:27], v3 offset:51200
  ds_read_b128 v[28:31], v3 offset:52224
  s_waitcnt lgkmcnt(6)
  v_mfma_f32_16x16x32_bf16 v[48:51], v[16:19], v[32:35], v[48:51]
  s_waitcnt lgkmcnt(5)
  v_mfma_f32_16x16x32_bf16 v[52:55], v[16:19], v[36:39], v[52:55]
  s_waitcnt lgkmcnt(4)
  v_mfma_f32_16x16x32_bf16 v[56:59], v[16:19], v[40:43], v[56:59]
  s_waitcnt lgkmcnt(3)
  v_mfma_f32_16x16x32_bf16 v[60:63], v[16:19], v[44:47], v[60:63]
  s_waitcnt lgkmcnt(2)
  v_mfma_f32_16x16x32_bf16 v[64:67], v[20:23], v[32:35], v[64:67]
  v_mfma_f32_16x16x32_bf16 v[68:71], v[20:23], v[36:39], v[68:71]
  v_mfma_f32_16x16x32_bf16 v[72:75], v[20:23], v[40:43], v[72:75]
  v_mfma_f32_16x16x32_bf16 v[76:79], v[20:23], v[44:47], v[76:79]
  s_waitcnt lgkmcnt(1)
  v_mfma_f32_16x16x32_bf16 v[80:83], v[24:27], v[32:35], v[80:83]
  v_mfma_f32_16x16x32_bf16 v[84:87], v[24:27], v[36:39], v[84:87]
  v_mfma_f32_16x16x32_bf16 v[88:91], v[24:27], v[40:43], v[88:91]
  v_mfma_f32_16x16x32_bf16 v[92:95], v[24:27], v[44:47], v[92:95]
  s_waitcnt lgkmcnt(0)
  v_mfma_f32_16x16x32_bf16 v[96:99], v[28:31], v[32:35], v[96:99]
  v_mfma_f32_16x16x32_bf16 v[100:103], v[28:31], v[36:39], v[100:103]
  v_mfma_f32_16x16x32_bf16 v[104:107], v[28:31], v[40:43], v[104:107]
  v_mfma_f32_16x16x32_bf16 v[108:111], v[28:31], v[44:47], v[108:111]
  s_waitcnt vmcnt(6)
  s_barrier
  s_add_u32 m0, s13, 49152
  s_nop 0
  buffer_load_dwordx4 v5, s[8:11], s24 offen lds
  s_add_u32 m0, s13, 50176
  s_nop 0
  buffer_load_dwordx4 v5, s[8:11], s25 offen lds
  s_add_u32 m0, s13, 51200
  s_nop 0
  buffer_load_dwordx4 v5, s[8:11], s26 offen lds
  v_add_u32 v5, 1024, v5
  ds_read_b128 v[32:35], v7 offset:8192
  ds_read_b128 v[16:19], v6 offset:8192
  ds_read_b128 v[36:39], v7 offset:9216
  ds_read_b128 v[40:43], v7 offset:10240
  ds_read_b128 v[44:47], v7 offset:11264
  ds_read_b128 v[20:23], v6 offset:9216
  ds_read_b128 v[24:27], v6 offset:10240
  ds_read_b128 v[28:31], v6 offset:11264
  s_waitcnt lgkmcnt(6)
  v_mfma_f32_16x16x32_bf16 v[48:51], v[16:19], v[32:35], v[48:51]
  s_waitcnt lgkmcnt(5)
  v_mfma_f32_16x16x32_bf16 v[52:55], v[16:19], v[36:39], v[52:55]
  s_waitcnt lgkmcnt(4)
  v_mfma_f32_16x16x32_bf16 v[56:59], v[16:19], v[40:43], v[56:59]
  s_waitcnt lgkmcnt(3)
  v_mfma_f32_16x16x32_bf16 v[60:63], v[16:19], v[44:47], v[60:63]
  s_waitcnt lgkmcnt(2)
  v_mfma_f32_16x16x32_bf16 v[64:67], v[20:23], v[32:35], v[64:67]
  v_mfma_f32_16x16x32_bf16 v[68:71], v[20:23], v[36:39], v[68:71]
  v_mfma_f32_16x16x32_bf16 v[72:75], v[20:23], v[40:43], v[72:75]
  v_mfma_f32_16x16x32_bf16 v[76:79], v[20:23], v[44:47], v[76:79]
  s_waitcnt lgkmcnt(1)
  v_mfma_f32_16x16x32_bf16 v[80:83], v[24:27], v[32:35], v[80:83]
  v_mfma_f32_16x16x32_bf16 v[84:87], v[24:27], v[36:39], v[84:87]
  v_mfma_f32_16x16x32_bf16 v[88:91], v[24:27], v[40:43], v[88:91]
  v_mfma_f32_16x16x32_bf16 v[92:95], v[24:27], v[44:47], v[92:95]
  s_waitcnt lgkmcnt(0)
  v_mfma_f32_16x16x32_bf16 v[96:99], v[28:31], v[32:35], v[96:99]
  v_mfma_f32_16x16x32_bf16 v[100:103], v[28:31], v[36:39], v[100:103]
  v_mfma_f32_16x16x32_bf16 v[104:107], v[28:31], v[40:43], v[104:107]
  v_mfma_f32_16x16x32_bf16 v[108:111], v[28:31], v[44:47], v[108:111]
  s_waitcnt vmcnt(6)
  s_barrier
  s_add_u32 m0, s13, 73728
  s_nop 0
  buffer_load_dwordx4 v5, s[8:11], s24 offen lds
  s_add_u32 m0, s13, 74752
  s_nop 0
  buffer_load_dwordx4 v5, s[8:11], s25 offen lds
  s_add_u32 m0, s13, 75776
  s_nop 0
  buffer_load_dwordx4 v5, s[8:11], s26 offen lds
  v_add_u32 v5, 1024, v5
  ds_read_b128 v[32:35], v4 offset:0
  ds_read_b128 v[16:19], v3 offset:0
  ds_read_b128 v[36:39], v4 offset:1024
  ds_read_b128 v[40:43], v4 offset:2048
  ds_read_b128 v[44:47], v4 offset:3072
  ds_read_b128 v[20:23], v3 offset:1024
  ds_read_b128 v[24:27], v3 offset:2048
  ds_read_b128 v[28:31], v3 offset:3072
  s_waitcnt lgkmcnt(6)
  v_mfma_f32_16x16x32_bf16 v[48:51], v[16:19], v[32:35], v[48:51]
  s_waitcnt lgkmcnt(5)
  v_mfma_f32_16x16x32_bf16 v[52:55], v[16:19], v[36:39], v[52:55]
  s_waitcnt lgkmcnt(4)
  v_mfma_f32_16x16x32_bf16 v[56:59], v[16:19], v[40:43], v[56:59]
  s_waitcnt lgkmcnt(3)
  v_mfma_f32_16x16x32_bf16 v[60:63], v[16:19], v[44:47], v[60:63]
  s_waitcnt lgkmcnt(2)
  v_mfma_f32_16x16x32_bf16 v[64:67], v[20:23], v[32:35], v[64:67]
  v_mfma_f32_16x16x32_bf16 v[68:71], v[20:23], v[36:39], v[68:71]
  v_mfma_f32_16x16x32_bf16 v[72:75], v[20:23], v[40:43], v[72:75]
  v_mfma_f32_16x16x32_bf16 v[76:79], v[20:23], v[44:47], v[76:79]
  s_waitcnt lgkmcnt(1)
  v_mfma_f32_16x16x32_bf16 v[80:83], v[24:27], v[32:35], v[80:83]
  v_mfma_f32_16x16x32_bf16 v[84:87], v[24:27], v[36:39], v[84:87]
  v_mfma_f32_16x16x32_bf16 v[88:91], v[24:27], v[40:43], v[88:91]
  v_mfma_f32_16x16x32_bf16 v[92:95], v[24:27], v[44:47], v[92:95]
  s_waitcnt lgkmcnt(0)
  v_mfma_f32_16x16x32_bf16 v[96:99], v[28:31], v[32:35], v[96:99]
  v_mfma_f32_16x16x32_bf16 v[100:103], v[28:31], v[36:39], v[100:103]
  v_mfma_f32_16x16x32_bf16 v[104:107], v[28:31], v[40:43], v[104:107]
  v_mfma_f32_16x16x32_bf16 v[108:111], v[28:31], v[44:47], v[108:111]
  s_waitcnt vmcnt(6)
  s_barrier
  ds_read_b128 v[32:35], v4 offset:24576
  ds_read_b128 v[16:19], v3 offset:24576
  ds_read_b128 v[36:39], v4 offset:25600
  ds_read_b128 v[40:43], v4 offset:26624
  ds_read_b128 v[44:47], v4 offset:27648
  ds_read_b128 v[20:23], v3 offset:25600
  ds_read_b128 v[24:27], v3 offset:26624
  ds_read_b128 v[28:31], v3 offset:27648
  s_waitcnt lgkmcnt(6)
  v_mfma_f32_16x16x32_bf16 v[48:51], v[16:19], v[32:35], v[48:51]
  s_waitcnt lgkmcnt(5)
  v_mfma_f32_16x16x32_bf16 v[52:55], v[16:19], v[36:39], v[52:55]
  s_waitcnt lgkmcnt(4)
  v_mfma_f32_16x16x32_bf16 v[56:59], v[16:19], v[40:43], v[56:59]
  s_waitcnt lgkmcnt(3)
  v_mfma_f32_16x16x32_bf16 v[60:63], v[16:19], v[44:47], v[60:63]
  s_waitcnt lgkmcnt(2)
  v_mfma_f32_16x16x32_bf16 v[64:67], v[20:23], v[32:35], v[64:67]
  v_mfma_f32_16x16x32_bf16 v[68:71], v[20:23], v[36:39], v[68:71]
  v_mfma_f32_16x16x32_bf16 v[72:75], v[20:23], v[40:43], v[72:75]
  v_mfma_f32_16x16x32_bf16 v[76:79], v[20:23], v[44:47], v[76:79]
  s_waitcnt lgkmcnt(1)
  v_mfma_f32_16x16x32_bf16 v[80:83], v[24:27], v[32:35], v[80:83]
  v_mfma_f32_16x16x32_bf16 v[84:87], v[24:27], v[36:39], v[84:87]
  v_mfma_f32_16x16x32_bf16 v[88:91], v[24:27], v[40:43], v[88:91]
  v_mfma_f32_16x16x32_bf16 v[92:95], v[24:27], v[44:47], v[92:95]
  s_waitcnt lgkmcnt(0)
  v_mfma_f32_16x16x32_bf16 v[96:99], v[28:31], v[32:35], v[96:99]
  v_mfma_f32_16x16x32_bf16 v[100:103], v[28:31], v[36:39], v[100:103]
  v_mfma_f32_16x16x32_bf16 v[104:107], v[28:31], v[40:43], v[104:107]
  v_mfma_f32_16x16x32_bf16 v[108:111], v[28:31], v[44:47], v[108:111]
  s_waitcnt vmcnt(3)
  s_barrier
  ds_read_b128 v[32:35], v4 offset:49152
  ds_read_b128 v[16:19], v3 offset:49152
  ds_read_b128 v[36:39], v4 offset:50176
  ds_read_b128 v[40:43], v4 offset:51200
  ds_read_b128 v[44:47], v4 offset:52224
  ds_read_b128 v[20:23], v3 offset:50176
  ds_read_b128 v[24:27], v3 offset:51200
  ds_read_b128 v[28:31], v3 offset:52224
  s_waitcnt lgkmcnt(6)
  v_mfma_f32_16x16x32_bf16 v[48:51], v[16:19], v[32:35], v[48:51]
  s_waitcnt lgkmcnt(5)
  v_mfma_f32_16x16x32_bf16 v[52:55], v[16:19], v[36:39], v[52:55]
  s_waitcnt lgkmcnt(4)
  v_mfma_f32_16x16x32_bf16 v[56:59], v[16:19], v[40:43], v[56:59]
  s_waitcnt lgkmcnt(3)
  v_mfma_f32_16x16x32_bf16 v[60:63], v[16:19], v[44:47], v[60:63]
  s_waitcnt lgkmcnt(2)
  v_mfma_f32_16x16x32_bf16 v[64:67], v[20:23], v[32:35], v[64:67]
  v_mfma_f32_16x16x32_bf16 v[68:71], v[20:23], v[36:39], v[68:71]
  v_mfma_f32_16x16x32_bf16 v[72:75], v[20:23], v[40:43], v[72:75]
  v_mfma_f32_16x16x32_bf16 v[76:79], v[20:23], v[44:47], v[76:79]
  s_waitcnt lgkmcnt(1)
  v_mfma_f32_16x16x32_bf16 v[80:83], v[24:27], v[32:35], v[80:83]
  v_mfma_f32_16x16x32_bf16 v[84:87], v[24:27], v[36:39], v[84:87]
  v_mfma_f32_16x16x32_bf16 v[88:91], v[24:27], v[40:43], v[88:91]
  v_mfma_f32_16x16x32_bf16 v[92:95], v[24:27], v[44:47], v[92:95]
  s_waitcnt lgkmcnt(0)
  v_mfma_f32_16x16x32_bf16 v[96:99], v[28:31], v[32:35], v[96:99]
  v_mfma_f32_16x16x32_bf16 v[100:103], v[28:31], v[36:39], v[100:103]
  v_mfma_f32_16x16x32_bf16 v[104:107], v[28:31], v[40:43], v[104:107]
  v_mfma_f32_16x16x32_bf16 v[108:111], v[28:31], v[44:47], v[108:111]
  s_waitcnt vmcnt(0)
  s_barrier
  ds_read_b128 v[32:35], v7 offset:8192
  ds_read_b128 v[16:19], v6 offset:8192
  ds_read_b128 v[36:39], v7 offset:9216
  ds_read_b128 v[40:43], v7 offset:10240
  ds_read_b128 v[44:47], v7 offset:11264
  ds_read_b128 v[20:23], v6 offset:9216
  ds_read_b128 v[24:27], v6 offset:10240
  ds_read_b128 v[28:31], v6 offset:11264
  s_waitcnt lgkmcnt(6)
  v_mfma_f32_16x16x32_bf16 v[48:51], v[16:19], v[32:35], v[48:51]
  s_waitcnt lgkmcnt(5)
  v_mfma_f32_16x16x32_bf16 v[52:55], v[16:19], v[36:39], v[52:55]
  s_waitcnt lgkmcnt(4)
  v_mfma_f32_16x16x32_bf16 v[56:59], v[16:19], v[40:43], v[56:59]
  s_waitcnt lgkmcnt(3)
  v_mfma_f32_16x16x32_bf16 v[60:63], v[16:19], v[44:47], v[60:63]
  s_waitcnt lgkmcnt(2)
  v_mfma_f32_16x16x32_bf16 v[64:67], v[20:23], v[32:35], v[64:67]
  v_mfma_f32_16x16x32_bf16 v[68:71], v[20:23], v[36:39], v[68:71]
  v_mfma_f32_16x16x32_bf16 v[72:75], v[20:23], v[40:43], v[72:75]
  v_mfma_f32_16x16x32_bf16 v[76:79], v[20:23], v[44:47], v[76:79]
  s_waitcnt lgkmcnt(1)
  v_mfma_f32_16x16x32_bf16 v[80:83], v[24:27], v[32:35], v[80:83]
  v_mfma_f32_16x16x32_bf16 v[84:87], v[24:27], v[36:39], v[84:87]
  v_mfma_f32_16x16x32_bf16 v[88:91], v[24:27], v[40:43], v[88:91]
  v_mfma_f32_16x16x32_bf16 v[92:95], v[24:27], v[44:47], v[92:95]
  s_waitcnt lgkmcnt(0)
  v_mfma_f32_16x16x32_bf16 v[96:99], v[28:31], v[32:35], v[96:99]
  v_mfma_f32_16x16x32_bf16 v[100:103], v[28:31], v[36:39], v[100:103]
  v_mfma_f32_16x16x32_bf16 v[104:107], v[28:31], v[40:43], v[104:107]
  v_mfma_f32_16x16x32_bf16 v[108:111], v[28:31], v[44:47], v[108:111]
  s_nop 15
  s_mul_i32 s18, s5, 8
  s_mul_i32 s12, s14, 4
  s_add_u32 s18, s18, s12
  s_mul_i32 s19, s6, 16
  s_mul_i32 s12, s15, 4
  s_add_u32 s19, s19, s12
  s_mov_b32 s21, 0xbfb8aa3b
  v_mul_f32 v6, s21, v48
  v_exp_f32 v6, v6
  s_nop 0
  v_add_f32 v6, 1.0, v6
  v_rcp_f32 v6, v6
  v_mul_f32 v48, v48, v80
  v_mul_f32 v48, v48, v6
  v_mul_f32 v6, s21, v49
  v_exp_f32 v6, v6
  s_nop 0
  v_add_f32 v6, 1.0, v6
  v_rcp_f32 v6, v6
  v_mul_f32 v49, v49, v81
  v_mul_f32 v49, v49, v6
  v_mul_f32 v6, s21, v50
  v_exp_f32 v6, v6
  s_nop 0
  v_add_f32 v6, 1.0, v6
  v_rcp_f32 v6, v6
  v_mul_f32 v50, v50, v82
  v_mul_f32 v50, v50, v6
  v_mul_f32 v6, s21, v51
  v_exp_f32 v6, v6
  s_nop 0
  v_add_f32 v6, 1.0, v6
  v_rcp_f32 v6, v6
  v_mul_f32 v51, v51, v83
  v_mul_f32 v51, v51, v6
  v_cvt_pk_bf16_f32 v16, v48, v49
  v_cvt_pk_bf16_f32 v17, v50, v51
  v_mul_f32 v6, s21, v64
  v_exp_f32 v6, v6
  s_nop 0
  v_add_f32 v6, 1.0, v6
  v_rcp_f32 v6, v6
  v_mul_f32 v64, v64, v96
  v_mul_f32 v64, v64, v6
  v_mul_f32 v6, s21, v65
  v_exp_f32 v6, v6
  s_nop 0
  v_add_f32 v6, 1.0, v6
  v_rcp_f32 v6, v6
  v_mul_f32 v65, v65, v97
  v_mul_f32 v65, v65, v6
  v_mul_f32 v6, s21, v66
  v_exp_f32 v6, v6
  s_nop 0
  v_add_f32 v6, 1.0, v6
  v_rcp_f32 v6, v6
  v_mul_f32 v66, v66, v98
  v_mul_f32 v66, v66, v6
  v_mul_f32 v6, s21, v67
  v_exp_f32 v6, v6
  s_nop 0
  v_add_f32 v6, 1.0, v6
  v_rcp_f32 v6, v6
  v_mul_f32 v67, v67, v99
  v_mul_f32 v67, v67, v6
  v_cvt_pk_bf16_f32 v18, v64, v65
  v_cvt_pk_bf16_f32 v19, v66, v67
  s_add_u32 s12, s19, 0
  s_mul_i32 s12, s12, 54
  s_lshr_b32 s20, s18, 2
  s_add_u32 s12, s12, s20
  s_lshl_b32 s12, s12, 10
  s_add_u32 s12, s12, 134303744
  buffer_store_dwordx4 v[16:19], v2, s[8:11], s12 offen
  v_mul_f32 v6, s21, v52
  v_exp_f32 v6, v6
  s_nop 0
  v_add_f32 v6, 1.0, v6
  v_rcp_f32 v6, v6
  v_mul_f32 v52, v52, v84
  v_mul_f32 v52, v52, v6
  v_mul_f32 v6, s21, v53
  v_exp_f32 v6, v6
  s_nop 0
  v_add_f32 v6, 1.0, v6
  v_rcp_f32 v6, v6
  v_mul_f32 v53, v53, v85
  v_mul_f32 v53, v53, v6
  v_mul_f32 v6, s21, v54
  v_exp_f32 v6, v6
  s_nop 0
  v_add_f32 v6, 1.0, v6
  v_rcp_f32 v6, v6
  v_mul_f32 v54, v54, v86
  v_mul_f32 v54, v54, v6
  v_mul_f32 v6, s21, v55
  v_exp_f32 v6, v6
  s_nop 0
  v_add_f32 v6, 1.0, v6
  v_rcp_f32 v6, v6
  v_mul_f32 v55, v55, v87
  v_mul_f32 v55, v55, v6
  v_cvt_pk_bf16_f32 v20, v52, v53
  v_cvt_pk_bf16_f32 v21, v54, v55
  v_mul_f32 v6, s21, v68
  v_exp_f32 v6, v6
  s_nop 0
  v_add_f32 v6, 1.0, v6
  v_rcp_f32 v6, v6
  v_mul_f32 v68, v68, v100
  v_mul_f32 v68, v68, v6
  v_mul_f32 v6, s21, v69
  v_exp_f32 v6, v6
  s_nop 0
  v_add_f32 v6, 1.0, v6
  v_rcp_f32 v6, v6
  v_mul_f32 v69, v69, v101
  v_mul_f32 v69, v69, v6
  v_mul_f32 v6, s21, v70
  v_exp_f32 v6, v6
  s_nop 0
  v_add_f32 v6, 1.0, v6
  v_rcp_f32 v6, v6
  v_mul_f32 v70, v70, v102
  v_mul_f32 v70, v70, v6
  v_mul_f32 v6, s21, v71
  v_exp_f32 v6, v6
  s_nop 0
  v_add_f32 v6, 1.0, v6
  v_rcp_f32 v6, v6
  v_mul_f32 v71, v71, v103
  v_mul_f32 v71, v71, v6
  v_cvt_pk_bf16_f32 v22, v68, v69
  v_cvt_pk_bf16_f32 v23, v70, v71
  s_add_u32 s12, s19, 1
  s_mul_i32 s12, s12, 54
  s_lshr_b32 s20, s18, 2
  s_add_u32 s12, s12, s20
  s_lshl_b32 s12, s12, 10
  s_add_u32 s12, s12, 134303744
  buffer_store_dwordx4 v[20:23], v2, s[8:11], s12 offen
  v_mul_f32 v6, s21, v56
  v_exp_f32 v6, v6
  s_nop 0
  v_add_f32 v6, 1.0, v6
  v_rcp_f32 v6, v6
  v_mul_f32 v56, v56, v88
  v_mul_f32 v56, v56, v6
  v_mul_f32 v6, s21, v57
  v_exp_f32 v6, v6
  s_nop 0
  v_add_f32 v6, 1.0, v6
  v_rcp_f32 v6, v6
  v_mul_f32 v57, v57, v89
  v_mul_f32 v57, v57, v6
  v_mul_f32 v6, s21, v58
  v_exp_f32 v6, v6
  s_nop 0
  v_add_f32 v6, 1.0, v6
  v_rcp_f32 v6, v6
  v_mul_f32 v58, v58, v90
  v_mul_f32 v58, v58, v6
  v_mul_f32 v6, s21, v59
  v_exp_f32 v6, v6
  s_nop 0
  v_add_f32 v6, 1.0, v6
  v_rcp_f32 v6, v6
  v_mul_f32 v59, v59, v91
  v_mul_f32 v59, v59, v6
  v_cvt_pk_bf16_f32 v24, v56, v57
  v_cvt_pk_bf16_f32 v25, v58, v59
  v_mul_f32 v6, s21, v72
  v_exp_f32 v6, v6
  s_nop 0
  v_add_f32 v6, 1.0, v6
  v_rcp_f32 v6, v6
  v_mul_f32 v72, v72, v104
  v_mul_f32 v72, v72, v6
  v_mul_f32 v6, s21, v73
  v_exp_f32 v6, v6
  s_nop 0
  v_add_f32 v6, 1.0, v6
  v_rcp_f32 v6, v6
  v_mul_f32 v73, v73, v105
  v_mul_f32 v73, v73, v6
  v_mul_f32 v6, s21, v74
  v_exp_f32 v6, v6
  s_nop 0
  v_add_f32 v6, 1.0, v6
  v_rcp_f32 v6, v6
  v_mul_f32 v74, v74, v106
  v_mul_f32 v74, v74, v6
  v_mul_f32 v6, s21, v75
  v_exp_f32 v6, v6
  s_nop 0
  v_add_f32 v6, 1.0, v6
  v_rcp_f32 v6, v6
  v_mul_f32 v75, v75, v107
  v_mul_f32 v75, v75, v6
  v_cvt_pk_bf16_f32 v26, v72, v73
  v_cvt_pk_bf16_f32 v27, v74, v75
  s_add_u32 s12, s19, 2
  s_mul_i32 s12, s12, 54
  s_lshr_b32 s20, s18, 2
  s_add_u32 s12, s12, s20
  s_lshl_b32 s12, s12, 10
  s_add_u32 s12, s12, 134303744
  buffer_store_dwordx4 v[24:27], v2, s[8:11], s12 offen
  v_mul_f32 v6, s21, v60
  v_exp_f32 v6, v6
  s_nop 0
  v_add_f32 v6, 1.0, v6
  v_rcp_f32 v6, v6
  v_mul_f32 v60, v60, v92
  v_mul_f32 v60, v60, v6
  v_mul_f32 v6, s21, v61
  v_exp_f32 v6, v6
  s_nop 0
  v_add_f32 v6, 1.0, v6
  v_rcp_f32 v6, v6
  v_mul_f32 v61, v61, v93
  v_mul_f32 v61, v61, v6
  v_mul_f32 v6, s21, v62
  v_exp_f32 v6, v6
  s_nop 0
  v_add_f32 v6, 1.0, v6
  v_rcp_f32 v6, v6
  v_mul_f32 v62, v62, v94
  v_mul_f32 v62, v62, v6
  v_mul_f32 v6, s21, v63
  v_exp_f32 v6, v6
  s_nop 0
  v_add_f32 v6, 1.0, v6
  v_rcp_f32 v6, v6
  v_mul_f32 v63, v63, v95
  v_mul_f32 v63, v63, v6
  v_cvt_pk_bf16_f32 v28, v60, v61
  v_cvt_pk_bf16_f32 v29, v62, v63
  v_mul_f32 v6, s21, v76
  v_exp_f32 v6, v6
  s_nop 0
  v_add_f32 v6, 1.0, v6
  v_rcp_f32 v6, v6
  v_mul_f32 v76, v76, v108
  v_mul_f32 v76, v76, v6
  v_mul_f32 v6, s21, v77
  v_exp_f32 v6, v6
  s_nop 0
  v_add_f32 v6, 1.0, v6
  v_rcp_f32 v6, v6
  v_mul_f32 v77, v77, v109
  v_mul_f32 v77, v77, v6
  v_mul_f32 v6, s21, v78
  v_exp_f32 v6, v6
  s_nop 0
  v_add_f32 v6, 1.0, v6
  v_rcp_f32 v6, v6
  v_mul_f32 v78, v78, v110
  v_mul_f32 v78, v78, v6
  v_mul_f32 v6, s21, v79
  v_exp_f32 v6, v6
  s_nop 0
  v_add_f32 v6, 1.0, v6
  v_rcp_f32 v6, v6
  v_mul_f32 v79, v79, v111
  v_mul_f32 v79, v79, v6
  v_cvt_pk_bf16_f32 v30, v76, v77
  v_cvt_pk_bf16_f32 v31, v78, v79
  s_add_u32 s12, s19, 3
  s_mul_i32 s12, s12, 54
  s_lshr_b32 s20, s18, 2
  s_add_u32 s12, s12, s20
  s_lshl_b32 s12, s12, 10
  s_add_u32 s12, s12, 134303744
  buffer_store_dwordx4 v[28:31], v2, s[8:11], s12 offen
  s_endpgm
ffn1_done:
  s_endpgm
.section .rodata,"a"
.p2align 6
.amdhsa_kernel ffn1_kernel
  .amdhsa_next_free_vgpr 112
  .amdhsa_next_free_sgpr 40
  .amdhsa_accum_offset 112
  .amdhsa_group_segment_fixed_size 0
  .amdhsa_kernarg_size 112
  .amdhsa_user_sgpr_count 2
  .amdhsa_user_sgpr_kernarg_segment_ptr 1
  .amdhsa_system_sgpr_workgroup_id_x 1
.end_amdhsa_kernel

.text
.globl ffn2_kernel
.p2align 8
.type ffn2_kernel,@function
ffn2_kernel:
  s_cmp_ge_u32 s2, 256
  s_cbranch_scc1 ffn2_kernel_done
  s_load_dwordx2 s[8:9], s[0:1], 104
  s_waitcnt lgkmcnt(0)
  s_and_b32 s9, s9, 0xffff
  s_mov_b32 s10, 268435456
  s_mov_b32 s11, 0x20000
  s_and_b32 s5, s2, 7
  s_lshl_b32 s5, s5, 2
  s_lshr_b32 s6, s2, 3
  s_and_b32 s6, s6, 3
  s_add_u32 s6, s5, s6
  s_lshr_b32 s5, s2, 5
  v_lshrrev_b32 v1, 6, v0
  s_nop 0
  v_readfirstlane_b32 s3, v1
  v_and_b32 v0, 63, v0
  v_lshlrev_b32 v2, 4, v0
  s_mul_i32 s12, s5, 5
  s_add_u32 s12, s12, 0
  s_mul_i32 s12, s12, 55296
  s_add_u32 s24, s12, 28016640
  s_mul_i32 s12, s5, 5
  s_add_u32 s12, s12, 1
  s_mul_i32 s12, s12, 55296
  s_add_u32 s25, s12, 28016640
  s_mul_i32 s12, s5, 5
  s_add_u32 s12, s12, 2
  s_mul_i32 s12, s12, 55296
  s_add_u32 s26, s12, 28016640
  s_mul_i32 s12, s5, 5
  s_add_u32 s12, s12, 3
  s_mul_i32 s12, s12, 55296
  s_add_u32 s27, s12, 28016640
  s_mul_i32 s12, s5, 5
  s_add_u32 s12, s12, 4
  s_mul_i32 s12, s12, 55296
  s_add_u32 s28, s12, 28016640
  s_mul_i32 s12, s6, 4
  s_add_u32 s12, s12, 0
  s_mul_i32 s12, s12, 55296
  s_add_u32 s29, s12, 134303744
  s_mul_i32 s12, s6, 4
  s_add_u32 s12, s12, 1
  s_mul_i32 s12, s12, 55296
  s_add_u32 s30, s12, 134303744
  s_mul_i32 s12, s6, 4
  s_add_u32 s12, s12, 2
  s_mul_i32 s12, s12, 55296
  s_add_u32 s31, s12, 134303744
  s_mul_i32 s12, s6, 4
  s_add_u32 s12, s12, 3
  s_mul_i32 s12, s12, 55296
  s_add_u32 s32, s12, 134303744
  s_lshl_b32 s12, s3, 10
  v_add_u32 v5, s12, v2
  s_sub_u32 s13, 57, s3
  s_lshr_b32 s13, s13, 2
  v_mov_b32 v152, 0
  v_mov_b32 v153, 0
  v_mov_b32 v154, 0
  v_mov_b32 v155, 0
  v_mov_b32 v156, 0
  v_mov_b32 v157, 0
  v_mov_b32 v158, 0
  v_mov_b32 v159, 0
  v_mov_b32 v160, 0
  v_mov_b32 v161, 0
  v_mov_b32 v162, 0
  v_mov_b32 v163, 0
  v_mov_b32 v164, 0
  v_mov_b32 v165, 0
  v_mov_b32 v166, 0
  v_mov_b32 v167, 0
  v_mov_b32 v168, 0
  v_mov_b32 v169, 0
  v_mov_b32 v170, 0
  v_mov_b32 v171, 0
  v_mov_b32 v172, 0
  v_mov_b32 v173, 0
  v_mov_b32 v174, 0
  v_mov_b32 v175, 0
  v_mov_b32 v176, 0
  v_mov_b32 v177, 0
  v_mov_b32 v178, 0
  v_mov_b32 v179, 0
  v_mov_b32 v180, 0
  v_mov_b32 v181, 0
  v_mov_b32 v182, 0
  v_mov_b32 v183, 0
  v_mov_b32 v184, 0
  v_mov_b32 v185, 0
  v_mov_b32 v186, 0
  v_mov_b32 v187, 0
  v_mov_b32 v188, 0
  v_mov_b32 v189, 0
  v_mov_b32 v190, 0
  v_mov_b32 v191, 0
  v_mov_b32 v192, 0
  v_mov_b32 v193, 0
  v_mov_b32 v194, 0
  v_mov_b32 v195, 0
  v_mov_b32 v196, 0
  v_mov_b32 v197, 0
  v_mov_b32 v198, 0
  v_mov_b32 v199, 0
  v_mov_b32 v200, 0
  v_mov_b32 v201, 0
  v_mov_b32 v202, 0
  v_mov_b32 v203, 0
  v_mov_b32 v204, 0
  v_mov_b32 v205, 0
  v_mov_b32 v206, 0
  v_mov_b32 v207, 0
  v_mov_b32 v208, 0
  v_mov_b32 v209, 0
  v_mov_b32 v210, 0
  v_mov_b32 v211, 0
  v_mov_b32 v212, 0
  v_mov_b32 v213, 0
  v_mov_b32 v214, 0
  v_mov_b32 v215, 0
  v_mov_b32 v216, 0
  v_mov_b32 v217, 0
  v_mov_b32 v218, 0
  v_mov_b32 v219, 0
  v_mov_b32 v220, 0
  v_mov_b32 v221, 0
  v_mov_b32 v222, 0
  v_mov_b32 v223, 0
  v_mov_b32 v224, 0
  v_mov_b32 v225, 0
  v_mov_b32 v226, 0
  v_mov_b32 v227, 0
  v_mov_b32 v228, 0
  v_mov_b32 v229, 0
  v_mov_b32 v230, 0
  v_mov_b32 v231, 0
  buffer_load_dwordx4 v[8:11], v5, s[8:11], s24 offen
  buffer_load_dwordx4 v[12:15], v5, s[8:11], s25 offen
  buffer_load_dwordx4 v[16:19], v5, s[8:11], s26 offen
  buffer_load_dwordx4 v[20:23], v5, s[8:11], s27 offen
  buffer_load_dwordx4 v[24:27], v5, s[8:11], s28 offen
  buffer_load_dwordx4 v[28:31], v5, s[8:11], s29 offen
  buffer_load_dwordx4 v[32:35], v5, s[8:11], s30 offen
  buffer_load_dwordx4 v[36:39], v5, s[8:11], s31 offen
  buffer_load_dwordx4 v[40:43], v5, s[8:11], s32 offen
  v_add_u32 v5, 4096, v5
  buffer_load_dwordx4 v[44:47], v5, s[8:11], s24 offen
  buffer_load_dwordx4 v[48:51], v5, s[8:11], s25 offen
  buffer_load_dwordx4 v[52:55], v5, s[8:11], s26 offen
  buffer_load_dwordx4 v[56:59], v5, s[8:11], s27 offen
  buffer_load_dwordx4 v[60:63], v5, s[8:11], s28 offen
  buffer_load_dwordx4 v[64:67], v5, s[8:11], s29 offen
  buffer_load_dwordx4 v[68:71], v5, s[8:11], s30 offen
  buffer_load_dwordx4 v[72:75], v5, s[8:11], s31 offen
  buffer_load_dwordx4 v[76:79], v5, s[8:11], s32 offen
  v_add_u32 v5, 4096, v5
  buffer_load_dwordx4 v[80:83], v5, s[8:11], s24 offen
  buffer_load_dwordx4 v[84:87], v5, s[8:11], s25 offen
  buffer_load_dwordx4 v[88:91], v5, s[8:11], s26 offen
  buffer_load_dwordx4 v[92:95], v5, s[8:11], s27 offen
  buffer_load_dwordx4 v[96:99], v5, s[8:11], s28 offen
  buffer_load_dwordx4 v[100:103], v5, s[8:11], s29 offen
  buffer_load_dwordx4 v[104:107], v5, s[8:11], s30 offen
  buffer_load_dwordx4 v[108:111], v5, s[8:11], s31 offen
  buffer_load_dwordx4 v[112:115], v5, s[8:11], s32 offen
  v_add_u32 v5, 4096, v5
ffn2_kernel_lp:
  buffer_load_dwordx4 v[116:119], v5, s[8:11], s24 offen
  buffer_load_dwordx4 v[120:123], v5, s[8:11], s25 offen
  buffer_load_dwordx4 v[124:127], v5, s[8:11], s26 offen
  buffer_load_dwordx4 v[128:131], v5, s[8:11], s27 offen
  buffer_load_dwordx4 v[132:135], v5, s[8:11], s28 offen
  buffer_load_dwordx4 v[136:139], v5, s[8:11], s29 offen
  buffer_load_dwordx4 v[140:143], v5, s[8:11], s30 offen
  buffer_load_dwordx4 v[144:147], v5, s[8:11], s31 offen
  buffer_load_dwordx4 v[148:151], v5, s[8:11], s32 offen
  v_add_u32 v5, 4096, v5
  s_waitcnt vmcnt(27)
  v_mfma_f32_16x16x32_bf16 v[152:155], v[8:11], v[28:31], v[152:155]
  v_mfma_f32_16x16x32_bf16 v[156:159], v[8:11], v[32:35], v[156:159]
  v_mfma_f32_16x16x32_bf16 v[160:163], v[8:11], v[36:39], v[160:163]
  v_mfma_f32_16x16x32_bf16 v[164:167], v[8:11], v[40:43], v[164:167]
  v_mfma_f32_16x16x32_bf16 v[168:171], v[12:15], v[28:31], v[168:171]
  v_mfma_f32_16x16x32_bf16 v[172:175], v[12:15], v[32:35], v[172:175]
  v_mfma_f32_16x16x32_bf16 v[176:179], v[12:15], v[36:39], v[176:179]
  v_mfma_f32_16x16x32_bf16 v[180:183], v[12:15], v[40:43], v[180:183]
  v_mfma_f32_16x16x32_bf16 v[184:187], v[16:19], v[28:31], v[184:187]
  v_mfma_f32_16x16x32_bf16 v[188:191], v[16:19], v[32:35], v[188:191]
  v_mfma_f32_16x16x32_bf16 v[192:195], v[16:19], v[36:39], v[192:195]
  v_mfma_f32_16x16x32_bf16 v[196:199], v[16:19], v[40:43], v[196:199]
  v_mfma_f32_16x16x32_bf16 v[200:203], v[20:23], v[28:31], v[200:203]
  v_mfma_f32_16x16x32_bf16 v[204:207], v[20:23], v[32:35], v[204:207]
  v_mfma_f32_16x16x32_bf16 v[208:211], v[20:23], v[36:39], v[208:211]
  v_mfma_f32_16x16x32_bf16 v[212:215], v[20:23], v[40:43], v[212:215]
  v_mfma_f32_16x16x32_bf16 v[216:219], v[24:27], v[28:31], v[216:219]
  v_mfma_f32_16x16x32_bf16 v[220:223], v[24:27], v[32:35], v[220:223]
  v_mfma_f32_16x16x32_bf16 v[224:227], v[24:27], v[36:39], v[224:227]
  v_mfma_f32_16x16x32_bf16 v[228:231], v[24:27], v[40:43], v[228:231]
  s_sub_u32 s13, s13, 1
  s_cmp_eq_u32 s13, 0
  s_cbranch_scc1 ffn2_kernel_fin
  buffer_load_dwordx4 v[8:11], v5, s[8:11], s24 offen
  buffer_load_dwordx4 v[12:15], v5, s[8:11], s25 offen
  buffer_load_dwordx4 v[16:19], v5, s[8:11], s26 offen
  buffer_load_dwordx4 v[20:23], v5, s[8:11], s27 offen
  buffer_load_dwordx4 v[24:27], v5, s[8:11], s28 offen
  buffer_load_dwordx4 v[28:31], v5, s[8:11], s29 offen
  buffer_load_dwordx4 v[32:35], v5, s[8:11], s30 offen
  buffer_load_dwordx4 v[36:39], v5, s[8:11], s31 offen
  buffer_load_dwordx4 v[40:43], v5, s[8:11], s32 offen
  v_add_u32 v5, 4096, v5
  s_waitcnt vmcnt(27)
  v_mfma_f32_16x16x32_bf16 v[152:155], v[44:47], v[64:67], v[152:155]
  v_mfma_f32_16x16x32_bf16 v[156:159], v[44:47], v[68:71], v[156:159]
  v_mfma_f32_16x16x32_bf16 v[160:163], v[44:47], v[72:75], v[160:163]
  v_mfma_f32_16x16x32_bf16 v[164:167], v[44:47], v[76:79], v[164:167]
  v_mfma_f32_16x16x32_bf16 v[168:171], v[48:51], v[64:67], v[168:171]
  v_mfma_f32_16x16x32_bf16 v[172:175], v[48:51], v[68:71], v[172:175]
  v_mfma_f32_16x16x32_bf16 v[176:179], v[48:51], v[72:75], v[176:179]
  v_mfma_f32_16x16x32_bf16 v[180:183], v[48:51], v[76:79], v[180:183]
  v_mfma_f32_16x16x32_bf16 v[184:187], v[52:55], v[64:67], v[184:187]
  v_mfma_f32_16x16x32_bf16 v[188:191], v[52:55], v[68:71], v[188:191]
  v_mfma_f32_16x16x32_bf16 v[192:195], v[52:55], v[72:75], v[192:195]
  v_mfma_f32_16x16x32_bf16 v[196:199], v[52:55], v[76:79], v[196:199]
  v_mfma_f32_16x16x32_bf16 v[200:203], v[56:59], v[64:67], v[200:203]
  v_mfma_f32_16x16x32_bf16 v[204:207], v[56:59], v[68:71], v[204:207]
  v_mfma_f32_16x16x32_bf16 v[208:211], v[56:59], v[72:75], v[208:211]
  v_mfma_f32_16x16x32_bf16 v[212:215], v[56:59], v[76:79], v[212:215]
  v_mfma_f32_16x16x32_bf16 v[216:219], v[60:63], v[64:67], v[216:219]
  v_mfma_f32_16x16x32_bf16 v[220:223], v[60:63], v[68:71], v[220:223]
  v_mfma_f32_16x16x32_bf16 v[224:227], v[60:63], v[72:75], v[224:227]
  v_mfma_f32_16x16x32_bf16 v[228:231], v[60:63], v[76:79], v[228:231]
  s_sub_u32 s13, s13, 1
  s_cmp_eq_u32 s13, 0
  s_cbranch_scc1 ffn2_kernel_fin
  buffer_load_dwordx4 v[44:47], v5, s[8:11], s24 offen
  buffer_load_dwordx4 v[48:51], v5, s[8:11], s25 offen
  buffer_load_dwordx4 v[52:55], v5, s[8:11], s26 offen
  buffer_load_dwordx4 v[56:59], v5, s[8:11], s27 offen
  buffer_load_dwordx4 v[60:63], v5, s[8:11], s28 offen
  buffer_load_dwordx4 v[64:67], v5, s[8:11], s29 offen
  buffer_load_dwordx4 v[68:71], v5, s[8:11], s30 offen
  buffer_load_dwordx4 v[72:75], v5, s[8:11], s31 offen
  buffer_load_dwordx4 v[76:79], v5, s[8:11], s32 offen
  v_add_u32 v5, 4096, v5
  s_waitcnt vmcnt(27)
  v_mfma_f32_16x16x32_bf16 v[152:155], v[80:83], v[100:103], v[152:155]
  v_mfma_f32_16x16x32_bf16 v[156:159], v[80:83], v[104:107], v[156:159]
  v_mfma_f32_16x16x32_bf16 v[160:163], v[80:83], v[108:111], v[160:163]
  v_mfma_f32_16x16x32_bf16 v[164:167], v[80:83], v[112:115], v[164:167]
  v_mfma_f32_16x16x32_bf16 v[168:171], v[84:87], v[100:103], v[168:171]
  v_mfma_f32_16x16x32_bf16 v[172:175], v[84:87], v[104:107], v[172:175]
  v_mfma_f32_16x16x32_bf16 v[176:179], v[84:87], v[108:111], v[176:179]
  v_mfma_f32_16x16x32_bf16 v[180:183], v[84:87], v[112:115], v[180:183]
  v_mfma_f32_16x16x32_bf16 v[184:187], v[88:91], v[100:103], v[184:187]
  v_mfma_f32_16x16x32_bf16 v[188:191], v[88:91], v[104:107], v[188:191]
  v_mfma_f32_16x16x32_bf16 v[192:195], v[88:91], v[108:111], v[192:195]
  v_mfma_f32_16x16x32_bf16 v[196:199], v[88:91], v[112:115], v[196:199]
  v_mfma_f32_16x16x32_bf16 v[200:203], v[92:95], v[100:103], v[200:203]
  v_mfma_f32_16x16x32_bf16 v[204:207], v[92:95], v[104:107], v[204:207]
  v_mfma_f32_16x16x32_bf16 v[208:211], v[92:95], v[108:111], v[208:211]
  v_mfma_f32_16x16x32_bf16 v[212:215], v[92:95], v[112:115], v[212:215]
  v_mfma_f32_16x16x32_bf16 v[216:219], v[96:99], v[100:103], v[216:219]
  v_mfma_f32_16x16x32_bf16 v[220:223], v[96:99], v[104:107], v[220:223]
  v_mfma_f32_16x16x32_bf16 v[224:227], v[96:99], v[108:111], v[224:227]
  v_mfma_f32_16x16x32_bf16 v[228:231], v[96:99], v[112:115], v[228:231]
  s_sub_u32 s13, s13, 1
  s_cmp_eq_u32 s13, 0
  s_cbranch_scc1 ffn2_kernel_fin
  buffer_load_dwordx4 v[80:83], v5, s[8:11], s24 offen
  buffer_load_dwordx4 v[84:87], v5, s[8:11], s25 offen
  buffer_load_dwordx4 v[88:91], v5, s[8:11], s26 offen
  buffer_load_dwordx4 v[92:95], v5, s[8:11], s27 offen
  buffer_load_dwordx4 v[96:99], v5, s[8:11], s28 offen
  buffer_load_dwordx4 v[100:103], v5, s[8:11], s29 offen
  buffer_load_dwordx4 v[104:107], v5, s[8:11], s30 offen
  buffer_load_dwordx4 v[108:111], v5, s[8:11], s31 offen
  buffer_load_dwordx4 v[112:115], v5, s[8:11], s32 offen
  v_add_u32 v5, 4096, v5
  s_waitcnt vmcnt(27)
  v_mfma_f32_16x16x32_bf16 v[152:155], v[116:119], v[136:139], v[152:155]
  v_mfma_f32_16x16x32_bf16 v[156:159], v[116:119], v[140:143], v[156:159]
  v_mfma_f32_16x16x32_bf16 v[160:163], v[116:119], v[144:147], v[160:163]
  v_mfma_f32_16x16x32_bf16 v[164:167], v[116:119], v[148:151], v[164:167]
  v_mfma_f32_16x16x32_bf16 v[168:171], v[120:123], v[136:139], v[168:171]
  v_mfma_f32_16x16x32_bf16 v[172:175], v[120:123], v[140:143], v[172:175]
  v_mfma_f32_16x16x32_bf16 v[176:179], v[120:123], v[144:147], v[176:179]
  v_mfma_f32_16x16x32_bf16 v[180:183], v[120:123], v[148:151], v[180:183]
  v_mfma_f32_16x16x32_bf16 v[184:187], v[124:127], v[136:139], v[184:187]
  v_mfma_f32_16x16x32_bf16 v[188:191], v[124:127], v[140:143], v[188:191]
  v_mfma_f32_16x16x32_bf16 v[192:195], v[124:127], v[144:147], v[192:195]
  v_mfma_f32_16x16x32_bf16 v[196:199], v[124:127], v[148:151], v[196:199]
  v_mfma_f32_16x16x32_bf16 v[200:203], v[128:131], v[136:139], v[200:203]
  v_mfma_f32_16x16x32_bf16 v[204:207], v[128:131], v[140:143], v[204:207]
  v_mfma_f32_16x16x32_bf16 v[208:211], v[128:131], v[144:147], v[208:211]
  v_mfma_f32_16x16x32_bf16 v[212:215], v[128:131], v[148:151], v[212:215]
  v_mfma_f32_16x16x32_bf16 v[216:219], v[132:135], v[136:139], v[216:219]
  v_mfma_f32_16x16x32_bf16 v[220:223], v[132:135], v[140:143], v[220:223]
  v_mfma_f32_16x16x32_bf16 v[224:227], v[132:135], v[144:147], v[224:227]
  v_mfma_f32_16x16x32_bf16 v[228:231], v[132:135], v[148:151], v[228:231]
  s_sub_u32 s13, s13, 1
  s_cmp_eq_u32 s13, 0
  s_cbranch_scc1 ffn2_kernel_fin
  s_branch ffn2_kernel_lp
ffn2_kernel_fin:
  s_nop 15
  s_waitcnt vmcnt(0)
  s_cmp_eq_u32 s3, 0
  s_cbranch_scc1 ffn2_kernel_sk1
  s_sub_u32 s12, s3, 1
  s_and_b32 s12, s12, 3
  s_add_u32 s12, s12, 0
  s_mul_i32 s12, s12, 5120
  v_add_u32 v3, s12, v2
  ds_write_b128 v3, v[152:155] offset:0
  ds_write_b128 v3, v[168:171] offset:1024
  ds_write_b128 v3, v[184:187] offset:2048
  ds_write_b128 v3, v[200:203] offset:3072
  ds_write_b128 v3, v[216:219] offset:4096
ffn2_kernel_sk1:
  s_cmp_eq_u32 s3, 1
  s_cbranch_scc1 ffn2_kernel_sk2
  s_sub_u32 s12, s3, 2
  s_and_b32 s12, s12, 3
  s_add_u32 s12, s12, 3
  s_mul_i32 s12, s12, 5120
  v_add_u32 v3, s12, v2
  ds_write_b128 v3, v[156:159] offset:0
  ds_write_b128 v3, v[172:175] offset:1024
  ds_write_b128 v3, v[188:191] offset:2048
  ds_write_b128 v3, v[204:207] offset:3072
  ds_write_b128 v3, v[220:223] offset:4096
ffn2_kernel_sk2:
  s_cmp_eq_u32 s3, 2
  s_cbranch_scc1 ffn2_kernel_sk3
  s_sub_u32 s12, s3, 3
  s_and_b32 s12, s12, 3
  s_add_u32 s12, s12, 6
  s_mul_i32 s12, s12, 5120
  v_add_u32 v3, s12, v2
  ds_write_b128 v3, v[160:163] offset:0
  ds_write_b128 v3, v[176:179] offset:1024
  ds_write_b128 v3, v[192:195] offset:2048
  ds_write_b128 v3, v[208:211] offset:3072
  ds_write_b128 v3, v[224:227] offset:4096
ffn2_kernel_sk3:
  s_cmp_eq_u32 s3, 3
  s_cbranch_scc1 ffn2_kernel_sk4
  s_sub_u32 s12, s3, 4
  s_and_b32 s12, s12, 3
  s_add_u32 s12, s12, 9
  s_mul_i32 s12, s12, 5120
  v_add_u32 v3, s12, v2
  ds_write_b128 v3, v[164:167] offset:0
  ds_write_b128 v3, v[180:183] offset:1024
  ds_write_b128 v3, v[196:199] offset:2048
  ds_write_b128 v3, v[212:215] offset:3072
  ds_write_b128 v3, v[228:231] offset:4096
ffn2_kernel_sk4:
  s_waitcnt lgkmcnt(0)
  s_barrier
  s_cmp_eq_u32 s3, 0
  s_cbranch_scc0 ffn2_kernel_sk5
  v_mov_b32 v8, v152
  v_mov_b32 v9, v153
  v_mov_b32 v10, v154
  v_mov_b32 v11, v155
  v_mov_b32 v12, v168
  v_mov_b32 v13, v169
  v_mov_b32 v14, v170
  v_mov_b32 v15, v171
  v_mov_b32 v16, v184
  v_mov_b32 v17, v185
  v_mov_b32 v18, v186
  v_mov_b32 v19, v187
  v_mov_b32 v20, v200
  v_mov_b32 v21, v201
  v_mov_b32 v22, v202
  v_mov_b32 v23, v203
  v_mov_b32 v24, v216
  v_mov_b32 v25, v217
  v_mov_b32 v26, v218
  v_mov_b32 v27, v219
ffn2_kernel_sk5:
  s_cmp_eq_u32 s3, 1
  s_cbranch_scc0 ffn2_kernel_sk6
  v_mov_b32 v8, v156
  v_mov_b32 v9, v157
  v_mov_b32 v10, v158
  v_mov_b32 v11, v159
  v_mov_b32 v12, v172
  v_mov_b32 v13, v173
  v_mov_b32 v14, v174
  v_mov_b32 v15, v175
  v_mov_b32 v16, v188
  v_mov_b32 v17, v189
  v_mov_b32 v18, v190
  v_mov_b32 v19, v191
  v_mov_b32 v20, v204
  v_mov_b32 v21, v205
  v_mov_b32 v22, v206
  v_mov_b32 v23, v207
  v_mov_b32 v24, v220
  v_mov_b32 v25, v221
  v_mov_b32 v26, v222
  v_mov_b32 v27, v223
ffn2_kernel_sk6:
  s_cmp_eq_u32 s3, 2
  s_cbranch_scc0 ffn2_kernel_sk7
  v_mov_b32 v8, v160
  v_mov_b32 v9, v161
  v_mov_b32 v10, v162
  v_mov_b32 v11, v163
  v_mov_b32 v12, v176
  v_mov_b32 v13, v177
  v_mov_b32 v14, v178
  v_mov_b32 v15, v179
  v_mov_b32 v16, v192
  v_mov_b32 v17, v193
  v_mov_b32 v18, v194
  v_mov_b32 v19, v195
  v_mov_b32 v20, v208
  v_mov_b32 v21, v209
  v_mov_b32 v22, v210
  v_mov_b32 v23, v211
  v_mov_b32 v24, v224
  v_mov_b32 v25, v225
  v_mov_b32 v26, v226
  v_mov_b32 v27, v227
ffn2_kernel_sk7:
  s_cmp_eq_u32 s3, 3
  s_cbranch_scc0 ffn2_kernel_sk8
  v_mov_b32 v8, v164
  v_mov_b32 v9, v165
  v_mov_b32 v10, v166
  v_mov_b32 v11, v167
  v_mov_b32 v12, v180
  v_mov_b32 v13, v181
  v_mov_b32 v14, v182
  v_mov_b32 v15, v183
  v_mov_b32 v16, v196
  v_mov_b32 v17, v197
  v_mov_b32 v18, v198
  v_mov_b32 v19, v199
  v_mov_b32 v20, v212
  v_mov_b32 v21, v213
  v_mov_b32 v22, v214
  v_mov_b32 v23, v215
  v_mov_b32 v24, v228
  v_mov_b32 v25, v229
  v_mov_b32 v26, v230
  v_mov_b32 v27, v231
ffn2_kernel_sk8:
  s_mul_i32 s12, s3, 15360
  v_add_u32 v3, s12, v2
  ds_read_b128 v[28:31], v3 offset:0
  ds_read_b128 v[32:35], v3 offset:1024
  ds_read_b128 v[36:39], v3 offset:2048
  ds_read_b128 v[40:43], v3 offset:3072
  ds_read_b128 v[44:47], v3 offset:4096
  ds_read_b128 v[48:51], v3 offset:5120
  ds_read_b128 v[52:55], v3 offset:6144
  ds_read_b128 v[56:59], v3 offset:7168
  ds_read_b128 v[60:63], v3 offset:8192
  ds_read_b128 v[64:67], v3 offset:9216
  ds_read_b128 v[68:71], v3 offset:10240
  ds_read_b128 v[72:75], v3 offset:11264
  ds_read_b128 v[76:79], v3 offset:12288
  ds_read_b128 v[80:83], v3 offset:13312
  ds_read_b128 v[84:87], v3 offset:14336
  s_load_dwordx2 s[12:13], s[0:1], 104
  s_waitcnt lgkmcnt(0)
  s_add_u32 s12, s12, 129060864
  s_addc_u32 s13, s13, 0
  s_and_b32 s13, s13, 0xffff
  s_mov_b32 s14, 2621440
  s_mov_b32 s15, 0x20000
  s_load_dwordx2 s[16:17], s[0:1], 88
  s_waitcnt lgkmcnt(0)
  s_and_b32 s17, s17, 0xffff
  s_mov_b32 s18, 2621440
  s_mov_b32 s19, 0x20000
  s_lshl_b32 s22, s6, 2
  s_add_u32 s22, s22, s3
  s_mul_i32 s22, s22, 20480
  v_and_b32 v3, 15, v0
  v_mul_u32_u24 v3, 1280, v3
  v_lshrrev_b32 v4, 4, v0
  v_lshl_add_u32 v3, v4, 4, v3
  v_add_u32 v3, s22, v3
  s_mul_i32 s20, s5, 5
  s_add_u32 s20, s20, 0
  s_lshr_b32 s21, s20, 1
  s_lshl_b32 s21, s21, 6
  s_and_b32 s20, s20, 1
  s_lshl_b32 s20, s20, 3
  s_add_u32 s24, s20, s21
  buffer_load_dwordx2 v[88:89], v3, s[12:15], s24 offen
  s_mul_i32 s20, s5, 5
  s_add_u32 s20, s20, 1
  s_lshr_b32 s21, s20, 1
  s_lshl_b32 s21, s21, 6
  s_and_b32 s20, s20, 1
  s_lshl_b32 s20, s20, 3
  s_add_u32 s25, s20, s21
  buffer_load_dwordx2 v[90:91], v3, s[12:15], s25 offen
  s_mul_i32 s20, s5, 5
  s_add_u32 s20, s20, 2
  s_lshr_b32 s21, s20, 1
  s_lshl_b32 s21, s21, 6
  s_and_b32 s20, s20, 1
  s_lshl_b32 s20, s20, 3
  s_add_u32 s26, s20, s21
  buffer_load_dwordx2 v[92:93], v3, s[12:15], s26 offen
  s_mul_i32 s20, s5, 5
  s_add_u32 s20, s20, 3
  s_lshr_b32 s21, s20, 1
  s_lshl_b32 s21, s21, 6
  s_and_b32 s20, s20, 1
  s_lshl_b32 s20, s20, 3
  s_add_u32 s27, s20, s21
  buffer_load_dwordx2 v[94:95], v3, s[12:15], s27 offen
  s_mul_i32 s20, s5, 5
  s_add_u32 s20, s20, 4
  s_lshr_b32 s21, s20, 1
  s_lshl_b32 s21, s21, 6
  s_and_b32 s20, s20, 1
  s_lshl_b32 s20, s20, 3
  s_add_u32 s28, s20, s21
  buffer_load_dwordx2 v[96:97], v3, s[12:15], s28 offen
  s_waitcnt lgkmcnt(0)
  v_add_f32 v8, v8, v28
  v_add_f32 v9, v9, v29
  v_add_f32 v10, v10, v30
  v_add_f32 v11, v11, v31
  v_add_f32 v12, v12, v32
  v_add_f32 v13, v13, v33
  v_add_f32 v14, v14, v34
  v_add_f32 v15, v15, v35
  v_add_f32 v16, v16, v36
  v_add_f32 v17, v17, v37
  v_add_f32 v18, v18, v38
  v_add_f32 v19, v19, v39
  v_add_f32 v20, v20, v40
  v_add_f32 v21, v21, v41
  v_add_f32 v22, v22, v42
  v_add_f32 v23, v23, v43
  v_add_f32 v24, v24, v44
  v_add_f32 v25, v25, v45
  v_add_f32 v26, v26, v46
  v_add_f32 v27, v27, v47
  v_add_f32 v8, v8, v48
  v_add_f32 v9, v9, v49
  v_add_f32 v10, v10, v50
  v_add_f32 v11, v11, v51
  v_add_f32 v12, v12, v52
  v_add_f32 v13, v13, v53
  v_add_f32 v14, v14, v54
  v_add_f32 v15, v15, v55
  v_add_f32 v16, v16, v56
  v_add_f32 v17, v17, v57
  v_add_f32 v18, v18, v58
  v_add_f32 v19, v19, v59
  v_add_f32 v20, v20, v60
  v_add_f32 v21, v21, v61
  v_add_f32 v22, v22, v62
  v_add_f32 v23, v23, v63
  v_add_f32 v24, v24, v64
  v_add_f32 v25, v25, v65
  v_add_f32 v26, v26, v66
  v_add_f32 v27, v27, v67
  v_add_f32 v8, v8, v68
  v_add_f32 v9, v9, v69
  v_add_f32 v10, v10, v70
  v_add_f32 v11, v11, v71
  v_add_f32 v12, v12, v72
  v_add_f32 v13, v13, v73
  v_add_f32 v14, v14, v74
  v_add_f32 v15, v15, v75
  v_add_f32 v16, v16, v76
  v_add_f32 v17, v17, v77
  v_add_f32 v18, v18, v78
  v_add_f32 v19, v19, v79
  v_add_f32 v20, v20, v80
  v_add_f32 v21, v21, v81
  v_add_f32 v22, v22, v82
  v_add_f32 v23, v23, v83
  v_add_f32 v24, v24, v84
  v_add_f32 v25, v25, v85
  v_add_f32 v26, v26, v86
  v_add_f32 v27, v27, v87
  s_waitcnt vmcnt(0)
  v_cvt_pk_bf16_f32 v8, v8, v9
  v_cvt_pk_bf16_f32 v9, v10, v11
  v_lshlrev_b32 v4, 16, v8
  v_and_b32 v5, 0xffff0000, v8
  v_lshlrev_b32 v6, 16, v88
  v_and_b32 v7, 0xffff0000, v88
  v_add_f32 v4, v4, v6
  v_add_f32 v5, v5, v7
  v_cvt_pk_bf16_f32 v88, v4, v5
  v_lshlrev_b32 v4, 16, v9
  v_and_b32 v5, 0xffff0000, v9
  v_lshlrev_b32 v6, 16, v89
  v_and_b32 v7, 0xffff0000, v89
  v_add_f32 v4, v4, v6
  v_add_f32 v5, v5, v7
  v_cvt_pk_bf16_f32 v89, v4, v5
  buffer_store_dwordx2 v[88:89], v3, s[16:19], s24 offen
  v_cvt_pk_bf16_f32 v12, v12, v13
  v_cvt_pk_bf16_f32 v13, v14, v15
  v_lshlrev_b32 v4, 16, v12
  v_and_b32 v5, 0xffff0000, v12
  v_lshlrev_b32 v6, 16, v90
  v_and_b32 v7, 0xffff0000, v90
  v_add_f32 v4, v4, v6
  v_add_f32 v5, v5, v7
  v_cvt_pk_bf16_f32 v90, v4, v5
  v_lshlrev_b32 v4, 16, v13
  v_and_b32 v5, 0xffff0000, v13
  v_lshlrev_b32 v6, 16, v91
  v_and_b32 v7, 0xffff0000, v91
  v_add_f32 v4, v4, v6
  v_add_f32 v5, v5, v7
  v_cvt_pk_bf16_f32 v91, v4, v5
  buffer_store_dwordx2 v[90:91], v3, s[16:19], s25 offen
  v_cvt_pk_bf16_f32 v16, v16, v17
  v_cvt_pk_bf16_f32 v17, v18, v19
  v_lshlrev_b32 v4, 16, v16
  v_and_b32 v5, 0xffff0000, v16
  v_lshlrev_b32 v6, 16, v92
  v_and_b32 v7, 0xffff0000, v92
  v_add_f32 v4, v4, v6
  v_add_f32 v5, v5, v7
  v_cvt_pk_bf16_f32 v92, v4, v5
  v_lshlrev_b32 v4, 16, v17
  v_and_b32 v5, 0xffff0000, v17
  v_lshlrev_b32 v6, 16, v93
  v_and_b32 v7, 0xffff0000, v93
  v_add_f32 v4, v4, v6
  v_add_f32 v5, v5, v7
  v_cvt_pk_bf16_f32 v93, v4, v5
  buffer_store_dwordx2 v[92:93], v3, s[16:19], s26 offen
  v_cvt_pk_bf16_f32 v20, v20, v21
  v_cvt_pk_bf16_f32 v21, v22, v23
  v_lshlrev_b32 v4, 16, v20
  v_and_b32 v5, 0xffff0000, v20
  v_lshlrev_b32 v6, 16, v94
  v_and_b32 v7, 0xffff0000, v94
  v_add_f32 v4, v4, v6
  v_add_f32 v5, v5, v7
  v_cvt_pk_bf16_f32 v94, v4, v5
  v_lshlrev_b32 v4, 16, v21
  v_and_b32 v5, 0xffff0000, v21
  v_lshlrev_b32 v6, 16, v95
  v_and_b32 v7, 0xffff0000, v95
  v_add_f32 v4, v4, v6
  v_add_f32 v5, v5, v7
  v_cvt_pk_bf16_f32 v95, v4, v5
  buffer_store_dwordx2 v[94:95], v3, s[16:19], s27 offen
  v_cvt_pk_bf16_f32 v24, v24, v25
  v_cvt_pk_bf16_f32 v25, v26, v27
  v_lshlrev_b32 v4, 16, v24
  v_and_b32 v5, 0xffff0000, v24
  v_lshlrev_b32 v6, 16, v96
  v_and_b32 v7, 0xffff0000, v96
  v_add_f32 v4, v4, v6
  v_add_f32 v5, v5, v7
  v_cvt_pk_bf16_f32 v96, v4, v5
  v_lshlrev_b32 v4, 16, v25
  v_and_b32 v5, 0xffff0000, v25
  v_lshlrev_b32 v6, 16, v97
  v_and_b32 v7, 0xffff0000, v97
  v_add_f32 v4, v4, v6
  v_add_f32 v5, v5, v7
  v_cvt_pk_bf16_f32 v97, v4, v5
  buffer_store_dwordx2 v[96:97], v3, s[16:19], s28 offen
ffn2_kernel_done:
  s_endpgm
.section .rodata,"a"
.p2align 6
.amdhsa_kernel ffn2_kernel
  .amdhsa_next_free_vgpr 256
  .amdhsa_next_free_sgpr 40
  .amdhsa_accum_offset 256
  .amdhsa_group_segment_fixed_size 0
  .amdhsa_kernarg_size 112
  .amdhsa_user_sgpr_count 2
  .amdhsa_user_sgpr_kernarg_segment_ptr 1
  .amdhsa_system_sgpr_workgroup_id_x 1
.end_amdhsa_kernel
```
